```python
import torch

def _softmax(x, axis=-1):
    return torch.softmax(x, dim=axis)

def _gelu(x):
    return torch.nn.functional.gelu(x, approximate='tanh')

def _silu(x):
    return torch.nn.functional.silu(x)

def _sigmoid(x):
    return torch.sigmoid(x)

def _layernorm(x, axis=-1, eps=1e-05):
    m = x.mean(dim=axis, keepdim=True)
    v = x.var(dim=axis, keepdim=True, unbiased=False)
    return (x - m) / torch.sqrt(v + eps)

def _scatter_add(tgt, idx, src, axis=0):
    return tgt.clone().index_add_(axis, idx, src)

def _segment_sum(src, seg, n):
    out = torch.zeros((n,) + src.shape[1:], dtype=src.dtype)
    return out.index_add_(0, seg, src)

def _pad(x, pw):
    flat = tuple((v for pair in reversed(pw) for v in pair))
    return torch.nn.functional.pad(x, flat)
kernel_name = 'concat_heads__linear_attn_block__memory_aug_recurrent_mem_tr__prompt'

def setup_inputs():

    _w = lambda a: (lambda t: t.to(torch.bfloat16) if t.is_floating_point() else t)(torch.as_tensor(a))

    def _A_setup():
        B, S, D = (1, 2048, 1024)
        return {'x': _w((lambda *s: torch.randn(*s, dtype=torch.bfloat16) * 0.05)(B, S, D)), 'wqkv': _w((lambda *s: torch.randn(*s, dtype=torch.bfloat16) * 1.6)(D, 3 * D)), 'wo': _w((lambda *s: torch.randn(*s, dtype=torch.bfloat16) * 0.05)(D, D))}
    _A_in = _A_setup()

    def _B_setup():
        B, S, Dm = (1, 2048, 1024)
        H, Dh = (32, 128)
        M, seg = (8, 32)
        seg = min(seg, S)
        S = S // seg * seg
        return {'x': _w((lambda *s: torch.randn(*s, dtype=torch.bfloat16) * 0.05)(B, S, Dm)), 'mem0': _w((lambda *s: torch.randn(*s, dtype=torch.bfloat16) * 0.8)(B, M, Dm)), 'Wq': _w((lambda *s: torch.randn(*s, dtype=torch.bfloat16) * 1.6)(Dm, H, Dh) * Dm ** (-0.5)), 'Wk': _w((lambda *s: torch.randn(*s, dtype=torch.bfloat16) * 1.6)(Dm, H, Dh) * Dm ** (-0.5)), 'Wv': _w((lambda *s: torch.randn(*s, dtype=torch.bfloat16) * 0.8)(Dm, H, Dh) * Dm ** (-0.5)), 'Wo': _w((lambda *s: torch.randn(*s, dtype=torch.bfloat16) * 0.8)(H, Dh, Dm) * (H * Dh) ** (-0.5)), 'seg_len': seg}
    _B_in = _B_setup()
    return {'A_x': _A_in['x'], 'A_wqkv': _A_in['wqkv'], 'A_wo': _A_in['wo'], 'B_x': _B_in['x'], 'B_mem0': _B_in['mem0'], 'B_Wq': _B_in['Wq'], 'B_Wk': _B_in['Wk'], 'B_Wv': _B_in['Wv'], 'B_Wo': _B_in['Wo'], 'B_seg_len': _B_in['seg_len']}

def reference(A_x, A_wqkv, A_wo, B_x, B_mem0, B_Wq, B_Wk, B_Wv, B_Wo, B_seg_len):

    def _A_ref(x, wqkv, wo):
        B, S, D = x.shape
        H = 32
        Dh = D // H
        qkv = (lambda x, *d: x.permute(*d))((x @ wqkv).reshape(B, S, 3, H, Dh), 2, 0, 3, 1, 4)
        q, k, v = (qkv[0], qkv[1], qkv[2])
        phi = lambda t: torch.where(t > 0, t + 1, torch.exp(t)) + 1e-06
        pq, pk = (phi(q), phi(k))
        kv = torch.einsum('bhsd,bhse->bhde', pk, v)
        z = torch.einsum('bhsd->bhd', pk)
        num = torch.einsum('bhqd,bhde->bhqe', pq, kv)
        den = torch.einsum('bhqd,bhd->bhq', pq, z)[..., None] + 1e-06
        o = num / den
        return (lambda x, *d: x.permute(*d))(o, 0, 2, 1, 3).reshape(B, S, D) @ wo

    def _B_ref(x, mem0, Wq, Wk, Wv, Wo, seg_len):
        B, S, Dm = x.shape
        H, Dh = (Wq.shape[1], Wq.shape[2])
        M = mem0.shape[1]
        scale = Dh ** (-0.5)
        n_seg = S // seg_len
        L = M + seg_len
        idx = torch.arange(L)
        mask = (idx[:, None] < M) | (idx[:, None] >= idx[None, :])
        mem = mem0
        outs = []
        for s in range(n_seg):
            xs = x[:, s * seg_len:(s + 1) * seg_len, :].clone()
            h = torch.concatenate([mem, xs], axis=1)
            q = torch.einsum('btd,dhe->bhte', h, Wq)
            k = torch.einsum('btd,dhe->bhte', h, Wk)
            v = torch.einsum('btd,dhe->bhte', h, Wv)
            scores = torch.einsum('bhqe,bhke->bhqk', q, k) * scale
            scores = torch.where(mask[None, None], scores, -1000000000.0)
            p = _softmax(scores, axis=-1)
            o = torch.einsum('bhqk,bhke->bhqe', p, v)
            o = torch.einsum('bhte,hed->btd', o, Wo)
            mem = o[:, :M, :].clone()
            outs.append(o[:, M:, :])
        return torch.concatenate(outs, axis=1)
    a = _A_ref(A_x, A_wqkv, A_wo)
    b = _B_ref(B_x, B_mem0, B_Wq, B_Wk, B_Wv, B_Wo, B_seg_len)
    return torch.concatenate([a, b], axis=-1)
```

```asm
; @launch kernel=concat_heads__linear_attn_block__memory_aug_recurrent_mem_tr__prompt_kernel grid=(256,1,1) block=(512,1,1) lds=163840
.amdgcn_target "amdgcn-amd-amdhsa--gfx950"
.text
.globl concat_heads__linear_attn_block__memory_aug_recurrent_mem_tr__prompt_kernel
.p2align 8
.type concat_heads__linear_attn_block__memory_aug_recurrent_mem_tr__prompt_kernel,@function
concat_heads__linear_attn_block__memory_aug_recurrent_mem_tr__prompt_kernel:
    s_cmp_ge_u32 s2, 256
    s_cbranch_scc1 w_exit
    s_load_dwordx16 s[4:19], s[0:1], 0
    s_load_dwordx2 s[20:21], s[0:1], 64
    s_load_dwordx4 s[24:27], s[0:1], 80
    s_load_dwordx2 s[28:29], s[0:1], 96
    s_getreg_b32 s44, hwreg(HW_REG_XCC_ID)
    s_and_b32 s44, s44, 7
    v_lshrrev_b32 v1, 6, v0
    v_mov_b32 v34, 0
    s_mov_b32 s46, 0
    v_readfirstlane_b32 s75, v1
    s_cmp_eq_u32 s75, 2
    s_cbranch_scc0 no_warm
    s_getpc_b64 s[30:31]
warm_pc:
    s_lshr_b32 s32, s2, 3
    s_lshl_b32 s32, s32, 12
    v_and_b32 v35, 63, v0
    v_lshl_add_u32 v35, v35, 6, s32
    v_min_u32 v35, code_end-warm_pc-4, v35
    v_and_b32 v35, -4, v35
    global_load_dword a95, v35, s[30:31]
no_warm:
    s_waitcnt lgkmcnt(0)
    s_add_u32 s28, s28, 0x1fffff
    s_addc_u32 s29, s29, 0
    s_and_b32 s28, s28, 0xffe00000
    s_cmp_lg_u32 s75, 0
    s_cbranch_scc1 no_tick
    s_and_b32 s32, s44, 3
    s_lshl_b32 s32, s32, 2
    s_and_b32 s33, s44, 4
    s_lshl_b32 s33, s33, 5
    s_add_u32 s32, s32, s33
    v_mov_b32 v35, s32
    v_mov_b32 v36, 1
    s_mov_b64 exec, 1
    global_atomic_add v37, v35, v36, s[26:27] sc0 sc1
    s_mov_b64 exec, -1
no_tick:
    v_and_b32 v0, 63, v0
    s_and_b32 s32, s75, s44
    s_bitcmp1_b32 s32, 2
    s_cbranch_scc0 no_epf
    s_lshr_b32 s33, s2, 3
    s_cmp_eq_u32 s75, 4
    s_cbranch_scc0 epf_w
    v_lshrrev_b32 v36, 3, v0
    v_lshlrev_b32 v36, 11, v36
    v_and_b32 v37, 7, v0
    v_lshl_add_u32 v36, v37, 7, v36
    s_lshl_b32 s33, s33, 14
    v_add_u32 v36, s33, v36
    global_load_dword a95, v36, s[10:11]
    s_branch no_epf
epf_w:
    s_sub_u32 s34, s75, 5
    s_lshl_b32 s34, s34, 2
    s_lshr_b32 s35, s33, 3
    s_add_u32 s35, s35, s34
    s_lshl_b32 s35, s35, 17
    s_and_b32 s36, s44, 1
    s_lshl_b32 s36, s36, 3
    s_and_b32 s37, s33, 7
    s_add_u32 s36, s36, s37
    s_lshl_b32 s36, s36, 9
    s_add_u32 s35, s35, s36
    v_lshrrev_b32 v36, 2, v0
    v_lshlrev_b32 v36, 13, v36
    v_and_b32 v37, 3, v0
    v_lshl_add_u32 v36, v37, 7, v36
    v_add_u32 v36, s35, v36
    s_bitcmp1_b32 s44, 1
    s_cselect_b64 s[30:31], s[18:19], s[16:17]
    global_load_dword a95, v36, s[30:31]
no_epf:
    s_lshl_b32 s67, s75, 11
    s_and_b32 s72, s75, 3
    s_lshr_b32 s73, s75, 2
    v_lshrrev_b32 v16, 4, v0
    v_bfe_u32 v17, v0, 2, 2
    v_lshl_add_u32 v18, v16, 3, v17
    v_lshlrev_b32 v18, 9, v18
    v_and_b32 v19, 3, v0
    v_lshl_add_u32 v18, v19, 3, v18
    s_lshl_b32 s74, s73, 8
    s_add_u32 s74, s74, 65536
    v_add_u32 v18, s74, v18
    v_and_b32 v16, 1, v16
    v_lshl_add_u32 v17, v16, 2, v17
    v_lshlrev_b32 v17, 5, v17
    v_add_u32 v8, v18, v17
    v_xor_b32 v9, 32, v8
    v_xor_b32 v10, 64, v8
    v_xor_b32 v11, 96, v8
    v_xor_b32 v12, 128, v8
    v_xor_b32 v13, 160, v8
    v_xor_b32 v14, 192, v8
    v_xor_b32 v15, 224, v8
    s_mul_i32 s76, s75, 2048
    s_mov_b32 s74, 2048
    v_lshrrev_b32 v16, 3, v0
    s_mul_i32 s64, s75, 16
    s_add_u32 s64, s64, 0
    v_add_u32 v16, s64, v16
    v_lshrrev_b32 v17, 1, v16
    v_xor_b32 v17, v17, v0
    v_and_b32 v17, 7, v17
    v_mul_lo_u32 v16, v16, s74
    v_lshl_add_u32 v28, v17, 4, v16
    v_lshrrev_b32 v16, 3, v0
    s_mul_i32 s64, s75, 16
    s_add_u32 s64, s64, 8
    v_add_u32 v16, s64, v16
    v_lshrrev_b32 v17, 1, v16
    v_xor_b32 v17, v17, v0
    v_and_b32 v17, 7, v17
    v_mul_lo_u32 v16, v16, s74
    v_lshl_add_u32 v29, v17, 4, v16
    v_and_b32 v16, 15, v0
    v_lshrrev_b32 v17, 1, v16
    v_lshrrev_b32 v18, 4, v0
    v_xor_b32 v17, v17, v18
    v_lshlrev_b32 v16, 7, v16
    v_lshl_add_u32 v6, v17, 4, v16
    s_mul_i32 s74, s72, 4096
    v_add_u32 v6, s74, v6
    v_xor_b32 v7, 64, v6
    s_mov_b32 s64, 128
    s_mov_b32 s86, 0
    v_lshrrev_b32 v16, 5, v0
    s_lshl_b32 s74, s75, 2
    s_add_u32 s74, s74, 0
    v_add_u32 v16, s74, v16
    v_and_b32 v17, 3, v16
    v_bfe_u32 v18, v16, 3, 1
    v_lshl_add_u32 v17, v18, 2, v17
    v_lshlrev_b32 v17, 1, v17
    v_and_b32 v18, 31, v0
    v_xor_b32 v17, v17, v18
    v_lshlrev_b32 v17, 4, v17
    s_mov_b32 s74, 8192
    v_mul_lo_u32 v16, v16, s74
    v_add_u32 v4, v16, v17
    v_lshrrev_b32 v16, 5, v0
    s_lshl_b32 s74, s75, 2
    s_add_u32 s74, s74, 2
    v_add_u32 v16, s74, v16
    v_and_b32 v17, 3, v16
    v_bfe_u32 v18, v16, 3, 1
    v_lshl_add_u32 v17, v18, 2, v17
    v_lshlrev_b32 v17, 1, v17
    v_and_b32 v18, 31, v0
    v_xor_b32 v17, v17, v18
    v_lshlrev_b32 v17, 4, v17
    s_mov_b32 s74, 8192
    v_mul_lo_u32 v16, v16, s74
    v_add_u32 v5, v16, v17
    s_mov_b32 s65, 262144
    s_mov_b32 s87, 0
    s_cmp_eq_u32 s75, 1
    s_cbranch_scc0 no_probe
    s_mov_b32 s47, 0
    s_cmp_lt_u32 s44, 4
    s_cbranch_scc0 probe_done
    s_add_u32 s30, s28, 2031616
    s_addc_u32 s31, s29, 0
    s_lshr_b32 s32, s2, 5
    s_and_b32 s33, s32, 1
    s_lshr_b32 s32, s32, 1
    s_lshl_b32 s32, s32, 2
    s_add_u32 s32, s32, s33
    s_lshl_b32 s32, s32, 12
    s_and_b32 s33, s2, 31
    s_lshl_b32 s33, s33, 7
    s_add_u32 s32, s32, s33
    v_mov_b32 v35, s32
    s_mov_b64 exec, 1
    s_mov_b32 s38, -1
    s_mov_b32 s39, -1
    s_mov_b32 s40, 6
probe_loop:
    s_memtime s[34:35]
    s_waitcnt lgkmcnt(0)
    global_store_dword v35, v34, s[30:31] sc1
    s_waitcnt vmcnt(0)
    s_memtime s[36:37]
    s_waitcnt lgkmcnt(0)
    s_sub_u32 s36, s36, s34
    s_min_u32 s36, s36, s38
    s_mov_b32 s38, s39
    s_mov_b32 s39, s36
    v_xor_b32 v35, 0x2000, v35
    s_sub_u32 s40, s40, 1
    s_cmp_lg_u32 s40, 0
    s_cbranch_scc1 probe_loop
    s_mov_b64 exec, -1
    s_cmp_lt_u32 s39, s38
    s_cselect_b32 s47, 1, 0
probe_done:
    v_mov_b32 v35, s47
    ds_write_b32 v34, v35 offset:4
no_probe:
    s_cmp_lg_u32 s75, 0
    s_cbranch_scc1 role_wait
    s_mov_b64 exec, 1
    s_waitcnt vmcnt(0)
    v_readfirstlane_b32 s45, v37
    s_cmp_lt_u32 s45, 32
    s_cbranch_scc1 role_have
    v_mov_b32 v35, 32
    global_atomic_add v37, v35, v36, s[26:27] sc0 sc1
    s_waitcnt vmcnt(0)
    v_readfirstlane_b32 s45, v37
role_poll:
    global_load_dwordx4 v[40:43], v34, s[26:27] sc1
    global_load_dwordx4 v[44:47], v34, s[26:27] offset:128 sc1
    s_waitcnt vmcnt(0)
    s_mov_b32 s33, 0
    v_readfirstlane_b32 s34, v40
    s_add_u32 s33, s33, s34
    v_readfirstlane_b32 s35, v41
    s_add_u32 s33, s33, s35
    v_readfirstlane_b32 s36, v42
    s_add_u32 s33, s33, s36
    v_readfirstlane_b32 s37, v43
    s_add_u32 s33, s33, s37
    v_readfirstlane_b32 s38, v44
    s_add_u32 s33, s33, s38
    v_readfirstlane_b32 s39, v45
    s_add_u32 s33, s33, s39
    v_readfirstlane_b32 s40, v46
    s_add_u32 s33, s33, s40
    v_readfirstlane_b32 s41, v47
    s_add_u32 s33, s33, s41
    s_cmp_eq_u32 s33, 256
    s_cbranch_scc1 role_pick
    s_sleep 8
    s_add_u32 s46, s46, 1
    s_cmp_lt_u32 s46, 400000
    s_cbranch_scc1 role_poll
    s_mov_b64 exec, -1
    s_branch w_fail
role_pick:
    s_min_u32 s33, s34, 32
    s_add_u32 s45, s45, s33
    s_mov_b32 s44, 0
    s_cmp_lt_u32 s45, 32
    s_cbranch_scc1 role_have
    s_sub_u32 s45, s45, 32
    s_min_u32 s33, s35, 32
    s_add_u32 s45, s45, s33
    s_mov_b32 s44, 1
    s_cmp_lt_u32 s45, 32
    s_cbranch_scc1 role_have
    s_sub_u32 s45, s45, 32
    s_min_u32 s33, s36, 32
    s_add_u32 s45, s45, s33
    s_mov_b32 s44, 2
    s_cmp_lt_u32 s45, 32
    s_cbranch_scc1 role_have
    s_sub_u32 s45, s45, 32
    s_min_u32 s33, s37, 32
    s_add_u32 s45, s45, s33
    s_mov_b32 s44, 3
    s_cmp_lt_u32 s45, 32
    s_cbranch_scc1 role_have
    s_sub_u32 s45, s45, 32
    s_min_u32 s33, s38, 32
    s_add_u32 s45, s45, s33
    s_mov_b32 s44, 4
    s_cmp_lt_u32 s45, 32
    s_cbranch_scc1 role_have
    s_sub_u32 s45, s45, 32
    s_min_u32 s33, s39, 32
    s_add_u32 s45, s45, s33
    s_mov_b32 s44, 5
    s_cmp_lt_u32 s45, 32
    s_cbranch_scc1 role_have
    s_sub_u32 s45, s45, 32
    s_min_u32 s33, s40, 32
    s_add_u32 s45, s45, s33
    s_mov_b32 s44, 6
    s_cmp_lt_u32 s45, 32
    s_cbranch_scc1 role_have
    s_sub_u32 s45, s45, 32
    s_min_u32 s33, s41, 32
    s_add_u32 s45, s45, s33
    s_mov_b32 s44, 7
role_have:
    s_lshl_b32 s32, s44, 5
    s_or_b32 s32, s32, s45
    v_mov_b32 v35, s32
    ds_write_b32 v34, v35
    s_mov_b64 exec, -1
role_wait:
    s_waitcnt lgkmcnt(0)
    s_barrier
    ds_read_b64 v[36:37], v34
    s_waitcnt lgkmcnt(0)
    v_readfirstlane_b32 s32, v36
    v_readfirstlane_b32 s47, v37
    s_cmp_lg_u32 s75, 0
    s_cbranch_scc1 voted
    s_cmp_ge_u32 s32, 128
    s_cbranch_scc1 voted
    s_and_b32 s47, s47, 1
    s_lshl_b32 s47, s47, 16
    s_or_b32 s47, s47, 1
    v_mov_b32 v35, s47
    s_mov_b64 exec, 1
    global_atomic_add v34, v35, s[26:27] offset:40 sc1
    s_mov_b64 exec, -1
voted:
    s_barrier
    s_and_b32 s45, s32, 31
    s_bfe_u32 s44, s32, 0x30005
    s_cmp_ge_u32 s44, 4
    s_cbranch_scc1 worker
    s_lshl_b32 s18, s44, 3
    s_lshr_b32 s19, s45, 2
    s_add_u32 s18, s18, s19
    s_and_b32 s19, s45, 3
    s_lshl_b32 s32, s75, 6
    v_add_u32 v0, s32, v0
    s_load_dwordx8 s[4:11], s[0:1], 40
    s_load_dwordx2 s[12:13], s[0:1], 32
    s_load_dwordx2 s[14:15], s[0:1], 88
    s_load_dwordx2 s[16:17], s[0:1], 96
    v_lshrrev_b32 v1, 6, v0
    v_and_b32 v0, 63, v0
    s_lshl_b32 s20, s18, 2
    s_add_u32 s20, s20, s19
    v_readfirstlane_b32 s21, v1
    v_lshlrev_b32 v6, 4, v0
    s_mov_b32 s24, 0
    s_waitcnt lgkmcnt(0)
    s_add_u32 s16, s16, 0x1fffff
    s_addc_u32 s17, s17, 0
    s_and_b32 s16, s16, 0xffe00000
    s_lshl_b32 s36, s18, 13
    s_add_u32 s36, s36, 1048576
    s_add_u32 s32, s16, s36
    s_addc_u32 s33, s17, 0
    s_add_u32 s82, s32, 524288
    s_addc_u32 s83, s33, 0
    s_and_b32 s45, s20, 63
    s_lshl_b32 s45, s45, 7
    s_lshr_b32 s36, s20, 6
    s_lshl_b32 s36, s36, 14
    s_add_u32 s45, s45, s36
    s_and_b32 s44, s20, 1
    s_lshl_b32 s44, s44, 12
    s_lshr_b32 s42, s20, 1
    s_lshl_b32 s42, s42, 14
    s_add_u32 s44, s44, s42
    v_mov_b32 v14, v6
    v_add_u32 v15, 0x1000, v6
    s_lshl_b32 s36, s19, 10
    v_add_u32 v9, s36, v6
    s_lshl_b32 s36, s19, 9
    s_add_u32 s36, s36, 4096
    v_and_b32 v8, 0x1ff, v6
    v_add_u32 v8, s36, v8
    s_cmp_eq_u32 s21, 7
    s_cbranch_scc0 rec_noclr
    v_mov_b32 v68, -1
    v_mov_b32 v69, -1
    v_mov_b32 v70, -1
    v_mov_b32 v71, -1
    v_add_u32 v16, s44, v6
    v_add_u32 v17, 0x2000, v16
    global_store_dwordx4 v16, v[68:71], s[16:17] offset:0 sc1
    global_store_dwordx4 v16, v[68:71], s[16:17] offset:1024 sc1
    global_store_dwordx4 v16, v[68:71], s[16:17] offset:2048 sc1
    global_store_dwordx4 v16, v[68:71], s[16:17] offset:3072 sc1
    global_store_dwordx4 v17, v[68:71], s[16:17] offset:0 sc1
    global_store_dwordx4 v17, v[68:71], s[16:17] offset:1024 sc1
    global_store_dwordx4 v17, v[68:71], s[16:17] offset:2048 sc1
    global_store_dwordx4 v17, v[68:71], s[16:17] offset:3072 sc1
    global_store_dwordx4 v9, v[68:71], s[32:33] sc1
    global_store_dwordx4 v8, v[68:71], s[32:33] sc1
    v_bfe_u32 v16, v0, 3, 2
    v_lshlrev_b32 v16, 15, v16
    v_lshrrev_b32 v17, 5, v0
    v_lshl_add_u32 v16, v17, 13, v16
    v_and_b32 v17, 7, v0
    v_lshl_add_u32 v16, v17, 4, v16
    s_add_u32 s36, s45, 2097152
    v_add_u32 v16, s36, v16
    global_store_dwordx4 v16, v[68:71], s[16:17] sc1
    v_add_u32 v16, 0x20000, v16
    global_store_dwordx4 v16, v[68:71], s[16:17] sc1
    v_add_u32 v16, 0x20000, v16
    global_store_dwordx4 v16, v[68:71], s[16:17] sc1
    v_add_u32 v16, 0x20000, v16
    global_store_dwordx4 v16, v[68:71], s[16:17] sc1
    v_add_u32 v16, 0x20000, v16
    global_store_dwordx4 v16, v[68:71], s[16:17] sc1
    v_add_u32 v16, 0x20000, v16
    global_store_dwordx4 v16, v[68:71], s[16:17] sc1
    v_add_u32 v16, 0x20000, v16
    global_store_dwordx4 v16, v[68:71], s[16:17] sc1
    v_add_u32 v16, 0x20000, v16
    global_store_dwordx4 v16, v[68:71], s[16:17] sc1
    v_add_u32 v16, 0x20000, v16
    global_store_dwordx4 v16, v[68:71], s[16:17] sc1
    v_add_u32 v16, 0x20000, v16
    global_store_dwordx4 v16, v[68:71], s[16:17] sc1
    v_add_u32 v16, 0x20000, v16
    global_store_dwordx4 v16, v[68:71], s[16:17] sc1
    v_add_u32 v16, 0x20000, v16
    global_store_dwordx4 v16, v[68:71], s[16:17] sc1
    v_add_u32 v16, 0x20000, v16
    global_store_dwordx4 v16, v[68:71], s[16:17] sc1
    v_add_u32 v16, 0x20000, v16
    global_store_dwordx4 v16, v[68:71], s[16:17] sc1
    v_add_u32 v16, 0x20000, v16
    global_store_dwordx4 v16, v[68:71], s[16:17] sc1
    v_add_u32 v16, 0x20000, v16
    global_store_dwordx4 v16, v[68:71], s[16:17] sc1
    v_add_u32 v16, 0x20000, v16
    s_lshl_b32 s36, s20, 7
    s_add_u32 s36, s36, 1966080
    v_and_b32 v16, 0x70, v6
    v_add_u32 v16, s36, v16
    global_store_dwordx4 v16, v[68:71], s[16:17] sc1
    s_lshl_b32 s36, s20, 10
    s_add_u32 s36, s36, 1310720
    v_add_u32 v16, s36, v6
    global_store_dwordx4 v16, v[68:71], s[16:17] sc1
    s_lshl_b32 s36, s20, 8
    s_add_u32 s36, s36, 1441792
    v_and_b32 v16, 0xf0, v6
    v_add_u32 v16, s36, v16
    global_store_dwordx4 v16, v[68:71], s[16:17] sc1
    s_lshr_b32 s36, s20, 3
    s_lshl_b32 s36, s36, 14
    s_and_b32 s42, s20, 7
    s_lshl_b32 s42, s42, 10
    s_add_u32 s36, s36, s42
    s_add_u32 s36, s36, 20709376
    v_add_u32 v16, s36, v6
    v_add_u32 v17, 0x2000, v16
    global_store_dwordx4 v16, v[68:71], s[16:17] sc1
    global_store_dwordx4 v17, v[68:71], s[16:17] sc1
    v_subrev_u32 v16, 0x40000, v16
    v_subrev_u32 v17, 0x40000, v17
    global_store_dwordx4 v16, v[68:71], s[16:17] sc1
    global_store_dwordx4 v17, v[68:71], s[16:17] sc1
    s_barrier
    v_mov_b32 v17, 1
    v_mov_b32 v16, 0
    s_waitcnt vmcnt(0)
    s_mov_b64 exec, 1
    global_atomic_add v16, v17, s[14:15] offset:44 sc1
    s_mov_b64 exec, -1
    s_branch rec_clrd
rec_noclr:
    s_barrier
rec_clrd:
    s_and_b32 s39, s19, 1
    s_xor_b32 s39, s39, 1
    s_lshl_b32 s39, s39, 1
    s_lshr_b32 s36, s19, 1
    s_add_u32 s39, s39, s36
    s_lshl_b32 s43, s21, 14
    s_lshl_b32 s36, s21, 20
    s_lshl_b32 s42, s18, 8
    s_add_u32 s36, s36, s42
    v_lshrrev_b32 v10, 2, v0
    v_lshlrev_b32 v10, 13, v10
    v_and_b32 v11, 3, v0
    v_lshl_add_u32 v10, v11, 4, v10
    s_lshl_b32 s42, s39, 6
    s_add_u32 s42, s42, s36
    v_add_u32 v10, s42, v10
    v_lshrrev_b32 v11, 3, v0
    v_lshlrev_b32 v11, 13, v11
    v_and_b32 v12, 7, v0
    v_lshl_add_u32 v11, v12, 4, v11
    s_and_b32 s42, s19, 1
    s_lshl_b32 s42, s42, 7
    s_add_u32 s42, s42, s36
    v_add_u32 v11, s42, v11
    s_cmp_lt_u32 s19, 2
    s_cbranch_scc1 rec_isq
    s_add_u32 m0, s43, 0
    s_nop 0
    global_load_lds_dwordx4 v11, s[6:7]
    v_add_u32 v11, 0x10000, v11
    s_add_u32 m0, s43, 1024
    s_nop 0
    global_load_lds_dwordx4 v11, s[6:7]
    v_add_u32 v11, 0x10000, v11
    s_add_u32 m0, s43, 2048
    s_nop 0
    global_load_lds_dwordx4 v11, s[6:7]
    v_add_u32 v11, 0x10000, v11
    s_add_u32 m0, s43, 3072
    s_nop 0
    global_load_lds_dwordx4 v11, s[6:7]
    v_add_u32 v11, 0x10000, v11
    s_add_u32 m0, s43, 4096
    s_nop 0
    global_load_lds_dwordx4 v11, s[6:7]
    v_add_u32 v11, 0x10000, v11
    s_add_u32 m0, s43, 5120
    s_nop 0
    global_load_lds_dwordx4 v11, s[6:7]
    v_add_u32 v11, 0x10000, v11
    s_add_u32 m0, s43, 6144
    s_nop 0
    global_load_lds_dwordx4 v11, s[6:7]
    v_add_u32 v11, 0x10000, v11
    s_add_u32 m0, s43, 7168
    s_nop 0
    global_load_lds_dwordx4 v11, s[6:7]
    v_add_u32 v11, 0x10000, v11
    s_add_u32 m0, s43, 8192
    s_nop 0
    global_load_lds_dwordx4 v11, s[6:7]
    v_add_u32 v11, 0x10000, v11
    s_add_u32 m0, s43, 9216
    s_nop 0
    global_load_lds_dwordx4 v11, s[6:7]
    v_add_u32 v11, 0x10000, v11
    s_add_u32 m0, s43, 10240
    s_nop 0
    global_load_lds_dwordx4 v11, s[6:7]
    v_add_u32 v11, 0x10000, v11
    s_add_u32 m0, s43, 11264
    s_nop 0
    global_load_lds_dwordx4 v11, s[6:7]
    v_add_u32 v11, 0x10000, v11
    s_add_u32 m0, s43, 12288
    s_nop 0
    global_load_lds_dwordx4 v11, s[6:7]
    v_add_u32 v11, 0x10000, v11
    s_add_u32 m0, s43, 13312
    s_nop 0
    global_load_lds_dwordx4 v11, s[6:7]
    v_add_u32 v11, 0x10000, v11
    s_add_u32 m0, s43, 14336
    s_nop 0
    global_load_lds_dwordx4 v11, s[6:7]
    v_add_u32 v11, 0x10000, v11
    s_add_u32 m0, s43, 15360
    s_nop 0
    global_load_lds_dwordx4 v11, s[6:7]
    s_branch rec_qkd
rec_isq:
    s_add_u32 m0, s43, 0
    s_nop 0
    global_load_lds_dwordx4 v11, s[4:5] nt
    v_add_u32 v11, 0x10000, v11
    s_add_u32 m0, s43, 1024
    s_nop 0
    global_load_lds_dwordx4 v11, s[4:5] nt
    v_add_u32 v11, 0x10000, v11
    s_add_u32 m0, s43, 2048
    s_nop 0
    global_load_lds_dwordx4 v11, s[4:5] nt
    v_add_u32 v11, 0x10000, v11
    s_add_u32 m0, s43, 3072
    s_nop 0
    global_load_lds_dwordx4 v11, s[4:5] nt
    v_add_u32 v11, 0x10000, v11
    s_add_u32 m0, s43, 4096
    s_nop 0
    global_load_lds_dwordx4 v11, s[4:5] nt
    v_add_u32 v11, 0x10000, v11
    s_add_u32 m0, s43, 5120
    s_nop 0
    global_load_lds_dwordx4 v11, s[4:5] nt
    v_add_u32 v11, 0x10000, v11
    s_add_u32 m0, s43, 6144
    s_nop 0
    global_load_lds_dwordx4 v11, s[4:5] nt
    v_add_u32 v11, 0x10000, v11
    s_add_u32 m0, s43, 7168
    s_nop 0
    global_load_lds_dwordx4 v11, s[4:5] nt
    v_add_u32 v11, 0x10000, v11
    s_add_u32 m0, s43, 8192
    s_nop 0
    global_load_lds_dwordx4 v11, s[4:5] nt
    v_add_u32 v11, 0x10000, v11
    s_add_u32 m0, s43, 9216
    s_nop 0
    global_load_lds_dwordx4 v11, s[4:5] nt
    v_add_u32 v11, 0x10000, v11
    s_add_u32 m0, s43, 10240
    s_nop 0
    global_load_lds_dwordx4 v11, s[4:5] nt
    v_add_u32 v11, 0x10000, v11
    s_add_u32 m0, s43, 11264
    s_nop 0
    global_load_lds_dwordx4 v11, s[4:5] nt
    v_add_u32 v11, 0x10000, v11
    s_add_u32 m0, s43, 12288
    s_nop 0
    global_load_lds_dwordx4 v11, s[4:5] nt
    v_add_u32 v11, 0x10000, v11
    s_add_u32 m0, s43, 13312
    s_nop 0
    global_load_lds_dwordx4 v11, s[4:5] nt
    v_add_u32 v11, 0x10000, v11
    s_add_u32 m0, s43, 14336
    s_nop 0
    global_load_lds_dwordx4 v11, s[4:5] nt
    v_add_u32 v11, 0x10000, v11
    s_add_u32 m0, s43, 15360
    s_nop 0
    global_load_lds_dwordx4 v11, s[4:5] nt
rec_qkd:
    v_lshrrev_b32 v12, 5, v0
    v_lshlrev_b32 v12, 4, v12
    v_bfe_u32 v13, v0, 4, 1
    v_lshl_add_u32 v12, v13, 2, v12
    v_bfe_u32 v13, v0, 2, 1
    v_add_u32 v12, v12, v13
    v_bfe_u32 v13, v0, 3, 1
    v_lshl_add_u32 v12, v13, 3, v12
    v_and_b32 v13, 3, v0
    v_lshlrev_b32 v13, 3, v13
    v_add_u32 v13, s43, v13
    v_lshl_add_u32 v7, v12, 7, v13
    v_lshl_add_u32 v12, v12, 6, v13
    s_waitcnt vmcnt(8)
    ds_read_b64_tr_b16 a[0:1], v7 offset:0
    ds_read_b64_tr_b16 a[2:3], v7 offset:256
    ds_read_b64_tr_b16 a[4:5], v7 offset:4096
    ds_read_b64_tr_b16 a[6:7], v7 offset:4352
    s_waitcnt lgkmcnt(4)
    ds_read_b64_tr_b16 a[16:17], v7 offset:32
    ds_read_b64_tr_b16 a[18:19], v7 offset:288
    ds_read_b64_tr_b16 a[20:21], v7 offset:4128
    ds_read_b64_tr_b16 a[22:23], v7 offset:4384
    s_waitcnt lgkmcnt(4)
    ds_read_b64_tr_b16 a[32:33], v7 offset:64
    ds_read_b64_tr_b16 a[34:35], v7 offset:320
    ds_read_b64_tr_b16 a[36:37], v7 offset:4160
    ds_read_b64_tr_b16 a[38:39], v7 offset:4416
    s_waitcnt lgkmcnt(4)
    ds_read_b64_tr_b16 a[48:49], v7 offset:96
    ds_read_b64_tr_b16 a[50:51], v7 offset:352
    ds_read_b64_tr_b16 a[52:53], v7 offset:4192
    ds_read_b64_tr_b16 a[54:55], v7 offset:4448
    s_waitcnt lgkmcnt(4)
    s_waitcnt lgkmcnt(0)
    s_add_u32 m0, s43, 0
    s_nop 0
    global_load_lds_dwordx4 v10, s[8:9]
    v_add_u32 v10, 0x20000, v10
    s_add_u32 m0, s43, 1024
    s_nop 0
    global_load_lds_dwordx4 v10, s[8:9]
    v_add_u32 v10, 0x20000, v10
    s_add_u32 m0, s43, 2048
    s_nop 0
    global_load_lds_dwordx4 v10, s[8:9]
    v_add_u32 v10, 0x20000, v10
    s_add_u32 m0, s43, 3072
    s_nop 0
    global_load_lds_dwordx4 v10, s[8:9]
    v_add_u32 v10, 0x20000, v10
    s_add_u32 m0, s43, 4096
    s_nop 0
    global_load_lds_dwordx4 v10, s[8:9]
    v_add_u32 v10, 0x20000, v10
    s_add_u32 m0, s43, 5120
    s_nop 0
    global_load_lds_dwordx4 v10, s[8:9]
    v_add_u32 v10, 0x20000, v10
    s_add_u32 m0, s43, 6144
    s_nop 0
    global_load_lds_dwordx4 v10, s[8:9]
    v_add_u32 v10, 0x20000, v10
    s_add_u32 m0, s43, 7168
    s_nop 0
    global_load_lds_dwordx4 v10, s[8:9]
    s_waitcnt vmcnt(8)
    ds_read_b64_tr_b16 a[8:9], v7 offset:8192
    ds_read_b64_tr_b16 a[10:11], v7 offset:8448
    ds_read_b64_tr_b16 a[12:13], v7 offset:12288
    ds_read_b64_tr_b16 a[14:15], v7 offset:12544
    s_waitcnt lgkmcnt(4)
    ds_read_b64_tr_b16 a[24:25], v7 offset:8224
    ds_read_b64_tr_b16 a[26:27], v7 offset:8480
    ds_read_b64_tr_b16 a[28:29], v7 offset:12320
    ds_read_b64_tr_b16 a[30:31], v7 offset:12576
    s_waitcnt lgkmcnt(4)
    ds_read_b64_tr_b16 a[40:41], v7 offset:8256
    ds_read_b64_tr_b16 a[42:43], v7 offset:8512
    ds_read_b64_tr_b16 a[44:45], v7 offset:12352
    ds_read_b64_tr_b16 a[46:47], v7 offset:12608
    s_waitcnt lgkmcnt(4)
    ds_read_b64_tr_b16 a[56:57], v7 offset:8288
    ds_read_b64_tr_b16 a[58:59], v7 offset:8544
    ds_read_b64_tr_b16 a[60:61], v7 offset:12384
    ds_read_b64_tr_b16 a[62:63], v7 offset:12640
    s_waitcnt lgkmcnt(4)
    s_waitcnt lgkmcnt(0)
    v_and_b32 v11, 7, v0
    v_lshlrev_b32 v11, 11, v11
    v_lshrrev_b32 v13, 3, v0
    v_lshl_add_u32 v11, v13, 4, v11
    s_lshl_b32 s36, s21, 8
    v_add_u32 v11, s36, v11
    global_load_dwordx4 v[16:19], v11, s[12:13]
    global_load_dwordx4 v[20:23], v11, s[12:13] offset:128
    v_lshrrev_b32 v10, 3, v0
    v_lshlrev_b32 v10, 11, v10
    v_and_b32 v11, 7, v0
    v_lshl_add_u32 v10, v11, 4, v10
    s_lshl_b32 s36, s18, 18
    s_lshl_b32 s42, s19, 9
    s_add_u32 s36, s36, s42
    s_and_b32 s42, s21, 3
    s_lshl_b32 s42, s42, 7
    s_add_u32 s36, s36, s42
    v_add_u32 v10, s36, v10
    v_mov_b32 v56, 0
    s_lshr_b32 s36, s18, 3
    s_lshl_b32 s36, s36, 2
    v_mov_b32 v57, s36
    s_cmp_lt_u32 s21, 4
    s_cbranch_scc0 rec_wv_only
    v_add_u32 v11, 131072, v10
    s_add_u32 m0, s43, 8192
    s_nop 0
    global_load_lds_dwordx4 v11, s[10:11]
    v_add_u32 v11, 0x4000, v11
    s_add_u32 m0, s43, 9216
    s_nop 0
    global_load_lds_dwordx4 v11, s[10:11]
    v_add_u32 v11, 0x4000, v11
    s_add_u32 m0, s43, 10240
    s_nop 0
    global_load_lds_dwordx4 v11, s[10:11]
    v_add_u32 v11, 0x4000, v11
    s_add_u32 m0, s43, 11264
    s_nop 0
    global_load_lds_dwordx4 v11, s[10:11]
    v_add_u32 v11, 0x4000, v11
    s_add_u32 m0, s43, 12288
    s_nop 0
    global_load_lds_dwordx4 v11, s[10:11]
    v_add_u32 v11, 0x4000, v11
    s_add_u32 m0, s43, 13312
    s_nop 0
    global_load_lds_dwordx4 v11, s[10:11]
    v_add_u32 v11, 0x4000, v11
    s_add_u32 m0, s43, 14336
    s_nop 0
    global_load_lds_dwordx4 v11, s[10:11]
    v_add_u32 v11, 0x4000, v11
    s_add_u32 m0, s43, 15360
    s_nop 0
    global_load_lds_dwordx4 v11, s[10:11]
    s_waitcnt vmcnt(8)
    ds_read_b64_tr_b16 a[64:65], v12 offset:0
    ds_read_b64_tr_b16 a[66:67], v12 offset:128
    ds_read_b64_tr_b16 a[68:69], v12 offset:2048
    ds_read_b64_tr_b16 a[70:71], v12 offset:2176
    s_waitcnt lgkmcnt(4)
    ds_read_b64_tr_b16 a[72:73], v12 offset:4096
    ds_read_b64_tr_b16 a[74:75], v12 offset:4224
    ds_read_b64_tr_b16 a[76:77], v12 offset:6144
    ds_read_b64_tr_b16 a[78:79], v12 offset:6272
    s_waitcnt lgkmcnt(4)
    ds_read_b64_tr_b16 a[80:81], v12 offset:32
    ds_read_b64_tr_b16 a[82:83], v12 offset:160
    ds_read_b64_tr_b16 a[84:85], v12 offset:2080
    ds_read_b64_tr_b16 a[86:87], v12 offset:2208
    s_waitcnt lgkmcnt(4)
    ds_read_b64_tr_b16 a[88:89], v12 offset:4128
    ds_read_b64_tr_b16 a[90:91], v12 offset:4256
    ds_read_b64_tr_b16 a[92:93], v12 offset:6176
    ds_read_b64_tr_b16 a[94:95], v12 offset:6304
    s_waitcnt lgkmcnt(4)
    s_waitcnt lgkmcnt(0)
    v_add_u32 v11, 0, v10
    s_add_u32 m0, s43, 0
    s_nop 0
    global_load_lds_dwordx4 v11, s[10:11]
    v_add_u32 v11, 0x4000, v11
    s_add_u32 m0, s43, 1024
    s_nop 0
    global_load_lds_dwordx4 v11, s[10:11]
    v_add_u32 v11, 0x4000, v11
    s_add_u32 m0, s43, 2048
    s_nop 0
    global_load_lds_dwordx4 v11, s[10:11]
    v_add_u32 v11, 0x4000, v11
    s_add_u32 m0, s43, 3072
    s_nop 0
    global_load_lds_dwordx4 v11, s[10:11]
    v_add_u32 v11, 0x4000, v11
    s_add_u32 m0, s43, 4096
    s_nop 0
    global_load_lds_dwordx4 v11, s[10:11]
    v_add_u32 v11, 0x4000, v11
    s_add_u32 m0, s43, 5120
    s_nop 0
    global_load_lds_dwordx4 v11, s[10:11]
    v_add_u32 v11, 0x4000, v11
    s_add_u32 m0, s43, 6144
    s_nop 0
    global_load_lds_dwordx4 v11, s[10:11]
    v_add_u32 v11, 0x4000, v11
    s_add_u32 m0, s43, 7168
    s_nop 0
    global_load_lds_dwordx4 v11, s[10:11]
    v_lshrrev_b32 v12, 2, v0
    v_lshlrev_b32 v12, 7, v12
    v_and_b32 v13, 3, v0
    v_lshl_add_u32 v12, v13, 4, v12
    v_add_u32 v12, s43, v12
    s_waitcnt vmcnt(0)
    ds_read_b64_tr_b16 v[96:97], v12 offset:0
    ds_read_b64_tr_b16 v[98:99], v12 offset:2048
    ds_read_b64_tr_b16 v[100:101], v12 offset:4096
    ds_read_b64_tr_b16 v[102:103], v12 offset:6144
    ds_read_b64_tr_b16 v[104:105], v12 offset:8192
    ds_read_b64_tr_b16 v[106:107], v12 offset:10240
    ds_read_b64_tr_b16 v[108:109], v12 offset:12288
    ds_read_b64_tr_b16 v[110:111], v12 offset:14336
    s_waitcnt lgkmcnt(0)
    ds_read_b64_tr_b16 v[112:113], v12 offset:8
    ds_read_b64_tr_b16 v[114:115], v12 offset:2056
    ds_read_b64_tr_b16 v[116:117], v12 offset:4104
    ds_read_b64_tr_b16 v[118:119], v12 offset:6152
    ds_read_b64_tr_b16 v[120:121], v12 offset:8200
    ds_read_b64_tr_b16 v[122:123], v12 offset:10248
    ds_read_b64_tr_b16 v[124:125], v12 offset:12296
    ds_read_b64_tr_b16 v[126:127], v12 offset:14344
    s_waitcnt lgkmcnt(0)
    ds_read_b64_tr_b16 v[128:129], v12 offset:64
    ds_read_b64_tr_b16 v[130:131], v12 offset:2112
    ds_read_b64_tr_b16 v[132:133], v12 offset:4160
    ds_read_b64_tr_b16 v[134:135], v12 offset:6208
    ds_read_b64_tr_b16 v[136:137], v12 offset:8256
    ds_read_b64_tr_b16 v[138:139], v12 offset:10304
    ds_read_b64_tr_b16 v[140:141], v12 offset:12352
    ds_read_b64_tr_b16 v[142:143], v12 offset:14400
    s_waitcnt lgkmcnt(0)
    ds_read_b64_tr_b16 v[144:145], v12 offset:72
    ds_read_b64_tr_b16 v[146:147], v12 offset:2120
    ds_read_b64_tr_b16 v[148:149], v12 offset:4168
    ds_read_b64_tr_b16 v[150:151], v12 offset:6216
    ds_read_b64_tr_b16 v[152:153], v12 offset:8264
    ds_read_b64_tr_b16 v[154:155], v12 offset:10312
    ds_read_b64_tr_b16 v[156:157], v12 offset:12360
    ds_read_b64_tr_b16 v[158:159], v12 offset:14408
    s_waitcnt lgkmcnt(0)
    s_branch rec_wdone
rec_wv_only:
    s_cmp_eq_u32 s21, 7
    s_cbranch_scc0 rec_wv2
    global_load_dwordx4 v[48:51], v9, s[32:33] sc1
    global_load_dwordx4 v[52:55], v8, s[32:33] sc1
    global_load_dwordx2 v[58:59], v56, s[14:15] offset:40 sc1
    global_load_dword v61, v57, s[14:15] sc1
rec_wv2:
    s_waitcnt vmcnt(0)
    ds_read_b64_tr_b16 a[64:65], v12 offset:0
    ds_read_b64_tr_b16 a[66:67], v12 offset:128
    ds_read_b64_tr_b16 a[68:69], v12 offset:2048
    ds_read_b64_tr_b16 a[70:71], v12 offset:2176
    s_waitcnt lgkmcnt(4)
    ds_read_b64_tr_b16 a[72:73], v12 offset:4096
    ds_read_b64_tr_b16 a[74:75], v12 offset:4224
    ds_read_b64_tr_b16 a[76:77], v12 offset:6144
    ds_read_b64_tr_b16 a[78:79], v12 offset:6272
    s_waitcnt lgkmcnt(4)
    ds_read_b64_tr_b16 a[80:81], v12 offset:32
    ds_read_b64_tr_b16 a[82:83], v12 offset:160
    ds_read_b64_tr_b16 a[84:85], v12 offset:2080
    ds_read_b64_tr_b16 a[86:87], v12 offset:2208
    s_waitcnt lgkmcnt(4)
    ds_read_b64_tr_b16 a[88:89], v12 offset:4128
    ds_read_b64_tr_b16 a[90:91], v12 offset:4256
    ds_read_b64_tr_b16 a[92:93], v12 offset:6176
    ds_read_b64_tr_b16 a[94:95], v12 offset:6304
    s_waitcnt lgkmcnt(4)
    s_waitcnt lgkmcnt(0)
rec_wdone:
    s_cmp_eq_u32 s21, 7
    s_cbranch_scc0 rec_sync1
rec_clrw:
    v_readfirstlane_b32 s36, v58
    v_readfirstlane_b32 s37, v59
    s_and_b32 s42, s36, 0xffff
    s_add_u32 s42, s42, s37
    s_cmp_eq_u32 s42, 256
    s_cbranch_scc1 rec_clrok
    s_sleep 8
    global_load_dwordx2 v[58:59], v56, s[14:15] offset:40 sc1
    s_waitcnt vmcnt(0)
    global_load_dword v61, v57, s[14:15] sc1
    s_waitcnt vmcnt(0)
    s_add_u32 s24, s24, 1
    s_cmp_lt_u32 s24, 400000
    s_cbranch_scc1 rec_clrw
    s_branch rec_fail
rec_clrok:
    v_cmp_gt_u32 vcc, 32, v61
    s_cbranch_vccz rec_cntok
    global_load_dword v61, v57, s[14:15] sc1
    s_waitcnt vmcnt(0)
rec_cntok:
    s_lshr_b32 s36, s36, 16
    s_cmp_gt_u32 s36, 64
    s_cselect_b32 s25, 1, 0
    v_mov_b32 v60, s25
    v_mov_b32 v56, 114688
    ds_write_b64 v56, v[60:61]
    v_mov_b32 v59, 0
    ds_write_b32 v56, v59 offset:8
rec_sync1:
    s_and_b32 s36, s21, 3
    s_lshl_b32 s36, s36, 11
    s_lshr_b32 s42, s21, 2
    s_lshl_b32 s42, s42, 14
    s_add_u32 s36, s36, s42
    v_add_u32 v1, s36, v6
    v_and_b32 v2, 8, v0
    v_cmp_eq_u32 vcc, 0, v2
    v_mov_b32 v2, 0xeeee
    v_mov_b32 v3, 0x4444
    s_nop 1
    v_cndmask_b32 v2, v2, v3, vcc
    s_mul_i32 s36, s21, 3072
    v_add_u32 v3, s36, v6
    s_mov_b32 s22, 0
    s_mov_b32 s51, 1
    s_waitcnt vmcnt(0) lgkmcnt(0)
    s_barrier
    v_min_u32 v16, -2, v16
    v_min_u32 v17, -2, v17
    v_min_u32 v18, -2, v18
    v_min_u32 v19, -2, v19
    v_min_u32 v20, -2, v20
    v_min_u32 v21, -2, v21
    v_min_u32 v22, -2, v22
    v_min_u32 v23, -2, v23
    v_mov_b32 v24, 114688
    ds_read_b64 v[24:25], v24
    s_waitcnt lgkmcnt(0)
    v_readfirstlane_b32 s25, v24
    v_readfirstlane_b32 s23, v25
    s_and_b32 s25, s25, 1
    s_lshl_b32 s36, s25, 13
    s_add_u32 s26, s16, s36
    s_addc_u32 s27, s17, 0
    s_mov_b32 s42, 153092096
    s_lshr_b32 s36, s42, 21
    s_xor_b32 s36, s36, s25
    s_and_b32 s36, s36, 1
    s_lshl_b32 s36, s36, 13
    s_add_u32 s36, s36, s42
    s_add_u32 s40, s16, s36
    s_addc_u32 s41, s17, 0
    s_mov_b32 s42, 2097152
    s_lshr_b32 s36, s42, 21
    s_xor_b32 s36, s36, s25
    s_and_b32 s36, s36, 1
    s_lshl_b32 s36, s36, 13
    s_add_u32 s36, s36, s42
    s_add_u32 s28, s16, s36
    s_addc_u32 s29, s17, 0
    s_lshr_b32 s38, s18, 1
    s_lshl_b32 s38, s38, 14
    s_and_b32 s36, s18, 1
    s_lshl_b32 s36, s36, 12
    s_add_u32 s38, s38, s36
    s_add_u32 s38, s38, 4194304
    s_lshr_b32 s36, s38, 21
    s_xor_b32 s36, s36, s25
    s_and_b32 s36, s36, 1
    s_lshl_b32 s36, s36, 13
    s_add_u32 s36, s36, s38
    s_add_u32 s30, s16, s36
    s_addc_u32 s31, s17, 0
    s_cmp_lt_u32 s21, 4
    s_cbranch_scc1 rec_setup_vo
    v_mov_b32 v148, 114696
    v_mov_b32 v149, 1
    s_mov_b32 s47, 0
    s_cmp_eq_u32 s21, 6
    s_cbranch_scc1 rec_setup_sm
    s_sub_u32 s37, s21, 4
    s_min_u32 s37, s37, 2
    s_lshl_b32 s36, s37, 10
    v_add_u32 v4, s36, v6
    v_and_b32 v48, 1, v0
    v_lshlrev_b32 v48, 4, v48
    v_mov_b32 v49, 0x3f80
    v_lshlrev_b32 v48, v48, v49
    v_bfe_u32 v49, v0, 3, 1
    v_bfe_u32 v50, v0, 1, 1
    v_lshl_add_u32 v49, v49, 1, v50
    v_lshrrev_b32 v50, 2, v0
    v_xor_b32 v50, v50, v0
    v_and_b32 v50, 4, v50
    v_add_u32 v49, v49, v50
    v_cmp_eq_u32 vcc, 0, v49
    s_nop 1
    v_cndmask_b32 v84, 0, v48, vcc
    v_cmp_eq_u32 vcc, 1, v49
    s_nop 1
    v_cndmask_b32 v85, 0, v48, vcc
    v_cmp_eq_u32 vcc, 2, v49
    s_nop 1
    v_cndmask_b32 v86, 0, v48, vcc
    v_cmp_eq_u32 vcc, 3, v49
    s_nop 1
    v_cndmask_b32 v87, 0, v48, vcc
    v_and_b32 v48, 7, v0
    v_lshlrev_b32 v48, 4, v48
    v_and_b32 v49, 8, v0
    v_lshrrev_b32 v50, 4, v0
    v_add_u32 v51, v48, v49
    v_lshl_add_u32 v10, v50, 7, v51
    s_and_b32 s46, s19, 1
    s_lshl_b32 s46, s46, 1
    s_add_u32 s46, s46, s37
    s_add_u32 s36, s39, 4
    s_cmp_eq_u32 s37, 2
    s_cselect_b32 s36, s36, s46
    s_lshl_b32 s36, s36, 9
    v_add_u32 v10, s36, v10
    v_lshl_add_u32 v5, v50, 8, v51
    s_lshl_b32 s36, s46, 10
    s_lshr_b32 s42, s19, 1
    s_lshl_b32 s42, s42, 7
    s_add_u32 s36, s36, s42
    v_add_u32 v5, s36, v5
    v_mov_b32 v24, 0
    v_mov_b32 v25, 0
    v_mov_b32 v26, 0
    v_mov_b32 v27, 0
    v_mov_b32 v28, 0
    v_mov_b32 v29, 0
    v_mov_b32 v30, 0
    v_mov_b32 v31, 0
    v_mov_b32 v32, 0
    v_mov_b32 v33, 0
    v_mov_b32 v34, 0
    v_mov_b32 v35, 0
    v_mov_b32 v36, 0
    v_mov_b32 v37, 0
    v_mov_b32 v38, 0
    v_mov_b32 v39, 0
    v_mov_b32 v40, 0
    v_mov_b32 v41, 0
    v_mov_b32 v42, 0
    v_mov_b32 v43, 0
    v_mov_b32 v44, 0
    v_mov_b32 v45, 0
    v_mov_b32 v46, 0
    v_mov_b32 v47, 0
    v_mov_b32 v144, -1
    v_mov_b32 v145, -1
    v_mov_b32 v146, -1
    v_mov_b32 v147, -1
    s_setprio 2
    s_cmp_eq_u32 s21, 7
    s_cbranch_scc1 rec_setup_m
    v_add_u32 v11, s44, v6
    v_and_b32 v15, 7, v0
    v_lshlrev_b32 v15, 4, v15
    v_bfe_u32 v48, v0, 4, 1
    v_lshl_add_u32 v15, v48, 3, v15
    v_add_u32 v15, s45, v15
    v_and_b32 v48, 1, v0
    v_lshlrev_b32 v48, 4, v48
    v_mov_b32 v49, 0x3f80
    v_lshlrev_b32 v48, v48, v49
    v_bfe_u32 v49, v0, 1, 3
    v_cmp_eq_u32 vcc, 0, v49
    s_nop 1
    v_cndmask_b32 v92, 0, v48, vcc
    v_cmp_eq_u32 vcc, 1, v49
    s_nop 1
    v_cndmask_b32 v93, 0, v48, vcc
    v_cmp_eq_u32 vcc, 2, v49
    s_nop 1
    v_cndmask_b32 v94, 0, v48, vcc
    v_cmp_eq_u32 vcc, 3, v49
    s_nop 1
    v_cndmask_b32 v95, 0, v48, vcc
    s_mul_i32 s54, s37, 33554432
    s_mul_i32 s55, s37, 16384
    s_add_u32 s55, s55, 131072
    s_lshl_b32 s36, s18, 14
    s_add_u32 s54, s54, s36
    s_add_u32 s54, s54, 20971520
    v_add_u32 v12, 0x1000, v6
    s_branch rec_v0_in
rec_v_loop:
    s_sleep 7
rec_v0:
    global_load_dwordx4 v[16:19], v1, s[28:29] sc1
    global_load_dwordx4 v[20:23], v1, s[28:29] offset:1024 sc1
    s_waitcnt vmcnt(0)
rec_v0_in:
    v_smfmac_f32_16x16x64_bf16 v[24:27], v[16:19], a[0:7], v2
    v_max3_u32 v0, v16, v17, v18
    v_max3_u32 v7, v19, v20, v21
    v_smfmac_f32_16x16x64_bf16 v[28:31], v[16:19], a[16:23], v2
    v_max3_u32 v0, v0, v22, v23
    v_max_u32 v0, v0, v7
    v_smfmac_f32_16x16x64_bf16 v[24:27], v[20:23], a[8:15], v2
    v_cmp_eq_u32 vcc, -1, v0
    s_cbranch_vccnz rec_v0_retry
    v_smfmac_f32_16x16x64_bf16 v[28:31], v[20:23], a[24:31], v2
    v_smfmac_f32_16x16x64_bf16 v[32:35], v[16:19], a[32:39], v2
    v_smfmac_f32_16x16x64_bf16 v[36:39], v[16:19], a[48:55], v2
    v_smfmac_f32_16x16x64_bf16 v[32:35], v[20:23], a[40:47], v2
    v_smfmac_f32_16x16x64_bf16 v[36:39], v[20:23], a[56:63], v2
    s_nop 3
    v_cvt_pk_bf16_f32 v24, v24, v25
    v_smfmac_f32_16x16x64_bf16 v[40:43], v[16:19], a[64:71], v2
    v_cvt_pk_bf16_f32 v25, v26, v27
    v_smfmac_f32_16x16x64_bf16 v[44:47], v[16:19], a[80:87], v2
    v_cvt_pk_bf16_f32 v26, v28, v29
    v_smfmac_f32_16x16x64_bf16 v[40:43], v[20:23], a[72:79], v2
    v_cvt_pk_bf16_f32 v27, v30, v31
    ds_write_b128 v3, v[24:27]
    v_smfmac_f32_16x16x64_bf16 v[44:47], v[20:23], a[88:95], v2
    v_cvt_pk_bf16_f32 v32, v32, v33
    v_cvt_pk_bf16_f32 v33, v34, v35
    v_cvt_pk_bf16_f32 v34, v36, v37
    v_cvt_pk_bf16_f32 v35, v38, v39
    ds_write_b128 v3, v[32:35] offset:1024
    s_nop 2
    v_cvt_pk_bf16_f32 v40, v40, v41
    v_cvt_pk_bf16_f32 v41, v42, v43
    v_cvt_pk_bf16_f32 v42, v44, v45
    v_cvt_pk_bf16_f32 v43, v46, v47
    ds_write_b128 v3, v[40:43] offset:2048
    s_waitcnt lgkmcnt(1)
    s_barrier
    ds_read_b128 v[48:51], v4 offset:0
    ds_read_b128 v[52:55], v4 offset:3072
    ds_read_b128 v[56:59], v4 offset:6144
    ds_read_b128 v[60:63], v4 offset:9216
    ds_read_b128 v[64:67], v4 offset:12288
    ds_read_b128 v[68:71], v4 offset:15360
    ds_read_b128 v[72:75], v4 offset:18432
    ds_read_b128 v[76:79], v4 offset:21504
    s_waitcnt lgkmcnt(8)
    s_barrier
    s_waitcnt lgkmcnt(7)
    v_mfma_f32_16x16x32_bf16 v[80:83], v[48:51], v[84:87], 0
    s_waitcnt lgkmcnt(6)
    v_mfma_f32_16x16x32_bf16 v[80:83], v[52:55], v[84:87], v[80:83]
    s_waitcnt lgkmcnt(5)
    v_mfma_f32_16x16x32_bf16 v[80:83], v[56:59], v[84:87], v[80:83]
    s_waitcnt lgkmcnt(4)
    v_mfma_f32_16x16x32_bf16 v[80:83], v[60:63], v[84:87], v[80:83]
    s_waitcnt lgkmcnt(3)
    v_mfma_f32_16x16x32_bf16 v[80:83], v[64:67], v[84:87], v[80:83]
    s_waitcnt lgkmcnt(2)
    v_mfma_f32_16x16x32_bf16 v[80:83], v[68:71], v[84:87], v[80:83]
    s_waitcnt lgkmcnt(1)
    v_mfma_f32_16x16x32_bf16 v[80:83], v[72:75], v[84:87], v[80:83]
    s_waitcnt lgkmcnt(0)
    v_mfma_f32_16x16x32_bf16 v[80:83], v[76:79], v[84:87], v[80:83]
    s_cmp_lt_u32 s23, 32
    s_nop 6
    v_cvt_pk_bf16_f32 v88, v80, v81
    v_cvt_pk_bf16_f32 v89, v82, v83
    v_and_b32 v90, -2, v88
    v_and_b32 v91, -2, v89
    s_cbranch_scc1 rec_v0_wt
    global_store_dwordx2 v5, v[90:91], s[32:33]
rec_v0_pd:
    s_cmp_eq_u32 s22, 0
    s_cbranch_scc1 rec_v_first
rec_v_fj:
    v_min_u32 v88, -2, v88
    v_min_u32 v89, -2, v89
    s_waitcnt vmcnt(0)
    s_barrier
    s_cmp_lt_u32 s19, 2
    s_cbranch_scc1 rec_v0_nq
    global_store_dwordx2 v10, v[88:89], s[30:31] sc1
rec_v0_nq:
    s_cmp_eq_u32 s21, 4
    s_cbranch_scc1 rec_v0_red
    v_mov_b32 v24, 0
    v_mov_b32 v25, 0
    v_mov_b32 v26, 0
    v_mov_b32 v27, 0
    v_mov_b32 v28, 0
    v_mov_b32 v29, 0
    v_mov_b32 v30, 0
    v_mov_b32 v31, 0
    v_mov_b32 v32, 0
    v_mov_b32 v33, 0
    v_mov_b32 v34, 0
    v_mov_b32 v35, 0
    v_mov_b32 v36, 0
    v_mov_b32 v37, 0
    v_mov_b32 v38, 0
    v_mov_b32 v39, 0
    v_mov_b32 v40, 0
    v_mov_b32 v41, 0
    v_mov_b32 v42, 0
    v_mov_b32 v43, 0
    v_mov_b32 v44, 0
    v_mov_b32 v45, 0
    v_mov_b32 v46, 0
    v_mov_b32 v47, 0
    s_add_u32 s22, s22, 1
    s_add_u32 s28, s28, 0x8000
    s_addc_u32 s29, s29, 0
    s_add_u32 s38, s38, 0x40000
    s_lshr_b32 s36, s38, 21
    s_xor_b32 s36, s36, s25
    s_and_b32 s36, s36, 1
    s_lshl_b32 s36, s36, 13
    s_add_u32 s36, s36, s38
    s_add_u32 s30, s16, s36
    s_addc_u32 s31, s17, 0
    s_waitcnt vmcnt(0)
    s_branch rec_v0_end
rec_v0_red:
    v_mov_b32 v24, 0
    v_mov_b32 v25, 0
    v_mov_b32 v26, 0
    v_mov_b32 v27, 0
    v_mov_b32 v28, 0
    v_mov_b32 v29, 0
    v_mov_b32 v30, 0
    v_mov_b32 v31, 0
    v_mov_b32 v32, 0
    v_mov_b32 v33, 0
    v_mov_b32 v34, 0
    v_mov_b32 v35, 0
    v_mov_b32 v36, 0
    v_mov_b32 v37, 0
    v_mov_b32 v38, 0
    v_mov_b32 v39, 0
    v_mov_b32 v40, 0
    v_mov_b32 v41, 0
    v_mov_b32 v42, 0
    v_mov_b32 v43, 0
    v_mov_b32 v44, 0
    v_mov_b32 v45, 0
    v_mov_b32 v46, 0
    v_mov_b32 v47, 0
    s_add_u32 s22, s22, 1
    s_add_u32 s28, s28, 0x8000
    s_addc_u32 s29, s29, 0
    s_add_u32 s38, s38, 0x40000
    s_lshr_b32 s36, s38, 21
    s_xor_b32 s36, s36, s25
    s_and_b32 s36, s36, 1
    s_lshl_b32 s36, s36, 13
    s_add_u32 s36, s36, s38
    s_add_u32 s30, s16, s36
    s_addc_u32 s31, s17, 0
    s_sleep 10
    global_load_dwordx4 v[96:99], v11, s[26:27] offset:0 sc1
    global_load_dwordx4 v[100:103], v11, s[26:27] offset:1024 sc1
    global_load_dwordx4 v[104:107], v11, s[26:27] offset:2048 sc1
    global_load_dwordx4 v[108:111], v11, s[26:27] offset:3072 sc1
    s_sleep 5
rec_v0_rp:
    global_load_dwordx4 v[112:115], v11, s[26:27] offset:0 sc1
    global_load_dwordx4 v[116:119], v11, s[26:27] offset:1024 sc1
    global_load_dwordx4 v[120:123], v11, s[26:27] offset:2048 sc1
    global_load_dwordx4 v[124:127], v11, s[26:27] offset:3072 sc1
    s_waitcnt vmcnt(4)
    v_mfma_f32_16x16x32_bf16 v[64:67], v[92:95], v[96:99], 0
    v_bitop3_b32 v73, v96, v97, v98 bitop3:0xfe
    v_bitop3_b32 v72, v99, v100, v101 bitop3:0xfe
    v_mfma_f32_16x16x32_bf16 v[64:67], v[92:95], v[100:103], v[64:67]
    v_bitop3_b32 v73, v73, v102, v103 bitop3:0xfe
    v_bitop3_b32 v72, v72, v104, v105 bitop3:0xfe
    v_mfma_f32_16x16x32_bf16 v[64:67], v[92:95], v[104:107], v[64:67]
    v_bitop3_b32 v73, v73, v106, v107 bitop3:0xfe
    v_bitop3_b32 v72, v72, v108, v109 bitop3:0xfe
    v_mfma_f32_16x16x32_bf16 v[64:67], v[92:95], v[108:111], v[64:67]
    v_bitop3_b32 v73, v73, v110, v111 bitop3:0xfe
    v_bitop3_b32 v73, v73, v72, 1 bitop3:0xa8
    v_cmp_ne_u32 vcc, 0, v73
    s_cbranch_vccz rec_v0_rok
    global_load_dwordx4 v[96:99], v11, s[26:27] offset:0 sc1
    global_load_dwordx4 v[100:103], v11, s[26:27] offset:1024 sc1
    global_load_dwordx4 v[104:107], v11, s[26:27] offset:2048 sc1
    global_load_dwordx4 v[108:111], v11, s[26:27] offset:3072 sc1
    s_waitcnt vmcnt(4)
    v_mfma_f32_16x16x32_bf16 v[64:67], v[92:95], v[112:115], 0
    v_bitop3_b32 v73, v112, v113, v114 bitop3:0xfe
    v_bitop3_b32 v72, v115, v116, v117 bitop3:0xfe
    v_mfma_f32_16x16x32_bf16 v[64:67], v[92:95], v[116:119], v[64:67]
    v_bitop3_b32 v73, v73, v118, v119 bitop3:0xfe
    v_bitop3_b32 v72, v72, v120, v121 bitop3:0xfe
    v_mfma_f32_16x16x32_bf16 v[64:67], v[92:95], v[120:123], v[64:67]
    v_bitop3_b32 v73, v73, v122, v123 bitop3:0xfe
    v_bitop3_b32 v72, v72, v124, v125 bitop3:0xfe
    v_mfma_f32_16x16x32_bf16 v[64:67], v[92:95], v[124:127], v[64:67]
    v_bitop3_b32 v73, v73, v126, v127 bitop3:0xfe
    v_bitop3_b32 v73, v73, v72, 1 bitop3:0xa8
    v_cmp_ne_u32 vcc, 0, v73
    s_cbranch_vccnz rec_v0_rr
rec_v0_rok:
    s_nop 3
    v_add_f32_dpp v72, v64, v64 row_ror:8 row_mask:0xf bank_mask:0xf
    v_add_f32_dpp v73, v65, v65 row_ror:8 row_mask:0xf bank_mask:0xf
    v_add_f32_dpp v74, v66, v66 row_ror:8 row_mask:0xf bank_mask:0xf
    v_add_f32_dpp v75, v67, v67 row_ror:8 row_mask:0xf bank_mask:0xf
    s_mov_b64 exec, 0x00ff00ff
    v_cvt_pk_bf16_f32 v76, v72, v73
    v_cvt_pk_bf16_f32 v77, v74, v75
    v_min_u32 v76, -2, v76
    v_min_u32 v77, -2, v77
    global_store_dwordx2 v15, v[76:77], s[28:29] sc1
    s_mov_b64 exec, -1
rec_v0_end:
    s_barrier
    s_sleep 7
rec_v1:
    global_load_dwordx4 v[16:19], v1, s[28:29] sc1
    global_load_dwordx4 v[20:23], v1, s[28:29] offset:1024 sc1
    s_waitcnt vmcnt(0)
rec_v1_in:
    v_smfmac_f32_16x16x64_bf16 v[24:27], v[16:19], a[0:7], v2
    v_max3_u32 v0, v16, v17, v18
    v_max3_u32 v7, v19, v20, v21
    v_smfmac_f32_16x16x64_bf16 v[28:31], v[16:19], a[16:23], v2
    v_max3_u32 v0, v0, v22, v23
    v_max_u32 v0, v0, v7
    v_smfmac_f32_16x16x64_bf16 v[24:27], v[20:23], a[8:15], v2
    v_cmp_eq_u32 vcc, -1, v0
    s_cbranch_vccnz rec_v1_retry
    v_smfmac_f32_16x16x64_bf16 v[28:31], v[20:23], a[24:31], v2
    v_smfmac_f32_16x16x64_bf16 v[32:35], v[16:19], a[32:39], v2
    v_smfmac_f32_16x16x64_bf16 v[36:39], v[16:19], a[48:55], v2
    v_smfmac_f32_16x16x64_bf16 v[32:35], v[20:23], a[40:47], v2
    v_smfmac_f32_16x16x64_bf16 v[36:39], v[20:23], a[56:63], v2
    s_nop 3
    v_cvt_pk_bf16_f32 v24, v24, v25
    v_smfmac_f32_16x16x64_bf16 v[40:43], v[16:19], a[64:71], v2
    v_cvt_pk_bf16_f32 v25, v26, v27
    v_smfmac_f32_16x16x64_bf16 v[44:47], v[16:19], a[80:87], v2
    v_cvt_pk_bf16_f32 v26, v28, v29
    v_smfmac_f32_16x16x64_bf16 v[40:43], v[20:23], a[72:79], v2
    v_cvt_pk_bf16_f32 v27, v30, v31
    ds_write_b128 v3, v[24:27]
    v_smfmac_f32_16x16x64_bf16 v[44:47], v[20:23], a[88:95], v2
    v_cvt_pk_bf16_f32 v32, v32, v33
    v_cvt_pk_bf16_f32 v33, v34, v35
    v_cvt_pk_bf16_f32 v34, v36, v37
    v_cvt_pk_bf16_f32 v35, v38, v39
    ds_write_b128 v3, v[32:35] offset:1024
    s_nop 2
    v_cvt_pk_bf16_f32 v40, v40, v41
    v_cvt_pk_bf16_f32 v41, v42, v43
    v_cvt_pk_bf16_f32 v42, v44, v45
    v_cvt_pk_bf16_f32 v43, v46, v47
    ds_write_b128 v3, v[40:43] offset:2048
    s_waitcnt lgkmcnt(1)
    s_barrier
    ds_read_b128 v[48:51], v4 offset:0
    ds_read_b128 v[52:55], v4 offset:3072
    ds_read_b128 v[56:59], v4 offset:6144
    ds_read_b128 v[60:63], v4 offset:9216
    ds_read_b128 v[64:67], v4 offset:12288
    ds_read_b128 v[68:71], v4 offset:15360
    ds_read_b128 v[72:75], v4 offset:18432
    ds_read_b128 v[76:79], v4 offset:21504
    s_waitcnt lgkmcnt(8)
    s_barrier
    s_waitcnt lgkmcnt(7)
    v_mfma_f32_16x16x32_bf16 v[80:83], v[48:51], v[84:87], 0
    s_waitcnt lgkmcnt(6)
    v_mfma_f32_16x16x32_bf16 v[80:83], v[52:55], v[84:87], v[80:83]
    s_waitcnt lgkmcnt(5)
    v_mfma_f32_16x16x32_bf16 v[80:83], v[56:59], v[84:87], v[80:83]
    s_waitcnt lgkmcnt(4)
    v_mfma_f32_16x16x32_bf16 v[80:83], v[60:63], v[84:87], v[80:83]
    s_waitcnt lgkmcnt(3)
    v_mfma_f32_16x16x32_bf16 v[80:83], v[64:67], v[84:87], v[80:83]
    s_waitcnt lgkmcnt(2)
    v_mfma_f32_16x16x32_bf16 v[80:83], v[68:71], v[84:87], v[80:83]
    s_waitcnt lgkmcnt(1)
    v_mfma_f32_16x16x32_bf16 v[80:83], v[72:75], v[84:87], v[80:83]
    s_waitcnt lgkmcnt(0)
    v_mfma_f32_16x16x32_bf16 v[80:83], v[76:79], v[84:87], v[80:83]
    s_cmp_eq_u32 s22, 63
    s_cbranch_scc1 rec_last_pub
    s_cmp_lt_u32 s23, 32
    s_nop 4
    v_cvt_pk_bf16_f32 v88, v80, v81
    v_cvt_pk_bf16_f32 v89, v82, v83
    v_or_b32 v90, 1, v88
    v_or_b32 v91, 1, v89
    s_cbranch_scc1 rec_v1_wt
    global_store_dwordx2 v5, v[90:91], s[32:33]
rec_v1_pd:
    v_min_u32 v88, -2, v88
    v_min_u32 v89, -2, v89
    s_waitcnt vmcnt(0)
    s_barrier
    s_cmp_lt_u32 s19, 2
    s_cbranch_scc1 rec_v1_nq
    global_store_dwordx2 v10, v[88:89], s[30:31] sc1
rec_v1_nq:
    s_cmp_eq_u32 s21, 4
    s_cbranch_scc1 rec_v1_red
    v_mov_b32 v24, 0
    v_mov_b32 v25, 0
    v_mov_b32 v26, 0
    v_mov_b32 v27, 0
    v_mov_b32 v28, 0
    v_mov_b32 v29, 0
    v_mov_b32 v30, 0
    v_mov_b32 v31, 0
    v_mov_b32 v32, 0
    v_mov_b32 v33, 0
    v_mov_b32 v34, 0
    v_mov_b32 v35, 0
    v_mov_b32 v36, 0
    v_mov_b32 v37, 0
    v_mov_b32 v38, 0
    v_mov_b32 v39, 0
    v_mov_b32 v40, 0
    v_mov_b32 v41, 0
    v_mov_b32 v42, 0
    v_mov_b32 v43, 0
    v_mov_b32 v44, 0
    v_mov_b32 v45, 0
    v_mov_b32 v46, 0
    v_mov_b32 v47, 0
    s_add_u32 s22, s22, 1
    s_add_u32 s28, s28, 0x8000
    s_addc_u32 s29, s29, 0
    s_add_u32 s38, s38, 0x40000
    s_lshr_b32 s36, s38, 21
    s_xor_b32 s36, s36, s25
    s_and_b32 s36, s36, 1
    s_lshl_b32 s36, s36, 13
    s_add_u32 s36, s36, s38
    s_add_u32 s30, s16, s36
    s_addc_u32 s31, s17, 0
    s_waitcnt vmcnt(0)
    s_branch rec_v1_end
rec_v1_red:
    v_mov_b32 v24, 0
    v_mov_b32 v25, 0
    v_mov_b32 v26, 0
    v_mov_b32 v27, 0
    v_mov_b32 v28, 0
    v_mov_b32 v29, 0
    v_mov_b32 v30, 0
    v_mov_b32 v31, 0
    v_mov_b32 v32, 0
    v_mov_b32 v33, 0
    v_mov_b32 v34, 0
    v_mov_b32 v35, 0
    v_mov_b32 v36, 0
    v_mov_b32 v37, 0
    v_mov_b32 v38, 0
    v_mov_b32 v39, 0
    v_mov_b32 v40, 0
    v_mov_b32 v41, 0
    v_mov_b32 v42, 0
    v_mov_b32 v43, 0
    v_mov_b32 v44, 0
    v_mov_b32 v45, 0
    v_mov_b32 v46, 0
    v_mov_b32 v47, 0
    s_add_u32 s22, s22, 1
    s_add_u32 s28, s28, 0x8000
    s_addc_u32 s29, s29, 0
    s_add_u32 s38, s38, 0x40000
    s_lshr_b32 s36, s38, 21
    s_xor_b32 s36, s36, s25
    s_and_b32 s36, s36, 1
    s_lshl_b32 s36, s36, 13
    s_add_u32 s36, s36, s38
    s_add_u32 s30, s16, s36
    s_addc_u32 s31, s17, 0
    s_sleep 10
    global_load_dwordx4 v[96:99], v11, s[26:27] offset:0 sc1
    global_load_dwordx4 v[100:103], v11, s[26:27] offset:1024 sc1
    global_load_dwordx4 v[104:107], v11, s[26:27] offset:2048 sc1
    global_load_dwordx4 v[108:111], v11, s[26:27] offset:3072 sc1
    s_sleep 5
rec_v1_rp:
    global_load_dwordx4 v[112:115], v11, s[26:27] offset:0 sc1
    global_load_dwordx4 v[116:119], v11, s[26:27] offset:1024 sc1
    global_load_dwordx4 v[120:123], v11, s[26:27] offset:2048 sc1
    global_load_dwordx4 v[124:127], v11, s[26:27] offset:3072 sc1
    s_waitcnt vmcnt(4)
    v_mfma_f32_16x16x32_bf16 v[64:67], v[92:95], v[96:99], 0
    v_bitop3_b32 v73, v96, v97, v98 bitop3:0x80
    v_bitop3_b32 v72, v99, v100, v101 bitop3:0x80
    v_mfma_f32_16x16x32_bf16 v[64:67], v[92:95], v[100:103], v[64:67]
    v_bitop3_b32 v73, v73, v102, v103 bitop3:0x80
    v_bitop3_b32 v72, v72, v104, v105 bitop3:0x80
    v_mfma_f32_16x16x32_bf16 v[64:67], v[92:95], v[104:107], v[64:67]
    v_bitop3_b32 v73, v73, v106, v107 bitop3:0x80
    v_bitop3_b32 v72, v72, v108, v109 bitop3:0x80
    v_mfma_f32_16x16x32_bf16 v[64:67], v[92:95], v[108:111], v[64:67]
    v_bitop3_b32 v73, v73, v110, v111 bitop3:0x80
    v_bitop3_b32 v73, v73, v72, 1 bitop3:0x80
    v_cmp_ne_u32 vcc, 1, v73
    s_cbranch_vccz rec_v1_rok
    global_load_dwordx4 v[96:99], v11, s[26:27] offset:0 sc1
    global_load_dwordx4 v[100:103], v11, s[26:27] offset:1024 sc1
    global_load_dwordx4 v[104:107], v11, s[26:27] offset:2048 sc1
    global_load_dwordx4 v[108:111], v11, s[26:27] offset:3072 sc1
    s_waitcnt vmcnt(4)
    v_mfma_f32_16x16x32_bf16 v[64:67], v[92:95], v[112:115], 0
    v_bitop3_b32 v73, v112, v113, v114 bitop3:0x80
    v_bitop3_b32 v72, v115, v116, v117 bitop3:0x80
    v_mfma_f32_16x16x32_bf16 v[64:67], v[92:95], v[116:119], v[64:67]
    v_bitop3_b32 v73, v73, v118, v119 bitop3:0x80
    v_bitop3_b32 v72, v72, v120, v121 bitop3:0x80
    v_mfma_f32_16x16x32_bf16 v[64:67], v[92:95], v[120:123], v[64:67]
    v_bitop3_b32 v73, v73, v122, v123 bitop3:0x80
    v_bitop3_b32 v72, v72, v124, v125 bitop3:0x80
    v_mfma_f32_16x16x32_bf16 v[64:67], v[92:95], v[124:127], v[64:67]
    v_bitop3_b32 v73, v73, v126, v127 bitop3:0x80
    v_bitop3_b32 v73, v73, v72, 1 bitop3:0x80
    v_cmp_ne_u32 vcc, 1, v73
    s_cbranch_vccnz rec_v1_rr
rec_v1_rok:
    s_nop 3
    v_add_f32_dpp v72, v64, v64 row_ror:8 row_mask:0xf bank_mask:0xf
    v_add_f32_dpp v73, v65, v65 row_ror:8 row_mask:0xf bank_mask:0xf
    v_add_f32_dpp v74, v66, v66 row_ror:8 row_mask:0xf bank_mask:0xf
    v_add_f32_dpp v75, v67, v67 row_ror:8 row_mask:0xf bank_mask:0xf
    s_mov_b64 exec, 0x00ff00ff
    v_cvt_pk_bf16_f32 v76, v72, v73
    v_cvt_pk_bf16_f32 v77, v74, v75
    v_min_u32 v76, -2, v76
    v_min_u32 v77, -2, v77
    global_store_dwordx2 v15, v[76:77], s[28:29] sc1
    s_mov_b64 exec, -1
rec_v1_end:
    s_barrier
    s_branch rec_v_loop
rec_v0_retry:
    s_nop 7
    v_mov_b32 v24, 0
    v_mov_b32 v25, 0
    v_mov_b32 v26, 0
    v_mov_b32 v27, 0
    v_mov_b32 v28, 0
    v_mov_b32 v29, 0
    v_mov_b32 v30, 0
    v_mov_b32 v31, 0
    s_add_u32 s24, s24, 1
    s_cmp_lt_u32 s24, 400000
    s_cbranch_scc1 rec_v0
    s_branch rec_fail
rec_v0_wt:
    global_store_dwordx2 v5, v[90:91], s[32:33] sc1
    s_branch rec_v0_pd
rec_v0_rr:
    s_add_u32 s24, s24, 1
    s_cmp_lt_u32 s24, 400000
    s_cbranch_scc1 rec_v0_rp
    s_branch rec_fail
rec_v1_retry:
    s_nop 7
    v_mov_b32 v24, 0
    v_mov_b32 v25, 0
    v_mov_b32 v26, 0
    v_mov_b32 v27, 0
    v_mov_b32 v28, 0
    v_mov_b32 v29, 0
    v_mov_b32 v30, 0
    v_mov_b32 v31, 0
    s_add_u32 s24, s24, 1
    s_cmp_lt_u32 s24, 400000
    s_cbranch_scc1 rec_v1
    s_branch rec_fail
rec_v1_wt:
    global_store_dwordx2 v5, v[90:91], s[32:33] sc1
    s_branch rec_v1_pd
rec_v1_rr:
    s_add_u32 s24, s24, 1
    s_cmp_lt_u32 s24, 400000
    s_cbranch_scc1 rec_v1_rp
    s_branch rec_fail
rec_v_first:
    s_barrier
    s_barrier
    s_branch rec_v_fj
rec_setup_m:
    v_lshrrev_b32 v5, 5, v0
    v_lshl_add_u32 v5, v5, 8, v48
    v_bfe_u32 v50, v0, 3, 2
    v_lshl_add_u32 v5, v50, 2, v5
    s_lshl_b32 s36, s39, 9
    s_add_u32 s36, s36, 4096
    v_add_u32 v5, s36, v5
    v_mov_b32 v93, 0
    s_branch rec_m0_in
rec_m_loop:
    s_sleep 7
rec_m0:
    global_load_dwordx4 v[16:19], v1, s[28:29] sc1
    global_load_dwordx4 v[20:23], v1, s[28:29] offset:1024 sc1
    s_waitcnt vmcnt(0)
rec_m0_in:
    v_smfmac_f32_16x16x64_bf16 v[24:27], v[16:19], a[0:7], v2
    v_max3_u32 v0, v16, v17, v18
    v_max3_u32 v7, v19, v20, v21
    v_smfmac_f32_16x16x64_bf16 v[28:31], v[16:19], a[16:23], v2
    v_max3_u32 v0, v0, v22, v23
    v_max_u32 v0, v0, v7
    v_smfmac_f32_16x16x64_bf16 v[24:27], v[20:23], a[8:15], v2
    v_cmp_eq_u32 vcc, -1, v0
    s_cbranch_vccnz rec_m0_retry
    v_smfmac_f32_16x16x64_bf16 v[28:31], v[20:23], a[24:31], v2
    v_smfmac_f32_16x16x64_bf16 v[32:35], v[16:19], a[32:39], v2
    v_smfmac_f32_16x16x64_bf16 v[36:39], v[16:19], a[48:55], v2
    v_smfmac_f32_16x16x64_bf16 v[32:35], v[20:23], a[40:47], v2
    v_smfmac_f32_16x16x64_bf16 v[36:39], v[20:23], a[56:63], v2
    s_nop 3
    v_cvt_pk_bf16_f32 v24, v24, v25
    v_smfmac_f32_16x16x64_bf16 v[40:43], v[16:19], a[64:71], v2
    v_cvt_pk_bf16_f32 v25, v26, v27
    v_smfmac_f32_16x16x64_bf16 v[44:47], v[16:19], a[80:87], v2
    v_cvt_pk_bf16_f32 v26, v28, v29
    v_smfmac_f32_16x16x64_bf16 v[40:43], v[20:23], a[72:79], v2
    v_cvt_pk_bf16_f32 v27, v30, v31
    ds_write_b128 v3, v[24:27]
    v_smfmac_f32_16x16x64_bf16 v[44:47], v[20:23], a[88:95], v2
    v_cvt_pk_bf16_f32 v32, v32, v33
    v_cvt_pk_bf16_f32 v33, v34, v35
    v_cvt_pk_bf16_f32 v34, v36, v37
    v_cvt_pk_bf16_f32 v35, v38, v39
    ds_write_b128 v3, v[32:35] offset:1024
    s_nop 2
    v_cvt_pk_bf16_f32 v40, v40, v41
    v_cvt_pk_bf16_f32 v41, v42, v43
    v_cvt_pk_bf16_f32 v42, v44, v45
    v_cvt_pk_bf16_f32 v43, v46, v47
    ds_write_b128 v3, v[40:43] offset:2048
    s_waitcnt lgkmcnt(1)
    s_barrier
    s_waitcnt lgkmcnt(0)
    s_barrier
    ds_read_b128 v[48:51], v4 offset:0
    ds_read_b128 v[52:55], v4 offset:3072
    ds_read_b128 v[56:59], v4 offset:6144
    ds_read_b128 v[60:63], v4 offset:9216
    ds_read_b128 v[64:67], v4 offset:12288
    ds_read_b128 v[68:71], v4 offset:15360
    ds_read_b128 v[72:75], v4 offset:18432
    ds_read_b128 v[76:79], v4 offset:21504
    s_waitcnt lgkmcnt(7)
    v_mfma_f32_16x16x32_bf16 v[80:83], v[48:51], v[84:87], 0
    s_waitcnt lgkmcnt(6)
    v_mfma_f32_16x16x32_bf16 v[80:83], v[52:55], v[84:87], v[80:83]
    s_waitcnt lgkmcnt(5)
    v_mfma_f32_16x16x32_bf16 v[80:83], v[56:59], v[84:87], v[80:83]
    s_waitcnt lgkmcnt(4)
    v_mfma_f32_16x16x32_bf16 v[80:83], v[60:63], v[84:87], v[80:83]
    s_waitcnt lgkmcnt(3)
    v_mfma_f32_16x16x32_bf16 v[80:83], v[64:67], v[84:87], v[80:83]
    s_waitcnt lgkmcnt(2)
    v_mfma_f32_16x16x32_bf16 v[80:83], v[68:71], v[84:87], v[80:83]
    s_waitcnt lgkmcnt(1)
    v_mfma_f32_16x16x32_bf16 v[80:83], v[72:75], v[84:87], v[80:83]
    s_waitcnt lgkmcnt(0)
    v_mfma_f32_16x16x32_bf16 v[80:83], v[76:79], v[84:87], v[80:83]
    s_cmp_lt_u32 s23, 32
    s_nop 6
    v_cvt_pk_bf16_f32 v88, v80, v81
    v_cvt_pk_bf16_f32 v89, v82, v83
    v_and_b32 v90, -2, v88
    v_and_b32 v91, -2, v89
    s_cbranch_scc1 rec_m0_wt
    global_store_dword v5, v90, s[32:33]
    global_store_dword v5, v91, s[32:33] offset:128
rec_m0_pd:
    s_cmp_eq_u32 s22, 0
    s_cbranch_scc1 rec_m_first
rec_m_fj:
    v_min_u32 v88, -2, v88
    v_min_u32 v89, -2, v89
    s_waitcnt vmcnt(0)
    s_barrier
    global_store_dwordx2 v10, v[88:89], s[30:31] sc1
    s_cmp_eq_u32 s20, 0
    s_cbranch_scc0 rec_m0_pg
    v_mov_b32 v92, s22
    s_mov_b64 exec, 1
    global_store_dword v93, v92, s[14:15] offset:192 sc1
    s_mov_b64 exec, -1
rec_m0_pg:
    s_add_u32 s53, s22, 3
    s_min_u32 s53, s53, 63
    s_sub_u32 s36, s53, 16
    s_mul_i32 s36, s36, 43
    s_lshr_b32 s36, s36, 8
    s_add_u32 s36, s36, 4
    s_lshr_b32 s53, s53, 2
    s_cmp_lt_u32 s53, 4
    s_cselect_b32 s53, s53, s36
    s_cmp_lt_u32 s53, s51
    s_cbranch_scc1 rec_m0_kvh
    s_lshl_b32 s52, s53, 7
    s_lshr_b32 s36, s18, 1
    s_lshl_b32 s36, s36, 2
    s_add_u32 s52, s52, s36
    s_add_u32 s52, s52, 1978368
    v_mov_b32 v17, s52
rec_m0_kv:
    global_load_dword v16, v17, s[16:17] sc1
    global_load_dword v18, v17, s[16:17] offset:64 sc1
    s_waitcnt vmcnt(0)
    v_or_b32 v16, v16, v18
    v_cmp_ne_u32 vcc, 0, v16
    s_cbranch_vccz rec_m0_kvok
    s_sleep 4
    s_add_u32 s24, s24, 1
    s_cmp_lt_u32 s24, 400000
    s_cbranch_scc1 rec_m0_kv
    s_branch rec_fail
rec_m0_kvok:
    s_add_u32 s51, s53, 1
rec_m0_kvh:
    v_mov_b32 v24, 0
    v_mov_b32 v25, 0
    v_mov_b32 v26, 0
    v_mov_b32 v27, 0
    v_mov_b32 v28, 0
    v_mov_b32 v29, 0
    v_mov_b32 v30, 0
    v_mov_b32 v31, 0
    v_mov_b32 v32, 0
    v_mov_b32 v33, 0
    v_mov_b32 v34, 0
    v_mov_b32 v35, 0
    v_mov_b32 v36, 0
    v_mov_b32 v37, 0
    v_mov_b32 v38, 0
    v_mov_b32 v39, 0
    v_mov_b32 v40, 0
    v_mov_b32 v41, 0
    v_mov_b32 v42, 0
    v_mov_b32 v43, 0
    v_mov_b32 v44, 0
    v_mov_b32 v45, 0
    v_mov_b32 v46, 0
    v_mov_b32 v47, 0
    s_add_u32 s22, s22, 1
    s_add_u32 s28, s28, 0x8000
    s_addc_u32 s29, s29, 0
    s_add_u32 s38, s38, 0x40000
    s_lshr_b32 s36, s38, 21
    s_xor_b32 s36, s36, s25
    s_and_b32 s36, s36, 1
    s_lshl_b32 s36, s36, 13
    s_add_u32 s36, s36, s38
    s_add_u32 s30, s16, s36
    s_addc_u32 s31, s17, 0
    s_waitcnt vmcnt(0) lgkmcnt(0)
    s_barrier
    s_cmp_ge_u32 s22, 61
    s_cbranch_scc1 rec_m0_hp
rec_m0_hd:
    s_sleep 7
rec_m1:
    global_load_dwordx4 v[16:19], v1, s[28:29] sc1
    global_load_dwordx4 v[20:23], v1, s[28:29] offset:1024 sc1
    s_waitcnt vmcnt(0)
rec_m1_in:
    v_smfmac_f32_16x16x64_bf16 v[24:27], v[16:19], a[0:7], v2
    v_max3_u32 v0, v16, v17, v18
    v_max3_u32 v7, v19, v20, v21
    v_smfmac_f32_16x16x64_bf16 v[28:31], v[16:19], a[16:23], v2
    v_max3_u32 v0, v0, v22, v23
    v_max_u32 v0, v0, v7
    v_smfmac_f32_16x16x64_bf16 v[24:27], v[20:23], a[8:15], v2
    v_cmp_eq_u32 vcc, -1, v0
    s_cbranch_vccnz rec_m1_retry
    v_smfmac_f32_16x16x64_bf16 v[28:31], v[20:23], a[24:31], v2
    v_smfmac_f32_16x16x64_bf16 v[32:35], v[16:19], a[32:39], v2
    v_smfmac_f32_16x16x64_bf16 v[36:39], v[16:19], a[48:55], v2
    v_smfmac_f32_16x16x64_bf16 v[32:35], v[20:23], a[40:47], v2
    v_smfmac_f32_16x16x64_bf16 v[36:39], v[20:23], a[56:63], v2
    s_nop 3
    v_cvt_pk_bf16_f32 v24, v24, v25
    v_smfmac_f32_16x16x64_bf16 v[40:43], v[16:19], a[64:71], v2
    v_cvt_pk_bf16_f32 v25, v26, v27
    v_smfmac_f32_16x16x64_bf16 v[44:47], v[16:19], a[80:87], v2
    v_cvt_pk_bf16_f32 v26, v28, v29
    v_smfmac_f32_16x16x64_bf16 v[40:43], v[20:23], a[72:79], v2
    v_cvt_pk_bf16_f32 v27, v30, v31
    ds_write_b128 v3, v[24:27]
    v_smfmac_f32_16x16x64_bf16 v[44:47], v[20:23], a[88:95], v2
    v_cvt_pk_bf16_f32 v32, v32, v33
    v_cvt_pk_bf16_f32 v33, v34, v35
    v_cvt_pk_bf16_f32 v34, v36, v37
    v_cvt_pk_bf16_f32 v35, v38, v39
    ds_write_b128 v3, v[32:35] offset:1024
    s_nop 2
    v_cvt_pk_bf16_f32 v40, v40, v41
    v_cvt_pk_bf16_f32 v41, v42, v43
    v_cvt_pk_bf16_f32 v42, v44, v45
    v_cvt_pk_bf16_f32 v43, v46, v47
    ds_write_b128 v3, v[40:43] offset:2048
    s_waitcnt lgkmcnt(1)
    s_barrier
    s_waitcnt lgkmcnt(0)
    s_barrier
    ds_read_b128 v[48:51], v4 offset:0
    ds_read_b128 v[52:55], v4 offset:3072
    ds_read_b128 v[56:59], v4 offset:6144
    ds_read_b128 v[60:63], v4 offset:9216
    ds_read_b128 v[64:67], v4 offset:12288
    ds_read_b128 v[68:71], v4 offset:15360
    ds_read_b128 v[72:75], v4 offset:18432
    ds_read_b128 v[76:79], v4 offset:21504
    s_waitcnt lgkmcnt(7)
    v_mfma_f32_16x16x32_bf16 v[80:83], v[48:51], v[84:87], 0
    s_waitcnt lgkmcnt(6)
    v_mfma_f32_16x16x32_bf16 v[80:83], v[52:55], v[84:87], v[80:83]
    s_waitcnt lgkmcnt(5)
    v_mfma_f32_16x16x32_bf16 v[80:83], v[56:59], v[84:87], v[80:83]
    s_waitcnt lgkmcnt(4)
    v_mfma_f32_16x16x32_bf16 v[80:83], v[60:63], v[84:87], v[80:83]
    s_waitcnt lgkmcnt(3)
    v_mfma_f32_16x16x32_bf16 v[80:83], v[64:67], v[84:87], v[80:83]
    s_waitcnt lgkmcnt(2)
    v_mfma_f32_16x16x32_bf16 v[80:83], v[68:71], v[84:87], v[80:83]
    s_waitcnt lgkmcnt(1)
    v_mfma_f32_16x16x32_bf16 v[80:83], v[72:75], v[84:87], v[80:83]
    s_waitcnt lgkmcnt(0)
    v_mfma_f32_16x16x32_bf16 v[80:83], v[76:79], v[84:87], v[80:83]
    s_cmp_eq_u32 s22, 63
    s_cbranch_scc1 rec_fin_m
    s_cmp_lt_u32 s23, 32
    s_nop 4
    v_cvt_pk_bf16_f32 v88, v80, v81
    v_cvt_pk_bf16_f32 v89, v82, v83
    v_or_b32 v90, 1, v88
    v_or_b32 v91, 1, v89
    s_cbranch_scc1 rec_m1_wt
    global_store_dword v5, v90, s[32:33]
    global_store_dword v5, v91, s[32:33] offset:128
rec_m1_pd:
    v_min_u32 v88, -2, v88
    v_min_u32 v89, -2, v89
    s_waitcnt vmcnt(0)
    s_barrier
    global_store_dwordx2 v10, v[88:89], s[30:31] sc1
    s_cmp_eq_u32 s20, 0
    s_cbranch_scc0 rec_m1_pg
    v_mov_b32 v92, s22
    s_mov_b64 exec, 1
    global_store_dword v93, v92, s[14:15] offset:192 sc1
    s_mov_b64 exec, -1
rec_m1_pg:
    s_add_u32 s53, s22, 3
    s_min_u32 s53, s53, 63
    s_sub_u32 s36, s53, 16
    s_mul_i32 s36, s36, 43
    s_lshr_b32 s36, s36, 8
    s_add_u32 s36, s36, 4
    s_lshr_b32 s53, s53, 2
    s_cmp_lt_u32 s53, 4
    s_cselect_b32 s53, s53, s36
    s_cmp_lt_u32 s53, s51
    s_cbranch_scc1 rec_m1_kvh
    s_lshl_b32 s52, s53, 7
    s_lshr_b32 s36, s18, 1
    s_lshl_b32 s36, s36, 2
    s_add_u32 s52, s52, s36
    s_add_u32 s52, s52, 1978368
    v_mov_b32 v17, s52
rec_m1_kv:
    global_load_dword v16, v17, s[16:17] sc1
    global_load_dword v18, v17, s[16:17] offset:64 sc1
    s_waitcnt vmcnt(0)
    v_or_b32 v16, v16, v18
    v_cmp_ne_u32 vcc, 0, v16
    s_cbranch_vccz rec_m1_kvok
    s_sleep 4
    s_add_u32 s24, s24, 1
    s_cmp_lt_u32 s24, 400000
    s_cbranch_scc1 rec_m1_kv
    s_branch rec_fail
rec_m1_kvok:
    s_add_u32 s51, s53, 1
rec_m1_kvh:
    v_mov_b32 v24, 0
    v_mov_b32 v25, 0
    v_mov_b32 v26, 0
    v_mov_b32 v27, 0
    v_mov_b32 v28, 0
    v_mov_b32 v29, 0
    v_mov_b32 v30, 0
    v_mov_b32 v31, 0
    v_mov_b32 v32, 0
    v_mov_b32 v33, 0
    v_mov_b32 v34, 0
    v_mov_b32 v35, 0
    v_mov_b32 v36, 0
    v_mov_b32 v37, 0
    v_mov_b32 v38, 0
    v_mov_b32 v39, 0
    v_mov_b32 v40, 0
    v_mov_b32 v41, 0
    v_mov_b32 v42, 0
    v_mov_b32 v43, 0
    v_mov_b32 v44, 0
    v_mov_b32 v45, 0
    v_mov_b32 v46, 0
    v_mov_b32 v47, 0
    s_add_u32 s22, s22, 1
    s_add_u32 s28, s28, 0x8000
    s_addc_u32 s29, s29, 0
    s_add_u32 s38, s38, 0x40000
    s_lshr_b32 s36, s38, 21
    s_xor_b32 s36, s36, s25
    s_and_b32 s36, s36, 1
    s_lshl_b32 s36, s36, 13
    s_add_u32 s36, s36, s38
    s_add_u32 s30, s16, s36
    s_addc_u32 s31, s17, 0
    s_waitcnt vmcnt(0) lgkmcnt(0)
    s_barrier
    s_cmp_ge_u32 s22, 61
    s_cbranch_scc1 rec_m1_hp
rec_m1_hd:
    s_branch rec_m_loop
rec_m0_retry:
    s_nop 7
    v_mov_b32 v24, 0
    v_mov_b32 v25, 0
    v_mov_b32 v26, 0
    v_mov_b32 v27, 0
    v_mov_b32 v28, 0
    v_mov_b32 v29, 0
    v_mov_b32 v30, 0
    v_mov_b32 v31, 0
    s_add_u32 s24, s24, 1
    s_cmp_lt_u32 s24, 400000
    s_cbranch_scc1 rec_m0
    s_branch rec_fail
rec_m0_wt:
    global_store_dword v5, v90, s[32:33] sc1
    global_store_dword v5, v91, s[32:33] offset:128 sc1
    s_branch rec_m0_pd
rec_m0_hp:
    s_sub_u32 s36, s22, 1
    v_mov_b32 v95, s36
    s_xor_b32 s36, s25, 1
    s_lshl_b32 s36, s36, 13
    s_add_u32 s36, s36, s45
    s_add_u32 s36, s36, 1441792
    v_mov_b32 v94, s36
    s_mov_b64 exec, 1
    global_store_dword v94, v95, s[16:17] sc1
    s_mov_b64 exec, -1
    s_branch rec_m0_hd
rec_m1_retry:
    s_nop 7
    v_mov_b32 v24, 0
    v_mov_b32 v25, 0
    v_mov_b32 v26, 0
    v_mov_b32 v27, 0
    v_mov_b32 v28, 0
    v_mov_b32 v29, 0
    v_mov_b32 v30, 0
    v_mov_b32 v31, 0
    s_add_u32 s24, s24, 1
    s_cmp_lt_u32 s24, 400000
    s_cbranch_scc1 rec_m1
    s_branch rec_fail
rec_m1_wt:
    global_store_dword v5, v90, s[32:33] sc1
    global_store_dword v5, v91, s[32:33] offset:128 sc1
    s_branch rec_m1_pd
rec_m1_hp:
    s_sub_u32 s36, s22, 1
    v_mov_b32 v95, s36
    s_xor_b32 s36, s25, 1
    s_lshl_b32 s36, s36, 13
    s_add_u32 s36, s36, s45
    s_add_u32 s36, s36, 1441792
    v_mov_b32 v94, s36
    s_mov_b64 exec, 1
    global_store_dword v94, v95, s[16:17] sc1
    s_mov_b64 exec, -1
    s_branch rec_m1_hd
rec_m_first:
    s_mov_b32 s53, 0
    s_lshl_b32 s52, s53, 7
    s_lshr_b32 s36, s18, 1
    s_lshl_b32 s36, s36, 2
    s_add_u32 s52, s52, s36
    s_add_u32 s52, s52, 1978368
    v_mov_b32 v17, s52
rec_kv0:
    global_load_dword v16, v17, s[16:17] sc1
    global_load_dword v18, v17, s[16:17] offset:64 sc1
    s_waitcnt vmcnt(0)
    v_or_b32 v16, v16, v18
    v_cmp_ne_u32 vcc, 0, v16
    s_cbranch_vccz rec_kv0ok
    s_sleep 4
    s_add_u32 s24, s24, 1
    s_cmp_lt_u32 s24, 400000
    s_cbranch_scc1 rec_kv0
    s_branch rec_fail
rec_kv0ok:
    s_mov_b32 s53, 0
    s_lshl_b32 s42, s53, 5
    s_add_u32 s42, s42, s18
    s_lshl_b32 s42, s42, 14
    s_add_u32 s42, s42, 20971520
    s_lshr_b32 s36, s42, 21
    s_xor_b32 s36, s36, s25
    s_xor_b32 s36, s36, 1
    s_and_b32 s36, s36, 1
    s_lshl_b32 s36, s36, 13
    s_add_u32 s36, s36, s42
    s_add_u32 s48, s16, s36
    s_addc_u32 s49, s17, 0
    s_add_u32 s34, s48, 33554432
    s_addc_u32 s35, s49, 0
    s_mov_b32 s50, 147456
    s_add_u32 m0, s50, 0
    s_nop 0
    global_load_lds_dwordx4 v14, s[34:35] offset:0 sc1
    global_load_lds_dwordx4 v14, s[34:35] offset:1024 sc1
    global_load_lds_dwordx4 v14, s[34:35] offset:2048 sc1
    global_load_lds_dwordx4 v14, s[34:35] offset:3072 sc1
    s_add_u32 m0, s50, 4096
    s_nop 0
    global_load_lds_dwordx4 v15, s[34:35] offset:0 sc1
    global_load_lds_dwordx4 v15, s[34:35] offset:1024 sc1
    global_load_lds_dwordx4 v15, s[34:35] offset:2048 sc1
    global_load_lds_dwordx4 v15, s[34:35] offset:3072 sc1
    s_mov_b32 s50, 131072
    s_add_u32 m0, s50, 0
    s_nop 0
    global_load_lds_dwordx4 v14, s[48:49] offset:0 sc1
    global_load_lds_dwordx4 v14, s[48:49] offset:1024 sc1
    global_load_lds_dwordx4 v14, s[48:49] offset:2048 sc1
    global_load_lds_dwordx4 v14, s[48:49] offset:3072 sc1
    s_add_u32 m0, s50, 4096
    s_nop 0
    global_load_lds_dwordx4 v15, s[48:49] offset:0 sc1
    global_load_lds_dwordx4 v15, s[48:49] offset:1024 sc1
    global_load_lds_dwordx4 v15, s[48:49] offset:2048 sc1
    global_load_lds_dwordx4 v15, s[48:49] offset:3072 sc1
    s_mov_b32 s53, 1
    s_lshl_b32 s42, s53, 5
    s_add_u32 s42, s42, s18
    s_lshl_b32 s42, s42, 14
    s_add_u32 s42, s42, 20971520
    s_lshr_b32 s36, s42, 21
    s_xor_b32 s36, s36, s25
    s_xor_b32 s36, s36, 1
    s_and_b32 s36, s36, 1
    s_lshl_b32 s36, s36, 13
    s_add_u32 s36, s36, s42
    s_add_u32 s48, s16, s36
    s_addc_u32 s49, s17, 0
    s_add_u32 s34, s48, 33554432
    s_addc_u32 s35, s49, 0
    s_mov_b32 s50, 155648
    s_add_u32 m0, s50, 0
    s_nop 0
    global_load_lds_dwordx4 v14, s[34:35] offset:0 sc1
    global_load_lds_dwordx4 v14, s[34:35] offset:1024 sc1
    global_load_lds_dwordx4 v14, s[34:35] offset:2048 sc1
    global_load_lds_dwordx4 v14, s[34:35] offset:3072 sc1
    s_add_u32 m0, s50, 4096
    s_nop 0
    global_load_lds_dwordx4 v15, s[34:35] offset:0 sc1
    global_load_lds_dwordx4 v15, s[34:35] offset:1024 sc1
    global_load_lds_dwordx4 v15, s[34:35] offset:2048 sc1
    global_load_lds_dwordx4 v15, s[34:35] offset:3072 sc1
    s_mov_b32 s50, 139264
    s_add_u32 m0, s50, 0
    s_nop 0
    global_load_lds_dwordx4 v14, s[48:49] offset:0 sc1
    global_load_lds_dwordx4 v14, s[48:49] offset:1024 sc1
    global_load_lds_dwordx4 v14, s[48:49] offset:2048 sc1
    global_load_lds_dwordx4 v14, s[48:49] offset:3072 sc1
    s_add_u32 m0, s50, 4096
    s_nop 0
    global_load_lds_dwordx4 v15, s[48:49] offset:0 sc1
    global_load_lds_dwordx4 v15, s[48:49] offset:1024 sc1
    global_load_lds_dwordx4 v15, s[48:49] offset:2048 sc1
    global_load_lds_dwordx4 v15, s[48:49] offset:3072 sc1
    s_waitcnt vmcnt(16)
    s_barrier
    s_barrier
    s_waitcnt vmcnt(0)
    s_branch rec_m_fj
rec_fin_m:
    s_nop 7
    v_cvt_pk_bf16_f32 v88, v80, v81
    v_cvt_pk_bf16_f32 v89, v82, v83
    v_min_u32 v88, -2, v88
    v_min_u32 v89, -2, v89
    global_store_dwordx2 v10, v[88:89], s[30:31] sc1
    s_cmp_eq_u32 s20, 0
    s_cbranch_scc0 rec_pg_last
    v_mov_b32 v92, s22
    s_mov_b64 exec, 1
    global_store_dword v93, v92, s[14:15] offset:192 sc1
    s_mov_b64 exec, -1
rec_pg_last:
    s_branch rec_fin
rec_setup_sm:
    v_add_u32 v14, 131072, v6
    v_and_b32 v48, 7, v0
    v_lshrrev_b32 v49, 4, v0
    v_lshl_add_u32 v9, v49, 3, v48
    v_lshlrev_b32 v9, 4, v9
    v_and_b32 v50, 8, v0
    v_add_u32 v9, v9, v50
    v_and_b32 v49, 1, v49
    v_lshl_add_u32 v10, v49, 3, v48
    v_lshlrev_b32 v10, 4, v10
    v_lshrrev_b32 v49, 5, v0
    v_lshl_add_u32 v10, v49, 2, v10
    v_lshrrev_b32 v50, 2, v50
    v_add_u32 v10, v10, v50
    s_mov_b32 s46, 0x3e0293ee
    v_mov_b32 v84, 0
    v_mov_b32 v85, 0
    v_mov_b32 v86, 0
    v_mov_b32 v87, 0
    ds_write_b128 v6, v[84:87] offset:26624
    ds_write_b128 v6, v[84:87] offset:27648
    v_mov_b32 v24, 0
    v_mov_b32 v25, 0
    v_mov_b32 v26, 0
    v_mov_b32 v27, 0
    v_mov_b32 v28, 0
    v_mov_b32 v29, 0
    v_mov_b32 v30, 0
    v_mov_b32 v31, 0
    v_mov_b32 v32, 0
    v_mov_b32 v33, 0
    v_mov_b32 v34, 0
    v_mov_b32 v35, 0
    v_mov_b32 v36, 0
    v_mov_b32 v37, 0
    v_mov_b32 v38, 0
    v_mov_b32 v39, 0
    v_mov_b32 v40, 0
    v_mov_b32 v41, 0
    v_mov_b32 v42, 0
    v_mov_b32 v43, 0
    v_mov_b32 v44, 0
    v_mov_b32 v45, 0
    v_mov_b32 v46, 0
    v_mov_b32 v47, 0
    s_setprio 2
    s_branch rec_s0_in
rec_s_loop:
    s_sleep 7
rec_s0:
    global_load_dwordx4 v[16:19], v1, s[28:29] sc1
    global_load_dwordx4 v[20:23], v1, s[28:29] offset:1024 sc1
    s_waitcnt vmcnt(0)
rec_s0_in:
    v_smfmac_f32_16x16x64_bf16 v[24:27], v[16:19], a[0:7], v2
    v_max3_u32 v0, v16, v17, v18
    v_max3_u32 v7, v19, v20, v21
    v_smfmac_f32_16x16x64_bf16 v[28:31], v[16:19], a[16:23], v2
    v_max3_u32 v0, v0, v22, v23
    v_max_u32 v0, v0, v7
    v_smfmac_f32_16x16x64_bf16 v[24:27], v[20:23], a[8:15], v2
    v_cmp_eq_u32 vcc, -1, v0
    s_cbranch_vccnz rec_s0_retry
    v_smfmac_f32_16x16x64_bf16 v[28:31], v[20:23], a[24:31], v2
    v_smfmac_f32_16x16x64_bf16 v[32:35], v[16:19], a[32:39], v2
    v_smfmac_f32_16x16x64_bf16 v[36:39], v[16:19], a[48:55], v2
    v_smfmac_f32_16x16x64_bf16 v[32:35], v[20:23], a[40:47], v2
    v_smfmac_f32_16x16x64_bf16 v[36:39], v[20:23], a[56:63], v2
    s_nop 3
    v_cvt_pk_bf16_f32 v24, v24, v25
    v_smfmac_f32_16x16x64_bf16 v[40:43], v[16:19], a[64:71], v2
    v_cvt_pk_bf16_f32 v25, v26, v27
    v_smfmac_f32_16x16x64_bf16 v[44:47], v[16:19], a[80:87], v2
    v_cvt_pk_bf16_f32 v26, v28, v29
    v_smfmac_f32_16x16x64_bf16 v[40:43], v[20:23], a[72:79], v2
    v_cvt_pk_bf16_f32 v27, v30, v31
    ds_write_b128 v3, v[24:27]
    v_smfmac_f32_16x16x64_bf16 v[44:47], v[20:23], a[88:95], v2
    v_cvt_pk_bf16_f32 v32, v32, v33
    v_cvt_pk_bf16_f32 v33, v34, v35
    v_cvt_pk_bf16_f32 v34, v36, v37
    v_cvt_pk_bf16_f32 v35, v38, v39
    ds_write_b128 v3, v[32:35] offset:1024
    s_nop 2
    v_cvt_pk_bf16_f32 v40, v40, v41
    v_cvt_pk_bf16_f32 v41, v42, v43
    v_cvt_pk_bf16_f32 v42, v44, v45
    v_cvt_pk_bf16_f32 v43, v46, v47
    ds_write_b128 v3, v[40:43] offset:2048
    s_waitcnt lgkmcnt(1)
    s_barrier
    s_waitcnt lgkmcnt(0)
    s_barrier
    s_cmp_eq_u32 s22, 0
    s_cbranch_scc1 rec_s_first
    s_sleep 7
rec_s_fj:
    global_load_dwordx4 v[48:51], v6, s[32:33] offset:0 sc1
    global_load_dwordx4 v[52:55], v6, s[32:33] offset:1024 sc1
    global_load_dwordx4 v[56:59], v6, s[32:33] offset:2048 sc1
    global_load_dwordx4 v[60:63], v6, s[32:33] offset:3072 sc1
    s_sleep 1
rec_s0_xp:
    global_load_dwordx4 v[128:131], v6, s[32:33] offset:0 sc1
    global_load_dwordx4 v[132:135], v6, s[32:33] offset:1024 sc1
    global_load_dwordx4 v[136:139], v6, s[32:33] offset:2048 sc1
    global_load_dwordx4 v[140:143], v6, s[32:33] offset:3072 sc1
    s_waitcnt vmcnt(4)
    v_mfma_f32_16x16x32_bf16 v[72:75], v[48:51], v[48:51], 0
    v_bitop3_b32 v15, v48, v49, v50 bitop3:0xfe
    v_bitop3_b32 v16, v51, v52, v53 bitop3:0xfe
    v_mfma_f32_16x16x32_bf16 v[72:75], v[52:55], v[52:55], v[72:75]
    v_bitop3_b32 v15, v15, v54, v55 bitop3:0xfe
    v_bitop3_b32 v16, v16, v56, v57 bitop3:0xfe
    v_mfma_f32_16x16x32_bf16 v[72:75], v[56:59], v[56:59], v[72:75]
    v_bitop3_b32 v15, v15, v58, v59 bitop3:0xfe
    v_bitop3_b32 v16, v16, v60, v61 bitop3:0xfe
    v_mfma_f32_16x16x32_bf16 v[72:75], v[60:63], v[60:63], v[72:75]
    v_bitop3_b32 v15, v15, v62, v63 bitop3:0xfe
    v_bitop3_b32 v15, v15, v16, 1 bitop3:0xa8
    v_cmp_ne_u32 vcc, 0, v15
    s_cbranch_vccnz rec_s0_xr
    v_mfma_f32_16x16x32_bf16 v[68:71], v[112:115], v[48:51], 0
    v_mfma_f32_16x16x32_bf16 v[68:71], v[116:119], v[52:55], v[68:71]
    v_mfma_f32_16x16x32_bf16 v[68:71], v[120:123], v[56:59], v[68:71]
    v_mfma_f32_16x16x32_bf16 v[68:71], v[124:127], v[60:63], v[68:71]
    v_mfma_f32_16x16x32_bf16 v[64:67], v[96:99], v[48:51], 0
    v_mov_b32_dpp v72, v73 row_shr:8 row_mask:0xf bank_mask:0xc
    v_mov_b32_dpp v74, v75 row_shr:8 row_mask:0xf bank_mask:0xc
    v_mfma_f32_16x16x32_bf16 v[64:67], v[100:103], v[52:55], v[64:67]
    v_mfma_f32_16x16x32_bf16 v[64:67], v[104:107], v[56:59], v[64:67]
    v_permlane32_swap_b32 v72, v74
    v_mfma_f32_16x16x32_bf16 v[64:67], v[108:111], v[60:63], v[64:67]
rec_s0_xj:
    s_nop 0
    v_max_f32_dpp v16, v74, v74 row_ror:8 row_mask:0xf bank_mask:0xf
    v_max3_f32 v16, v16, v68, v69
    v_max3_f32 v16, v16, v70, v71
    s_nop 3
    v_max3_f32 v16, v16, v64, v65
    v_max3_f32 v16, v16, v66, v67
    v_mov_b32 v17, v16
    v_mov_b32_dpp v64, v68 row_shr:8 row_mask:0xf bank_mask:0xc
    v_mov_b32_dpp v65, v69 row_shr:8 row_mask:0xf bank_mask:0xc
    v_permlane16_swap_b32 v16, v17
    v_max_f32 v16, v16, v17
    v_mov_b32 v17, v16
    v_mov_b32_dpp v66, v70 row_shr:8 row_mask:0xf bank_mask:0xc
    v_mov_b32_dpp v67, v71 row_shr:8 row_mask:0xf bank_mask:0xc
    v_permlane32_swap_b32 v16, v17
    v_max_f32 v16, v16, v17
    v_mul_f32 v16, s46, v16
    s_nop 1
    v_mov_b32_dpp v16, v16 row_shr:8 row_mask:0xf bank_mask:0xc
    v_fma_f32 v74, v74, s46, -v16
    v_fma_f32 v64, v64, s46, -v16
    v_fma_f32 v65, v65, s46, -v16
    v_fma_f32 v66, v66, s46, -v16
    v_fma_f32 v67, v67, s46, -v16
    v_exp_f32 v74, v74
    v_exp_f32 v64, v64
    v_cvt_pk_bf16_f32 v82, v74, v74
    v_exp_f32 v65, v65
    ds_write_b16 v10, v82 offset:25600
    v_exp_f32 v66, v66
    ds_write_b16 v10, v82 offset:25856
    v_exp_f32 v67, v67
    v_cvt_pk_bf16_f32 v80, v64, v65
    v_cvt_pk_bf16_f32 v81, v66, v67
    ds_write_b64 v9, v[80:81] offset:24576
    s_waitcnt lgkmcnt(0)
    s_barrier
    ds_read_b128 v[96:99], v14 offset:0
    ds_read_b128 v[100:103], v14 offset:1024
    ds_read_b128 v[104:107], v14 offset:2048
    ds_read_b128 v[108:111], v14 offset:3072
    ds_read_b128 v[112:115], v14 offset:4096
    ds_read_b128 v[116:119], v14 offset:5120
    ds_read_b128 v[120:123], v14 offset:6144
    ds_read_b128 v[124:127], v14 offset:7168
    v_xor_b32 v14, 0x2000, v14
    v_mov_b32 v24, 0
    v_mov_b32 v25, 0
    v_mov_b32 v26, 0
    v_mov_b32 v27, 0
    v_mov_b32 v28, 0
    v_mov_b32 v29, 0
    v_mov_b32 v30, 0
    v_mov_b32 v31, 0
    v_mov_b32 v32, 0
    v_mov_b32 v33, 0
    v_mov_b32 v34, 0
    v_mov_b32 v35, 0
    v_mov_b32 v36, 0
    v_mov_b32 v37, 0
    v_mov_b32 v38, 0
    v_mov_b32 v39, 0
    v_mov_b32 v40, 0
    v_mov_b32 v41, 0
    v_mov_b32 v42, 0
    v_mov_b32 v43, 0
    v_mov_b32 v44, 0
    v_mov_b32 v45, 0
    v_mov_b32 v46, 0
    v_mov_b32 v47, 0
    s_add_u32 s22, s22, 1
    s_add_u32 s28, s28, 0x8000
    s_addc_u32 s29, s29, 0
    s_add_u32 s38, s38, 0x40000
    s_lshr_b32 s36, s38, 21
    s_xor_b32 s36, s36, s25
    s_and_b32 s36, s36, 1
    s_lshl_b32 s36, s36, 13
    s_add_u32 s36, s36, s38
    s_add_u32 s30, s16, s36
    s_addc_u32 s31, s17, 0
    s_waitcnt vmcnt(0) lgkmcnt(0)
    s_barrier
    s_sleep 7
rec_s1:
    global_load_dwordx4 v[16:19], v1, s[28:29] sc1
    global_load_dwordx4 v[20:23], v1, s[28:29] offset:1024 sc1
    s_waitcnt vmcnt(0)
rec_s1_in:
    v_smfmac_f32_16x16x64_bf16 v[24:27], v[16:19], a[0:7], v2
    v_max3_u32 v0, v16, v17, v18
    v_max3_u32 v7, v19, v20, v21
    v_smfmac_f32_16x16x64_bf16 v[28:31], v[16:19], a[16:23], v2
    v_max3_u32 v0, v0, v22, v23
    v_max_u32 v0, v0, v7
    v_smfmac_f32_16x16x64_bf16 v[24:27], v[20:23], a[8:15], v2
    v_cmp_eq_u32 vcc, -1, v0
    s_cbranch_vccnz rec_s1_retry
    v_smfmac_f32_16x16x64_bf16 v[28:31], v[20:23], a[24:31], v2
    v_smfmac_f32_16x16x64_bf16 v[32:35], v[16:19], a[32:39], v2
    v_smfmac_f32_16x16x64_bf16 v[36:39], v[16:19], a[48:55], v2
    v_smfmac_f32_16x16x64_bf16 v[32:35], v[20:23], a[40:47], v2
    v_smfmac_f32_16x16x64_bf16 v[36:39], v[20:23], a[56:63], v2
    s_nop 3
    v_cvt_pk_bf16_f32 v24, v24, v25
    v_smfmac_f32_16x16x64_bf16 v[40:43], v[16:19], a[64:71], v2
    v_cvt_pk_bf16_f32 v25, v26, v27
    v_smfmac_f32_16x16x64_bf16 v[44:47], v[16:19], a[80:87], v2
    v_cvt_pk_bf16_f32 v26, v28, v29
    v_smfmac_f32_16x16x64_bf16 v[40:43], v[20:23], a[72:79], v2
    v_cvt_pk_bf16_f32 v27, v30, v31
    ds_write_b128 v3, v[24:27]
    v_smfmac_f32_16x16x64_bf16 v[44:47], v[20:23], a[88:95], v2
    v_cvt_pk_bf16_f32 v32, v32, v33
    v_cvt_pk_bf16_f32 v33, v34, v35
    v_cvt_pk_bf16_f32 v34, v36, v37
    v_cvt_pk_bf16_f32 v35, v38, v39
    ds_write_b128 v3, v[32:35] offset:1024
    s_nop 2
    v_cvt_pk_bf16_f32 v40, v40, v41
    v_cvt_pk_bf16_f32 v41, v42, v43
    v_cvt_pk_bf16_f32 v42, v44, v45
    v_cvt_pk_bf16_f32 v43, v46, v47
    ds_write_b128 v3, v[40:43] offset:2048
    s_waitcnt lgkmcnt(1)
    s_barrier
    s_waitcnt lgkmcnt(0)
    s_barrier
    s_cmp_eq_u32 s22, 63
    s_cbranch_scc1 rec_fin
    s_sleep 7
    global_load_dwordx4 v[48:51], v6, s[32:33] offset:0 sc1
    global_load_dwordx4 v[52:55], v6, s[32:33] offset:1024 sc1
    global_load_dwordx4 v[56:59], v6, s[32:33] offset:2048 sc1
    global_load_dwordx4 v[60:63], v6, s[32:33] offset:3072 sc1
    s_sleep 1
rec_s1_xp:
    global_load_dwordx4 v[128:131], v6, s[32:33] offset:0 sc1
    global_load_dwordx4 v[132:135], v6, s[32:33] offset:1024 sc1
    global_load_dwordx4 v[136:139], v6, s[32:33] offset:2048 sc1
    global_load_dwordx4 v[140:143], v6, s[32:33] offset:3072 sc1
    s_waitcnt vmcnt(4)
    v_mfma_f32_16x16x32_bf16 v[72:75], v[48:51], v[48:51], 0
    v_bitop3_b32 v15, v48, v49, v50 bitop3:0x80
    v_bitop3_b32 v16, v51, v52, v53 bitop3:0x80
    v_mfma_f32_16x16x32_bf16 v[72:75], v[52:55], v[52:55], v[72:75]
    v_bitop3_b32 v15, v15, v54, v55 bitop3:0x80
    v_bitop3_b32 v16, v16, v56, v57 bitop3:0x80
    v_mfma_f32_16x16x32_bf16 v[72:75], v[56:59], v[56:59], v[72:75]
    v_bitop3_b32 v15, v15, v58, v59 bitop3:0x80
    v_bitop3_b32 v16, v16, v60, v61 bitop3:0x80
    v_mfma_f32_16x16x32_bf16 v[72:75], v[60:63], v[60:63], v[72:75]
    v_bitop3_b32 v15, v15, v62, v63 bitop3:0x80
    v_bitop3_b32 v15, v15, v16, 1 bitop3:0x80
    v_cmp_ne_u32 vcc, 1, v15
    s_cbranch_vccnz rec_s1_xr
    v_mfma_f32_16x16x32_bf16 v[68:71], v[112:115], v[48:51], 0
    v_mfma_f32_16x16x32_bf16 v[68:71], v[116:119], v[52:55], v[68:71]
    v_mfma_f32_16x16x32_bf16 v[68:71], v[120:123], v[56:59], v[68:71]
    v_mfma_f32_16x16x32_bf16 v[68:71], v[124:127], v[60:63], v[68:71]
    v_mfma_f32_16x16x32_bf16 v[64:67], v[96:99], v[48:51], 0
    v_mov_b32_dpp v72, v73 row_shr:8 row_mask:0xf bank_mask:0xc
    v_mov_b32_dpp v74, v75 row_shr:8 row_mask:0xf bank_mask:0xc
    v_mfma_f32_16x16x32_bf16 v[64:67], v[100:103], v[52:55], v[64:67]
    v_mfma_f32_16x16x32_bf16 v[64:67], v[104:107], v[56:59], v[64:67]
    v_permlane32_swap_b32 v72, v74
    v_mfma_f32_16x16x32_bf16 v[64:67], v[108:111], v[60:63], v[64:67]
rec_s1_xj:
    s_nop 0
    v_max_f32_dpp v16, v74, v74 row_ror:8 row_mask:0xf bank_mask:0xf
    v_max3_f32 v16, v16, v68, v69
    v_max3_f32 v16, v16, v70, v71
    s_nop 3
    v_max3_f32 v16, v16, v64, v65
    v_max3_f32 v16, v16, v66, v67
    v_mov_b32 v17, v16
    v_mov_b32_dpp v64, v68 row_shr:8 row_mask:0xf bank_mask:0xc
    v_mov_b32_dpp v65, v69 row_shr:8 row_mask:0xf bank_mask:0xc
    v_permlane16_swap_b32 v16, v17
    v_max_f32 v16, v16, v17
    v_mov_b32 v17, v16
    v_mov_b32_dpp v66, v70 row_shr:8 row_mask:0xf bank_mask:0xc
    v_mov_b32_dpp v67, v71 row_shr:8 row_mask:0xf bank_mask:0xc
    v_permlane32_swap_b32 v16, v17
    v_max_f32 v16, v16, v17
    v_mul_f32 v16, s46, v16
    s_nop 1
    v_mov_b32_dpp v16, v16 row_shr:8 row_mask:0xf bank_mask:0xc
    v_fma_f32 v74, v74, s46, -v16
    v_fma_f32 v64, v64, s46, -v16
    v_fma_f32 v65, v65, s46, -v16
    v_fma_f32 v66, v66, s46, -v16
    v_fma_f32 v67, v67, s46, -v16
    v_exp_f32 v74, v74
    v_exp_f32 v64, v64
    v_cvt_pk_bf16_f32 v82, v74, v74
    v_exp_f32 v65, v65
    ds_write_b16 v10, v82 offset:25600
    v_exp_f32 v66, v66
    ds_write_b16 v10, v82 offset:25856
    v_exp_f32 v67, v67
    v_cvt_pk_bf16_f32 v80, v64, v65
    v_cvt_pk_bf16_f32 v81, v66, v67
    ds_write_b64 v9, v[80:81] offset:24576
    s_waitcnt lgkmcnt(0)
    s_barrier
    ds_read_b128 v[96:99], v14 offset:0
    ds_read_b128 v[100:103], v14 offset:1024
    ds_read_b128 v[104:107], v14 offset:2048
    ds_read_b128 v[108:111], v14 offset:3072
    ds_read_b128 v[112:115], v14 offset:4096
    ds_read_b128 v[116:119], v14 offset:5120
    ds_read_b128 v[120:123], v14 offset:6144
    ds_read_b128 v[124:127], v14 offset:7168
    v_xor_b32 v14, 0x2000, v14
    v_mov_b32 v24, 0
    v_mov_b32 v25, 0
    v_mov_b32 v26, 0
    v_mov_b32 v27, 0
    v_mov_b32 v28, 0
    v_mov_b32 v29, 0
    v_mov_b32 v30, 0
    v_mov_b32 v31, 0
    v_mov_b32 v32, 0
    v_mov_b32 v33, 0
    v_mov_b32 v34, 0
    v_mov_b32 v35, 0
    v_mov_b32 v36, 0
    v_mov_b32 v37, 0
    v_mov_b32 v38, 0
    v_mov_b32 v39, 0
    v_mov_b32 v40, 0
    v_mov_b32 v41, 0
    v_mov_b32 v42, 0
    v_mov_b32 v43, 0
    v_mov_b32 v44, 0
    v_mov_b32 v45, 0
    v_mov_b32 v46, 0
    v_mov_b32 v47, 0
    s_add_u32 s22, s22, 1
    s_add_u32 s28, s28, 0x8000
    s_addc_u32 s29, s29, 0
    s_add_u32 s38, s38, 0x40000
    s_lshr_b32 s36, s38, 21
    s_xor_b32 s36, s36, s25
    s_and_b32 s36, s36, 1
    s_lshl_b32 s36, s36, 13
    s_add_u32 s36, s36, s38
    s_add_u32 s30, s16, s36
    s_addc_u32 s31, s17, 0
    s_waitcnt vmcnt(0) lgkmcnt(0)
    s_barrier
    s_branch rec_s_loop
rec_s0_retry:
    s_nop 7
    v_mov_b32 v24, 0
    v_mov_b32 v25, 0
    v_mov_b32 v26, 0
    v_mov_b32 v27, 0
    v_mov_b32 v28, 0
    v_mov_b32 v29, 0
    v_mov_b32 v30, 0
    v_mov_b32 v31, 0
    s_add_u32 s24, s24, 1
    s_cmp_lt_u32 s24, 400000
    s_cbranch_scc1 rec_s0
    s_branch rec_fail
rec_s0_xr:
    global_load_dwordx4 v[48:51], v6, s[32:33] offset:0 sc1
    global_load_dwordx4 v[52:55], v6, s[32:33] offset:1024 sc1
    global_load_dwordx4 v[56:59], v6, s[32:33] offset:2048 sc1
    global_load_dwordx4 v[60:63], v6, s[32:33] offset:3072 sc1
    s_waitcnt vmcnt(4)
    v_mfma_f32_16x16x32_bf16 v[72:75], v[128:131], v[128:131], 0
    v_bitop3_b32 v15, v128, v129, v130 bitop3:0xfe
    v_bitop3_b32 v16, v131, v132, v133 bitop3:0xfe
    v_mfma_f32_16x16x32_bf16 v[72:75], v[132:135], v[132:135], v[72:75]
    v_bitop3_b32 v15, v15, v134, v135 bitop3:0xfe
    v_bitop3_b32 v16, v16, v136, v137 bitop3:0xfe
    v_mfma_f32_16x16x32_bf16 v[72:75], v[136:139], v[136:139], v[72:75]
    v_bitop3_b32 v15, v15, v138, v139 bitop3:0xfe
    v_bitop3_b32 v16, v16, v140, v141 bitop3:0xfe
    v_mfma_f32_16x16x32_bf16 v[72:75], v[140:143], v[140:143], v[72:75]
    v_bitop3_b32 v15, v15, v142, v143 bitop3:0xfe
    v_bitop3_b32 v15, v15, v16, 1 bitop3:0xa8
    v_cmp_ne_u32 vcc, 0, v15
    s_cbranch_vccnz rec_s0_xg
    v_mfma_f32_16x16x32_bf16 v[68:71], v[112:115], v[128:131], 0
    v_mfma_f32_16x16x32_bf16 v[68:71], v[116:119], v[132:135], v[68:71]
    v_mfma_f32_16x16x32_bf16 v[68:71], v[120:123], v[136:139], v[68:71]
    v_mfma_f32_16x16x32_bf16 v[68:71], v[124:127], v[140:143], v[68:71]
    v_mfma_f32_16x16x32_bf16 v[64:67], v[96:99], v[128:131], 0
    v_mov_b32_dpp v72, v73 row_shr:8 row_mask:0xf bank_mask:0xc
    v_mov_b32_dpp v74, v75 row_shr:8 row_mask:0xf bank_mask:0xc
    v_mfma_f32_16x16x32_bf16 v[64:67], v[100:103], v[132:135], v[64:67]
    v_mfma_f32_16x16x32_bf16 v[64:67], v[104:107], v[136:139], v[64:67]
    v_permlane32_swap_b32 v72, v74
    v_mfma_f32_16x16x32_bf16 v[64:67], v[108:111], v[140:143], v[64:67]
    s_branch rec_s0_xj
rec_s0_xg:
    s_add_u32 s24, s24, 1
    s_cmp_lt_u32 s24, 400000
    s_cbranch_scc1 rec_s0_xp
    s_branch rec_fail
rec_s1_retry:
    s_nop 7
    v_mov_b32 v24, 0
    v_mov_b32 v25, 0
    v_mov_b32 v26, 0
    v_mov_b32 v27, 0
    v_mov_b32 v28, 0
    v_mov_b32 v29, 0
    v_mov_b32 v30, 0
    v_mov_b32 v31, 0
    s_add_u32 s24, s24, 1
    s_cmp_lt_u32 s24, 400000
    s_cbranch_scc1 rec_s1
    s_branch rec_fail
rec_s1_xr:
    global_load_dwordx4 v[48:51], v6, s[32:33] offset:0 sc1
    global_load_dwordx4 v[52:55], v6, s[32:33] offset:1024 sc1
    global_load_dwordx4 v[56:59], v6, s[32:33] offset:2048 sc1
    global_load_dwordx4 v[60:63], v6, s[32:33] offset:3072 sc1
    s_waitcnt vmcnt(4)
    v_mfma_f32_16x16x32_bf16 v[72:75], v[128:131], v[128:131], 0
    v_bitop3_b32 v15, v128, v129, v130 bitop3:0x80
    v_bitop3_b32 v16, v131, v132, v133 bitop3:0x80
    v_mfma_f32_16x16x32_bf16 v[72:75], v[132:135], v[132:135], v[72:75]
    v_bitop3_b32 v15, v15, v134, v135 bitop3:0x80
    v_bitop3_b32 v16, v16, v136, v137 bitop3:0x80
    v_mfma_f32_16x16x32_bf16 v[72:75], v[136:139], v[136:139], v[72:75]
    v_bitop3_b32 v15, v15, v138, v139 bitop3:0x80
    v_bitop3_b32 v16, v16, v140, v141 bitop3:0x80
    v_mfma_f32_16x16x32_bf16 v[72:75], v[140:143], v[140:143], v[72:75]
    v_bitop3_b32 v15, v15, v142, v143 bitop3:0x80
    v_bitop3_b32 v15, v15, v16, 1 bitop3:0x80
    v_cmp_ne_u32 vcc, 1, v15
    s_cbranch_vccnz rec_s1_xg
    v_mfma_f32_16x16x32_bf16 v[68:71], v[112:115], v[128:131], 0
    v_mfma_f32_16x16x32_bf16 v[68:71], v[116:119], v[132:135], v[68:71]
    v_mfma_f32_16x16x32_bf16 v[68:71], v[120:123], v[136:139], v[68:71]
    v_mfma_f32_16x16x32_bf16 v[68:71], v[124:127], v[140:143], v[68:71]
    v_mfma_f32_16x16x32_bf16 v[64:67], v[96:99], v[128:131], 0
    v_mov_b32_dpp v72, v73 row_shr:8 row_mask:0xf bank_mask:0xc
    v_mov_b32_dpp v74, v75 row_shr:8 row_mask:0xf bank_mask:0xc
    v_mfma_f32_16x16x32_bf16 v[64:67], v[100:103], v[132:135], v[64:67]
    v_mfma_f32_16x16x32_bf16 v[64:67], v[104:107], v[136:139], v[64:67]
    v_permlane32_swap_b32 v72, v74
    v_mfma_f32_16x16x32_bf16 v[64:67], v[108:111], v[140:143], v[64:67]
    s_branch rec_s1_xj
rec_s1_xg:
    s_add_u32 s24, s24, 1
    s_cmp_lt_u32 s24, 400000
    s_cbranch_scc1 rec_s1_xp
    s_branch rec_fail
rec_s_first:
    s_barrier
    ds_read_b128 v[96:99], v14 offset:0
    ds_read_b128 v[100:103], v14 offset:1024
    ds_read_b128 v[104:107], v14 offset:2048
    ds_read_b128 v[108:111], v14 offset:3072
    ds_read_b128 v[112:115], v14 offset:4096
    ds_read_b128 v[116:119], v14 offset:5120
    ds_read_b128 v[120:123], v14 offset:6144
    ds_read_b128 v[124:127], v14 offset:7168
    v_xor_b32 v14, 0x2000, v14
    s_waitcnt lgkmcnt(0)
    s_barrier
    s_branch rec_s_fj
rec_setup_vo:
    v_add_u32 v8, 0x1000, v6
    v_lshrrev_b32 v9, 4, v0
    s_lshl_b32 s36, s19, 5
    s_lshl_b32 s42, s21, 3
    s_add_u32 s36, s36, s42
    v_add_u32 v9, s36, v9
    v_bfe_u32 v11, v0, 3, 1
    v_lshl_add_u32 v9, v11, 2, v9
    v_and_b32 v11, 1, v9
    v_lshlrev_b32 v11, 12, v11
    v_lshrrev_b32 v9, 1, v9
    v_lshl_add_u32 v9, v9, 14, v11
    v_and_b32 v11, 7, v0
    v_lshl_add_u32 v9, v11, 4, v9
    s_lshl_b32 s36, s18, 7
    v_add_u32 v9, s36, v9
    v_lshrrev_b32 v12, 4, v0
    v_and_b32 v13, 7, v0
    v_lshl_add_u32 v12, v12, 3, v13
    v_lshlrev_b32 v12, 4, v12
    v_add_u32 v12, 24576, v12
    v_mov_b32 v11, 26624
    v_and_b32 v13, 8, v0
    v_cmp_eq_u32 vcc, 0, v13
    s_nop 1
    v_cndmask_b32 v13, v12, v11, vcc
    v_cndmask_b32 v12, v11, v12, vcc
    v_add_u32 v14, 147456, v6
    s_lshr_b32 s36, s21, 1
    s_mul_i32 s54, s36, 33554432
    s_mul_i32 s55, s36, 16384
    s_and_b32 s36, s21, 1
    s_lshl_b32 s36, s36, 12
    s_add_u32 s54, s54, s36
    s_add_u32 s55, s55, s36
    s_add_u32 s55, s55, 131072
    s_lshl_b32 s36, s18, 14
    s_add_u32 s54, s54, s36
    s_add_u32 s54, s54, 20971520
    v_mov_b32 v56, 0x3f803f80
    v_mov_b32 v57, 0x3f803f80
    v_mov_b32 v58, 0x3f803f80
    v_mov_b32 v59, 0x3f803f80
    v_mov_b32 v60, 0x3f003f00
    v_mov_b32 v61, 0x3f003f00
    v_mov_b32 v62, 0x3f003f00
    v_mov_b32 v63, 0x3f003f00
    v_mov_b32 v64, 0
    v_mov_b32 v65, 0
    v_mov_b32 v66, 0
    v_mov_b32 v67, 0
    v_mov_b32 v68, 0
    v_mov_b32 v69, 0
    v_mov_b32 v70, 0
    v_mov_b32 v71, 0
    v_mov_b32 v72, 0
    v_mov_b32 v73, 0
    v_mov_b32 v74, 0
    v_mov_b32 v75, 0
    v_mov_b32 v76, 0
    v_mov_b32 v77, 0
    v_mov_b32 v78, 0
    v_mov_b32 v79, 0
    s_add_u32 s53, s22, 2
    s_min_u32 s53, s53, 63
    s_lshl_b32 s53, s53, 19
    s_add_u32 s53, s53, s54
    s_lshr_b32 s36, s53, 21
    s_xor_b32 s36, s36, s25
    s_xor_b32 s36, s36, 1
    s_and_b32 s36, s36, 1
    s_lshl_b32 s36, s36, 13
    s_add_u32 s36, s36, s53
    s_add_u32 s48, s16, s36
    s_addc_u32 s49, s17, 0
    s_add_u32 m0, s55, 0
    v_mov_b32 v24, 0
    v_mov_b32 v25, 0
    v_mov_b32 v26, 0
    v_mov_b32 v27, 0
    v_mov_b32 v28, 0
    v_mov_b32 v29, 0
    v_mov_b32 v30, 0
    v_mov_b32 v31, 0
    v_mov_b32 v32, 0
    v_mov_b32 v33, 0
    v_mov_b32 v34, 0
    v_mov_b32 v35, 0
    v_mov_b32 v36, 0
    v_mov_b32 v37, 0
    v_mov_b32 v38, 0
    v_mov_b32 v39, 0
    v_mov_b32 v40, 0
    v_mov_b32 v41, 0
    v_mov_b32 v42, 0
    v_mov_b32 v43, 0
    v_mov_b32 v44, 0
    v_mov_b32 v45, 0
    v_mov_b32 v46, 0
    v_mov_b32 v47, 0
    s_setprio 1
    s_branch rec_o0_in
rec_o_loop:
    s_sleep 7
rec_o0:
    global_load_dwordx4 v[16:19], v1, s[28:29] sc1
    global_load_dwordx4 v[20:23], v1, s[28:29] offset:1024 sc1
    s_waitcnt vmcnt(0)
rec_o0_in:
    v_smfmac_f32_16x16x64_bf16 v[24:27], v[16:19], a[0:7], v2
    v_max3_u32 v0, v16, v17, v18
    v_max3_u32 v7, v19, v20, v21
    v_smfmac_f32_16x16x64_bf16 v[28:31], v[16:19], a[16:23], v2
    v_max3_u32 v0, v0, v22, v23
    v_max_u32 v0, v0, v7
    v_smfmac_f32_16x16x64_bf16 v[24:27], v[20:23], a[8:15], v2
    v_cmp_eq_u32 vcc, -1, v0
    s_cbranch_vccnz rec_o0_retry
    v_smfmac_f32_16x16x64_bf16 v[28:31], v[20:23], a[24:31], v2
    v_smfmac_f32_16x16x64_bf16 v[32:35], v[16:19], a[32:39], v2
    v_smfmac_f32_16x16x64_bf16 v[36:39], v[16:19], a[48:55], v2
    v_smfmac_f32_16x16x64_bf16 v[32:35], v[20:23], a[40:47], v2
    v_smfmac_f32_16x16x64_bf16 v[36:39], v[20:23], a[56:63], v2
    s_nop 3
    v_cvt_pk_bf16_f32 v24, v24, v25
    v_smfmac_f32_16x16x64_bf16 v[40:43], v[16:19], a[64:71], v2
    v_cvt_pk_bf16_f32 v25, v26, v27
    v_smfmac_f32_16x16x64_bf16 v[44:47], v[16:19], a[80:87], v2
    v_cvt_pk_bf16_f32 v26, v28, v29
    v_smfmac_f32_16x16x64_bf16 v[40:43], v[20:23], a[72:79], v2
    v_cvt_pk_bf16_f32 v27, v30, v31
    ds_write_b128 v3, v[24:27]
    v_smfmac_f32_16x16x64_bf16 v[44:47], v[20:23], a[88:95], v2
    v_cvt_pk_bf16_f32 v32, v32, v33
    v_cvt_pk_bf16_f32 v33, v34, v35
    v_cvt_pk_bf16_f32 v34, v36, v37
    v_cvt_pk_bf16_f32 v35, v38, v39
    ds_write_b128 v3, v[32:35] offset:1024
    s_nop 2
    v_cvt_pk_bf16_f32 v40, v40, v41
    v_cvt_pk_bf16_f32 v41, v42, v43
    v_cvt_pk_bf16_f32 v42, v44, v45
    v_cvt_pk_bf16_f32 v43, v46, v47
    ds_write_b128 v3, v[40:43] offset:2048
    s_waitcnt lgkmcnt(1)
    s_barrier
    s_waitcnt lgkmcnt(0)
    s_barrier
    s_sleep 10
rec_o0_vp:
    global_load_dwordx4 v[48:51], v8, s[32:33] offset:0 sc1
    global_load_dwordx4 v[52:55], v8, s[32:33] offset:1024 sc1
    s_waitcnt vmcnt(0)
    v_bitop3_b32 v17, v48, v49, v50 bitop3:0xfe
    v_bitop3_b32 v16, v51, v52, v53 bitop3:0xfe
    v_bitop3_b32 v17, v17, v54, v55 bitop3:0xfe
    v_bitop3_b32 v17, v17, v16, 1 bitop3:0xa8
    v_cmp_ne_u32 vcc, 0, v17
    s_cbranch_vccnz rec_o0_vr
    v_smfmac_f32_16x16x64_bf16 v[64:67], v[48:51], v[96:103], v2
    v_smfmac_f32_16x16x64_bf16 v[68:71], v[48:51], v[112:119], v2
    v_smfmac_f32_16x16x64_bf16 v[72:75], v[48:51], v[128:135], v2
    v_smfmac_f32_16x16x64_bf16 v[76:79], v[48:51], v[144:151], v2
    v_smfmac_f32_16x16x64_bf16 v[64:67], v[52:55], v[104:111], v2
    v_smfmac_f32_16x16x64_bf16 v[68:71], v[52:55], v[120:127], v2
    v_smfmac_f32_16x16x64_bf16 v[72:75], v[52:55], v[136:143], v2
    v_smfmac_f32_16x16x64_bf16 v[76:79], v[52:55], v[152:159], v2
    s_nop 4
    v_cvt_pk_bf16_f32 v24, v64, v65
    v_cvt_pk_bf16_f32 v25, v66, v67
    v_cvt_pk_bf16_f32 v28, v68, v69
    v_cvt_pk_bf16_f32 v29, v70, v71
    v_cvt_pk_bf16_f32 v26, v72, v73
    v_cvt_pk_bf16_f32 v27, v74, v75
    s_nop 1
    v_cvt_pk_bf16_f32 v30, v76, v77
    v_cvt_pk_bf16_f32 v31, v78, v79
    s_cmp_eq_u32 s22, 0
    s_cbranch_scc1 rec_o_first
rec_o_fj:
    global_load_lds_dwordx4 v6, s[48:49] offset:0 sc1
    global_load_lds_dwordx4 v6, s[48:49] offset:1024 sc1
    global_load_lds_dwordx4 v6, s[48:49] offset:2048 sc1
    global_load_lds_dwordx4 v6, s[48:49] offset:3072 sc1
    s_barrier
    ds_read_b64 v[36:37], v12 offset:1024
    ds_read_b64 v[38:39], v13 offset:1024
    ds_read_b128 v[32:35], v12
    ds_read_b128 v[48:51], v13
    s_waitcnt lgkmcnt(2)
    v_mfma_f32_16x16x32_bf16 v[40:43], v[60:63], v[36:39], 0
    v_mfma_f32_16x16x32_bf16 v[64:67], v[24:27], v[36:39], 0
    s_waitcnt lgkmcnt(0)
    v_or_b32 v44, v32, v48
    v_or_b32 v45, v33, v49
    v_or_b32 v46, v34, v50
    v_or_b32 v47, v35, v51
    v_mfma_f32_16x16x32_bf16 v[64:67], v[80:83], v[32:35], v[64:67]
    v_mfma_f32_16x16x32_bf16 v[68:71], v[28:31], v[36:39], 0
    v_mfma_f32_16x16x32_bf16 v[40:43], v[56:59], v[44:47], v[40:43]
    v_mfma_f32_16x16x32_bf16 v[64:67], v[88:91], v[48:51], v[64:67]
    v_mfma_f32_16x16x32_bf16 v[68:71], v[84:87], v[32:35], v[68:71]
    v_mfma_f32_16x16x32_bf16 v[68:71], v[92:95], v[48:51], v[68:71]
    s_nop 4
    v_rcp_f32 v40, v40
    s_nop 0
    v_pk_mul_f32 v[64:65], v[64:65], v[40:41] op_sel_hi:[1,0]
    v_pk_mul_f32 v[66:67], v[66:67], v[40:41] op_sel_hi:[1,0]
    v_cvt_pk_bf16_f32 v48, v64, v65
    v_cvt_pk_bf16_f32 v49, v66, v67
    v_pk_mul_f32 v[68:69], v[68:69], v[40:41] op_sel_hi:[1,0]
    v_pk_mul_f32 v[70:71], v[70:71], v[40:41] op_sel_hi:[1,0]
    v_cvt_pk_bf16_f32 v50, v68, v69
    v_cvt_pk_bf16_f32 v51, v70, v71
    v_and_b32 v48, -2, v48
    v_and_b32 v49, -2, v49
    v_and_b32 v50, -2, v50
    v_and_b32 v51, -2, v51
    global_store_dwordx4 v9, v[48:51], s[26:27] sc1
    ds_read_b128 v[16:19], v14 offset:0
    ds_read_b128 v[20:23], v14 offset:1024
    ds_read_b128 v[24:27], v14 offset:2048
    ds_read_b128 v[28:31], v14 offset:3072
    ds_read_b128 v[32:35], v14 offset:4096
    ds_read_b128 v[36:39], v14 offset:5120
    ds_read_b128 v[40:43], v14 offset:6144
    ds_read_b128 v[44:47], v14 offset:7168
    v_xor_b32 v14, 0x2000, v14
    s_waitcnt lgkmcnt(0)
    v_mfma_f32_16x16x32_bf16 v[64:67], v[16:19], v[96:99], 0
    v_mfma_f32_16x16x32_bf16 v[68:71], v[32:35], v[96:99], 0
    v_mfma_f32_16x16x32_bf16 v[72:75], v[16:19], v[112:115], 0
    v_mfma_f32_16x16x32_bf16 v[76:79], v[32:35], v[112:115], 0
    v_mfma_f32_16x16x32_bf16 v[64:67], v[20:23], v[100:103], v[64:67]
    v_mfma_f32_16x16x32_bf16 v[68:71], v[36:39], v[100:103], v[68:71]
    v_mfma_f32_16x16x32_bf16 v[72:75], v[20:23], v[116:119], v[72:75]
    v_mfma_f32_16x16x32_bf16 v[76:79], v[36:39], v[116:119], v[76:79]
    v_mfma_f32_16x16x32_bf16 v[64:67], v[24:27], v[104:107], v[64:67]
    v_mfma_f32_16x16x32_bf16 v[68:71], v[40:43], v[104:107], v[68:71]
    v_mfma_f32_16x16x32_bf16 v[72:75], v[24:27], v[120:123], v[72:75]
    v_mfma_f32_16x16x32_bf16 v[76:79], v[40:43], v[120:123], v[76:79]
    v_mfma_f32_16x16x32_bf16 v[64:67], v[28:31], v[108:111], v[64:67]
    v_mfma_f32_16x16x32_bf16 v[68:71], v[44:47], v[108:111], v[68:71]
    v_mfma_f32_16x16x32_bf16 v[72:75], v[28:31], v[124:127], v[72:75]
    v_mfma_f32_16x16x32_bf16 v[76:79], v[44:47], v[124:127], v[76:79]
    s_nop 7
    v_cvt_pk_bf16_f32 v80, v64, v65
    v_cvt_pk_bf16_f32 v81, v66, v67
    v_cvt_pk_bf16_f32 v82, v68, v69
    v_cvt_pk_bf16_f32 v83, v70, v71
    v_cvt_pk_bf16_f32 v84, v72, v73
    v_cvt_pk_bf16_f32 v85, v74, v75
    v_cvt_pk_bf16_f32 v86, v76, v77
    v_cvt_pk_bf16_f32 v87, v78, v79
    v_mfma_f32_16x16x32_bf16 v[64:67], v[16:19], v[128:131], 0
    v_mfma_f32_16x16x32_bf16 v[68:71], v[32:35], v[128:131], 0
    v_mfma_f32_16x16x32_bf16 v[72:75], v[16:19], v[144:147], 0
    v_mfma_f32_16x16x32_bf16 v[76:79], v[32:35], v[144:147], 0
    v_mfma_f32_16x16x32_bf16 v[64:67], v[20:23], v[132:135], v[64:67]
    v_mfma_f32_16x16x32_bf16 v[68:71], v[36:39], v[132:135], v[68:71]
    v_mfma_f32_16x16x32_bf16 v[72:75], v[20:23], v[148:151], v[72:75]
    v_mfma_f32_16x16x32_bf16 v[76:79], v[36:39], v[148:151], v[76:79]
    v_mfma_f32_16x16x32_bf16 v[64:67], v[24:27], v[136:139], v[64:67]
    v_mfma_f32_16x16x32_bf16 v[68:71], v[40:43], v[136:139], v[68:71]
    v_mfma_f32_16x16x32_bf16 v[72:75], v[24:27], v[152:155], v[72:75]
    v_mfma_f32_16x16x32_bf16 v[76:79], v[40:43], v[152:155], v[76:79]
    v_mfma_f32_16x16x32_bf16 v[64:67], v[28:31], v[140:143], v[64:67]
    v_mfma_f32_16x16x32_bf16 v[68:71], v[44:47], v[140:143], v[68:71]
    v_mfma_f32_16x16x32_bf16 v[72:75], v[28:31], v[156:159], v[72:75]
    v_mfma_f32_16x16x32_bf16 v[76:79], v[44:47], v[156:159], v[76:79]
    s_nop 7
    v_cvt_pk_bf16_f32 v88, v64, v65
    v_cvt_pk_bf16_f32 v89, v66, v67
    v_cvt_pk_bf16_f32 v90, v68, v69
    v_cvt_pk_bf16_f32 v91, v70, v71
    v_cvt_pk_bf16_f32 v92, v72, v73
    v_cvt_pk_bf16_f32 v93, v74, v75
    v_cvt_pk_bf16_f32 v94, v76, v77
    v_cvt_pk_bf16_f32 v95, v78, v79
    v_mov_b32 v56, 0x3f803f80
    v_mov_b32 v57, 0x3f803f80
    v_mov_b32 v58, 0x3f803f80
    v_mov_b32 v59, 0x3f803f80
    v_mov_b32 v60, 0x3f003f00
    v_mov_b32 v61, 0x3f003f00
    v_mov_b32 v62, 0x3f003f00
    v_mov_b32 v63, 0x3f003f00
    v_mov_b32 v64, 0
    v_mov_b32 v65, 0
    v_mov_b32 v66, 0
    v_mov_b32 v67, 0
    v_mov_b32 v68, 0
    v_mov_b32 v69, 0
    v_mov_b32 v70, 0
    v_mov_b32 v71, 0
    v_mov_b32 v72, 0
    v_mov_b32 v73, 0
    v_mov_b32 v74, 0
    v_mov_b32 v75, 0
    v_mov_b32 v76, 0
    v_mov_b32 v77, 0
    v_mov_b32 v78, 0
    v_mov_b32 v79, 0
    s_add_u32 s53, s22, 3
    s_min_u32 s53, s53, 63
    s_lshl_b32 s53, s53, 19
    s_add_u32 s53, s53, s54
    s_lshr_b32 s36, s53, 21
    s_xor_b32 s36, s36, s25
    s_xor_b32 s36, s36, 1
    s_and_b32 s36, s36, 1
    s_lshl_b32 s36, s36, 13
    s_add_u32 s36, s36, s53
    s_add_u32 s48, s16, s36
    s_addc_u32 s49, s17, 0
    s_add_u32 m0, s55, 8192
    v_mov_b32 v24, 0
    v_mov_b32 v25, 0
    v_mov_b32 v26, 0
    v_mov_b32 v27, 0
    v_mov_b32 v28, 0
    v_mov_b32 v29, 0
    v_mov_b32 v30, 0
    v_mov_b32 v31, 0
    v_mov_b32 v32, 0
    v_mov_b32 v33, 0
    v_mov_b32 v34, 0
    v_mov_b32 v35, 0
    v_mov_b32 v36, 0
    v_mov_b32 v37, 0
    v_mov_b32 v38, 0
    v_mov_b32 v39, 0
    v_mov_b32 v40, 0
    v_mov_b32 v41, 0
    v_mov_b32 v42, 0
    v_mov_b32 v43, 0
    v_mov_b32 v44, 0
    v_mov_b32 v45, 0
    v_mov_b32 v46, 0
    v_mov_b32 v47, 0
    s_add_u32 s22, s22, 1
    s_add_u32 s28, s28, 0x8000
    s_addc_u32 s29, s29, 0
    s_add_u32 s38, s38, 0x40000
    s_lshr_b32 s36, s38, 21
    s_xor_b32 s36, s36, s25
    s_and_b32 s36, s36, 1
    s_lshl_b32 s36, s36, 13
    s_add_u32 s36, s36, s38
    s_add_u32 s30, s16, s36
    s_addc_u32 s31, s17, 0
    s_waitcnt vmcnt(0) lgkmcnt(0)
    s_barrier
    s_sleep 7
rec_o1:
    global_load_dwordx4 v[16:19], v1, s[28:29] sc1
    global_load_dwordx4 v[20:23], v1, s[28:29] offset:1024 sc1
    s_waitcnt vmcnt(0)
rec_o1_in:
    v_smfmac_f32_16x16x64_bf16 v[24:27], v[16:19], a[0:7], v2
    v_max3_u32 v0, v16, v17, v18
    v_max3_u32 v7, v19, v20, v21
    v_smfmac_f32_16x16x64_bf16 v[28:31], v[16:19], a[16:23], v2
    v_max3_u32 v0, v0, v22, v23
    v_max_u32 v0, v0, v7
    v_smfmac_f32_16x16x64_bf16 v[24:27], v[20:23], a[8:15], v2
    v_cmp_eq_u32 vcc, -1, v0
    s_cbranch_vccnz rec_o1_retry
    v_smfmac_f32_16x16x64_bf16 v[28:31], v[20:23], a[24:31], v2
    v_smfmac_f32_16x16x64_bf16 v[32:35], v[16:19], a[32:39], v2
    v_smfmac_f32_16x16x64_bf16 v[36:39], v[16:19], a[48:55], v2
    v_smfmac_f32_16x16x64_bf16 v[32:35], v[20:23], a[40:47], v2
    v_smfmac_f32_16x16x64_bf16 v[36:39], v[20:23], a[56:63], v2
    s_nop 3
    v_cvt_pk_bf16_f32 v24, v24, v25
    v_smfmac_f32_16x16x64_bf16 v[40:43], v[16:19], a[64:71], v2
    v_cvt_pk_bf16_f32 v25, v26, v27
    v_smfmac_f32_16x16x64_bf16 v[44:47], v[16:19], a[80:87], v2
    v_cvt_pk_bf16_f32 v26, v28, v29
    v_smfmac_f32_16x16x64_bf16 v[40:43], v[20:23], a[72:79], v2
    v_cvt_pk_bf16_f32 v27, v30, v31
    ds_write_b128 v3, v[24:27]
    v_smfmac_f32_16x16x64_bf16 v[44:47], v[20:23], a[88:95], v2
    v_cvt_pk_bf16_f32 v32, v32, v33
    v_cvt_pk_bf16_f32 v33, v34, v35
    v_cvt_pk_bf16_f32 v34, v36, v37
    v_cvt_pk_bf16_f32 v35, v38, v39
    ds_write_b128 v3, v[32:35] offset:1024
    s_nop 2
    v_cvt_pk_bf16_f32 v40, v40, v41
    v_cvt_pk_bf16_f32 v41, v42, v43
    v_cvt_pk_bf16_f32 v42, v44, v45
    v_cvt_pk_bf16_f32 v43, v46, v47
    ds_write_b128 v3, v[40:43] offset:2048
    s_waitcnt lgkmcnt(1)
    s_barrier
    s_waitcnt lgkmcnt(0)
    s_barrier
    s_cmp_eq_u32 s22, 63
    s_cbranch_scc1 rec_fin
    s_sleep 10
rec_o1_vp:
    global_load_dwordx4 v[48:51], v8, s[32:33] offset:0 sc1
    global_load_dwordx4 v[52:55], v8, s[32:33] offset:1024 sc1
    s_waitcnt vmcnt(0)
    v_bitop3_b32 v17, v48, v49, v50 bitop3:0x80
    v_bitop3_b32 v16, v51, v52, v53 bitop3:0x80
    v_bitop3_b32 v17, v17, v54, v55 bitop3:0x80
    v_bitop3_b32 v17, v17, v16, 1 bitop3:0x80
    v_cmp_ne_u32 vcc, 1, v17
    s_cbranch_vccnz rec_o1_vr
    v_smfmac_f32_16x16x64_bf16 v[64:67], v[48:51], v[96:103], v2
    v_smfmac_f32_16x16x64_bf16 v[68:71], v[48:51], v[112:119], v2
    v_smfmac_f32_16x16x64_bf16 v[72:75], v[48:51], v[128:135], v2
    v_smfmac_f32_16x16x64_bf16 v[76:79], v[48:51], v[144:151], v2
    v_smfmac_f32_16x16x64_bf16 v[64:67], v[52:55], v[104:111], v2
    v_smfmac_f32_16x16x64_bf16 v[68:71], v[52:55], v[120:127], v2
    v_smfmac_f32_16x16x64_bf16 v[72:75], v[52:55], v[136:143], v2
    v_smfmac_f32_16x16x64_bf16 v[76:79], v[52:55], v[152:159], v2
    s_nop 4
    v_cvt_pk_bf16_f32 v24, v64, v65
    v_cvt_pk_bf16_f32 v25, v66, v67
    v_cvt_pk_bf16_f32 v28, v68, v69
    v_cvt_pk_bf16_f32 v29, v70, v71
    v_cvt_pk_bf16_f32 v26, v72, v73
    v_cvt_pk_bf16_f32 v27, v74, v75
    s_nop 1
    v_cvt_pk_bf16_f32 v30, v76, v77
    v_cvt_pk_bf16_f32 v31, v78, v79
    global_load_lds_dwordx4 v6, s[48:49] offset:0 sc1
    global_load_lds_dwordx4 v6, s[48:49] offset:1024 sc1
    global_load_lds_dwordx4 v6, s[48:49] offset:2048 sc1
    global_load_lds_dwordx4 v6, s[48:49] offset:3072 sc1
    s_barrier
    ds_read_b64 v[36:37], v12 offset:1024
    ds_read_b64 v[38:39], v13 offset:1024
    ds_read_b128 v[32:35], v12
    ds_read_b128 v[48:51], v13
    s_waitcnt lgkmcnt(2)
    v_mfma_f32_16x16x32_bf16 v[40:43], v[60:63], v[36:39], 0
    v_mfma_f32_16x16x32_bf16 v[64:67], v[24:27], v[36:39], 0
    s_waitcnt lgkmcnt(0)
    v_or_b32 v44, v32, v48
    v_or_b32 v45, v33, v49
    v_or_b32 v46, v34, v50
    v_or_b32 v47, v35, v51
    v_mfma_f32_16x16x32_bf16 v[64:67], v[80:83], v[32:35], v[64:67]
    v_mfma_f32_16x16x32_bf16 v[68:71], v[28:31], v[36:39], 0
    v_mfma_f32_16x16x32_bf16 v[40:43], v[56:59], v[44:47], v[40:43]
    v_mfma_f32_16x16x32_bf16 v[64:67], v[88:91], v[48:51], v[64:67]
    v_mfma_f32_16x16x32_bf16 v[68:71], v[84:87], v[32:35], v[68:71]
    v_mfma_f32_16x16x32_bf16 v[68:71], v[92:95], v[48:51], v[68:71]
    s_nop 4
    v_rcp_f32 v40, v40
    s_nop 0
    v_pk_mul_f32 v[64:65], v[64:65], v[40:41] op_sel_hi:[1,0]
    v_pk_mul_f32 v[66:67], v[66:67], v[40:41] op_sel_hi:[1,0]
    v_cvt_pk_bf16_f32 v48, v64, v65
    v_cvt_pk_bf16_f32 v49, v66, v67
    v_pk_mul_f32 v[68:69], v[68:69], v[40:41] op_sel_hi:[1,0]
    v_pk_mul_f32 v[70:71], v[70:71], v[40:41] op_sel_hi:[1,0]
    v_cvt_pk_bf16_f32 v50, v68, v69
    v_cvt_pk_bf16_f32 v51, v70, v71
    v_or_b32 v48, 1, v48
    v_or_b32 v49, 1, v49
    v_or_b32 v50, 1, v50
    v_or_b32 v51, 1, v51
    global_store_dwordx4 v9, v[48:51], s[26:27] sc1
    ds_read_b128 v[16:19], v14 offset:0
    ds_read_b128 v[20:23], v14 offset:1024
    ds_read_b128 v[24:27], v14 offset:2048
    ds_read_b128 v[28:31], v14 offset:3072
    ds_read_b128 v[32:35], v14 offset:4096
    ds_read_b128 v[36:39], v14 offset:5120
    ds_read_b128 v[40:43], v14 offset:6144
    ds_read_b128 v[44:47], v14 offset:7168
    v_xor_b32 v14, 0x2000, v14
    s_waitcnt lgkmcnt(0)
    v_mfma_f32_16x16x32_bf16 v[64:67], v[16:19], v[96:99], 0
    v_mfma_f32_16x16x32_bf16 v[68:71], v[32:35], v[96:99], 0
    v_mfma_f32_16x16x32_bf16 v[72:75], v[16:19], v[112:115], 0
    v_mfma_f32_16x16x32_bf16 v[76:79], v[32:35], v[112:115], 0
    v_mfma_f32_16x16x32_bf16 v[64:67], v[20:23], v[100:103], v[64:67]
    v_mfma_f32_16x16x32_bf16 v[68:71], v[36:39], v[100:103], v[68:71]
    v_mfma_f32_16x16x32_bf16 v[72:75], v[20:23], v[116:119], v[72:75]
    v_mfma_f32_16x16x32_bf16 v[76:79], v[36:39], v[116:119], v[76:79]
    v_mfma_f32_16x16x32_bf16 v[64:67], v[24:27], v[104:107], v[64:67]
    v_mfma_f32_16x16x32_bf16 v[68:71], v[40:43], v[104:107], v[68:71]
    v_mfma_f32_16x16x32_bf16 v[72:75], v[24:27], v[120:123], v[72:75]
    v_mfma_f32_16x16x32_bf16 v[76:79], v[40:43], v[120:123], v[76:79]
    v_mfma_f32_16x16x32_bf16 v[64:67], v[28:31], v[108:111], v[64:67]
    v_mfma_f32_16x16x32_bf16 v[68:71], v[44:47], v[108:111], v[68:71]
    v_mfma_f32_16x16x32_bf16 v[72:75], v[28:31], v[124:127], v[72:75]
    v_mfma_f32_16x16x32_bf16 v[76:79], v[44:47], v[124:127], v[76:79]
    s_nop 7
    v_cvt_pk_bf16_f32 v80, v64, v65
    v_cvt_pk_bf16_f32 v81, v66, v67
    v_cvt_pk_bf16_f32 v82, v68, v69
    v_cvt_pk_bf16_f32 v83, v70, v71
    v_cvt_pk_bf16_f32 v84, v72, v73
    v_cvt_pk_bf16_f32 v85, v74, v75
    v_cvt_pk_bf16_f32 v86, v76, v77
    v_cvt_pk_bf16_f32 v87, v78, v79
    v_mfma_f32_16x16x32_bf16 v[64:67], v[16:19], v[128:131], 0
    v_mfma_f32_16x16x32_bf16 v[68:71], v[32:35], v[128:131], 0
    v_mfma_f32_16x16x32_bf16 v[72:75], v[16:19], v[144:147], 0
    v_mfma_f32_16x16x32_bf16 v[76:79], v[32:35], v[144:147], 0
    v_mfma_f32_16x16x32_bf16 v[64:67], v[20:23], v[132:135], v[64:67]
    v_mfma_f32_16x16x32_bf16 v[68:71], v[36:39], v[132:135], v[68:71]
    v_mfma_f32_16x16x32_bf16 v[72:75], v[20:23], v[148:151], v[72:75]
    v_mfma_f32_16x16x32_bf16 v[76:79], v[36:39], v[148:151], v[76:79]
    v_mfma_f32_16x16x32_bf16 v[64:67], v[24:27], v[136:139], v[64:67]
    v_mfma_f32_16x16x32_bf16 v[68:71], v[40:43], v[136:139], v[68:71]
    v_mfma_f32_16x16x32_bf16 v[72:75], v[24:27], v[152:155], v[72:75]
    v_mfma_f32_16x16x32_bf16 v[76:79], v[40:43], v[152:155], v[76:79]
    v_mfma_f32_16x16x32_bf16 v[64:67], v[28:31], v[140:143], v[64:67]
    v_mfma_f32_16x16x32_bf16 v[68:71], v[44:47], v[140:143], v[68:71]
    v_mfma_f32_16x16x32_bf16 v[72:75], v[28:31], v[156:159], v[72:75]
    v_mfma_f32_16x16x32_bf16 v[76:79], v[44:47], v[156:159], v[76:79]
    s_nop 7
    v_cvt_pk_bf16_f32 v88, v64, v65
    v_cvt_pk_bf16_f32 v89, v66, v67
    v_cvt_pk_bf16_f32 v90, v68, v69
    v_cvt_pk_bf16_f32 v91, v70, v71
    v_cvt_pk_bf16_f32 v92, v72, v73
    v_cvt_pk_bf16_f32 v93, v74, v75
    v_cvt_pk_bf16_f32 v94, v76, v77
    v_cvt_pk_bf16_f32 v95, v78, v79
    v_mov_b32 v56, 0x3f803f80
    v_mov_b32 v57, 0x3f803f80
    v_mov_b32 v58, 0x3f803f80
    v_mov_b32 v59, 0x3f803f80
    v_mov_b32 v60, 0x3f003f00
    v_mov_b32 v61, 0x3f003f00
    v_mov_b32 v62, 0x3f003f00
    v_mov_b32 v63, 0x3f003f00
    v_mov_b32 v64, 0
    v_mov_b32 v65, 0
    v_mov_b32 v66, 0
    v_mov_b32 v67, 0
    v_mov_b32 v68, 0
    v_mov_b32 v69, 0
    v_mov_b32 v70, 0
    v_mov_b32 v71, 0
    v_mov_b32 v72, 0
    v_mov_b32 v73, 0
    v_mov_b32 v74, 0
    v_mov_b32 v75, 0
    v_mov_b32 v76, 0
    v_mov_b32 v77, 0
    v_mov_b32 v78, 0
    v_mov_b32 v79, 0
    s_add_u32 s53, s22, 3
    s_min_u32 s53, s53, 63
    s_lshl_b32 s53, s53, 19
    s_add_u32 s53, s53, s54
    s_lshr_b32 s36, s53, 21
    s_xor_b32 s36, s36, s25
    s_xor_b32 s36, s36, 1
    s_and_b32 s36, s36, 1
    s_lshl_b32 s36, s36, 13
    s_add_u32 s36, s36, s53
    s_add_u32 s48, s16, s36
    s_addc_u32 s49, s17, 0
    s_add_u32 m0, s55, 0
    v_mov_b32 v24, 0
    v_mov_b32 v25, 0
    v_mov_b32 v26, 0
    v_mov_b32 v27, 0
    v_mov_b32 v28, 0
    v_mov_b32 v29, 0
    v_mov_b32 v30, 0
    v_mov_b32 v31, 0
    v_mov_b32 v32, 0
    v_mov_b32 v33, 0
    v_mov_b32 v34, 0
    v_mov_b32 v35, 0
    v_mov_b32 v36, 0
    v_mov_b32 v37, 0
    v_mov_b32 v38, 0
    v_mov_b32 v39, 0
    v_mov_b32 v40, 0
    v_mov_b32 v41, 0
    v_mov_b32 v42, 0
    v_mov_b32 v43, 0
    v_mov_b32 v44, 0
    v_mov_b32 v45, 0
    v_mov_b32 v46, 0
    v_mov_b32 v47, 0
    s_add_u32 s22, s22, 1
    s_add_u32 s28, s28, 0x8000
    s_addc_u32 s29, s29, 0
    s_add_u32 s38, s38, 0x40000
    s_lshr_b32 s36, s38, 21
    s_xor_b32 s36, s36, s25
    s_and_b32 s36, s36, 1
    s_lshl_b32 s36, s36, 13
    s_add_u32 s36, s36, s38
    s_add_u32 s30, s16, s36
    s_addc_u32 s31, s17, 0
    s_waitcnt vmcnt(0) lgkmcnt(0)
    s_barrier
    s_branch rec_o_loop
rec_o0_retry:
    s_nop 7
    v_mov_b32 v24, 0
    v_mov_b32 v25, 0
    v_mov_b32 v26, 0
    v_mov_b32 v27, 0
    v_mov_b32 v28, 0
    v_mov_b32 v29, 0
    v_mov_b32 v30, 0
    v_mov_b32 v31, 0
    s_add_u32 s24, s24, 1
    s_cmp_lt_u32 s24, 400000
    s_cbranch_scc1 rec_o0
    s_branch rec_fail
rec_o0_vr:
    s_add_u32 s24, s24, 1
    s_cmp_lt_u32 s24, 400000
    s_cbranch_scc1 rec_o0_vp
    s_branch rec_fail
rec_o1_retry:
    s_nop 7
    v_mov_b32 v24, 0
    v_mov_b32 v25, 0
    v_mov_b32 v26, 0
    v_mov_b32 v27, 0
    v_mov_b32 v28, 0
    v_mov_b32 v29, 0
    v_mov_b32 v30, 0
    v_mov_b32 v31, 0
    s_add_u32 s24, s24, 1
    s_cmp_lt_u32 s24, 400000
    s_cbranch_scc1 rec_o1
    s_branch rec_fail
rec_o1_vr:
    s_add_u32 s24, s24, 1
    s_cmp_lt_u32 s24, 400000
    s_cbranch_scc1 rec_o1_vp
    s_branch rec_fail
rec_o_first:
    v_mov_b32 v48, v24
    v_mov_b32 v49, v25
    v_mov_b32 v50, v26
    v_mov_b32 v51, v27
    v_mov_b32 v52, v28
    v_mov_b32 v53, v29
    v_mov_b32 v54, v30
    v_mov_b32 v55, v31
    s_barrier
    ds_read_b128 v[16:19], v14 offset:0
    ds_read_b128 v[20:23], v14 offset:1024
    ds_read_b128 v[24:27], v14 offset:2048
    ds_read_b128 v[28:31], v14 offset:3072
    ds_read_b128 v[32:35], v14 offset:4096
    ds_read_b128 v[36:39], v14 offset:5120
    ds_read_b128 v[40:43], v14 offset:6144
    ds_read_b128 v[44:47], v14 offset:7168
    v_xor_b32 v14, 0x2000, v14
    s_waitcnt lgkmcnt(0)
    s_barrier
    v_mfma_f32_16x16x32_bf16 v[64:67], v[16:19], v[96:99], 0
    v_mfma_f32_16x16x32_bf16 v[68:71], v[32:35], v[96:99], 0
    v_mfma_f32_16x16x32_bf16 v[72:75], v[16:19], v[112:115], 0
    v_mfma_f32_16x16x32_bf16 v[76:79], v[32:35], v[112:115], 0
    v_mfma_f32_16x16x32_bf16 v[64:67], v[20:23], v[100:103], v[64:67]
    v_mfma_f32_16x16x32_bf16 v[68:71], v[36:39], v[100:103], v[68:71]
    v_mfma_f32_16x16x32_bf16 v[72:75], v[20:23], v[116:119], v[72:75]
    v_mfma_f32_16x16x32_bf16 v[76:79], v[36:39], v[116:119], v[76:79]
    v_mfma_f32_16x16x32_bf16 v[64:67], v[24:27], v[104:107], v[64:67]
    v_mfma_f32_16x16x32_bf16 v[68:71], v[40:43], v[104:107], v[68:71]
    v_mfma_f32_16x16x32_bf16 v[72:75], v[24:27], v[120:123], v[72:75]
    v_mfma_f32_16x16x32_bf16 v[76:79], v[40:43], v[120:123], v[76:79]
    v_mfma_f32_16x16x32_bf16 v[64:67], v[28:31], v[108:111], v[64:67]
    v_mfma_f32_16x16x32_bf16 v[68:71], v[44:47], v[108:111], v[68:71]
    v_mfma_f32_16x16x32_bf16 v[72:75], v[28:31], v[124:127], v[72:75]
    v_mfma_f32_16x16x32_bf16 v[76:79], v[44:47], v[124:127], v[76:79]
    s_nop 7
    v_cvt_pk_bf16_f32 v80, v64, v65
    v_cvt_pk_bf16_f32 v81, v66, v67
    v_cvt_pk_bf16_f32 v82, v68, v69
    v_cvt_pk_bf16_f32 v83, v70, v71
    v_cvt_pk_bf16_f32 v84, v72, v73
    v_cvt_pk_bf16_f32 v85, v74, v75
    v_cvt_pk_bf16_f32 v86, v76, v77
    v_cvt_pk_bf16_f32 v87, v78, v79
    v_mfma_f32_16x16x32_bf16 v[64:67], v[16:19], v[128:131], 0
    v_mfma_f32_16x16x32_bf16 v[68:71], v[32:35], v[128:131], 0
    v_mfma_f32_16x16x32_bf16 v[72:75], v[16:19], v[144:147], 0
    v_mfma_f32_16x16x32_bf16 v[76:79], v[32:35], v[144:147], 0
    v_mfma_f32_16x16x32_bf16 v[64:67], v[20:23], v[132:135], v[64:67]
    v_mfma_f32_16x16x32_bf16 v[68:71], v[36:39], v[132:135], v[68:71]
    v_mfma_f32_16x16x32_bf16 v[72:75], v[20:23], v[148:151], v[72:75]
    v_mfma_f32_16x16x32_bf16 v[76:79], v[36:39], v[148:151], v[76:79]
    v_mfma_f32_16x16x32_bf16 v[64:67], v[24:27], v[136:139], v[64:67]
    v_mfma_f32_16x16x32_bf16 v[68:71], v[40:43], v[136:139], v[68:71]
    v_mfma_f32_16x16x32_bf16 v[72:75], v[24:27], v[152:155], v[72:75]
    v_mfma_f32_16x16x32_bf16 v[76:79], v[40:43], v[152:155], v[76:79]
    v_mfma_f32_16x16x32_bf16 v[64:67], v[28:31], v[140:143], v[64:67]
    v_mfma_f32_16x16x32_bf16 v[68:71], v[44:47], v[140:143], v[68:71]
    v_mfma_f32_16x16x32_bf16 v[72:75], v[28:31], v[156:159], v[72:75]
    v_mfma_f32_16x16x32_bf16 v[76:79], v[44:47], v[156:159], v[76:79]
    s_nop 7
    v_cvt_pk_bf16_f32 v88, v64, v65
    v_cvt_pk_bf16_f32 v89, v66, v67
    v_cvt_pk_bf16_f32 v90, v68, v69
    v_cvt_pk_bf16_f32 v91, v70, v71
    v_cvt_pk_bf16_f32 v92, v72, v73
    v_cvt_pk_bf16_f32 v93, v74, v75
    v_cvt_pk_bf16_f32 v94, v76, v77
    v_cvt_pk_bf16_f32 v95, v78, v79
    v_mov_b32 v24, v48
    v_mov_b32 v25, v49
    v_mov_b32 v26, v50
    v_mov_b32 v27, v51
    v_mov_b32 v28, v52
    v_mov_b32 v29, v53
    v_mov_b32 v30, v54
    v_mov_b32 v31, v55
    s_branch rec_o_fj
rec_last_pub:
    s_nop 7
    v_cvt_pk_bf16_f32 v88, v80, v81
    v_cvt_pk_bf16_f32 v89, v82, v83
    v_min_u32 v88, -2, v88
    v_min_u32 v89, -2, v89
    s_or_b32 s36, s19, s37
    s_and_b32 s36, s36, 2
    s_cbranch_scc0 rec_fin
    global_store_dwordx2 v10, v[88:89], s[30:31] sc1
rec_fin:
    s_waitcnt vmcnt(0)
    s_barrier
    s_cmp_eq_u32 s21, 0
    s_cbranch_scc0 rec_end
    v_mov_b32 v95, 63
    s_xor_b32 s36, s25, 1
    s_lshl_b32 s36, s36, 13
    s_add_u32 s36, s36, s45
    s_add_u32 s36, s36, 1441792
    v_mov_b32 v94, s36
    s_mov_b64 exec, 1
    global_store_dword v94, v95, s[16:17] sc1
    s_mov_b64 exec, -1
    s_branch rec_end
rec_fail:
    v_mov_b32 v16, 0
    v_mov_b32 v17, 0xdead
    global_store_dword v16, v17, s[14:15] offset:252
rec_end:
    s_endpgm
worker:
    s_sub_u32 s44, s44, 4
    s_mov_b32 s88, 0
    s_mov_b32 s89, 0
    s_mov_b32 s77, 0
    s_lshl_b32 s96, s44, 5
    s_add_u32 s96, s96, s45
    s_lshl_b32 s96, s96, 3
    s_add_u32 s96, s96, s75
    s_lshl_b32 s32, s44, 3
    s_lshr_b32 s44, s45, 3
    s_and_b32 s45, s45, 7
    s_add_u32 s45, s45, s32
    s_mul_i32 s32, s96, 3072
    s_add_u32 s32, s32, 1048576
    s_add_u32 s90, s10, s32
    s_addc_u32 s91, s11, 0
    s_mov_b32 s99, 3008
    s_mul_i32 s32, s96, 3072
    s_add_u32 s32, s32, 1048576
    s_add_u32 s92, s10, s32
    s_addc_u32 s93, s11, 0
    s_mov_b32 s100, 3008
    s_mul_i32 s32, s96, 3072
    s_add_u32 s32, s32, 1048576
    s_add_u32 s94, s10, s32
    s_addc_u32 s95, s11, 0
    s_mov_b32 s101, 3008
    s_mov_b32 s98, 1
    s_mov_b32 s98, 0
    s_mov_b32 s23, s44
    s_mov_b32 s30, s45
    s_mul_i32 s31, s23, 8
    s_add_u32 s31, s31, 0
    s_lshl_b32 s32, s31, 15
    s_add_u32 s80, s10, s32
    s_addc_u32 s81, s11, 0
    s_cmp_lt_u32 s30, 16
    s_cselect_b32 s82, s16, s18
    s_cselect_b32 s83, s17, s19
    s_cselect_b32 s33, 20, 52
    s_lshl_b32 s33, s33, 20
    s_and_b32 s35, s30, 15
    s_lshl_b32 s32, s35, 9
    s_add_u32 s82, s82, s32
    s_addc_u32 s83, s83, 0
    s_mov_b32 s66, 7
    s_mov_b32 s78, 0
    s_mov_b32 s79, 0
    s_cmp_lt_u32 s44, 2
    s_cbranch_scc1 no_wpf
    s_and_b32 s34, s44, 1
    s_lshl_b32 s34, s34, 3
    s_add_u32 s34, s34, s75
    v_lshrrev_b32 v16, 2, v0
    s_lshl_b32 s32, s34, 4
    s_add_u32 s32, s32, 192
    v_add_u32 v16, s32, v16
    v_and_b32 v17, 3, v0
    v_lshlrev_b32 v17, 7, v17
    s_and_b32 s32, s45, 7
    s_lshl_b32 s32, s32, 4
    s_add_u32 s32, s32, s34
    v_min_u32 v18, 1023, v16
    v_lshl_add_u32 v18, v18, 13, v17
    global_load_dword a95, v18, s[82:83]
    v_add_u32 v16, 256, v16
    v_bfe_u32 v18, v0, 3, 1
    v_lshlrev_b32 v18, 11, v18
    v_and_b32 v19, 7, v0
    v_lshl_add_u32 v18, v19, 7, v18
    s_lshl_b32 s36, s32, 12
    s_add_u32 s36, s36, 1024
    v_add_u32 v18, s36, v18
    global_load_dword a95, v18, s[10:11]
    s_barrier
    v_min_u32 v18, 1023, v16
    v_lshl_add_u32 v18, v18, 13, v17
    global_load_dword a95, v18, s[82:83]
    v_add_u32 v16, 256, v16
    s_barrier
    v_min_u32 v18, 1023, v16
    v_lshl_add_u32 v18, v18, 13, v17
    global_load_dword a95, v18, s[82:83]
    v_add_u32 v16, 256, v16
    s_barrier
    v_min_u32 v18, 1023, v16
    v_lshl_add_u32 v18, v18, 13, v17
    global_load_dword a95, v18, s[82:83]
    v_add_u32 v16, 256, v16
    s_lshl_b32 s36, s32, 12
    s_add_u32 s36, s36, 524288
    v_and_b32 v18, 31, v0
    v_lshl_add_u32 v18, v18, 7, s36
    global_load_dword a95, v18, s[10:11]
no_wpf:
    s_getpc_b64 s[70:71]
call_1:
    s_add_u32 s70, s70, core_T2-call_1
    s_addc_u32 s71, s71, (core_T2-call_1)>>32
    s_swappc_b64 s[68:69], s[70:71]
vl_2:
    s_waitcnt vmcnt(0)
    v_readfirstlane_b32 s22, v18
    v_readfirstlane_b32 s34, v19
    s_and_b32 s32, s22, 0xffff
    s_add_u32 s32, s32, s34
    s_cmp_eq_u32 s32, 256
    s_cbranch_scc1 vo_3
    s_sleep 8
    global_load_dwordx2 v[18:19], v16, s[26:27] offset:40 sc1
    s_add_u32 s46, s46, 1
    s_cmp_lt_u32 s46, 400000
    s_cbranch_scc1 vl_2
    s_branch w_fail
vo_3:
    s_lshr_b32 s22, s22, 16
    s_cmp_gt_u32 s22, 64
    s_cselect_b32 s22, 1, 0
    s_lshl_b32 s34, s35, 1
    s_add_u32 s34, s34, s73
    s_lshl_b32 s34, s34, 14
    s_add_u32 s33, s33, s34
    s_mul_i32 s36, s72, 2
    s_add_u32 s36, s36, s31
    v_lshlrev_b32 v19, 4, v0
    s_add_u32 s32, s36, 0
    s_and_b32 s34, s32, 1
    s_lshl_b32 s34, s34, 12
    s_lshr_b32 s32, s32, 1
    s_lshl_b32 s32, s32, 19
    s_add_u32 s32, s32, s34
    s_add_u32 s32, s32, s33
    s_lshr_b32 s34, s32, 21
    s_xor_b32 s34, s34, s22
    s_xor_b32 s34, s34, 1
    s_and_b32 s34, s34, 1
    s_lshl_b32 s34, s34, 13
    s_add_u32 s32, s32, s34
    v_add_u32 v20, s32, v19
    s_add_u32 s32, s36, 1
    s_and_b32 s34, s32, 1
    s_lshl_b32 s34, s34, 12
    s_lshr_b32 s32, s32, 1
    s_lshl_b32 s32, s32, 19
    s_add_u32 s32, s32, s34
    s_add_u32 s32, s32, s33
    s_lshr_b32 s34, s32, 21
    s_xor_b32 s34, s34, s22
    s_xor_b32 s34, s34, 1
    s_and_b32 s34, s34, 1
    s_lshl_b32 s34, s34, 13
    s_add_u32 s32, s32, s34
    v_add_u32 v21, s32, v19
    s_lshl_b32 s88, s23, 7
    s_lshl_b32 s32, s30, 2
    s_add_u32 s88, s88, s32
    s_add_u32 s88, s88, 1978368
    v_cvt_pk_bf16_f32 v24, v32, v33
    v_cvt_pk_bf16_f32 v25, v34, v35
    v_cvt_pk_bf16_f32 v26, v36, v37
    v_cvt_pk_bf16_f32 v27, v38, v39
    global_store_dwordx4 v20, v[24:27], s[28:29] offset:0 sc1
    v_cvt_pk_bf16_f32 v16, v40, v41
    v_cvt_pk_bf16_f32 v17, v42, v43
    v_cvt_pk_bf16_f32 v18, v44, v45
    v_cvt_pk_bf16_f32 v19, v46, v47
    global_store_dwordx4 v20, v[16:19], s[28:29] offset:1024 sc1
    v_cvt_pk_bf16_f32 v24, v48, v49
    v_cvt_pk_bf16_f32 v25, v50, v51
    v_cvt_pk_bf16_f32 v26, v52, v53
    v_cvt_pk_bf16_f32 v27, v54, v55
    global_store_dwordx4 v20, v[24:27], s[28:29] offset:2048 sc1
    v_cvt_pk_bf16_f32 v16, v56, v57
    v_cvt_pk_bf16_f32 v17, v58, v59
    v_cvt_pk_bf16_f32 v18, v60, v61
    v_cvt_pk_bf16_f32 v19, v62, v63
    global_store_dwordx4 v20, v[16:19], s[28:29] offset:3072 sc1
    v_cvt_pk_bf16_f32 v24, v64, v65
    v_cvt_pk_bf16_f32 v25, v66, v67
    v_cvt_pk_bf16_f32 v26, v68, v69
    v_cvt_pk_bf16_f32 v27, v70, v71
    global_store_dwordx4 v21, v[24:27], s[28:29] offset:0 sc1
    v_cvt_pk_bf16_f32 v16, v72, v73
    v_cvt_pk_bf16_f32 v17, v74, v75
    v_cvt_pk_bf16_f32 v18, v76, v77
    v_cvt_pk_bf16_f32 v19, v78, v79
    global_store_dwordx4 v21, v[16:19], s[28:29] offset:1024 sc1
    v_cvt_pk_bf16_f32 v24, v80, v81
    v_cvt_pk_bf16_f32 v25, v82, v83
    v_cvt_pk_bf16_f32 v26, v84, v85
    v_cvt_pk_bf16_f32 v27, v86, v87
    global_store_dwordx4 v21, v[24:27], s[28:29] offset:2048 sc1
    v_cvt_pk_bf16_f32 v16, v88, v89
    v_cvt_pk_bf16_f32 v17, v90, v91
    v_cvt_pk_bf16_f32 v18, v92, v93
    v_cvt_pk_bf16_f32 v19, v94, v95
    global_store_dwordx4 v21, v[16:19], s[28:29] offset:3072 sc1
    s_mul_i32 s32, s96, 4096
    s_add_u32 s32, s32, 0
    s_add_u32 s90, s4, s32
    s_addc_u32 s91, s5, 0
    s_mov_b32 s99, 4032
    s_mul_i32 s32, s96, 6144
    s_add_u32 s32, s32, 0
    s_add_u32 s92, s6, s32
    s_addc_u32 s93, s7, 0
    s_mov_b32 s100, 4032
    s_mul_i32 s32, s96, 6144
    s_add_u32 s32, s32, 4096
    s_add_u32 s94, s6, s32
    s_addc_u32 s95, s7, 0
    s_mov_b32 s101, 1984
    s_mov_b32 s98, 1
    s_mov_b32 s23, s44
    s_mov_b32 s30, s45
    s_mul_i32 s31, s23, 12
    s_add_u32 s31, s31, 32
    s_mul_i32 s76, s75, 3072
    s_mov_b32 s74, 2048
    v_lshrrev_b32 v16, 3, v0
    s_mul_i32 s64, s75, 24
    s_add_u32 s64, s64, 0
    v_add_u32 v16, s64, v16
    v_lshrrev_b32 v17, 1, v16
    v_xor_b32 v17, v17, v0
    v_and_b32 v17, 7, v17
    v_mul_lo_u32 v16, v16, s74
    v_lshl_add_u32 v28, v17, 4, v16
    v_lshrrev_b32 v16, 3, v0
    s_mul_i32 s64, s75, 24
    s_add_u32 s64, s64, 8
    v_add_u32 v16, s64, v16
    v_lshrrev_b32 v17, 1, v16
    v_xor_b32 v17, v17, v0
    v_and_b32 v17, 7, v17
    v_mul_lo_u32 v16, v16, s74
    v_lshl_add_u32 v29, v17, 4, v16
    v_lshrrev_b32 v16, 3, v0
    s_mul_i32 s64, s75, 24
    s_add_u32 s64, s64, 16
    v_add_u32 v16, s64, v16
    v_lshrrev_b32 v17, 1, v16
    v_xor_b32 v17, v17, v0
    v_and_b32 v17, 7, v17
    v_mul_lo_u32 v16, v16, s74
    v_lshl_add_u32 v30, v17, 4, v16
    v_and_b32 v16, 15, v0
    v_lshrrev_b32 v17, 1, v16
    v_lshrrev_b32 v18, 4, v0
    v_xor_b32 v17, v17, v18
    v_lshlrev_b32 v16, 7, v16
    v_lshl_add_u32 v6, v17, 4, v16
    s_mul_i32 s74, s72, 6144
    v_add_u32 v6, s74, v6
    v_xor_b32 v7, 64, v6
    s_mov_b32 s64, 128
    s_mov_b32 s86, 0
    v_lshrrev_b32 v16, 5, v0
    s_lshl_b32 s74, s75, 2
    s_add_u32 s74, s74, 0
    v_add_u32 v16, s74, v16
    v_and_b32 v17, 3, v16
    v_bfe_u32 v18, v16, 3, 1
    v_lshl_add_u32 v17, v18, 2, v17
    v_lshlrev_b32 v17, 1, v17
    v_and_b32 v18, 31, v0
    v_xor_b32 v17, v17, v18
    v_lshlrev_b32 v17, 4, v17
    s_mov_b32 s74, 8192
    v_mul_lo_u32 v16, v16, s74
    v_add_u32 v4, v16, v17
    v_lshrrev_b32 v16, 5, v0
    s_lshl_b32 s74, s75, 2
    s_add_u32 s74, s74, 2
    v_add_u32 v16, s74, v16
    v_and_b32 v17, 3, v16
    v_bfe_u32 v18, v16, 3, 1
    v_lshl_add_u32 v17, v18, 2, v17
    v_lshlrev_b32 v17, 1, v17
    v_and_b32 v18, 31, v0
    v_xor_b32 v17, v17, v18
    v_lshlrev_b32 v17, 4, v17
    s_mov_b32 s74, 8192
    v_mul_lo_u32 v16, v16, s74
    v_add_u32 v5, v16, v17
    s_mov_b32 s65, 262144
    s_mov_b32 s87, 0
    s_lshl_b32 s32, s31, 15
    s_add_u32 s80, s10, s32
    s_addc_u32 s81, s11, 0
    s_cmp_lt_u32 s30, 16
    s_cselect_b32 s82, s16, s18
    s_cselect_b32 s83, s17, s19
    s_cselect_b32 s33, 20, 52
    s_lshl_b32 s33, s33, 20
    s_and_b32 s35, s30, 15
    s_lshl_b32 s32, s35, 9
    s_add_u32 s82, s82, s32
    s_addc_u32 s83, s83, 0
    s_mov_b32 s66, 7
    s_waitcnt vmcnt(0)
    s_barrier
    s_cmp_lg_u32 s75, 0
    s_cbranch_scc1 sig_4
    v_mov_b32 v16, s88
    v_mov_b32 v17, 0
    s_mov_b64 exec, 1
    global_store_dword v16, v17, s[28:29] sc1
    s_mov_b64 exec, -1
sig_4:
    s_mul_i32 s32, s96, 3072
    s_add_u32 s32, s32, 1048576
    v_lshlrev_b32 v20, 6, v0
    v_min_u32 v20, 3008, v20
    v_add_u32 v20, s32, v20
    global_load_dword a95, v20, s[10:11]
    s_getpc_b64 s[70:71]
call_5:
    s_add_u32 s70, s70, core_T3-call_5
    s_addc_u32 s71, s71, (core_T3-call_5)>>32
    s_swappc_b64 s[68:69], s[70:71]
    s_lshl_b32 s34, s35, 1
    s_add_u32 s34, s34, s73
    s_lshl_b32 s34, s34, 14
    s_add_u32 s33, s33, s34
    s_mul_i32 s36, s72, 3
    s_add_u32 s36, s36, s31
    v_lshlrev_b32 v19, 4, v0
    s_add_u32 s32, s36, 0
    s_and_b32 s34, s32, 1
    s_lshl_b32 s34, s34, 12
    s_lshr_b32 s32, s32, 1
    s_lshl_b32 s32, s32, 19
    s_add_u32 s32, s32, s34
    s_add_u32 s32, s32, s33
    s_lshr_b32 s34, s32, 21
    s_xor_b32 s34, s34, s22
    s_xor_b32 s34, s34, 1
    s_and_b32 s34, s34, 1
    s_lshl_b32 s34, s34, 13
    s_add_u32 s32, s32, s34
    v_add_u32 v20, s32, v19
    s_add_u32 s32, s36, 1
    s_and_b32 s34, s32, 1
    s_lshl_b32 s34, s34, 12
    s_lshr_b32 s32, s32, 1
    s_lshl_b32 s32, s32, 19
    s_add_u32 s32, s32, s34
    s_add_u32 s32, s32, s33
    s_lshr_b32 s34, s32, 21
    s_xor_b32 s34, s34, s22
    s_xor_b32 s34, s34, 1
    s_and_b32 s34, s34, 1
    s_lshl_b32 s34, s34, 13
    s_add_u32 s32, s32, s34
    v_add_u32 v21, s32, v19
    s_add_u32 s32, s36, 2
    s_and_b32 s34, s32, 1
    s_lshl_b32 s34, s34, 12
    s_lshr_b32 s32, s32, 1
    s_lshl_b32 s32, s32, 19
    s_add_u32 s32, s32, s34
    s_add_u32 s32, s32, s33
    s_lshr_b32 s34, s32, 21
    s_xor_b32 s34, s34, s22
    s_xor_b32 s34, s34, 1
    s_and_b32 s34, s34, 1
    s_lshl_b32 s34, s34, 13
    s_add_u32 s32, s32, s34
    v_add_u32 v22, s32, v19
    s_lshl_b32 s88, s23, 7
    s_lshl_b32 s32, s30, 2
    s_add_u32 s88, s88, s32
    s_add_u32 s88, s88, 1978880
    s_mov_b32 s89, 1
    s_mov_b32 s77, 1
    s_mul_i32 s32, s96, 8192
    s_add_u32 s32, s32, 0
    s_add_u32 s90, s14, s32
    s_addc_u32 s91, s15, 0
    s_mov_b32 s99, 4032
    s_mul_i32 s32, s96, 8192
    s_add_u32 s32, s32, 4096
    s_add_u32 s92, s14, s32
    s_addc_u32 s93, s15, 0
    s_mov_b32 s100, 4032
    s_mul_i32 s32, s96, 2048
    s_add_u32 s32, s32, 0
    s_add_u32 s94, s8, s32
    s_addc_u32 s95, s9, 0
    s_mov_b32 s101, 1984
    s_mov_b32 s98, 1
    s_cmp_lt_u32 s44, 2
    s_cbranch_scc1 w_g1c
    s_lshl_b32 s23, s44, 1
    s_and_b32 s32, s45, 1
    s_add_u32 s23, s23, s32
    s_cmp_eq_u32 s23, 6
    s_cbranch_scc1 w_wot0
    s_bfe_u32 s30, s45, 0x10003
    s_lshl_b32 s30, s30, 1
    s_and_b32 s32, s45, 1
    s_add_u32 s30, s30, s32
    s_lshr_b32 s31, s45, 4
    s_lshl_b32 s31, s31, 2
    s_bfe_u32 s32, s45, 0x20001
    s_add_u32 s31, s31, s32
    s_and_b32 s32, s44, 1
    s_lshl_b32 s32, s32, 2
    s_add_u32 s30, s30, s32
w_kv:
    s_mul_i32 s76, s75, 4096
    s_mov_b32 s74, 2048
    v_lshrrev_b32 v16, 3, v0
    s_mul_i32 s64, s75, 32
    s_add_u32 s64, s64, 0
    v_add_u32 v16, s64, v16
    v_lshrrev_b32 v17, 1, v16
    v_xor_b32 v17, v17, v0
    v_and_b32 v17, 7, v17
    v_mul_lo_u32 v16, v16, s74
    v_lshl_add_u32 v28, v17, 4, v16
    v_lshrrev_b32 v16, 3, v0
    s_mul_i32 s64, s75, 32
    s_add_u32 s64, s64, 8
    v_add_u32 v16, s64, v16
    v_lshrrev_b32 v17, 1, v16
    v_xor_b32 v17, v17, v0
    v_and_b32 v17, 7, v17
    v_mul_lo_u32 v16, v16, s74
    v_lshl_add_u32 v29, v17, 4, v16
    v_lshrrev_b32 v16, 3, v0
    s_mul_i32 s64, s75, 32
    s_add_u32 s64, s64, 16
    v_add_u32 v16, s64, v16
    v_lshrrev_b32 v17, 1, v16
    v_xor_b32 v17, v17, v0
    v_and_b32 v17, 7, v17
    v_mul_lo_u32 v16, v16, s74
    v_lshl_add_u32 v30, v17, 4, v16
    v_lshrrev_b32 v16, 3, v0
    s_mul_i32 s64, s75, 32
    s_add_u32 s64, s64, 24
    v_add_u32 v16, s64, v16
    v_lshrrev_b32 v17, 1, v16
    v_xor_b32 v17, v17, v0
    v_and_b32 v17, 7, v17
    v_mul_lo_u32 v16, v16, s74
    v_lshl_add_u32 v31, v17, 4, v16
    v_and_b32 v16, 15, v0
    v_lshrrev_b32 v17, 1, v16
    v_lshrrev_b32 v18, 4, v0
    v_xor_b32 v17, v17, v18
    v_lshlrev_b32 v16, 7, v16
    v_lshl_add_u32 v6, v17, 4, v16
    s_mul_i32 s74, s72, 8192
    v_add_u32 v6, s74, v6
    v_xor_b32 v7, 64, v6
    s_mov_b32 s64, 128
    s_mov_b32 s86, 0
    v_lshrrev_b32 v16, 5, v0
    s_lshl_b32 s74, s75, 2
    s_add_u32 s74, s74, 0
    v_add_u32 v16, s74, v16
    v_and_b32 v17, 3, v16
    v_bfe_u32 v18, v16, 3, 1
    v_lshl_add_u32 v17, v18, 2, v17
    v_lshlrev_b32 v17, 1, v17
    v_and_b32 v18, 31, v0
    v_xor_b32 v17, v17, v18
    v_bfe_u32 v18, v17, 3, 1
    v_lshlrev_b32 v18, 11, v18
    v_lshrrev_b32 v19, 4, v17
    v_lshl_add_u32 v18, v19, 7, v18
    v_and_b32 v17, 7, v17
    v_lshl_add_u32 v17, v17, 4, v18
    s_mov_b32 s74, 6144
    v_mul_lo_u32 v16, v16, s74
    v_add_u32 v4, v16, v17
    v_lshrrev_b32 v16, 5, v0
    s_lshl_b32 s74, s75, 2
    s_add_u32 s74, s74, 2
    v_add_u32 v16, s74, v16
    v_and_b32 v17, 3, v16
    v_bfe_u32 v18, v16, 3, 1
    v_lshl_add_u32 v17, v18, 2, v17
    v_lshlrev_b32 v17, 1, v17
    v_and_b32 v18, 31, v0
    v_xor_b32 v17, v17, v18
    v_bfe_u32 v18, v17, 3, 1
    v_lshlrev_b32 v18, 11, v18
    v_lshrrev_b32 v19, 4, v17
    v_lshl_add_u32 v18, v19, 7, v18
    v_and_b32 v17, 7, v17
    v_lshl_add_u32 v17, v17, 4, v18
    s_mov_b32 s74, 6144
    v_mul_lo_u32 v16, v16, s74
    v_add_u32 v5, v16, v17
    s_mov_b32 s65, 196608
    s_mov_b32 s87, 0
    s_lshl_b32 s32, s31, 19
    s_add_u32 s80, s4, s32
    s_addc_u32 s81, s5, 0
    s_lshl_b32 s32, s30, 8
    s_add_u32 s32, s32, 2048
    s_add_u32 s82, s6, s32
    s_addc_u32 s83, s7, 0
    s_mov_b32 s66, 7
    s_getpc_b64 s[70:71]
call_6:
    s_add_u32 s70, s70, core_N-call_6
    s_addc_u32 s71, s71, (core_N-call_6)>>32
    s_swappc_b64 s[68:69], s[70:71]
    s_mov_b32 s40, 1069066811
    s_mov_b32 s41, 897988541
    v_mul_f32 v16, s40, v32
    v_mul_f32 v17, s40, v33
    v_mul_f32 v18, s40, v34
    v_mul_f32 v19, s40, v35
    v_mul_f32 v20, s40, v36
    v_mul_f32 v21, s40, v37
    v_mul_f32 v22, s40, v38
    v_mul_f32 v23, s40, v39
    v_min_f32 v16, 0, v16
    v_min_f32 v17, 0, v17
    v_min_f32 v18, 0, v18
    v_min_f32 v19, 0, v19
    v_min_f32 v20, 0, v20
    v_min_f32 v21, 0, v21
    v_min_f32 v22, 0, v22
    v_min_f32 v23, 0, v23
    v_exp_f32 v16, v16
    v_exp_f32 v17, v17
    v_exp_f32 v18, v18
    v_exp_f32 v19, v19
    v_exp_f32 v20, v20
    v_exp_f32 v21, v21
    v_exp_f32 v22, v22
    v_exp_f32 v23, v23
    v_max_f32 v32, 0, v32
    v_max_f32 v33, 0, v33
    v_max_f32 v34, 0, v34
    v_max_f32 v35, 0, v35
    v_max_f32 v36, 0, v36
    v_max_f32 v37, 0, v37
    v_max_f32 v38, 0, v38
    v_max_f32 v39, 0, v39
    v_add_f32 v32, v32, v16
    v_add_f32 v33, v33, v17
    v_add_f32 v34, v34, v18
    v_add_f32 v35, v35, v19
    v_add_f32 v36, v36, v20
    v_add_f32 v37, v37, v21
    v_add_f32 v38, v38, v22
    v_add_f32 v39, v39, v23
    v_add_f32 v32, s41, v32
    v_add_f32 v33, s41, v33
    v_add_f32 v34, s41, v34
    v_add_f32 v35, s41, v35
    v_add_f32 v36, s41, v36
    v_add_f32 v37, s41, v37
    v_add_f32 v38, s41, v38
    v_add_f32 v39, s41, v39
    v_mul_f32 v16, s40, v40
    v_mul_f32 v17, s40, v41
    v_mul_f32 v18, s40, v42
    v_mul_f32 v19, s40, v43
    v_mul_f32 v20, s40, v44
    v_mul_f32 v21, s40, v45
    v_mul_f32 v22, s40, v46
    v_mul_f32 v23, s40, v47
    v_min_f32 v16, 0, v16
    v_min_f32 v17, 0, v17
    v_min_f32 v18, 0, v18
    v_min_f32 v19, 0, v19
    v_min_f32 v20, 0, v20
    v_min_f32 v21, 0, v21
    v_min_f32 v22, 0, v22
    v_min_f32 v23, 0, v23
    v_exp_f32 v16, v16
    v_exp_f32 v17, v17
    v_exp_f32 v18, v18
    v_exp_f32 v19, v19
    v_exp_f32 v20, v20
    v_exp_f32 v21, v21
    v_exp_f32 v22, v22
    v_exp_f32 v23, v23
    v_max_f32 v40, 0, v40
    v_max_f32 v41, 0, v41
    v_max_f32 v42, 0, v42
    v_max_f32 v43, 0, v43
    v_max_f32 v44, 0, v44
    v_max_f32 v45, 0, v45
    v_max_f32 v46, 0, v46
    v_max_f32 v47, 0, v47
    v_add_f32 v40, v40, v16
    v_add_f32 v41, v41, v17
    v_add_f32 v42, v42, v18
    v_add_f32 v43, v43, v19
    v_add_f32 v44, v44, v20
    v_add_f32 v45, v45, v21
    v_add_f32 v46, v46, v22
    v_add_f32 v47, v47, v23
    v_add_f32 v40, s41, v40
    v_add_f32 v41, s41, v41
    v_add_f32 v42, s41, v42
    v_add_f32 v43, s41, v43
    v_add_f32 v44, s41, v44
    v_add_f32 v45, s41, v45
    v_add_f32 v46, s41, v46
    v_add_f32 v47, s41, v47
    v_mul_f32 v16, s40, v64
    v_mul_f32 v17, s40, v65
    v_mul_f32 v18, s40, v66
    v_mul_f32 v19, s40, v67
    v_mul_f32 v20, s40, v68
    v_mul_f32 v21, s40, v69
    v_mul_f32 v22, s40, v70
    v_mul_f32 v23, s40, v71
    v_min_f32 v16, 0, v16
    v_min_f32 v17, 0, v17
    v_min_f32 v18, 0, v18
    v_min_f32 v19, 0, v19
    v_min_f32 v20, 0, v20
    v_min_f32 v21, 0, v21
    v_min_f32 v22, 0, v22
    v_min_f32 v23, 0, v23
    v_exp_f32 v16, v16
    v_exp_f32 v17, v17
    v_exp_f32 v18, v18
    v_exp_f32 v19, v19
    v_exp_f32 v20, v20
    v_exp_f32 v21, v21
    v_exp_f32 v22, v22
    v_exp_f32 v23, v23
    v_max_f32 v64, 0, v64
    v_max_f32 v65, 0, v65
    v_max_f32 v66, 0, v66
    v_max_f32 v67, 0, v67
    v_max_f32 v68, 0, v68
    v_max_f32 v69, 0, v69
    v_max_f32 v70, 0, v70
    v_max_f32 v71, 0, v71
    v_add_f32 v64, v64, v16
    v_add_f32 v65, v65, v17
    v_add_f32 v66, v66, v18
    v_add_f32 v67, v67, v19
    v_add_f32 v68, v68, v20
    v_add_f32 v69, v69, v21
    v_add_f32 v70, v70, v22
    v_add_f32 v71, v71, v23
    v_add_f32 v64, s41, v64
    v_add_f32 v65, s41, v65
    v_add_f32 v66, s41, v66
    v_add_f32 v67, s41, v67
    v_add_f32 v68, s41, v68
    v_add_f32 v69, s41, v69
    v_add_f32 v70, s41, v70
    v_add_f32 v71, s41, v71
    v_mul_f32 v16, s40, v72
    v_mul_f32 v17, s40, v73
    v_mul_f32 v18, s40, v74
    v_mul_f32 v19, s40, v75
    v_mul_f32 v20, s40, v76
    v_mul_f32 v21, s40, v77
    v_mul_f32 v22, s40, v78
    v_mul_f32 v23, s40, v79
    v_min_f32 v16, 0, v16
    v_min_f32 v17, 0, v17
    v_min_f32 v18, 0, v18
    v_min_f32 v19, 0, v19
    v_min_f32 v20, 0, v20
    v_min_f32 v21, 0, v21
    v_min_f32 v22, 0, v22
    v_min_f32 v23, 0, v23
    v_exp_f32 v16, v16
    v_exp_f32 v17, v17
    v_exp_f32 v18, v18
    v_exp_f32 v19, v19
    v_exp_f32 v20, v20
    v_exp_f32 v21, v21
    v_exp_f32 v22, v22
    v_exp_f32 v23, v23
    v_max_f32 v72, 0, v72
    v_max_f32 v73, 0, v73
    v_max_f32 v74, 0, v74
    v_max_f32 v75, 0, v75
    v_max_f32 v76, 0, v76
    v_max_f32 v77, 0, v77
    v_max_f32 v78, 0, v78
    v_max_f32 v79, 0, v79
    v_add_f32 v72, v72, v16
    v_add_f32 v73, v73, v17
    v_add_f32 v74, v74, v18
    v_add_f32 v75, v75, v19
    v_add_f32 v76, v76, v20
    v_add_f32 v77, v77, v21
    v_add_f32 v78, v78, v22
    v_add_f32 v79, v79, v23
    v_add_f32 v72, s41, v72
    v_add_f32 v73, s41, v73
    v_add_f32 v74, s41, v74
    v_add_f32 v75, s41, v75
    v_add_f32 v76, s41, v76
    v_add_f32 v77, s41, v77
    v_add_f32 v78, s41, v78
    v_add_f32 v79, s41, v79
    v_mul_f32 v16, s40, v96
    v_mul_f32 v17, s40, v97
    v_mul_f32 v18, s40, v98
    v_mul_f32 v19, s40, v99
    v_mul_f32 v20, s40, v100
    v_mul_f32 v21, s40, v101
    v_mul_f32 v22, s40, v102
    v_mul_f32 v23, s40, v103
    v_min_f32 v16, 0, v16
    v_min_f32 v17, 0, v17
    v_min_f32 v18, 0, v18
    v_min_f32 v19, 0, v19
    v_min_f32 v20, 0, v20
    v_min_f32 v21, 0, v21
    v_min_f32 v22, 0, v22
    v_min_f32 v23, 0, v23
    v_exp_f32 v16, v16
    v_exp_f32 v17, v17
    v_exp_f32 v18, v18
    v_exp_f32 v19, v19
    v_exp_f32 v20, v20
    v_exp_f32 v21, v21
    v_exp_f32 v22, v22
    v_exp_f32 v23, v23
    v_max_f32 v96, 0, v96
    v_max_f32 v97, 0, v97
    v_max_f32 v98, 0, v98
    v_max_f32 v99, 0, v99
    v_max_f32 v100, 0, v100
    v_max_f32 v101, 0, v101
    v_max_f32 v102, 0, v102
    v_max_f32 v103, 0, v103
    v_add_f32 v96, v96, v16
    v_add_f32 v97, v97, v17
    v_add_f32 v98, v98, v18
    v_add_f32 v99, v99, v19
    v_add_f32 v100, v100, v20
    v_add_f32 v101, v101, v21
    v_add_f32 v102, v102, v22
    v_add_f32 v103, v103, v23
    v_add_f32 v96, s41, v96
    v_add_f32 v97, s41, v97
    v_add_f32 v98, s41, v98
    v_add_f32 v99, s41, v99
    v_add_f32 v100, s41, v100
    v_add_f32 v101, s41, v101
    v_add_f32 v102, s41, v102
    v_add_f32 v103, s41, v103
    v_mul_f32 v16, s40, v104
    v_mul_f32 v17, s40, v105
    v_mul_f32 v18, s40, v106
    v_mul_f32 v19, s40, v107
    v_mul_f32 v20, s40, v108
    v_mul_f32 v21, s40, v109
    v_mul_f32 v22, s40, v110
    v_mul_f32 v23, s40, v111
    v_min_f32 v16, 0, v16
    v_min_f32 v17, 0, v17
    v_min_f32 v18, 0, v18
    v_min_f32 v19, 0, v19
    v_min_f32 v20, 0, v20
    v_min_f32 v21, 0, v21
    v_min_f32 v22, 0, v22
    v_min_f32 v23, 0, v23
    v_exp_f32 v16, v16
    v_exp_f32 v17, v17
    v_exp_f32 v18, v18
    v_exp_f32 v19, v19
    v_exp_f32 v20, v20
    v_exp_f32 v21, v21
    v_exp_f32 v22, v22
    v_exp_f32 v23, v23
    v_max_f32 v104, 0, v104
    v_max_f32 v105, 0, v105
    v_max_f32 v106, 0, v106
    v_max_f32 v107, 0, v107
    v_max_f32 v108, 0, v108
    v_max_f32 v109, 0, v109
    v_max_f32 v110, 0, v110
    v_max_f32 v111, 0, v111
    v_add_f32 v104, v104, v16
    v_add_f32 v105, v105, v17
    v_add_f32 v106, v106, v18
    v_add_f32 v107, v107, v19
    v_add_f32 v108, v108, v20
    v_add_f32 v109, v109, v21
    v_add_f32 v110, v110, v22
    v_add_f32 v111, v111, v23
    v_add_f32 v104, s41, v104
    v_add_f32 v105, s41, v105
    v_add_f32 v106, s41, v106
    v_add_f32 v107, s41, v107
    v_add_f32 v108, s41, v108
    v_add_f32 v109, s41, v109
    v_add_f32 v110, s41, v110
    v_add_f32 v111, s41, v111
    v_mul_f32 v16, s40, v128
    v_mul_f32 v17, s40, v129
    v_mul_f32 v18, s40, v130
    v_mul_f32 v19, s40, v131
    v_mul_f32 v20, s40, v132
    v_mul_f32 v21, s40, v133
    v_mul_f32 v22, s40, v134
    v_mul_f32 v23, s40, v135
    v_min_f32 v16, 0, v16
    v_min_f32 v17, 0, v17
    v_min_f32 v18, 0, v18
    v_min_f32 v19, 0, v19
    v_min_f32 v20, 0, v20
    v_min_f32 v21, 0, v21
    v_min_f32 v22, 0, v22
    v_min_f32 v23, 0, v23
    v_exp_f32 v16, v16
    v_exp_f32 v17, v17
    v_exp_f32 v18, v18
    v_exp_f32 v19, v19
    v_exp_f32 v20, v20
    v_exp_f32 v21, v21
    v_exp_f32 v22, v22
    v_exp_f32 v23, v23
    v_max_f32 v128, 0, v128
    v_max_f32 v129, 0, v129
    v_max_f32 v130, 0, v130
    v_max_f32 v131, 0, v131
    v_max_f32 v132, 0, v132
    v_max_f32 v133, 0, v133
    v_max_f32 v134, 0, v134
    v_max_f32 v135, 0, v135
    v_add_f32 v128, v128, v16
    v_add_f32 v129, v129, v17
    v_add_f32 v130, v130, v18
    v_add_f32 v131, v131, v19
    v_add_f32 v132, v132, v20
    v_add_f32 v133, v133, v21
    v_add_f32 v134, v134, v22
    v_add_f32 v135, v135, v23
    v_add_f32 v128, s41, v128
    v_add_f32 v129, s41, v129
    v_add_f32 v130, s41, v130
    v_add_f32 v131, s41, v131
    v_add_f32 v132, s41, v132
    v_add_f32 v133, s41, v133
    v_add_f32 v134, s41, v134
    v_add_f32 v135, s41, v135
    v_mul_f32 v16, s40, v136
    v_mul_f32 v17, s40, v137
    v_mul_f32 v18, s40, v138
    v_mul_f32 v19, s40, v139
    v_mul_f32 v20, s40, v140
    v_mul_f32 v21, s40, v141
    v_mul_f32 v22, s40, v142
    v_mul_f32 v23, s40, v143
    v_min_f32 v16, 0, v16
    v_min_f32 v17, 0, v17
    v_min_f32 v18, 0, v18
    v_min_f32 v19, 0, v19
    v_min_f32 v20, 0, v20
    v_min_f32 v21, 0, v21
    v_min_f32 v22, 0, v22
    v_min_f32 v23, 0, v23
    v_exp_f32 v16, v16
    v_exp_f32 v17, v17
    v_exp_f32 v18, v18
    v_exp_f32 v19, v19
    v_exp_f32 v20, v20
    v_exp_f32 v21, v21
    v_exp_f32 v22, v22
    v_exp_f32 v23, v23
    v_max_f32 v136, 0, v136
    v_max_f32 v137, 0, v137
    v_max_f32 v138, 0, v138
    v_max_f32 v139, 0, v139
    v_max_f32 v140, 0, v140
    v_max_f32 v141, 0, v141
    v_max_f32 v142, 0, v142
    v_max_f32 v143, 0, v143
    v_add_f32 v136, v136, v16
    v_add_f32 v137, v137, v17
    v_add_f32 v138, v138, v18
    v_add_f32 v139, v139, v19
    v_add_f32 v140, v140, v20
    v_add_f32 v141, v141, v21
    v_add_f32 v142, v142, v22
    v_add_f32 v143, v143, v23
    v_add_f32 v136, s41, v136
    v_add_f32 v137, s41, v137
    v_add_f32 v138, s41, v138
    v_add_f32 v139, s41, v139
    v_add_f32 v140, s41, v140
    v_add_f32 v141, s41, v141
    v_add_f32 v142, s41, v142
    v_add_f32 v143, s41, v143
    v_cvt_pk_bf16_f32 v32, v32, v33
    v_cvt_pk_bf16_f32 v33, v34, v35
    v_cvt_pk_bf16_f32 v34, v64, v65
    v_cvt_pk_bf16_f32 v35, v66, v67
    v_cvt_pk_bf16_f32 v36, v36, v37
    v_cvt_pk_bf16_f32 v37, v38, v39
    v_cvt_pk_bf16_f32 v38, v68, v69
    v_cvt_pk_bf16_f32 v39, v70, v71
    v_cvt_pk_bf16_f32 v40, v40, v41
    v_cvt_pk_bf16_f32 v41, v42, v43
    v_cvt_pk_bf16_f32 v42, v72, v73
    v_cvt_pk_bf16_f32 v43, v74, v75
    v_cvt_pk_bf16_f32 v44, v44, v45
    v_cvt_pk_bf16_f32 v45, v46, v47
    v_cvt_pk_bf16_f32 v46, v76, v77
    v_cvt_pk_bf16_f32 v47, v78, v79
    v_cvt_pk_bf16_f32 v48, v48, v49
    v_cvt_pk_bf16_f32 v49, v50, v51
    v_cvt_pk_bf16_f32 v50, v80, v81
    v_cvt_pk_bf16_f32 v51, v82, v83
    v_cvt_pk_bf16_f32 v52, v52, v53
    v_cvt_pk_bf16_f32 v53, v54, v55
    v_cvt_pk_bf16_f32 v54, v84, v85
    v_cvt_pk_bf16_f32 v55, v86, v87
    v_cvt_pk_bf16_f32 v56, v56, v57
    v_cvt_pk_bf16_f32 v57, v58, v59
    v_cvt_pk_bf16_f32 v58, v88, v89
    v_cvt_pk_bf16_f32 v59, v90, v91
    v_cvt_pk_bf16_f32 v60, v60, v61
    v_cvt_pk_bf16_f32 v61, v62, v63
    v_cvt_pk_bf16_f32 v62, v92, v93
    v_cvt_pk_bf16_f32 v63, v94, v95
    v_cvt_pk_bf16_f32 v96, v96, v97
    v_cvt_pk_bf16_f32 v97, v98, v99
    v_cvt_pk_bf16_f32 v98, v128, v129
    v_cvt_pk_bf16_f32 v99, v130, v131
    v_cvt_pk_bf16_f32 v100, v100, v101
    v_cvt_pk_bf16_f32 v101, v102, v103
    v_cvt_pk_bf16_f32 v102, v132, v133
    v_cvt_pk_bf16_f32 v103, v134, v135
    v_cvt_pk_bf16_f32 v104, v104, v105
    v_cvt_pk_bf16_f32 v105, v106, v107
    v_cvt_pk_bf16_f32 v106, v136, v137
    v_cvt_pk_bf16_f32 v107, v138, v139
    v_cvt_pk_bf16_f32 v108, v108, v109
    v_cvt_pk_bf16_f32 v109, v110, v111
    v_cvt_pk_bf16_f32 v110, v140, v141
    v_cvt_pk_bf16_f32 v111, v142, v143
    v_cvt_pk_bf16_f32 v112, v112, v113
    v_cvt_pk_bf16_f32 v113, v114, v115
    v_cvt_pk_bf16_f32 v114, v144, v145
    v_cvt_pk_bf16_f32 v115, v146, v147
    v_cvt_pk_bf16_f32 v116, v116, v117
    v_cvt_pk_bf16_f32 v117, v118, v119
    v_cvt_pk_bf16_f32 v118, v148, v149
    v_cvt_pk_bf16_f32 v119, v150, v151
    v_cvt_pk_bf16_f32 v120, v120, v121
    v_cvt_pk_bf16_f32 v121, v122, v123
    v_cvt_pk_bf16_f32 v122, v152, v153
    v_cvt_pk_bf16_f32 v123, v154, v155
    v_cvt_pk_bf16_f32 v124, v124, v125
    v_cvt_pk_bf16_f32 v125, v126, v127
    v_cvt_pk_bf16_f32 v126, v156, v157
    v_cvt_pk_bf16_f32 v127, v158, v159
    v_mov_b32 v16, 0x3f803f80
    v_mov_b32 v17, 0x3f803f80
    v_mov_b32 v18, 0x3f803f80
    v_mov_b32 v19, 0x3f803f80
    v_lshlrev_b32 v20, 4, v0
    s_mul_i32 s32, s73, 49152
    s_lshl_b32 s33, s72, 10
    s_add_u32 s32, s32, s33
    v_add_u32 v21, s32, v20
    v_mfma_f32_16x16x32_bf16 v[64:67], v[32:35], v[48:51], 0
    v_mfma_f32_16x16x32_bf16 v[68:71], v[36:39], v[48:51], 0
    v_mfma_f32_16x16x32_bf16 v[72:75], v[32:35], v[52:55], 0
    v_mfma_f32_16x16x32_bf16 v[76:79], v[36:39], v[52:55], 0
    v_mfma_f32_16x16x32_bf16 v[80:83], v[32:35], v[16:19], 0
    v_mfma_f32_16x16x32_bf16 v[84:87], v[36:39], v[16:19], 0
    v_mfma_f32_16x16x32_bf16 v[128:131], v[40:43], v[56:59], 0
    v_mfma_f32_16x16x32_bf16 v[132:135], v[44:47], v[56:59], 0
    v_mfma_f32_16x16x32_bf16 v[136:139], v[40:43], v[60:63], 0
    v_mfma_f32_16x16x32_bf16 v[140:143], v[44:47], v[60:63], 0
    v_mfma_f32_16x16x32_bf16 v[144:147], v[40:43], v[16:19], 0
    v_mfma_f32_16x16x32_bf16 v[148:151], v[44:47], v[16:19], 0
    v_mfma_f32_16x16x32_bf16 v[64:67], v[96:99], v[112:115], v[64:67]
    v_mfma_f32_16x16x32_bf16 v[68:71], v[100:103], v[112:115], v[68:71]
    v_mfma_f32_16x16x32_bf16 v[72:75], v[96:99], v[116:119], v[72:75]
    v_mfma_f32_16x16x32_bf16 v[76:79], v[100:103], v[116:119], v[76:79]
    v_mfma_f32_16x16x32_bf16 v[80:83], v[96:99], v[16:19], v[80:83]
    v_mfma_f32_16x16x32_bf16 v[84:87], v[100:103], v[16:19], v[84:87]
    v_mfma_f32_16x16x32_bf16 v[128:131], v[104:107], v[120:123], v[128:131]
    v_mfma_f32_16x16x32_bf16 v[132:135], v[108:111], v[120:123], v[132:135]
    v_mfma_f32_16x16x32_bf16 v[136:139], v[104:107], v[124:127], v[136:139]
    v_mfma_f32_16x16x32_bf16 v[140:143], v[108:111], v[124:127], v[140:143]
    v_mfma_f32_16x16x32_bf16 v[144:147], v[104:107], v[16:19], v[144:147]
    v_mfma_f32_16x16x32_bf16 v[148:151], v[108:111], v[16:19], v[148:151]
    s_barrier
    s_nop 7
    ds_write_b128 v21, v[64:67] offset:0
    ds_write_b128 v21, v[68:71] offset:4096
    ds_write_b128 v21, v[72:75] offset:8192
    ds_write_b128 v21, v[76:79] offset:12288
    ds_write_b128 v21, v[80:83] offset:16384
    ds_write_b128 v21, v[84:87] offset:20480
    ds_write_b128 v21, v[128:131] offset:24576
    ds_write_b128 v21, v[132:135] offset:28672
    ds_write_b128 v21, v[136:139] offset:32768
    ds_write_b128 v21, v[140:143] offset:36864
    ds_write_b128 v21, v[144:147] offset:40960
    ds_write_b128 v21, v[148:151] offset:45056
    s_mul_i32 s32, s75, 12288
    v_add_u32 v21, s32, v20
    s_waitcnt lgkmcnt(0)
    s_barrier
    ds_read_b128 v[32:35], v21 offset:0
    ds_read_b128 v[36:39], v21 offset:1024
    ds_read_b128 v[40:43], v21 offset:2048
    ds_read_b128 v[44:47], v21 offset:3072
    ds_read_b128 v[48:51], v21 offset:4096
    ds_read_b128 v[52:55], v21 offset:5120
    ds_read_b128 v[56:59], v21 offset:6144
    ds_read_b128 v[60:63], v21 offset:7168
    ds_read_b128 v[64:67], v21 offset:8192
    ds_read_b128 v[68:71], v21 offset:9216
    ds_read_b128 v[72:75], v21 offset:10240
    ds_read_b128 v[76:79], v21 offset:11264
    s_lshl_b32 s32, s31, 5
    s_lshl_b32 s33, s30, 2
    s_add_u32 s32, s32, s33
    s_mul_i32 s32, s32, 6144
    s_mul_i32 s33, s75, 3072
    s_add_u32 s32, s32, s33
    s_add_u32 s32, s32, 130023424
    v_add_u32 v22, s32, v20
    s_waitcnt lgkmcnt(0)
    v_pk_add_f32 v[32:33], v[32:33], v[36:37]
    v_pk_add_f32 v[40:41], v[40:41], v[44:45]
    v_pk_add_f32 v[34:35], v[34:35], v[38:39]
    v_pk_add_f32 v[42:43], v[42:43], v[46:47]
    v_pk_add_f32 v[32:33], v[32:33], v[40:41]
    v_pk_add_f32 v[34:35], v[34:35], v[42:43]
    global_store_dwordx4 v22, v[32:35], s[28:29] offset:0 sc1
    v_pk_add_f32 v[48:49], v[48:49], v[52:53]
    v_pk_add_f32 v[56:57], v[56:57], v[60:61]
    v_pk_add_f32 v[50:51], v[50:51], v[54:55]
    v_pk_add_f32 v[58:59], v[58:59], v[62:63]
    v_pk_add_f32 v[48:49], v[48:49], v[56:57]
    v_pk_add_f32 v[50:51], v[50:51], v[58:59]
    global_store_dwordx4 v22, v[48:51], s[28:29] offset:1024 sc1
    v_pk_add_f32 v[64:65], v[64:65], v[68:69]
    v_pk_add_f32 v[72:73], v[72:73], v[76:77]
    v_pk_add_f32 v[66:67], v[66:67], v[70:71]
    v_pk_add_f32 v[74:75], v[74:75], v[78:79]
    v_pk_add_f32 v[64:65], v[64:65], v[72:73]
    v_pk_add_f32 v[66:67], v[66:67], v[74:75]
    global_store_dwordx4 v22, v[64:67], s[28:29] offset:2048 sc1
    s_waitcnt vmcnt(0)
    s_barrier
    s_cmp_lg_u32 s75, 0
    s_cbranch_scc1 sig_7
    v_mov_b32 v16, 36
    v_mov_b32 v17, 1
    s_mov_b64 exec, 1
    global_atomic_add v16, v17, s[26:27] sc1
    s_mov_b64 exec, -1
sig_7:
    s_cmp_eq_u32 s23, 5
    s_cbranch_scc0 w_kvd
    s_mov_b32 s23, 7
    s_add_u32 s30, s30, 3
    s_branch w_kv
w_kvd:
    s_cmp_eq_u32 s23, 7
    s_cbranch_scc1 w_g1c
w_wot0:
    s_and_b32 s32, s44, 1
    s_add_u32 s30, s45, s32
    s_mov_b32 s31, 0
w_wot:
    s_barrier
    v_lshrrev_b32 v2, 4, v0
    v_lshlrev_b32 v2, 11, v2
    v_and_b32 v3, 15, v0
    v_lshl_add_u32 v2, v3, 4, v2
    s_lshl_b32 s32, s30, 18
    s_lshl_b32 s33, s31, 17
    s_add_u32 s32, s32, s33
    s_lshl_b32 s33, s75, 8
    s_add_u32 s32, s32, s33
    v_add_u32 v2, s32, v2
    s_lshl_b32 s43, s75, 14
    s_add_u32 m0, s43, 0
    s_nop 0
    global_load_lds_dwordx4 v2, s[20:21]
    v_add_u32 v2, 0x2000, v2
    s_add_u32 m0, s43, 1024
    s_nop 0
    global_load_lds_dwordx4 v2, s[20:21]
    v_add_u32 v2, 0x2000, v2
    s_add_u32 m0, s43, 2048
    s_nop 0
    global_load_lds_dwordx4 v2, s[20:21]
    v_add_u32 v2, 0x2000, v2
    s_add_u32 m0, s43, 3072
    s_nop 0
    global_load_lds_dwordx4 v2, s[20:21]
    v_add_u32 v2, 0x2000, v2
    s_add_u32 m0, s43, 4096
    s_nop 0
    global_load_lds_dwordx4 v2, s[20:21]
    v_add_u32 v2, 0x2000, v2
    s_add_u32 m0, s43, 5120
    s_nop 0
    global_load_lds_dwordx4 v2, s[20:21]
    v_add_u32 v2, 0x2000, v2
    s_add_u32 m0, s43, 6144
    s_nop 0
    global_load_lds_dwordx4 v2, s[20:21]
    v_add_u32 v2, 0x2000, v2
    s_add_u32 m0, s43, 7168
    s_nop 0
    global_load_lds_dwordx4 v2, s[20:21]
    v_add_u32 v2, 0x2000, v2
    s_add_u32 m0, s43, 8192
    s_nop 0
    global_load_lds_dwordx4 v2, s[20:21]
    v_add_u32 v2, 0x2000, v2
    s_add_u32 m0, s43, 9216
    s_nop 0
    global_load_lds_dwordx4 v2, s[20:21]
    v_add_u32 v2, 0x2000, v2
    s_add_u32 m0, s43, 10240
    s_nop 0
    global_load_lds_dwordx4 v2, s[20:21]
    v_add_u32 v2, 0x2000, v2
    s_add_u32 m0, s43, 11264
    s_nop 0
    global_load_lds_dwordx4 v2, s[20:21]
    v_add_u32 v2, 0x2000, v2
    s_add_u32 m0, s43, 12288
    s_nop 0
    global_load_lds_dwordx4 v2, s[20:21]
    v_add_u32 v2, 0x2000, v2
    s_add_u32 m0, s43, 13312
    s_nop 0
    global_load_lds_dwordx4 v2, s[20:21]
    v_add_u32 v2, 0x2000, v2
    s_add_u32 m0, s43, 14336
    s_nop 0
    global_load_lds_dwordx4 v2, s[20:21]
    v_add_u32 v2, 0x2000, v2
    s_add_u32 m0, s43, 15360
    s_nop 0
    global_load_lds_dwordx4 v2, s[20:21]
    v_add_u32 v2, 0x2000, v2
    s_cmp_eq_u32 s77, 0
    s_cbranch_scc1 ps_8
    v_cvt_pk_bf16_f32 v24, v32, v33
    v_cvt_pk_bf16_f32 v25, v34, v35
    v_cvt_pk_bf16_f32 v26, v36, v37
    v_cvt_pk_bf16_f32 v27, v38, v39
    global_store_dwordx4 v20, v[24:27], s[28:29] offset:0 sc1
    v_cvt_pk_bf16_f32 v16, v40, v41
    v_cvt_pk_bf16_f32 v17, v42, v43
    v_cvt_pk_bf16_f32 v18, v44, v45
    v_cvt_pk_bf16_f32 v19, v46, v47
    global_store_dwordx4 v20, v[16:19], s[28:29] offset:1024 sc1
    v_cvt_pk_bf16_f32 v24, v48, v49
    v_cvt_pk_bf16_f32 v25, v50, v51
    v_cvt_pk_bf16_f32 v26, v52, v53
    v_cvt_pk_bf16_f32 v27, v54, v55
    global_store_dwordx4 v20, v[24:27], s[28:29] offset:2048 sc1
    v_cvt_pk_bf16_f32 v16, v56, v57
    v_cvt_pk_bf16_f32 v17, v58, v59
    v_cvt_pk_bf16_f32 v18, v60, v61
    v_cvt_pk_bf16_f32 v19, v62, v63
    global_store_dwordx4 v20, v[16:19], s[28:29] offset:3072 sc1
    v_cvt_pk_bf16_f32 v24, v64, v65
    v_cvt_pk_bf16_f32 v25, v66, v67
    v_cvt_pk_bf16_f32 v26, v68, v69
    v_cvt_pk_bf16_f32 v27, v70, v71
    global_store_dwordx4 v21, v[24:27], s[28:29] offset:0 sc1
    v_cvt_pk_bf16_f32 v16, v72, v73
    v_cvt_pk_bf16_f32 v17, v74, v75
    v_cvt_pk_bf16_f32 v18, v76, v77
    v_cvt_pk_bf16_f32 v19, v78, v79
    global_store_dwordx4 v21, v[16:19], s[28:29] offset:1024 sc1
    v_cvt_pk_bf16_f32 v24, v80, v81
    v_cvt_pk_bf16_f32 v25, v82, v83
    v_cvt_pk_bf16_f32 v26, v84, v85
    v_cvt_pk_bf16_f32 v27, v86, v87
    global_store_dwordx4 v21, v[24:27], s[28:29] offset:2048 sc1
    v_cvt_pk_bf16_f32 v16, v88, v89
    v_cvt_pk_bf16_f32 v17, v90, v91
    v_cvt_pk_bf16_f32 v18, v92, v93
    v_cvt_pk_bf16_f32 v19, v94, v95
    global_store_dwordx4 v21, v[16:19], s[28:29] offset:3072 sc1
    v_cvt_pk_bf16_f32 v24, v96, v97
    v_cvt_pk_bf16_f32 v25, v98, v99
    v_cvt_pk_bf16_f32 v26, v100, v101
    v_cvt_pk_bf16_f32 v27, v102, v103
    global_store_dwordx4 v22, v[24:27], s[28:29] offset:0 sc1
    v_cvt_pk_bf16_f32 v16, v104, v105
    v_cvt_pk_bf16_f32 v17, v106, v107
    v_cvt_pk_bf16_f32 v18, v108, v109
    v_cvt_pk_bf16_f32 v19, v110, v111
    global_store_dwordx4 v22, v[16:19], s[28:29] offset:1024 sc1
    v_cvt_pk_bf16_f32 v24, v112, v113
    v_cvt_pk_bf16_f32 v25, v114, v115
    v_cvt_pk_bf16_f32 v26, v116, v117
    v_cvt_pk_bf16_f32 v27, v118, v119
    global_store_dwordx4 v22, v[24:27], s[28:29] offset:2048 sc1
    v_cvt_pk_bf16_f32 v16, v120, v121
    v_cvt_pk_bf16_f32 v17, v122, v123
    v_cvt_pk_bf16_f32 v18, v124, v125
    v_cvt_pk_bf16_f32 v19, v126, v127
    global_store_dwordx4 v22, v[16:19], s[28:29] offset:3072 sc1
ps_8:
    s_mov_b32 s77, 0
    v_lshrrev_b32 v3, 2, v0
    v_lshlrev_b32 v3, 8, v3
    v_and_b32 v16, 3, v0
    v_lshl_add_u32 v3, v16, 4, v3
    v_add_u32 v3, s43, v3
    s_lshl_b32 s32, s75, 21
    s_lshl_b32 s33, s30, 14
    s_add_u32 s32, s32, s33
    s_lshl_b32 s33, s31, 12
    s_add_u32 s32, s32, s33
    s_add_u32 s32, s32, 132120576
    s_lshr_b32 s33, s32, 21
    s_xor_b32 s33, s33, s22
    s_xor_b32 s33, s33, 1
    s_and_b32 s33, s33, 1
    s_lshl_b32 s33, s33, 13
    s_add_u32 s33, s33, s32
    s_add_u32 s34, s28, s33
    s_addc_u32 s35, s29, 0
    v_lshlrev_b32 v20, 4, v0
    v_add_u32 v21, 524288, v20
    v_add_u32 v22, 1048576, v20
    v_add_u32 v23, 1572864, v20
    s_waitcnt vmcnt(0)
    ds_read_b64_tr_b16 v[32:33], v3 offset:0
    ds_read_b64_tr_b16 v[34:35], v3 offset:4096
    ds_read_b64_tr_b16 v[36:37], v3 offset:8
    ds_read_b64_tr_b16 v[38:39], v3 offset:4104
    ds_read_b64_tr_b16 v[40:41], v3 offset:8192
    ds_read_b64_tr_b16 v[42:43], v3 offset:12288
    ds_read_b64_tr_b16 v[44:45], v3 offset:8200
    ds_read_b64_tr_b16 v[46:47], v3 offset:12296
    s_waitcnt lgkmcnt(0)
    global_store_dwordx4 v20, v[32:35], s[34:35] offset:0 sc1
    global_store_dwordx4 v20, v[36:39], s[34:35] offset:1024 sc1
    global_store_dwordx4 v20, v[40:43], s[34:35] offset:2048 sc1
    global_store_dwordx4 v20, v[44:47], s[34:35] offset:3072 sc1
    ds_read_b64_tr_b16 v[48:49], v3 offset:64
    ds_read_b64_tr_b16 v[50:51], v3 offset:4160
    ds_read_b64_tr_b16 v[52:53], v3 offset:72
    ds_read_b64_tr_b16 v[54:55], v3 offset:4168
    ds_read_b64_tr_b16 v[56:57], v3 offset:8256
    ds_read_b64_tr_b16 v[58:59], v3 offset:12352
    ds_read_b64_tr_b16 v[60:61], v3 offset:8264
    ds_read_b64_tr_b16 v[62:63], v3 offset:12360
    s_waitcnt lgkmcnt(0)
    global_store_dwordx4 v21, v[48:51], s[34:35] offset:0 sc1
    global_store_dwordx4 v21, v[52:55], s[34:35] offset:1024 sc1
    global_store_dwordx4 v21, v[56:59], s[34:35] offset:2048 sc1
    global_store_dwordx4 v21, v[60:63], s[34:35] offset:3072 sc1
    ds_read_b64_tr_b16 v[64:65], v3 offset:128
    ds_read_b64_tr_b16 v[66:67], v3 offset:4224
    ds_read_b64_tr_b16 v[68:69], v3 offset:136
    ds_read_b64_tr_b16 v[70:71], v3 offset:4232
    ds_read_b64_tr_b16 v[72:73], v3 offset:8320
    ds_read_b64_tr_b16 v[74:75], v3 offset:12416
    ds_read_b64_tr_b16 v[76:77], v3 offset:8328
    ds_read_b64_tr_b16 v[78:79], v3 offset:12424
    s_waitcnt lgkmcnt(0)
    global_store_dwordx4 v22, v[64:67], s[34:35] offset:0 sc1
    global_store_dwordx4 v22, v[68:71], s[34:35] offset:1024 sc1
    global_store_dwordx4 v22, v[72:75], s[34:35] offset:2048 sc1
    global_store_dwordx4 v22, v[76:79], s[34:35] offset:3072 sc1
    ds_read_b64_tr_b16 v[80:81], v3 offset:192
    ds_read_b64_tr_b16 v[82:83], v3 offset:4288
    ds_read_b64_tr_b16 v[84:85], v3 offset:200
    ds_read_b64_tr_b16 v[86:87], v3 offset:4296
    ds_read_b64_tr_b16 v[88:89], v3 offset:8384
    ds_read_b64_tr_b16 v[90:91], v3 offset:12480
    ds_read_b64_tr_b16 v[92:93], v3 offset:8392
    ds_read_b64_tr_b16 v[94:95], v3 offset:12488
    s_waitcnt lgkmcnt(0)
    global_store_dwordx4 v23, v[80:83], s[34:35] offset:0 sc1
    global_store_dwordx4 v23, v[84:87], s[34:35] offset:1024 sc1
    global_store_dwordx4 v23, v[88:91], s[34:35] offset:2048 sc1
    global_store_dwordx4 v23, v[92:95], s[34:35] offset:3072 sc1
    s_lshl_b32 s32, s30, 1
    s_add_u32 s32, s32, s31
    s_lshl_b32 s32, s32, 16
    s_lshr_b32 s33, s75, 1
    s_lshl_b32 s33, s33, 14
    s_add_u32 s32, s32, s33
    s_and_b32 s33, s75, 1
    s_lshl_b32 s33, s33, 12
    s_add_u32 s32, s32, s33
    s_add_u32 s32, s32, 148897792
    s_lshr_b32 s33, s32, 21
    s_xor_b32 s33, s33, s22
    s_xor_b32 s33, s33, 1
    s_and_b32 s33, s33, 1
    s_lshl_b32 s33, s33, 13
    s_add_u32 s33, s33, s32
    s_add_u32 s34, s28, s33
    s_addc_u32 s35, s29, 0
    v_mov_b32 v24, -1
    v_mov_b32 v25, -1
    v_mov_b32 v26, -1
    v_mov_b32 v27, -1
    global_store_dwordx4 v20, v[24:27], s[34:35] offset:0 sc1
    global_store_dwordx4 v20, v[24:27], s[34:35] offset:1024 sc1
    global_store_dwordx4 v20, v[24:27], s[34:35] offset:2048 sc1
    global_store_dwordx4 v20, v[24:27], s[34:35] offset:3072 sc1
    s_waitcnt vmcnt(0)
    s_barrier
    s_cmp_lg_u32 s75, 0
    s_cbranch_scc1 sig_9
    s_lshl_b32 s32, s31, 7
    s_lshl_b32 s33, s30, 2
    s_add_u32 s32, s32, s33
    s_add_u32 s32, s32, 1979904
    v_mov_b32 v16, s32
    v_mov_b32 v17, 0
    s_mov_b64 exec, 1
    global_store_dword v16, v17, s[28:29] sc1
    s_mov_b64 exec, -1
sig_9:
    s_add_u32 s31, s31, 1
    s_cmp_lt_u32 s31, 2
    s_cbranch_scc1 w_wot
w_g1c:
    s_mov_b32 s23, s44
    s_mov_b32 s30, s45
    s_mul_i32 s31, s23, 12
    s_add_u32 s31, s31, 80
    s_mul_i32 s76, s75, 3072
    s_mov_b32 s74, 2048
    v_lshrrev_b32 v16, 3, v0
    s_mul_i32 s64, s75, 24
    s_add_u32 s64, s64, 0
    v_add_u32 v16, s64, v16
    v_lshrrev_b32 v17, 1, v16
    v_xor_b32 v17, v17, v0
    v_and_b32 v17, 7, v17
    v_mul_lo_u32 v16, v16, s74
    v_lshl_add_u32 v28, v17, 4, v16
    v_lshrrev_b32 v16, 3, v0
    s_mul_i32 s64, s75, 24
    s_add_u32 s64, s64, 8
    v_add_u32 v16, s64, v16
    v_lshrrev_b32 v17, 1, v16
    v_xor_b32 v17, v17, v0
    v_and_b32 v17, 7, v17
    v_mul_lo_u32 v16, v16, s74
    v_lshl_add_u32 v29, v17, 4, v16
    v_lshrrev_b32 v16, 3, v0
    s_mul_i32 s64, s75, 24
    s_add_u32 s64, s64, 16
    v_add_u32 v16, s64, v16
    v_lshrrev_b32 v17, 1, v16
    v_xor_b32 v17, v17, v0
    v_and_b32 v17, 7, v17
    v_mul_lo_u32 v16, v16, s74
    v_lshl_add_u32 v30, v17, 4, v16
    v_and_b32 v16, 15, v0
    v_lshrrev_b32 v17, 1, v16
    v_lshrrev_b32 v18, 4, v0
    v_xor_b32 v17, v17, v18
    v_lshlrev_b32 v16, 7, v16
    v_lshl_add_u32 v6, v17, 4, v16
    s_mul_i32 s74, s72, 6144
    v_add_u32 v6, s74, v6
    v_xor_b32 v7, 64, v6
    s_mov_b32 s64, 128
    s_mov_b32 s86, 0
    v_lshrrev_b32 v16, 5, v0
    s_lshl_b32 s74, s75, 2
    s_add_u32 s74, s74, 0
    v_add_u32 v16, s74, v16
    v_and_b32 v17, 3, v16
    v_bfe_u32 v18, v16, 3, 1
    v_lshl_add_u32 v17, v18, 2, v17
    v_lshlrev_b32 v17, 1, v17
    v_and_b32 v18, 31, v0
    v_xor_b32 v17, v17, v18
    v_lshlrev_b32 v17, 4, v17
    s_mov_b32 s74, 8192
    v_mul_lo_u32 v16, v16, s74
    v_add_u32 v4, v16, v17
    v_lshrrev_b32 v16, 5, v0
    s_lshl_b32 s74, s75, 2
    s_add_u32 s74, s74, 2
    v_add_u32 v16, s74, v16
    v_and_b32 v17, 3, v16
    v_bfe_u32 v18, v16, 3, 1
    v_lshl_add_u32 v17, v18, 2, v17
    v_lshlrev_b32 v17, 1, v17
    v_and_b32 v18, 31, v0
    v_xor_b32 v17, v17, v18
    v_lshlrev_b32 v17, 4, v17
    s_mov_b32 s74, 8192
    v_mul_lo_u32 v16, v16, s74
    v_add_u32 v5, v16, v17
    s_mov_b32 s65, 262144
    s_mov_b32 s87, 0
    s_lshl_b32 s32, s31, 15
    s_add_u32 s80, s10, s32
    s_addc_u32 s81, s11, 0
    s_cmp_lt_u32 s30, 16
    s_cselect_b32 s82, s16, s18
    s_cselect_b32 s83, s17, s19
    s_cselect_b32 s33, 20, 52
    s_lshl_b32 s33, s33, 20
    s_and_b32 s35, s30, 15
    s_lshl_b32 s32, s35, 9
    s_add_u32 s82, s82, s32
    s_addc_u32 s83, s83, 0
    s_mov_b32 s66, 7
    s_getpc_b64 s[70:71]
call_10:
    s_add_u32 s70, s70, core_T3-call_10
    s_addc_u32 s71, s71, (core_T3-call_10)>>32
    s_swappc_b64 s[68:69], s[70:71]
    s_lshl_b32 s34, s35, 1
    s_add_u32 s34, s34, s73
    s_lshl_b32 s34, s34, 14
    s_add_u32 s33, s33, s34
    s_mul_i32 s36, s72, 3
    s_add_u32 s36, s36, s31
    v_lshlrev_b32 v19, 4, v0
    s_add_u32 s32, s36, 0
    s_and_b32 s34, s32, 1
    s_lshl_b32 s34, s34, 12
    s_lshr_b32 s32, s32, 1
    s_lshl_b32 s32, s32, 19
    s_add_u32 s32, s32, s34
    s_add_u32 s32, s32, s33
    s_lshr_b32 s34, s32, 21
    s_xor_b32 s34, s34, s22
    s_xor_b32 s34, s34, 1
    s_and_b32 s34, s34, 1
    s_lshl_b32 s34, s34, 13
    s_add_u32 s32, s32, s34
    v_add_u32 v20, s32, v19
    s_add_u32 s32, s36, 1
    s_and_b32 s34, s32, 1
    s_lshl_b32 s34, s34, 12
    s_lshr_b32 s32, s32, 1
    s_lshl_b32 s32, s32, 19
    s_add_u32 s32, s32, s34
    s_add_u32 s32, s32, s33
    s_lshr_b32 s34, s32, 21
    s_xor_b32 s34, s34, s22
    s_xor_b32 s34, s34, 1
    s_and_b32 s34, s34, 1
    s_lshl_b32 s34, s34, 13
    s_add_u32 s32, s32, s34
    v_add_u32 v21, s32, v19
    s_add_u32 s32, s36, 2
    s_and_b32 s34, s32, 1
    s_lshl_b32 s34, s34, 12
    s_lshr_b32 s32, s32, 1
    s_lshl_b32 s32, s32, 19
    s_add_u32 s32, s32, s34
    s_add_u32 s32, s32, s33
    s_lshr_b32 s34, s32, 21
    s_xor_b32 s34, s34, s22
    s_xor_b32 s34, s34, 1
    s_and_b32 s34, s34, 1
    s_lshl_b32 s34, s34, 13
    s_add_u32 s32, s32, s34
    v_add_u32 v22, s32, v19
    s_lshl_b32 s88, s23, 7
    s_lshl_b32 s32, s30, 2
    s_add_u32 s88, s88, s32
    s_add_u32 s88, s88, 1979392
    s_mov_b32 s89, 1
    s_mov_b32 s77, 1
w_g2a:
    s_lshr_b32 s30, s45, 1
    s_and_b32 s31, s45, 1
    s_lshr_b32 s32, s44, 1
    s_xor_b32 s32, s32, s44
    s_lshl_b32 s32, s32, 1
    s_add_u32 s31, s31, s32
    s_and_b32 s32, s75, 4
    s_and_b32 s33, s75, 1
    s_lshl_b32 s33, s33, 1
    s_or_b32 s32, s32, s33
    s_bfe_u32 s33, s75, 0x10001
    s_or_b32 s32, s32, s33
    s_mul_i32 s76, s75, 4096
    s_mov_b32 s74, 2048
    v_lshrrev_b32 v16, 3, v0
    s_mul_i32 s64, s32, 32
    s_add_u32 s64, s64, 0
    v_add_u32 v16, s64, v16
    v_lshrrev_b32 v17, 1, v16
    v_xor_b32 v17, v17, v0
    v_and_b32 v17, 7, v17
    v_mul_lo_u32 v16, v16, s74
    v_lshl_add_u32 v28, v17, 4, v16
    v_lshrrev_b32 v16, 3, v0
    s_mul_i32 s64, s32, 32
    s_add_u32 s64, s64, 8
    v_add_u32 v16, s64, v16
    v_lshrrev_b32 v17, 1, v16
    v_xor_b32 v17, v17, v0
    v_and_b32 v17, 7, v17
    v_mul_lo_u32 v16, v16, s74
    v_lshl_add_u32 v29, v17, 4, v16
    v_lshrrev_b32 v16, 3, v0
    s_mul_i32 s64, s32, 32
    s_add_u32 s64, s64, 16
    v_add_u32 v16, s64, v16
    v_lshrrev_b32 v17, 1, v16
    v_xor_b32 v17, v17, v0
    v_and_b32 v17, 7, v17
    v_mul_lo_u32 v16, v16, s74
    v_lshl_add_u32 v30, v17, 4, v16
    v_lshrrev_b32 v16, 3, v0
    s_mul_i32 s64, s32, 32
    s_add_u32 s64, s64, 24
    v_add_u32 v16, s64, v16
    v_lshrrev_b32 v17, 1, v16
    v_xor_b32 v17, v17, v0
    v_and_b32 v17, 7, v17
    v_mul_lo_u32 v16, v16, s74
    v_lshl_add_u32 v31, v17, 4, v16
    v_and_b32 v16, 15, v0
    v_lshrrev_b32 v17, 1, v16
    v_lshrrev_b32 v18, 4, v0
    v_xor_b32 v17, v17, v18
    v_lshlrev_b32 v16, 7, v16
    v_lshl_add_u32 v6, v17, 4, v16
    s_mul_i32 s74, s72, 8192
    v_add_u32 v6, s74, v6
    v_xor_b32 v7, 64, v6
    s_mov_b32 s64, 128
    s_mov_b32 s86, 0
    v_lshrrev_b32 v16, 5, v0
    s_lshl_b32 s74, s75, 2
    s_add_u32 s74, s74, 0
    v_add_u32 v16, s74, v16
    v_and_b32 v17, 3, v16
    v_bfe_u32 v18, v16, 3, 1
    v_lshl_add_u32 v17, v18, 2, v17
    v_lshlrev_b32 v17, 1, v17
    v_and_b32 v18, 31, v0
    v_xor_b32 v17, v17, v18
    v_lshlrev_b32 v17, 4, v17
    s_mov_b32 s74, 8192
    v_mul_lo_u32 v16, v16, s74
    v_add_u32 v4, v16, v17
    v_lshrrev_b32 v16, 5, v0
    s_lshl_b32 s74, s75, 2
    s_add_u32 s74, s74, 2
    v_add_u32 v16, s74, v16
    v_and_b32 v17, 3, v16
    v_bfe_u32 v18, v16, 3, 1
    v_lshl_add_u32 v17, v18, 2, v17
    v_lshlrev_b32 v17, 1, v17
    v_and_b32 v18, 31, v0
    v_xor_b32 v17, v17, v18
    v_lshlrev_b32 v17, 4, v17
    s_mov_b32 s74, 8192
    v_mul_lo_u32 v16, v16, s74
    v_add_u32 v5, v16, v17
    s_mov_b32 s65, 262144
    s_mov_b32 s87, 0
    s_lshl_b32 s32, s31, 19
    s_add_u32 s80, s10, s32
    s_addc_u32 s81, s11, 0
    s_lshl_b32 s32, s30, 9
    s_add_u32 s82, s14, s32
    s_addc_u32 s83, s15, 0
    s_mov_b32 s66, 7
    s_getpc_b64 s[70:71]
call_11:
    s_add_u32 s70, s70, core_T-call_11
    s_addc_u32 s71, s71, (core_T-call_11)>>32
    s_swappc_b64 s[68:69], s[70:71]
    s_lshl_b32 s38, s31, 3
    s_and_b32 s33, s72, 2
    s_add_u32 s38, s38, s33
    s_add_u32 s38, s38, s72
    s_mov_b32 s39, s38
    s_lshl_b32 s38, s38, 5
    s_lshl_b32 s42, s30, 1
    s_add_u32 s42, s42, s73
    s_add_u32 s38, s38, s42
    s_lshl_b32 s34, s38, 14
    s_add_u32 s34, s34, 20971520
    s_lshr_b32 s35, s34, 21
    s_xor_b32 s35, s35, s22
    s_xor_b32 s35, s35, 1
    s_and_b32 s35, s35, 1
    s_lshl_b32 s35, s35, 13
    s_add_u32 s35, s35, s34
    s_add_u32 s32, s28, s35
    s_addc_u32 s33, s29, 0
    s_add_u32 s34, s32, 33554432
    s_addc_u32 s35, s33, 0
    v_lshlrev_b32 v16, 4, v0
    v_add_u32 v17, 0x1000, v16
    v_add_u32 v18, 0x100000, v16
    v_add_u32 v19, 0x101000, v16
    s_mul_i32 s43, s75, 20480
    s_sub_u32 s48, s39, 16
    s_mul_i32 s48, s48, 43
    s_lshr_b32 s48, s48, 8
    s_add_u32 s48, s48, 4
    s_lshr_b32 s47, s39, 2
    s_cmp_lt_u32 s47, 4
    s_cselect_b32 s47, s47, s48
    s_add_u32 s49, s39, 2
    s_sub_u32 s48, s49, 16
    s_mul_i32 s48, s48, 43
    s_lshr_b32 s48, s48, 8
    s_add_u32 s48, s48, 4
    s_lshr_b32 s49, s49, 2
    s_cmp_lt_u32 s49, 4
    s_cselect_b32 s49, s49, s48
    s_sub_u32 s49, s49, s47
    s_lshl_b32 s47, s47, 7
    s_lshl_b32 s48, s30, 2
    s_add_u32 s47, s47, s48
    s_add_u32 s47, s47, 1978368
    v_and_b32 v22, s49, v0
    v_lshl_add_u32 v22, v22, 7, s47
    v_mov_b32 v23, 0
kp_12:
    global_load_dword v26, v22, s[28:29] sc1
    global_load_dword v27, v22, s[28:29] offset:64 sc1
    global_load_dword v24, v23, s[26:27] offset:192 sc1
    s_waitcnt vmcnt(0)
    v_or_b32 v26, v26, v27
    v_cmp_ne_u32 vcc, 0, v26
    s_cbranch_vccz ko_13
    s_sleep 12
    s_add_u32 s46, s46, 1
    s_cmp_lt_u32 s46, 400000
    s_cbranch_scc1 kp_12
    s_branch w_fail
ko_13:
    v_readfirstlane_b32 s48, v24
    s_nop 0
    s_max_u32 s48, s48, 1
    s_sub_u32 s48, s48, 1
    s_barrier
    s_and_b32 s47, s42, 15
    s_lshl_b32 s47, s47, 9
    s_lshr_b32 s49, s42, 4
    s_lshl_b32 s49, s49, 14
    s_add_u32 s47, s47, s49
    s_xor_b32 s49, s22, 1
    s_lshl_b32 s49, s49, 13
    s_add_u32 s47, s47, s49
    s_add_u32 s47, s47, 1441792
    v_and_b32 v31, 3, v0
    v_lshl_add_u32 v31, v31, 7, s47
    s_max_u32 s54, s39, 5
    s_sub_u32 s54, s54, 5
ap_14:
    s_cmp_lt_u32 s54, s48
    s_cbranch_scc1 ao_15
    s_cmp_lt_u32 s48, 59
    s_cbranch_scc1 nf_16
    s_sleep 2
    global_load_dword v24, v31, s[28:29] sc1
    s_waitcnt vmcnt(0)
    v_readlane_b32 s49, v24, 0
    v_readlane_b32 s50, v24, 1
    s_min_i32 s49, s49, s50
    v_readlane_b32 s50, v24, 2
    s_min_i32 s49, s49, s50
    v_readlane_b32 s50, v24, 3
    s_min_i32 s49, s49, s50
    s_add_u32 s49, s49, 1
    s_max_u32 s48, s48, s49
    s_add_u32 s46, s46, 1
    s_cmp_lt_u32 s46, 400000
    s_cbranch_scc1 ap_14
    s_branch w_fail
nf_16:
    s_sleep 8
    global_load_dword v24, v23, s[26:27] offset:192 sc1
    s_waitcnt vmcnt(0)
    v_readfirstlane_b32 s48, v24
    s_nop 0
    s_max_u32 s48, s48, 1
    s_sub_u32 s48, s48, 1
    s_add_u32 s46, s46, 1
    s_cmp_lt_u32 s46, 400000
    s_cbranch_scc1 ap_14
    s_branch w_fail
ao_15:
    global_load_dwordx4 a[0:3], v16, s[32:33] offset:0 sc1
    global_load_dwordx4 a[4:7], v16, s[32:33] offset:1024 sc1
    global_load_dwordx4 a[8:11], v16, s[32:33] offset:2048 sc1
    global_load_dwordx4 a[12:15], v16, s[32:33] offset:3072 sc1
    s_add_u32 m0, s43, 0
    s_nop 0
    global_load_lds_dwordx4 v16, s[34:35] offset:0 sc1
    global_load_lds_dwordx4 v16, s[34:35] offset:1024 sc1
    global_load_lds_dwordx4 v16, s[34:35] offset:2048 sc1
    global_load_lds_dwordx4 v16, s[34:35] offset:3072 sc1
    global_load_dwordx4 a[16:19], v17, s[32:33] offset:0 sc1
    global_load_dwordx4 a[20:23], v17, s[32:33] offset:1024 sc1
    global_load_dwordx4 a[24:27], v17, s[32:33] offset:2048 sc1
    global_load_dwordx4 a[28:31], v17, s[32:33] offset:3072 sc1
    s_add_u32 m0, s43, 4096
    s_nop 0
    global_load_lds_dwordx4 v17, s[34:35] offset:0 sc1
    global_load_lds_dwordx4 v17, s[34:35] offset:1024 sc1
    global_load_lds_dwordx4 v17, s[34:35] offset:2048 sc1
    global_load_lds_dwordx4 v17, s[34:35] offset:3072 sc1
    v_cvt_pk_bf16_f32 v32, v32, v33
    v_cvt_pk_bf16_f32 v33, v34, v35
    v_cvt_pk_bf16_f32 v34, v36, v37
    v_cvt_pk_bf16_f32 v35, v38, v39
    v_cvt_pk_bf16_f32 v36, v40, v41
    v_cvt_pk_bf16_f32 v37, v42, v43
    v_cvt_pk_bf16_f32 v38, v44, v45
    v_cvt_pk_bf16_f32 v39, v46, v47
    v_cvt_pk_bf16_f32 v40, v48, v49
    v_cvt_pk_bf16_f32 v41, v50, v51
    v_cvt_pk_bf16_f32 v42, v52, v53
    v_cvt_pk_bf16_f32 v43, v54, v55
    v_cvt_pk_bf16_f32 v44, v56, v57
    v_cvt_pk_bf16_f32 v45, v58, v59
    v_cvt_pk_bf16_f32 v46, v60, v61
    v_cvt_pk_bf16_f32 v47, v62, v63
    v_cvt_pk_bf16_f32 v48, v64, v65
    v_cvt_pk_bf16_f32 v49, v66, v67
    v_cvt_pk_bf16_f32 v50, v68, v69
    v_cvt_pk_bf16_f32 v51, v70, v71
    v_cvt_pk_bf16_f32 v52, v72, v73
    v_cvt_pk_bf16_f32 v53, v74, v75
    v_cvt_pk_bf16_f32 v54, v76, v77
    v_cvt_pk_bf16_f32 v55, v78, v79
    v_cvt_pk_bf16_f32 v56, v80, v81
    v_cvt_pk_bf16_f32 v57, v82, v83
    v_cvt_pk_bf16_f32 v58, v84, v85
    v_cvt_pk_bf16_f32 v59, v86, v87
    v_cvt_pk_bf16_f32 v60, v88, v89
    v_cvt_pk_bf16_f32 v61, v90, v91
    v_cvt_pk_bf16_f32 v62, v92, v93
    v_cvt_pk_bf16_f32 v63, v94, v95
    v_cvt_pk_bf16_f32 v64, v96, v97
    v_cvt_pk_bf16_f32 v65, v98, v99
    v_cvt_pk_bf16_f32 v66, v100, v101
    v_cvt_pk_bf16_f32 v67, v102, v103
    v_cvt_pk_bf16_f32 v68, v104, v105
    v_cvt_pk_bf16_f32 v69, v106, v107
    v_cvt_pk_bf16_f32 v70, v108, v109
    v_cvt_pk_bf16_f32 v71, v110, v111
    v_cvt_pk_bf16_f32 v72, v112, v113
    v_cvt_pk_bf16_f32 v73, v114, v115
    v_cvt_pk_bf16_f32 v74, v116, v117
    v_cvt_pk_bf16_f32 v75, v118, v119
    v_cvt_pk_bf16_f32 v76, v120, v121
    v_cvt_pk_bf16_f32 v77, v122, v123
    v_cvt_pk_bf16_f32 v78, v124, v125
    v_cvt_pk_bf16_f32 v79, v126, v127
    v_cvt_pk_bf16_f32 v80, v128, v129
    v_cvt_pk_bf16_f32 v81, v130, v131
    v_cvt_pk_bf16_f32 v82, v132, v133
    v_cvt_pk_bf16_f32 v83, v134, v135
    v_cvt_pk_bf16_f32 v84, v136, v137
    v_cvt_pk_bf16_f32 v85, v138, v139
    v_cvt_pk_bf16_f32 v86, v140, v141
    v_cvt_pk_bf16_f32 v87, v142, v143
    v_cvt_pk_bf16_f32 v88, v144, v145
    v_cvt_pk_bf16_f32 v89, v146, v147
    v_cvt_pk_bf16_f32 v90, v148, v149
    v_cvt_pk_bf16_f32 v91, v150, v151
    v_cvt_pk_bf16_f32 v92, v152, v153
    v_cvt_pk_bf16_f32 v93, v154, v155
    v_cvt_pk_bf16_f32 v94, v156, v157
    v_cvt_pk_bf16_f32 v95, v158, v159
    s_lshr_b32 s50, s38, 1
    s_lshl_b32 s50, s50, 14
    s_and_b32 s51, s38, 1
    s_lshl_b32 s51, s51, 12
    s_add_u32 s50, s50, s51
    s_add_u32 s50, s50, 4194304
    s_lshr_b32 s51, s50, 21
    s_xor_b32 s51, s51, s22
    s_and_b32 s51, s51, 1
    s_lshl_b32 s51, s51, 13
    s_add_u32 s51, s51, s50
    s_add_u32 s52, s28, s51
    s_addc_u32 s53, s29, 0
    v_and_b32 v28, 7, v0
    v_lshlrev_b32 v28, 4, v28
    v_lshrrev_b32 v24, 4, v0
    v_lshl_add_u32 v28, v24, 7, v28
    s_cmp_lt_u32 s39, s48
    s_cbranch_scc1 e0_17
    global_load_dwordx4 a[32:35], v18, s[32:33] offset:0 sc1
    global_load_dwordx4 a[36:39], v18, s[32:33] offset:1024 sc1
    global_load_dwordx4 a[40:43], v18, s[32:33] offset:2048 sc1
    global_load_dwordx4 a[44:47], v18, s[32:33] offset:3072 sc1
    s_add_u32 m0, s43, 10240
    s_nop 0
    global_load_lds_dwordx4 v18, s[34:35] offset:0 sc1
    global_load_lds_dwordx4 v18, s[34:35] offset:1024 sc1
    global_load_lds_dwordx4 v18, s[34:35] offset:2048 sc1
    global_load_lds_dwordx4 v18, s[34:35] offset:3072 sc1
    global_load_dwordx4 a[48:51], v19, s[32:33] offset:0 sc1
    global_load_dwordx4 a[52:55], v19, s[32:33] offset:1024 sc1
    global_load_dwordx4 a[56:59], v19, s[32:33] offset:2048 sc1
    global_load_dwordx4 a[60:63], v19, s[32:33] offset:3072 sc1
    s_add_u32 m0, s43, 14336
    s_nop 0
    global_load_lds_dwordx4 v19, s[34:35] offset:0 sc1
    global_load_lds_dwordx4 v19, s[34:35] offset:1024 sc1
    global_load_lds_dwordx4 v19, s[34:35] offset:2048 sc1
    global_load_lds_dwordx4 v19, s[34:35] offset:3072 sc1
ap_19:
    s_cmp_lt_u32 s39, s48
    s_cbranch_scc1 ao_20
    s_cmp_lt_u32 s48, 59
    s_cbranch_scc1 nf_21
    s_sleep 2
    global_load_dword v24, v31, s[28:29] sc1
    s_waitcnt vmcnt(0)
    v_readlane_b32 s49, v24, 0
    v_readlane_b32 s50, v24, 1
    s_min_i32 s49, s49, s50
    v_readlane_b32 s50, v24, 2
    s_min_i32 s49, s49, s50
    v_readlane_b32 s50, v24, 3
    s_min_i32 s49, s49, s50
    s_add_u32 s49, s49, 1
    s_max_u32 s48, s48, s49
    s_add_u32 s46, s46, 1
    s_cmp_lt_u32 s46, 400000
    s_cbranch_scc1 ap_19
    s_branch w_fail
nf_21:
    s_sleep 8
    global_load_dword v24, v23, s[26:27] offset:192 sc1
    s_waitcnt vmcnt(0)
    v_readfirstlane_b32 s48, v24
    s_nop 0
    s_max_u32 s48, s48, 1
    s_sub_u32 s48, s48, 1
    s_add_u32 s46, s46, 1
    s_cmp_lt_u32 s46, 400000
    s_cbranch_scc1 ap_19
    s_branch w_fail
ao_20:
    global_load_dwordx4 v[108:111], v28, s[52:53] offset:0 sc1
    global_load_dwordx4 v[112:115], v28, s[52:53] offset:512 sc1
    global_load_dwordx4 v[116:119], v28, s[52:53] offset:1024 sc1
    global_load_dwordx4 v[120:123], v28, s[52:53] offset:1536 sc1
    global_load_dwordx4 v[124:127], v16, s[52:53] offset:2048 sc1
    global_load_dwordx4 v[128:131], v16, s[52:53] offset:3072 sc1
    s_add_u32 s52, s52, 0x80000
    s_addc_u32 s53, s53, 0
    s_waitcnt vmcnt(0)
    s_branch l0_18
e0_17:
    global_load_dwordx4 v[108:111], v28, s[52:53] offset:0 sc1
    global_load_dwordx4 v[112:115], v28, s[52:53] offset:512 sc1
    global_load_dwordx4 v[116:119], v28, s[52:53] offset:1024 sc1
    global_load_dwordx4 v[120:123], v28, s[52:53] offset:1536 sc1
    global_load_dwordx4 v[124:127], v16, s[52:53] offset:2048 sc1
    global_load_dwordx4 v[128:131], v16, s[52:53] offset:3072 sc1
    s_add_u32 s52, s52, 0x80000
    s_addc_u32 s53, s53, 0
    global_load_dwordx4 a[32:35], v18, s[32:33] offset:0 sc1
    global_load_dwordx4 a[36:39], v18, s[32:33] offset:1024 sc1
    global_load_dwordx4 a[40:43], v18, s[32:33] offset:2048 sc1
    global_load_dwordx4 a[44:47], v18, s[32:33] offset:3072 sc1
    s_add_u32 m0, s43, 10240
    s_nop 0
    global_load_lds_dwordx4 v18, s[34:35] offset:0 sc1
    global_load_lds_dwordx4 v18, s[34:35] offset:1024 sc1
    global_load_lds_dwordx4 v18, s[34:35] offset:2048 sc1
    global_load_lds_dwordx4 v18, s[34:35] offset:3072 sc1
    global_load_dwordx4 a[48:51], v19, s[32:33] offset:0 sc1
    global_load_dwordx4 a[52:55], v19, s[32:33] offset:1024 sc1
    global_load_dwordx4 a[56:59], v19, s[32:33] offset:2048 sc1
    global_load_dwordx4 a[60:63], v19, s[32:33] offset:3072 sc1
    s_add_u32 m0, s43, 14336
    s_nop 0
    global_load_lds_dwordx4 v19, s[34:35] offset:0 sc1
    global_load_lds_dwordx4 v19, s[34:35] offset:1024 sc1
    global_load_lds_dwordx4 v19, s[34:35] offset:2048 sc1
    global_load_lds_dwordx4 v19, s[34:35] offset:3072 sc1
l0_18:
    v_lshrrev_b32 v24, 4, v0
    v_lshlrev_b32 v24, 2, v24
    v_and_b32 v25, 15, v0
    v_mov_b32 v26, 0xff800000
    v_add_u32 v27, 0, v24
    v_cmp_gt_u32 vcc, v27, v25
    s_nop 1
    v_cndmask_b32 v96, 0, v26, vcc
    v_add_u32 v27, 1, v24
    v_cmp_gt_u32 vcc, v27, v25
    s_nop 1
    v_cndmask_b32 v97, 0, v26, vcc
    v_add_u32 v27, 2, v24
    v_cmp_gt_u32 vcc, v27, v25
    s_nop 1
    v_cndmask_b32 v98, 0, v26, vcc
    v_add_u32 v27, 3, v24
    v_cmp_gt_u32 vcc, v27, v25
    s_nop 1
    v_cndmask_b32 v99, 0, v26, vcc
    v_cmp_gt_u32 vcc, 32, v0
    s_nop 1
    v_cndmask_b32 v100, 0, v26, vcc
    v_cndmask_b32 v101, 0, v26, vcc
    v_cndmask_b32 v102, 0, v26, vcc
    v_cndmask_b32 v103, 0, v26, vcc
    v_mov_b32 v104, 0x3f803f80
    v_mov_b32 v105, 0x3f803f80
    v_mov_b32 v106, 0x3f803f80
    v_mov_b32 v107, 0x3f803f80
    v_and_b32 v24, 3, v0
    v_lshrrev_b32 v25, 2, v0
    v_lshlrev_b32 v18, 4, v25
    v_lshl_add_u32 v18, v24, 8, v18
    v_add_u32 v18, s43, v18
    v_and_b32 v25, 7, v25
    v_lshlrev_b32 v19, 4, v25
    v_lshl_add_u32 v19, v24, 7, v19
    v_add_u32 v19, s43, v19
    v_add_u32 v20, s43, v16
    v_mov_b32 v21, v16
    v_add_u32 v22, 0x40000, v21
    s_lshl_b32 s50, s39, 19
    s_lshl_b32 s51, s30, 14
    s_add_u32 s50, s50, s51
    s_lshl_b32 s51, s73, 12
    s_add_u32 s50, s50, s51
    s_add_u32 s50, s50, 88080384
    s_lshr_b32 s51, s50, 21
    s_xor_b32 s51, s51, s22
    s_xor_b32 s51, s51, 1
    s_and_b32 s51, s51, 1
    s_lshl_b32 s51, s51, 13
    s_add_u32 s51, s51, s50
    s_add_u32 s36, s28, s51
    s_addc_u32 s37, s29, 0
    s_mov_b32 s40, 1040356334
    s_add_u32 s54, s39, 2
    s_waitcnt vmcnt(16)
    ds_write_b128 v20, v[124:127] offset:8192
    ds_write_b128 v20, v[128:131] offset:9216
    v_mfma_f32_16x16x32_bf16 v[132:135], a[0:3], v[32:35], v[96:99]
    v_mfma_f32_16x16x32_bf16 v[136:139], v[108:111], v[32:35], v[100:103]
    v_mfma_f32_16x16x32_bf16 v[140:143], a[0:3], v[48:51], 0
    v_mfma_f32_16x16x32_bf16 v[144:147], a[16:19], v[48:51], v[96:99]
    v_mfma_f32_16x16x32_bf16 v[148:151], v[108:111], v[48:51], v[100:103]
    v_mfma_f32_16x16x32_bf16 v[132:135], a[4:7], v[36:39], v[132:135]
    v_mfma_f32_16x16x32_bf16 v[136:139], v[112:115], v[36:39], v[136:139]
    v_mfma_f32_16x16x32_bf16 v[140:143], a[4:7], v[52:55], v[140:143]
    v_mfma_f32_16x16x32_bf16 v[144:147], a[20:23], v[52:55], v[144:147]
    v_mfma_f32_16x16x32_bf16 v[148:151], v[112:115], v[52:55], v[148:151]
    v_mfma_f32_16x16x32_bf16 v[132:135], a[8:11], v[40:43], v[132:135]
    v_mfma_f32_16x16x32_bf16 v[136:139], v[116:119], v[40:43], v[136:139]
    v_mfma_f32_16x16x32_bf16 v[140:143], a[8:11], v[56:59], v[140:143]
    v_mfma_f32_16x16x32_bf16 v[144:147], a[24:27], v[56:59], v[144:147]
    v_mfma_f32_16x16x32_bf16 v[148:151], v[116:119], v[56:59], v[148:151]
    v_mfma_f32_16x16x32_bf16 v[132:135], a[12:15], v[44:47], v[132:135]
    v_mfma_f32_16x16x32_bf16 v[136:139], v[120:123], v[44:47], v[136:139]
    v_mfma_f32_16x16x32_bf16 v[140:143], a[12:15], v[60:63], v[140:143]
    v_mfma_f32_16x16x32_bf16 v[144:147], a[28:31], v[60:63], v[144:147]
    v_mfma_f32_16x16x32_bf16 v[148:151], v[120:123], v[60:63], v[148:151]
    s_mov_b32 s55, 0
    s_cmp_lt_u32 s54, s48
    s_cbranch_scc0 n1_22
    global_load_dwordx4 v[32:35], v28, s[52:53] offset:0 sc1
    global_load_dwordx4 v[36:39], v28, s[52:53] offset:512 sc1
    global_load_dwordx4 v[40:43], v28, s[52:53] offset:1024 sc1
    global_load_dwordx4 v[44:47], v28, s[52:53] offset:1536 sc1
    global_load_dwordx4 v[48:51], v16, s[52:53] offset:2048 sc1
    global_load_dwordx4 v[52:55], v16, s[52:53] offset:3072 sc1
    s_add_u32 s52, s52, 0x80000
    s_addc_u32 s53, s53, 0
    s_mov_b32 s55, 1
n1_22:
    ds_read_b64_tr_b16 a[64:65], v18 offset:0
    ds_read_b64_tr_b16 a[66:67], v18 offset:4096
    ds_read_b64_tr_b16 a[72:73], v19 offset:8192
    ds_read_b64_tr_b16 a[68:69], v18 offset:8
    ds_read_b64_tr_b16 a[70:71], v18 offset:4104
    ds_read_b64_tr_b16 a[74:75], v19 offset:8200
    s_nop 3
    v_max3_f32 v24, v132, v133, v134
    v_max3_f32 v24, v24, v135, v136
    v_max3_f32 v24, v24, v137, v138
    v_max_f32 v24, v24, v139
    v_mov_b32 v25, v24
    s_nop 1
    v_permlane16_swap_b32 v24, v25
    v_max_f32 v24, v24, v25
    v_mov_b32 v25, v24
    s_nop 1
    v_permlane32_swap_b32 v24, v25
    v_max_f32 v24, v24, v25
    v_mul_f32 v24, s40, v24
    v_fma_f32 v132, v132, s40, -v24
    v_fma_f32 v133, v133, s40, -v24
    v_fma_f32 v134, v134, s40, -v24
    v_fma_f32 v135, v135, s40, -v24
    v_fma_f32 v136, v136, s40, -v24
    v_fma_f32 v137, v137, s40, -v24
    v_fma_f32 v138, v138, s40, -v24
    v_fma_f32 v139, v139, s40, -v24
    v_exp_f32 v132, v132
    v_exp_f32 v133, v133
    v_exp_f32 v134, v134
    v_exp_f32 v135, v135
    v_exp_f32 v136, v136
    v_exp_f32 v137, v137
    v_exp_f32 v138, v138
    v_exp_f32 v139, v139
    v_max3_f32 v24, v140, v141, v142
    v_max3_f32 v24, v24, v143, v144
    v_max3_f32 v24, v24, v145, v146
    v_max3_f32 v24, v24, v147, v148
    v_max3_f32 v24, v24, v149, v150
    v_max_f32 v24, v24, v151
    v_mov_b32 v25, v24
    s_nop 1
    v_permlane16_swap_b32 v24, v25
    v_max_f32 v24, v24, v25
    v_mov_b32 v25, v24
    s_nop 1
    v_permlane32_swap_b32 v24, v25
    v_max_f32 v24, v24, v25
    v_mul_f32 v24, s40, v24
    v_fma_f32 v140, v140, s40, -v24
    v_fma_f32 v141, v141, s40, -v24
    v_fma_f32 v142, v142, s40, -v24
    v_fma_f32 v143, v143, s40, -v24
    v_fma_f32 v144, v144, s40, -v24
    v_fma_f32 v145, v145, s40, -v24
    v_fma_f32 v146, v146, s40, -v24
    v_fma_f32 v147, v147, s40, -v24
    v_fma_f32 v148, v148, s40, -v24
    v_fma_f32 v149, v149, s40, -v24
    v_fma_f32 v150, v150, s40, -v24
    v_fma_f32 v151, v151, s40, -v24
    v_exp_f32 v140, v140
    v_exp_f32 v141, v141
    v_exp_f32 v142, v142
    v_exp_f32 v143, v143
    v_exp_f32 v144, v144
    v_exp_f32 v145, v145
    v_exp_f32 v146, v146
    v_exp_f32 v147, v147
    v_exp_f32 v148, v148
    v_exp_f32 v149, v149
    v_exp_f32 v150, v150
    v_exp_f32 v151, v151
    s_nop 0
    v_cvt_pk_bf16_f32 v108, v132, v133
    v_cvt_pk_bf16_f32 v109, v134, v135
    v_mov_b32 v110, 0
    v_mov_b32 v111, 0
    v_cvt_pk_bf16_f32 v112, v136, v137
    v_cvt_pk_bf16_f32 v113, v138, v139
    v_cvt_pk_bf16_f32 v116, v140, v141
    v_cvt_pk_bf16_f32 v117, v142, v143
    v_cvt_pk_bf16_f32 v118, v144, v145
    v_cvt_pk_bf16_f32 v119, v146, v147
    v_cvt_pk_bf16_f32 v114, v148, v149
    v_cvt_pk_bf16_f32 v115, v150, v151
    s_nop 1
    v_mfma_f32_16x16x32_bf16 v[120:123], v[104:107], v[108:111], 0
    v_mfma_f32_16x16x32_bf16 v[124:127], v[104:107], v[116:119], 0
    s_nop 5
    v_mfma_f32_16x16x16_bf16 v[120:123], v[104:105], v[112:113], v[120:123]
    v_mfma_f32_16x16x16_bf16 v[124:127], v[104:105], v[114:115], v[124:127]
    s_nop 7
    v_rcp_f32 v24, v120
    v_rcp_f32 v26, v124
    s_nop 0
    v_mov_b32 v25, v24
    v_mov_b32 v27, v26
    ds_read_b64_tr_b16 a[76:77], v18 offset:1024
    ds_read_b64_tr_b16 a[78:79], v18 offset:5120
    ds_read_b64_tr_b16 a[84:85], v19 offset:8704
    ds_read_b64_tr_b16 a[80:81], v18 offset:1032
    ds_read_b64_tr_b16 a[82:83], v18 offset:5128
    ds_read_b64_tr_b16 a[86:87], v19 offset:8712
    s_waitcnt lgkmcnt(6)
    v_mfma_f32_16x16x32_bf16 v[132:135], a[64:67], v[108:111], 0
    v_mfma_f32_16x16x32_bf16 v[136:139], a[68:71], v[108:111], 0
    v_mfma_f32_16x16x32_bf16 v[140:143], a[64:67], v[116:119], 0
    v_mfma_f32_16x16x32_bf16 v[144:147], a[68:71], v[116:119], 0
    s_nop 2
    v_mfma_f32_16x16x16_bf16 v[132:135], a[72:73], v[112:113], v[132:135]
    v_mfma_f32_16x16x16_bf16 v[136:139], a[74:75], v[112:113], v[136:139]
    v_mfma_f32_16x16x16_bf16 v[140:143], a[72:73], v[114:115], v[140:143]
    v_mfma_f32_16x16x16_bf16 v[144:147], a[74:75], v[114:115], v[144:147]
    s_nop 7
    v_pk_mul_f32 v[132:133], v[132:133], v[24:25]
    v_pk_mul_f32 v[134:135], v[134:135], v[24:25]
    v_pk_mul_f32 v[136:137], v[136:137], v[24:25]
    v_pk_mul_f32 v[138:139], v[138:139], v[24:25]
    v_cvt_pk_bf16_f32 v152, v132, v133
    v_cvt_pk_bf16_f32 v153, v134, v135
    v_cvt_pk_bf16_f32 v154, v136, v137
    v_cvt_pk_bf16_f32 v155, v138, v139
    global_store_dwordx4 v21, v[152:155], s[36:37] offset:0 sc1
    v_pk_mul_f32 v[140:141], v[140:141], v[26:27]
    v_pk_mul_f32 v[142:143], v[142:143], v[26:27]
    v_pk_mul_f32 v[144:145], v[144:145], v[26:27]
    v_pk_mul_f32 v[146:147], v[146:147], v[26:27]
    v_cvt_pk_bf16_f32 v156, v140, v141
    v_cvt_pk_bf16_f32 v157, v142, v143
    v_cvt_pk_bf16_f32 v158, v144, v145
    v_cvt_pk_bf16_f32 v159, v146, v147
    global_store_dwordx4 v22, v[156:159], s[36:37] offset:0 sc1
    ds_read_b64_tr_b16 a[64:65], v18 offset:2048
    ds_read_b64_tr_b16 a[66:67], v18 offset:6144
    ds_read_b64_tr_b16 a[72:73], v19 offset:9216
    ds_read_b64_tr_b16 a[68:69], v18 offset:2056
    ds_read_b64_tr_b16 a[70:71], v18 offset:6152
    ds_read_b64_tr_b16 a[74:75], v19 offset:9224
    s_waitcnt lgkmcnt(6)
    v_mfma_f32_16x16x32_bf16 v[132:135], a[76:79], v[108:111], 0
    v_mfma_f32_16x16x32_bf16 v[136:139], a[80:83], v[108:111], 0
    v_mfma_f32_16x16x32_bf16 v[140:143], a[76:79], v[116:119], 0
    v_mfma_f32_16x16x32_bf16 v[144:147], a[80:83], v[116:119], 0
    s_nop 2
    v_mfma_f32_16x16x16_bf16 v[132:135], a[84:85], v[112:113], v[132:135]
    v_mfma_f32_16x16x16_bf16 v[136:139], a[86:87], v[112:113], v[136:139]
    v_mfma_f32_16x16x16_bf16 v[140:143], a[84:85], v[114:115], v[140:143]
    v_mfma_f32_16x16x16_bf16 v[144:147], a[86:87], v[114:115], v[144:147]
    s_nop 7
    v_pk_mul_f32 v[132:133], v[132:133], v[24:25]
    v_pk_mul_f32 v[134:135], v[134:135], v[24:25]
    v_pk_mul_f32 v[136:137], v[136:137], v[24:25]
    v_pk_mul_f32 v[138:139], v[138:139], v[24:25]
    v_cvt_pk_bf16_f32 v152, v132, v133
    v_cvt_pk_bf16_f32 v153, v134, v135
    v_cvt_pk_bf16_f32 v154, v136, v137
    v_cvt_pk_bf16_f32 v155, v138, v139
    global_store_dwordx4 v21, v[152:155], s[36:37] offset:1024 sc1
    v_pk_mul_f32 v[140:141], v[140:141], v[26:27]
    v_pk_mul_f32 v[142:143], v[142:143], v[26:27]
    v_pk_mul_f32 v[144:145], v[144:145], v[26:27]
    v_pk_mul_f32 v[146:147], v[146:147], v[26:27]
    v_cvt_pk_bf16_f32 v156, v140, v141
    v_cvt_pk_bf16_f32 v157, v142, v143
    v_cvt_pk_bf16_f32 v158, v144, v145
    v_cvt_pk_bf16_f32 v159, v146, v147
    global_store_dwordx4 v22, v[156:159], s[36:37] offset:1024 sc1
    ds_read_b64_tr_b16 a[76:77], v18 offset:3072
    ds_read_b64_tr_b16 a[78:79], v18 offset:7168
    ds_read_b64_tr_b16 a[84:85], v19 offset:9728
    ds_read_b64_tr_b16 a[80:81], v18 offset:3080
    ds_read_b64_tr_b16 a[82:83], v18 offset:7176
    ds_read_b64_tr_b16 a[86:87], v19 offset:9736
    s_waitcnt lgkmcnt(6)
    v_mfma_f32_16x16x32_bf16 v[132:135], a[64:67], v[108:111], 0
    v_mfma_f32_16x16x32_bf16 v[136:139], a[68:71], v[108:111], 0
    v_mfma_f32_16x16x32_bf16 v[140:143], a[64:67], v[116:119], 0
    v_mfma_f32_16x16x32_bf16 v[144:147], a[68:71], v[116:119], 0
    s_nop 2
    v_mfma_f32_16x16x16_bf16 v[132:135], a[72:73], v[112:113], v[132:135]
    v_mfma_f32_16x16x16_bf16 v[136:139], a[74:75], v[112:113], v[136:139]
    v_mfma_f32_16x16x16_bf16 v[140:143], a[72:73], v[114:115], v[140:143]
    v_mfma_f32_16x16x16_bf16 v[144:147], a[74:75], v[114:115], v[144:147]
    s_nop 7
    v_pk_mul_f32 v[132:133], v[132:133], v[24:25]
    v_pk_mul_f32 v[134:135], v[134:135], v[24:25]
    v_pk_mul_f32 v[136:137], v[136:137], v[24:25]
    v_pk_mul_f32 v[138:139], v[138:139], v[24:25]
    v_cvt_pk_bf16_f32 v152, v132, v133
    v_cvt_pk_bf16_f32 v153, v134, v135
    v_cvt_pk_bf16_f32 v154, v136, v137
    v_cvt_pk_bf16_f32 v155, v138, v139
    global_store_dwordx4 v21, v[152:155], s[36:37] offset:2048 sc1
    v_pk_mul_f32 v[140:141], v[140:141], v[26:27]
    v_pk_mul_f32 v[142:143], v[142:143], v[26:27]
    v_pk_mul_f32 v[144:145], v[144:145], v[26:27]
    v_pk_mul_f32 v[146:147], v[146:147], v[26:27]
    v_cvt_pk_bf16_f32 v156, v140, v141
    v_cvt_pk_bf16_f32 v157, v142, v143
    v_cvt_pk_bf16_f32 v158, v144, v145
    v_cvt_pk_bf16_f32 v159, v146, v147
    global_store_dwordx4 v22, v[156:159], s[36:37] offset:2048 sc1
    s_waitcnt lgkmcnt(0)
    v_mfma_f32_16x16x32_bf16 v[132:135], a[76:79], v[108:111], 0
    v_mfma_f32_16x16x32_bf16 v[136:139], a[80:83], v[108:111], 0
    v_mfma_f32_16x16x32_bf16 v[140:143], a[76:79], v[116:119], 0
    v_mfma_f32_16x16x32_bf16 v[144:147], a[80:83], v[116:119], 0
    s_nop 2
    v_mfma_f32_16x16x16_bf16 v[132:135], a[84:85], v[112:113], v[132:135]
    v_mfma_f32_16x16x16_bf16 v[136:139], a[86:87], v[112:113], v[136:139]
    v_mfma_f32_16x16x16_bf16 v[140:143], a[84:85], v[114:115], v[140:143]
    v_mfma_f32_16x16x16_bf16 v[144:147], a[86:87], v[114:115], v[144:147]
    s_nop 7
    v_pk_mul_f32 v[132:133], v[132:133], v[24:25]
    v_pk_mul_f32 v[134:135], v[134:135], v[24:25]
    v_pk_mul_f32 v[136:137], v[136:137], v[24:25]
    v_pk_mul_f32 v[138:139], v[138:139], v[24:25]
    v_cvt_pk_bf16_f32 v152, v132, v133
    v_cvt_pk_bf16_f32 v153, v134, v135
    v_cvt_pk_bf16_f32 v154, v136, v137
    v_cvt_pk_bf16_f32 v155, v138, v139
    global_store_dwordx4 v21, v[152:155], s[36:37] offset:3072 sc1
    v_pk_mul_f32 v[140:141], v[140:141], v[26:27]
    v_pk_mul_f32 v[142:143], v[142:143], v[26:27]
    v_pk_mul_f32 v[144:145], v[144:145], v[26:27]
    v_pk_mul_f32 v[146:147], v[146:147], v[26:27]
    v_cvt_pk_bf16_f32 v156, v140, v141
    v_cvt_pk_bf16_f32 v157, v142, v143
    v_cvt_pk_bf16_f32 v158, v144, v145
    v_cvt_pk_bf16_f32 v159, v146, v147
    global_store_dwordx4 v22, v[156:159], s[36:37] offset:3072 sc1
    s_add_u32 s36, s36, 0x100000
    s_addc_u32 s37, s37, 0
    s_cmp_eq_u32 s55, 1
    s_cbranch_scc1 h1_23
    s_lshl_b32 s47, s39, 7
    s_lshl_b32 s49, s42, 2
    s_add_u32 s47, s47, s49
    s_add_u32 s47, s47, 1966080
    s_lshr_b32 s50, s39, 1
    s_lshl_b32 s50, s50, 14
    s_and_b32 s49, s39, 1
    s_lshl_b32 s49, s49, 12
    s_add_u32 s50, s50, s49
    s_lshl_b32 s49, s42, 7
    s_add_u32 s50, s50, s49
    s_xor_b32 s49, s22, 1
    s_lshl_b32 s49, s49, 13
    s_add_u32 s50, s50, s49
    s_add_u32 s50, s50, 917504
    s_cmp_ge_u32 s39, 48
    s_cselect_b32 s47, s50, s47
    v_mov_b32 v29, s47
    s_waitcnt vmcnt(0)
    s_mov_b64 exec, 1
    global_store_dword v29, v23, s[28:29] sc1
    s_mov_b64 exec, -1
    s_min_u32 s51, s54, 61
ap_24:
    s_cmp_lt_u32 s51, s48
    s_cbranch_scc1 ao_25
    s_cmp_lt_u32 s48, 59
    s_cbranch_scc1 nf_26
    s_sleep 2
    global_load_dword v24, v31, s[28:29] sc1
    s_waitcnt vmcnt(0)
    v_readlane_b32 s49, v24, 0
    v_readlane_b32 s50, v24, 1
    s_min_i32 s49, s49, s50
    v_readlane_b32 s50, v24, 2
    s_min_i32 s49, s49, s50
    v_readlane_b32 s50, v24, 3
    s_min_i32 s49, s49, s50
    s_add_u32 s49, s49, 1
    s_max_u32 s48, s48, s49
    s_add_u32 s46, s46, 1
    s_cmp_lt_u32 s46, 400000
    s_cbranch_scc1 ap_24
    s_branch w_fail
nf_26:
    s_sleep 8
    global_load_dword v24, v23, s[26:27] offset:192 sc1
    s_waitcnt vmcnt(0)
    v_readfirstlane_b32 s48, v24
    s_nop 0
    s_max_u32 s48, s48, 1
    s_sub_u32 s48, s48, 1
    s_add_u32 s46, s46, 1
    s_cmp_lt_u32 s46, 400000
    s_cbranch_scc1 ap_24
    s_branch w_fail
ao_25:
m1_27:
    global_load_dwordx4 v[32:35], v28, s[52:53] offset:0 sc1
    global_load_dwordx4 v[36:39], v28, s[52:53] offset:512 sc1
    global_load_dwordx4 v[40:43], v28, s[52:53] offset:1024 sc1
    global_load_dwordx4 v[44:47], v28, s[52:53] offset:1536 sc1
    global_load_dwordx4 v[48:51], v16, s[52:53] offset:2048 sc1
    global_load_dwordx4 v[52:55], v16, s[52:53] offset:3072 sc1
    s_waitcnt vmcnt(0)
    s_cmp_lt_u32 s54, 62
    s_cbranch_scc1 h1_23
    v_max3_u32 v24, v32, v33, v34
    v_max3_u32 v24, v24, v35, v36
    v_max3_u32 v24, v24, v37, v38
    v_max3_u32 v24, v24, v39, v40
    v_max3_u32 v24, v24, v41, v42
    v_max3_u32 v24, v24, v43, v44
    v_max3_u32 v24, v24, v45, v46
    v_max3_u32 v24, v24, v47, v48
    v_max3_u32 v24, v24, v49, v50
    v_max3_u32 v24, v24, v51, v52
    v_max3_u32 v24, v24, v53, v54
    v_max_u32 v24, v24, v55
    v_cmp_eq_u32 vcc, -1, v24
    s_cbranch_vccz h1_23
    s_sleep 2
    s_add_u32 s46, s46, 1
    s_cmp_lt_u32 s46, 400000
    s_cbranch_scc1 m1_27
    s_branch w_fail
h1_23:
    s_waitcnt vmcnt(8)
    ds_write_b128 v20, v[48:51] offset:18432
    ds_write_b128 v20, v[52:55] offset:19456
    v_mfma_f32_16x16x32_bf16 v[132:135], a[32:35], v[64:67], v[96:99]
    v_mfma_f32_16x16x32_bf16 v[136:139], v[32:35], v[64:67], v[100:103]
    v_mfma_f32_16x16x32_bf16 v[140:143], a[32:35], v[80:83], 0
    v_mfma_f32_16x16x32_bf16 v[144:147], a[48:51], v[80:83], v[96:99]
    v_mfma_f32_16x16x32_bf16 v[148:151], v[32:35], v[80:83], v[100:103]
    v_mfma_f32_16x16x32_bf16 v[132:135], a[36:39], v[68:71], v[132:135]
    v_mfma_f32_16x16x32_bf16 v[136:139], v[36:39], v[68:71], v[136:139]
    v_mfma_f32_16x16x32_bf16 v[140:143], a[36:39], v[84:87], v[140:143]
    v_mfma_f32_16x16x32_bf16 v[144:147], a[52:55], v[84:87], v[144:147]
    v_mfma_f32_16x16x32_bf16 v[148:151], v[36:39], v[84:87], v[148:151]
    v_mfma_f32_16x16x32_bf16 v[132:135], a[40:43], v[72:75], v[132:135]
    v_mfma_f32_16x16x32_bf16 v[136:139], v[40:43], v[72:75], v[136:139]
    v_mfma_f32_16x16x32_bf16 v[140:143], a[40:43], v[88:91], v[140:143]
    v_mfma_f32_16x16x32_bf16 v[144:147], a[56:59], v[88:91], v[144:147]
    v_mfma_f32_16x16x32_bf16 v[148:151], v[40:43], v[88:91], v[148:151]
    v_mfma_f32_16x16x32_bf16 v[132:135], a[44:47], v[76:79], v[132:135]
    v_mfma_f32_16x16x32_bf16 v[136:139], v[44:47], v[76:79], v[136:139]
    v_mfma_f32_16x16x32_bf16 v[140:143], a[44:47], v[92:95], v[140:143]
    v_mfma_f32_16x16x32_bf16 v[144:147], a[60:63], v[92:95], v[144:147]
    v_mfma_f32_16x16x32_bf16 v[148:151], v[44:47], v[92:95], v[148:151]
    ds_read_b64_tr_b16 a[64:65], v18 offset:10240
    ds_read_b64_tr_b16 a[66:67], v18 offset:14336
    ds_read_b64_tr_b16 a[72:73], v19 offset:18432
    ds_read_b64_tr_b16 a[68:69], v18 offset:10248
    ds_read_b64_tr_b16 a[70:71], v18 offset:14344
    ds_read_b64_tr_b16 a[74:75], v19 offset:18440
    s_nop 3
    v_max3_f32 v24, v132, v133, v134
    v_max3_f32 v24, v24, v135, v136
    v_max3_f32 v24, v24, v137, v138
    v_max_f32 v24, v24, v139
    v_mov_b32 v25, v24
    s_nop 1
    v_permlane16_swap_b32 v24, v25
    v_max_f32 v24, v24, v25
    v_mov_b32 v25, v24
    s_nop 1
    v_permlane32_swap_b32 v24, v25
    v_max_f32 v24, v24, v25
    v_mul_f32 v24, s40, v24
    v_fma_f32 v132, v132, s40, -v24
    v_fma_f32 v133, v133, s40, -v24
    v_fma_f32 v134, v134, s40, -v24
    v_fma_f32 v135, v135, s40, -v24
    v_fma_f32 v136, v136, s40, -v24
    v_fma_f32 v137, v137, s40, -v24
    v_fma_f32 v138, v138, s40, -v24
    v_fma_f32 v139, v139, s40, -v24
    v_exp_f32 v132, v132
    v_exp_f32 v133, v133
    v_exp_f32 v134, v134
    v_exp_f32 v135, v135
    v_exp_f32 v136, v136
    v_exp_f32 v137, v137
    v_exp_f32 v138, v138
    v_exp_f32 v139, v139
    v_max3_f32 v24, v140, v141, v142
    v_max3_f32 v24, v24, v143, v144
    v_max3_f32 v24, v24, v145, v146
    v_max3_f32 v24, v24, v147, v148
    v_max3_f32 v24, v24, v149, v150
    v_max_f32 v24, v24, v151
    v_mov_b32 v25, v24
    s_nop 1
    v_permlane16_swap_b32 v24, v25
    v_max_f32 v24, v24, v25
    v_mov_b32 v25, v24
    s_nop 1
    v_permlane32_swap_b32 v24, v25
    v_max_f32 v24, v24, v25
    v_mul_f32 v24, s40, v24
    v_fma_f32 v140, v140, s40, -v24
    v_fma_f32 v141, v141, s40, -v24
    v_fma_f32 v142, v142, s40, -v24
    v_fma_f32 v143, v143, s40, -v24
    v_fma_f32 v144, v144, s40, -v24
    v_fma_f32 v145, v145, s40, -v24
    v_fma_f32 v146, v146, s40, -v24
    v_fma_f32 v147, v147, s40, -v24
    v_fma_f32 v148, v148, s40, -v24
    v_fma_f32 v149, v149, s40, -v24
    v_fma_f32 v150, v150, s40, -v24
    v_fma_f32 v151, v151, s40, -v24
    v_exp_f32 v140, v140
    v_exp_f32 v141, v141
    v_exp_f32 v142, v142
    v_exp_f32 v143, v143
    v_exp_f32 v144, v144
    v_exp_f32 v145, v145
    v_exp_f32 v146, v146
    v_exp_f32 v147, v147
    v_exp_f32 v148, v148
    v_exp_f32 v149, v149
    v_exp_f32 v150, v150
    v_exp_f32 v151, v151
    s_nop 0
    v_cvt_pk_bf16_f32 v108, v132, v133
    v_cvt_pk_bf16_f32 v109, v134, v135
    v_mov_b32 v110, 0
    v_mov_b32 v111, 0
    v_cvt_pk_bf16_f32 v112, v136, v137
    v_cvt_pk_bf16_f32 v113, v138, v139
    v_cvt_pk_bf16_f32 v116, v140, v141
    v_cvt_pk_bf16_f32 v117, v142, v143
    v_cvt_pk_bf16_f32 v118, v144, v145
    v_cvt_pk_bf16_f32 v119, v146, v147
    v_cvt_pk_bf16_f32 v114, v148, v149
    v_cvt_pk_bf16_f32 v115, v150, v151
    s_nop 1
    v_mfma_f32_16x16x32_bf16 v[120:123], v[104:107], v[108:111], 0
    v_mfma_f32_16x16x32_bf16 v[124:127], v[104:107], v[116:119], 0
    s_nop 5
    v_mfma_f32_16x16x16_bf16 v[120:123], v[104:105], v[112:113], v[120:123]
    v_mfma_f32_16x16x16_bf16 v[124:127], v[104:105], v[114:115], v[124:127]
    s_cmp_eq_u32 s55, 1
    s_cbranch_scc0 d0_28
    s_lshl_b32 s47, s39, 7
    s_lshl_b32 s49, s42, 2
    s_add_u32 s47, s47, s49
    s_add_u32 s47, s47, 1966080
    s_lshr_b32 s50, s39, 1
    s_lshl_b32 s50, s50, 14
    s_and_b32 s49, s39, 1
    s_lshl_b32 s49, s49, 12
    s_add_u32 s50, s50, s49
    s_lshl_b32 s49, s42, 7
    s_add_u32 s50, s50, s49
    s_xor_b32 s49, s22, 1
    s_lshl_b32 s49, s49, 13
    s_add_u32 s50, s50, s49
    s_add_u32 s50, s50, 917504
    s_cmp_ge_u32 s39, 48
    s_cselect_b32 s47, s50, s47
    v_mov_b32 v29, s47
    s_waitcnt vmcnt(0)
    s_mov_b64 exec, 1
    global_store_dword v29, v23, s[28:29] sc1
    s_mov_b64 exec, -1
d0_28:
    s_nop 7
    v_rcp_f32 v24, v120
    v_rcp_f32 v26, v124
    s_nop 0
    v_mov_b32 v25, v24
    v_mov_b32 v27, v26
    ds_read_b64_tr_b16 a[76:77], v18 offset:11264
    ds_read_b64_tr_b16 a[78:79], v18 offset:15360
    ds_read_b64_tr_b16 a[84:85], v19 offset:18944
    ds_read_b64_tr_b16 a[80:81], v18 offset:11272
    ds_read_b64_tr_b16 a[82:83], v18 offset:15368
    ds_read_b64_tr_b16 a[86:87], v19 offset:18952
    s_waitcnt lgkmcnt(6)
    v_mfma_f32_16x16x32_bf16 v[132:135], a[64:67], v[108:111], 0
    v_mfma_f32_16x16x32_bf16 v[136:139], a[68:71], v[108:111], 0
    v_mfma_f32_16x16x32_bf16 v[140:143], a[64:67], v[116:119], 0
    v_mfma_f32_16x16x32_bf16 v[144:147], a[68:71], v[116:119], 0
    s_nop 2
    v_mfma_f32_16x16x16_bf16 v[132:135], a[72:73], v[112:113], v[132:135]
    v_mfma_f32_16x16x16_bf16 v[136:139], a[74:75], v[112:113], v[136:139]
    v_mfma_f32_16x16x16_bf16 v[140:143], a[72:73], v[114:115], v[140:143]
    v_mfma_f32_16x16x16_bf16 v[144:147], a[74:75], v[114:115], v[144:147]
    ds_read_b64_tr_b16 a[64:65], v18 offset:12288
    ds_read_b64_tr_b16 a[66:67], v18 offset:16384
    ds_read_b64_tr_b16 a[72:73], v19 offset:19456
    ds_read_b64_tr_b16 a[68:69], v18 offset:12296
    ds_read_b64_tr_b16 a[70:71], v18 offset:16392
    ds_read_b64_tr_b16 a[74:75], v19 offset:19464
    s_waitcnt lgkmcnt(6)
    v_mfma_f32_16x16x32_bf16 v[64:67], a[76:79], v[108:111], 0
    v_mfma_f32_16x16x32_bf16 v[68:71], a[80:83], v[108:111], 0
    v_mfma_f32_16x16x32_bf16 v[72:75], a[76:79], v[116:119], 0
    v_mfma_f32_16x16x32_bf16 v[76:79], a[80:83], v[116:119], 0
    v_pk_mul_f32 v[132:133], v[132:133], v[24:25]
    v_pk_mul_f32 v[134:135], v[134:135], v[24:25]
    v_pk_mul_f32 v[136:137], v[136:137], v[24:25]
    v_pk_mul_f32 v[138:139], v[138:139], v[24:25]
    v_mfma_f32_16x16x16_bf16 v[64:67], a[84:85], v[112:113], v[64:67]
    v_cvt_pk_bf16_f32 v152, v132, v133
    v_cvt_pk_bf16_f32 v153, v134, v135
    v_mfma_f32_16x16x16_bf16 v[68:71], a[86:87], v[112:113], v[68:71]
    v_cvt_pk_bf16_f32 v154, v136, v137
    v_cvt_pk_bf16_f32 v155, v138, v139
    v_mfma_f32_16x16x16_bf16 v[72:75], a[84:85], v[114:115], v[72:75]
    global_store_dwordx4 v21, v[152:155], s[36:37] offset:0 sc1
    v_pk_mul_f32 v[140:141], v[140:141], v[26:27]
    v_mfma_f32_16x16x16_bf16 v[76:79], a[86:87], v[114:115], v[76:79]
    v_pk_mul_f32 v[142:143], v[142:143], v[26:27]
    v_pk_mul_f32 v[144:145], v[144:145], v[26:27]
    v_pk_mul_f32 v[146:147], v[146:147], v[26:27]
    v_cvt_pk_bf16_f32 v156, v140, v141
    v_cvt_pk_bf16_f32 v157, v142, v143
    v_cvt_pk_bf16_f32 v158, v144, v145
    v_cvt_pk_bf16_f32 v159, v146, v147
    global_store_dwordx4 v22, v[156:159], s[36:37] offset:0 sc1
    ds_read_b64_tr_b16 a[76:77], v18 offset:13312
    ds_read_b64_tr_b16 a[78:79], v18 offset:17408
    ds_read_b64_tr_b16 a[84:85], v19 offset:19968
    ds_read_b64_tr_b16 a[80:81], v18 offset:13320
    ds_read_b64_tr_b16 a[82:83], v18 offset:17416
    ds_read_b64_tr_b16 a[86:87], v19 offset:19976
    s_waitcnt lgkmcnt(6)
    v_mfma_f32_16x16x32_bf16 v[132:135], a[64:67], v[108:111], 0
    v_mfma_f32_16x16x32_bf16 v[136:139], a[68:71], v[108:111], 0
    v_mfma_f32_16x16x32_bf16 v[140:143], a[64:67], v[116:119], 0
    v_mfma_f32_16x16x32_bf16 v[144:147], a[68:71], v[116:119], 0
    v_pk_mul_f32 v[64:65], v[64:65], v[24:25]
    v_pk_mul_f32 v[66:67], v[66:67], v[24:25]
    v_pk_mul_f32 v[68:69], v[68:69], v[24:25]
    v_pk_mul_f32 v[70:71], v[70:71], v[24:25]
    v_mfma_f32_16x16x16_bf16 v[132:135], a[72:73], v[112:113], v[132:135]
    v_cvt_pk_bf16_f32 v152, v64, v65
    v_cvt_pk_bf16_f32 v153, v66, v67
    v_mfma_f32_16x16x16_bf16 v[136:139], a[74:75], v[112:113], v[136:139]
    v_cvt_pk_bf16_f32 v154, v68, v69
    v_cvt_pk_bf16_f32 v155, v70, v71
    v_mfma_f32_16x16x16_bf16 v[140:143], a[72:73], v[114:115], v[140:143]
    global_store_dwordx4 v21, v[152:155], s[36:37] offset:1024 sc1
    v_pk_mul_f32 v[72:73], v[72:73], v[26:27]
    v_mfma_f32_16x16x16_bf16 v[144:147], a[74:75], v[114:115], v[144:147]
    v_pk_mul_f32 v[74:75], v[74:75], v[26:27]
    v_pk_mul_f32 v[76:77], v[76:77], v[26:27]
    v_pk_mul_f32 v[78:79], v[78:79], v[26:27]
    v_cvt_pk_bf16_f32 v156, v72, v73
    v_cvt_pk_bf16_f32 v157, v74, v75
    v_cvt_pk_bf16_f32 v158, v76, v77
    v_cvt_pk_bf16_f32 v159, v78, v79
    global_store_dwordx4 v22, v[156:159], s[36:37] offset:1024 sc1
    s_waitcnt lgkmcnt(0)
    v_mfma_f32_16x16x32_bf16 v[64:67], a[76:79], v[108:111], 0
    v_mfma_f32_16x16x32_bf16 v[68:71], a[80:83], v[108:111], 0
    v_mfma_f32_16x16x32_bf16 v[72:75], a[76:79], v[116:119], 0
    v_mfma_f32_16x16x32_bf16 v[76:79], a[80:83], v[116:119], 0
    s_nop 2
    v_pk_mul_f32 v[132:133], v[132:133], v[24:25]
    v_pk_mul_f32 v[134:135], v[134:135], v[24:25]
    v_pk_mul_f32 v[136:137], v[136:137], v[24:25]
    v_pk_mul_f32 v[138:139], v[138:139], v[24:25]
    v_mfma_f32_16x16x16_bf16 v[64:67], a[84:85], v[112:113], v[64:67]
    v_cvt_pk_bf16_f32 v152, v132, v133
    v_cvt_pk_bf16_f32 v153, v134, v135
    v_mfma_f32_16x16x16_bf16 v[68:71], a[86:87], v[112:113], v[68:71]
    v_cvt_pk_bf16_f32 v154, v136, v137
    v_cvt_pk_bf16_f32 v155, v138, v139
    v_mfma_f32_16x16x16_bf16 v[72:75], a[84:85], v[114:115], v[72:75]
    global_store_dwordx4 v21, v[152:155], s[36:37] offset:2048 sc1
    v_pk_mul_f32 v[140:141], v[140:141], v[26:27]
    v_mfma_f32_16x16x16_bf16 v[76:79], a[86:87], v[114:115], v[76:79]
    v_pk_mul_f32 v[142:143], v[142:143], v[26:27]
    v_pk_mul_f32 v[144:145], v[144:145], v[26:27]
    v_pk_mul_f32 v[146:147], v[146:147], v[26:27]
    v_cvt_pk_bf16_f32 v156, v140, v141
    v_cvt_pk_bf16_f32 v157, v142, v143
    v_cvt_pk_bf16_f32 v158, v144, v145
    v_cvt_pk_bf16_f32 v159, v146, v147
    global_store_dwordx4 v22, v[156:159], s[36:37] offset:2048 sc1
    s_nop 7
    v_pk_mul_f32 v[64:65], v[64:65], v[24:25]
    v_pk_mul_f32 v[66:67], v[66:67], v[24:25]
    v_pk_mul_f32 v[68:69], v[68:69], v[24:25]
    v_pk_mul_f32 v[70:71], v[70:71], v[24:25]
    v_cvt_pk_bf16_f32 v152, v64, v65
    v_cvt_pk_bf16_f32 v153, v66, v67
    v_cvt_pk_bf16_f32 v154, v68, v69
    v_cvt_pk_bf16_f32 v155, v70, v71
    global_store_dwordx4 v21, v[152:155], s[36:37] offset:3072 sc1
    v_pk_mul_f32 v[72:73], v[72:73], v[26:27]
    v_pk_mul_f32 v[74:75], v[74:75], v[26:27]
    v_pk_mul_f32 v[76:77], v[76:77], v[26:27]
    v_pk_mul_f32 v[78:79], v[78:79], v[26:27]
    v_cvt_pk_bf16_f32 v156, v72, v73
    v_cvt_pk_bf16_f32 v157, v74, v75
    v_cvt_pk_bf16_f32 v158, v76, v77
    v_cvt_pk_bf16_f32 v159, v78, v79
    global_store_dwordx4 v22, v[156:159], s[36:37] offset:3072 sc1
    s_lshl_b32 s47, s54, 7
    s_lshl_b32 s49, s42, 2
    s_add_u32 s47, s47, s49
    s_add_u32 s47, s47, 1966080
    s_lshr_b32 s50, s54, 1
    s_lshl_b32 s50, s50, 14
    s_and_b32 s49, s54, 1
    s_lshl_b32 s49, s49, 12
    s_add_u32 s50, s50, s49
    s_lshl_b32 s49, s42, 7
    s_add_u32 s50, s50, s49
    s_xor_b32 s49, s22, 1
    s_lshl_b32 s49, s49, 13
    s_add_u32 s50, s50, s49
    s_add_u32 s50, s50, 917504
    s_cmp_ge_u32 s54, 48
    s_cselect_b32 s47, s50, s47
    v_mov_b32 v29, s47
    s_waitcnt vmcnt(0)
    s_mov_b64 exec, 1
    global_store_dword v29, v23, s[28:29] sc1
    s_mov_b64 exec, -1
    s_cmp_eq_u32 s44, 0
    s_cbranch_scc1 w_g5
    s_cmp_eq_u32 s44, 2
    s_cbranch_scc1 w_set2
    s_lshr_b32 s30, s45, 3
    s_cmp_eq_u32 s44, 3
    s_cbranch_scc1 w_f1
    s_and_b32 s31, s45, 7
    s_lshl_b32 s32, s30, 3
    s_add_u32 s32, s32, s75
    s_lshl_b32 s32, s32, 19
    s_add_u32 s32, s32, 132120576
    s_lshr_b32 s33, s32, 21
    s_xor_b32 s33, s33, s22
    s_xor_b32 s33, s33, 1
    s_and_b32 s33, s33, 1
    s_lshl_b32 s33, s33, 13
    s_add_u32 s32, s32, s33
    v_lshlrev_b32 v16, 4, v0
    s_mul_i32 s74, s75, 262144
    s_lshl_b32 s76, s75, 11
    v_add_u32 v28, s74, v16
    v_add_u32 v29, 1024, v28
    s_mul_i32 s74, s72, 4096
    v_add_u32 v6, s74, v16
    v_add_u32 v7, 1024, v6
    s_mov_b32 s64, 2048
    s_mov_b32 s86, 0x2000
    v_lshlrev_b32 v16, 4, v0
    v_add_u32 v4, s32, v16
    v_add_u32 v5, 1024, v4
    s_lshl_b32 s74, s73, 13
    s_add_u32 s74, s74, 65536
    v_add_u32 v27, s74, v16
    s_mov_b32 s65, 2048
    s_mov_b32 s87, 0x2000
    s_cmp_lg_u32 s75, 0
    s_cbranch_scc1 to_30
    v_lshlrev_b32 v18, 2, v0
    v_add_u32 v18, 1979904, v18
tl_29:
    global_load_dword v19, v18, s[28:29] sc1
    s_waitcnt vmcnt(0)
    v_cmp_ne_u32 vcc, 0, v19
    s_cbranch_vccz to_30
    s_sleep 8
    s_add_u32 s46, s46, 1
    s_cmp_lt_u32 s46, 400000
    s_cbranch_scc1 tl_29
    s_branch w_fail
to_30:
    s_cmp_lg_u32 s75, 0
    s_cbranch_scc1 fo_32
    s_lshl_b32 s32, s31, 9
    s_add_u32 s32, s32, 1966080
    v_lshl_add_u32 v16, v0, 2, s32
fl_31:
    global_load_dword v17, v16, s[28:29] sc1
    global_load_dword v19, v16, s[28:29] offset:256 sc1
    s_waitcnt vmcnt(0)
    v_or_b32 v17, v17, v19
    v_cmp_ne_u32 vcc, 0, v17
    s_cbranch_vccz fo_32
    s_sleep 8
    s_add_u32 s46, s46, 1
    s_cmp_lt_u32 s46, 400000
    s_cbranch_scc1 fl_31
    s_branch w_fail
fo_32:
    s_lshl_b32 s32, s31, 21
    s_add_u32 s32, s32, 88080384
    s_lshr_b32 s33, s32, 21
    s_xor_b32 s33, s33, s22
    s_xor_b32 s33, s33, 1
    s_and_b32 s33, s33, 1
    s_lshl_b32 s33, s33, 13
    s_add_u32 s33, s33, s32
    s_add_u32 s80, s28, s33
    s_addc_u32 s81, s29, 0
    s_mov_b64 s[82:83], s[28:29]
    s_mov_b32 s66, 31
    s_add_u32 s32, s31, s30
    s_and_b32 s78, s32, 3
    s_lshl_b32 s78, s78, 11
    s_and_b32 s33, s32, 4
    s_lshl_b32 s33, s33, 12
    s_or_b32 s78, s78, s33
    s_and_b32 s79, s32, 1
    s_lshl_b32 s79, s79, 12
    s_and_b32 s33, s32, 6
    s_lshl_b32 s33, s33, 13
    s_or_b32 s79, s79, s33
    s_getpc_b64 s[70:71]
call_33:
    s_add_u32 s70, s70, core_F2-call_33
    s_addc_u32 s71, s71, (core_F2-call_33)>>32
    s_swappc_b64 s[68:69], s[70:71]
    v_and_b32 v26, 15, v0
    v_lshlrev_b32 v26, 12, v26
    v_lshrrev_b32 v25, 4, v0
    v_lshl_add_u32 v20, v25, 4, v26
    s_lshl_b32 s32, s72, 17
    s_lshl_b32 s33, s73, 8
    s_add_u32 s32, s32, s33
    v_add_u32 v20, s32, v20
    v_add_u32 v21, 0x10000, v20
    s_lshl_b32 s32, s31, 19
    s_lshl_b32 s33, s30, 9
    s_add_u32 s32, s32, s33
    s_add_u32 s32, s32, 2048
    s_add_u32 s34, s24, s32
    s_addc_u32 s35, s25, 0
    v_cvt_pk_bf16_f32 v24, v32, v33
    v_cvt_pk_bf16_f32 v25, v34, v35
    v_cvt_pk_bf16_f32 v26, v36, v37
    v_cvt_pk_bf16_f32 v27, v38, v39
    global_store_dwordx4 v20, v[24:27], s[34:35] offset:0 sc1
    v_cvt_pk_bf16_f32 v16, v40, v41
    v_cvt_pk_bf16_f32 v17, v42, v43
    v_cvt_pk_bf16_f32 v18, v44, v45
    v_cvt_pk_bf16_f32 v19, v46, v47
    global_store_dwordx4 v20, v[16:19], s[34:35] offset:64 sc1
    v_cvt_pk_bf16_f32 v24, v48, v49
    v_cvt_pk_bf16_f32 v25, v50, v51
    v_cvt_pk_bf16_f32 v26, v52, v53
    v_cvt_pk_bf16_f32 v27, v54, v55
    global_store_dwordx4 v20, v[24:27], s[34:35] offset:128 sc1
    v_cvt_pk_bf16_f32 v16, v56, v57
    v_cvt_pk_bf16_f32 v17, v58, v59
    v_cvt_pk_bf16_f32 v18, v60, v61
    v_cvt_pk_bf16_f32 v19, v62, v63
    global_store_dwordx4 v20, v[16:19], s[34:35] offset:192 sc1
    v_cvt_pk_bf16_f32 v24, v64, v65
    v_cvt_pk_bf16_f32 v25, v66, v67
    v_cvt_pk_bf16_f32 v26, v68, v69
    v_cvt_pk_bf16_f32 v27, v70, v71
    global_store_dwordx4 v21, v[24:27], s[34:35] offset:0 sc1
    v_cvt_pk_bf16_f32 v16, v72, v73
    v_cvt_pk_bf16_f32 v17, v74, v75
    v_cvt_pk_bf16_f32 v18, v76, v77
    v_cvt_pk_bf16_f32 v19, v78, v79
    global_store_dwordx4 v21, v[16:19], s[34:35] offset:64 sc1
    v_cvt_pk_bf16_f32 v24, v80, v81
    v_cvt_pk_bf16_f32 v25, v82, v83
    v_cvt_pk_bf16_f32 v26, v84, v85
    v_cvt_pk_bf16_f32 v27, v86, v87
    global_store_dwordx4 v21, v[24:27], s[34:35] offset:128 sc1
    v_cvt_pk_bf16_f32 v16, v88, v89
    v_cvt_pk_bf16_f32 v17, v90, v91
    v_cvt_pk_bf16_f32 v18, v92, v93
    v_cvt_pk_bf16_f32 v19, v94, v95
    global_store_dwordx4 v21, v[16:19], s[34:35] offset:192 sc1
    s_mov_b32 s34, 0x520f
    s_branch w_stream
w_f1:
    s_lshl_b32 s31, s31, 2
    s_bfe_u32 s32, s45, 0x20001
    s_add_u32 s31, s31, s32
    s_lshl_b32 s32, s30, 3
    s_add_u32 s32, s32, s75
    s_lshl_b32 s32, s32, 19
    s_add_u32 s32, s32, 132120576
    s_lshr_b32 s33, s32, 21
    s_xor_b32 s33, s33, s22
    s_xor_b32 s33, s33, 1
    s_and_b32 s33, s33, 1
    s_lshl_b32 s33, s33, 13
    s_add_u32 s32, s32, s33
    v_lshlrev_b32 v16, 4, v0
    s_lshr_b32 s74, s75, 1
    s_mul_i32 s74, s74, 262144
    s_and_b32 s76, s75, 1
    s_lshl_b32 s76, s76, 10
    s_add_u32 s74, s74, s76
    v_add_u32 v28, s74, v16
    s_lshl_b32 s76, s75, 10
    s_mul_i32 s74, s72, 2048
    v_add_u32 v6, s74, v16
    v_add_u32 v7, 1024, v6
    s_mov_b32 s64, 2048
    s_mov_b32 s86, 0x2000
    v_lshlrev_b32 v16, 4, v0
    v_add_u32 v4, s32, v16
    v_add_u32 v5, 1024, v4
    s_lshl_b32 s74, s73, 13
    s_add_u32 s74, s74, 65536
    v_add_u32 v27, s74, v16
    s_mov_b32 s65, 2048
    s_mov_b32 s87, 0x2000
    s_cmp_lg_u32 s75, 0
    s_cbranch_scc1 to_35
    v_lshlrev_b32 v18, 2, v0
    v_add_u32 v18, 1979904, v18
tl_34:
    global_load_dword v19, v18, s[28:29] sc1
    s_waitcnt vmcnt(0)
    v_cmp_ne_u32 vcc, 0, v19
    s_cbranch_vccz to_35
    s_sleep 8
    s_add_u32 s46, s46, 1
    s_cmp_lt_u32 s46, 400000
    s_cbranch_scc1 tl_34
    s_branch w_fail
to_35:
    s_cmp_lg_u32 s75, 0
    s_cbranch_scc1 fo_37
    s_lshl_b32 s32, s31, 8
    s_add_u32 s32, s32, 1966080
    v_lshl_add_u32 v16, v0, 2, s32
fl_36:
    global_load_dword v17, v16, s[28:29] sc1
    global_load_dword v19, v16, s[28:29] offset:0 sc1
    s_waitcnt vmcnt(0)
    v_or_b32 v17, v17, v19
    v_cmp_ne_u32 vcc, 0, v17
    s_cbranch_vccz fo_37
    s_sleep 8
    s_add_u32 s46, s46, 1
    s_cmp_lt_u32 s46, 400000
    s_cbranch_scc1 fl_36
    s_branch w_fail
fo_37:
    s_lshl_b32 s32, s31, 20
    s_add_u32 s32, s32, 88080384
    s_lshr_b32 s33, s32, 21
    s_xor_b32 s33, s33, s22
    s_xor_b32 s33, s33, 1
    s_and_b32 s33, s33, 1
    s_lshl_b32 s33, s33, 13
    s_add_u32 s33, s33, s32
    s_add_u32 s80, s28, s33
    s_addc_u32 s81, s29, 0
    s_mov_b64 s[82:83], s[28:29]
    s_mov_b32 s66, 31
    s_add_u32 s32, s31, s30
    s_and_b32 s78, s32, 3
    s_lshl_b32 s78, s78, 11
    s_and_b32 s33, s32, 4
    s_lshl_b32 s33, s33, 12
    s_or_b32 s78, s78, s33
    s_and_b32 s79, s32, 1
    s_lshl_b32 s79, s79, 12
    s_and_b32 s33, s32, 6
    s_lshl_b32 s33, s33, 13
    s_or_b32 s79, s79, s33
    s_getpc_b64 s[70:71]
call_38:
    s_add_u32 s70, s70, core_F1-call_38
    s_addc_u32 s71, s71, (core_F1-call_38)>>32
    s_swappc_b64 s[68:69], s[70:71]
    v_and_b32 v26, 15, v0
    v_lshlrev_b32 v26, 12, v26
    v_lshrrev_b32 v25, 4, v0
    v_lshl_add_u32 v20, v25, 4, v26
    s_lshl_b32 s32, s72, 16
    s_lshl_b32 s33, s73, 8
    s_add_u32 s32, s32, s33
    v_add_u32 v20, s32, v20
    v_add_u32 v21, 0x10000, v20
    s_lshl_b32 s32, s31, 18
    s_lshl_b32 s33, s30, 9
    s_add_u32 s32, s32, s33
    s_add_u32 s32, s32, 2048
    s_add_u32 s34, s24, s32
    s_addc_u32 s35, s25, 0
    v_cvt_pk_bf16_f32 v24, v32, v33
    v_cvt_pk_bf16_f32 v25, v34, v35
    v_cvt_pk_bf16_f32 v26, v36, v37
    v_cvt_pk_bf16_f32 v27, v38, v39
    global_store_dwordx4 v20, v[24:27], s[34:35] offset:0 sc1
    v_cvt_pk_bf16_f32 v16, v40, v41
    v_cvt_pk_bf16_f32 v17, v42, v43
    v_cvt_pk_bf16_f32 v18, v44, v45
    v_cvt_pk_bf16_f32 v19, v46, v47
    global_store_dwordx4 v20, v[16:19], s[34:35] offset:64 sc1
    v_cvt_pk_bf16_f32 v24, v48, v49
    v_cvt_pk_bf16_f32 v25, v50, v51
    v_cvt_pk_bf16_f32 v26, v52, v53
    v_cvt_pk_bf16_f32 v27, v54, v55
    global_store_dwordx4 v20, v[24:27], s[34:35] offset:128 sc1
    v_cvt_pk_bf16_f32 v16, v56, v57
    v_cvt_pk_bf16_f32 v17, v58, v59
    v_cvt_pk_bf16_f32 v18, v60, v61
    v_cvt_pk_bf16_f32 v19, v62, v63
    global_store_dwordx4 v20, v[16:19], s[34:35] offset:192 sc1
w_set2:
    s_bitcmp1_b32 s45, 0
    s_cbranch_scc1 w_exit
    s_and_b32 s32, s44, 1
    s_add_u32 s45, s45, s32
    s_mov_b32 s34, 0x8980
    s_branch w_stream
w_g5:
    s_bfe_u32 s30, s45, 0x10003
    s_lshl_b32 s30, s30, 1
    s_and_b32 s32, s45, 1
    s_add_u32 s30, s30, s32
    s_lshr_b32 s31, s45, 4
    s_lshl_b32 s31, s31, 2
    s_bfe_u32 s32, s45, 0x20001
    s_add_u32 s31, s31, s32
    s_mul_i32 s76, s75, 4096
    s_mov_b32 s74, 2048
    v_lshrrev_b32 v16, 3, v0
    s_mul_i32 s64, s75, 32
    s_add_u32 s64, s64, 0
    v_add_u32 v16, s64, v16
    v_lshrrev_b32 v17, 1, v16
    v_xor_b32 v17, v17, v0
    v_and_b32 v17, 7, v17
    v_mul_lo_u32 v16, v16, s74
    v_lshl_add_u32 v28, v17, 4, v16
    v_lshrrev_b32 v16, 3, v0
    s_mul_i32 s64, s75, 32
    s_add_u32 s64, s64, 8
    v_add_u32 v16, s64, v16
    v_lshrrev_b32 v17, 1, v16
    v_xor_b32 v17, v17, v0
    v_and_b32 v17, 7, v17
    v_mul_lo_u32 v16, v16, s74
    v_lshl_add_u32 v29, v17, 4, v16
    v_lshrrev_b32 v16, 3, v0
    s_mul_i32 s64, s75, 32
    s_add_u32 s64, s64, 16
    v_add_u32 v16, s64, v16
    v_lshrrev_b32 v17, 1, v16
    v_xor_b32 v17, v17, v0
    v_and_b32 v17, 7, v17
    v_mul_lo_u32 v16, v16, s74
    v_lshl_add_u32 v30, v17, 4, v16
    v_lshrrev_b32 v16, 3, v0
    s_mul_i32 s64, s75, 32
    s_add_u32 s64, s64, 24
    v_add_u32 v16, s64, v16
    v_lshrrev_b32 v17, 1, v16
    v_xor_b32 v17, v17, v0
    v_and_b32 v17, 7, v17
    v_mul_lo_u32 v16, v16, s74
    v_lshl_add_u32 v31, v17, 4, v16
    v_and_b32 v16, 15, v0
    v_lshrrev_b32 v17, 1, v16
    v_lshrrev_b32 v18, 4, v0
    v_xor_b32 v17, v17, v18
    v_lshlrev_b32 v16, 7, v16
    v_lshl_add_u32 v6, v17, 4, v16
    s_mul_i32 s74, s72, 8192
    v_add_u32 v6, s74, v6
    v_xor_b32 v7, 64, v6
    s_mov_b32 s64, 128
    s_mov_b32 s86, 0
    v_lshrrev_b32 v16, 5, v0
    s_lshl_b32 s74, s75, 2
    s_add_u32 s74, s74, 0
    v_add_u32 v16, s74, v16
    v_and_b32 v17, 3, v16
    v_bfe_u32 v18, v16, 3, 1
    v_lshl_add_u32 v17, v18, 2, v17
    v_lshlrev_b32 v17, 1, v17
    v_and_b32 v18, 31, v0
    v_xor_b32 v17, v17, v18
    v_lshlrev_b32 v17, 4, v17
    s_mov_b32 s74, 6144
    v_mul_lo_u32 v16, v16, s74
    v_add_u32 v4, v16, v17
    v_lshrrev_b32 v16, 5, v0
    s_lshl_b32 s74, s75, 2
    s_add_u32 s74, s74, 2
    v_add_u32 v16, s74, v16
    v_and_b32 v17, 3, v16
    v_bfe_u32 v18, v16, 3, 1
    v_lshl_add_u32 v17, v18, 2, v17
    v_lshlrev_b32 v17, 1, v17
    v_and_b32 v18, 31, v0
    v_xor_b32 v17, v17, v18
    v_lshlrev_b32 v17, 4, v17
    s_mov_b32 s74, 6144
    v_mul_lo_u32 v16, v16, s74
    v_add_u32 v5, v16, v17
    s_mov_b32 s65, 196608
    s_mov_b32 s87, 0
    s_lshl_b32 s32, s31, 19
    s_add_u32 s80, s4, s32
    s_addc_u32 s81, s5, 0
    s_lshl_b32 s32, s30, 9
    s_add_u32 s82, s6, s32
    s_addc_u32 s83, s7, 0
    s_mov_b32 s66, 7
    s_getpc_b64 s[70:71]
call_39:
    s_add_u32 s70, s70, core_T-call_39
    s_addc_u32 s71, s71, (core_T-call_39)>>32
    s_swappc_b64 s[68:69], s[70:71]
    s_mov_b32 s40, 1069066811
    s_mov_b32 s41, 897988541
    v_mul_f32 v16, s40, v32
    v_mul_f32 v17, s40, v33
    v_mul_f32 v18, s40, v34
    v_mul_f32 v19, s40, v35
    v_mul_f32 v20, s40, v36
    v_mul_f32 v21, s40, v37
    v_mul_f32 v22, s40, v38
    v_mul_f32 v23, s40, v39
    v_min_f32 v16, 0, v16
    v_min_f32 v17, 0, v17
    v_min_f32 v18, 0, v18
    v_min_f32 v19, 0, v19
    v_min_f32 v20, 0, v20
    v_min_f32 v21, 0, v21
    v_min_f32 v22, 0, v22
    v_min_f32 v23, 0, v23
    v_exp_f32 v16, v16
    v_exp_f32 v17, v17
    v_exp_f32 v18, v18
    v_exp_f32 v19, v19
    v_exp_f32 v20, v20
    v_exp_f32 v21, v21
    v_exp_f32 v22, v22
    v_exp_f32 v23, v23
    v_max_f32 v32, 0, v32
    v_max_f32 v33, 0, v33
    v_max_f32 v34, 0, v34
    v_max_f32 v35, 0, v35
    v_max_f32 v36, 0, v36
    v_max_f32 v37, 0, v37
    v_max_f32 v38, 0, v38
    v_max_f32 v39, 0, v39
    v_add_f32 v32, v32, v16
    v_add_f32 v33, v33, v17
    v_add_f32 v34, v34, v18
    v_add_f32 v35, v35, v19
    v_add_f32 v36, v36, v20
    v_add_f32 v37, v37, v21
    v_add_f32 v38, v38, v22
    v_add_f32 v39, v39, v23
    v_add_f32 v32, s41, v32
    v_add_f32 v33, s41, v33
    v_add_f32 v34, s41, v34
    v_add_f32 v35, s41, v35
    v_add_f32 v36, s41, v36
    v_add_f32 v37, s41, v37
    v_add_f32 v38, s41, v38
    v_add_f32 v39, s41, v39
    v_mul_f32 v16, s40, v40
    v_mul_f32 v17, s40, v41
    v_mul_f32 v18, s40, v42
    v_mul_f32 v19, s40, v43
    v_mul_f32 v20, s40, v44
    v_mul_f32 v21, s40, v45
    v_mul_f32 v22, s40, v46
    v_mul_f32 v23, s40, v47
    v_min_f32 v16, 0, v16
    v_min_f32 v17, 0, v17
    v_min_f32 v18, 0, v18
    v_min_f32 v19, 0, v19
    v_min_f32 v20, 0, v20
    v_min_f32 v21, 0, v21
    v_min_f32 v22, 0, v22
    v_min_f32 v23, 0, v23
    v_exp_f32 v16, v16
    v_exp_f32 v17, v17
    v_exp_f32 v18, v18
    v_exp_f32 v19, v19
    v_exp_f32 v20, v20
    v_exp_f32 v21, v21
    v_exp_f32 v22, v22
    v_exp_f32 v23, v23
    v_max_f32 v40, 0, v40
    v_max_f32 v41, 0, v41
    v_max_f32 v42, 0, v42
    v_max_f32 v43, 0, v43
    v_max_f32 v44, 0, v44
    v_max_f32 v45, 0, v45
    v_max_f32 v46, 0, v46
    v_max_f32 v47, 0, v47
    v_add_f32 v40, v40, v16
    v_add_f32 v41, v41, v17
    v_add_f32 v42, v42, v18
    v_add_f32 v43, v43, v19
    v_add_f32 v44, v44, v20
    v_add_f32 v45, v45, v21
    v_add_f32 v46, v46, v22
    v_add_f32 v47, v47, v23
    v_add_f32 v40, s41, v40
    v_add_f32 v41, s41, v41
    v_add_f32 v42, s41, v42
    v_add_f32 v43, s41, v43
    v_add_f32 v44, s41, v44
    v_add_f32 v45, s41, v45
    v_add_f32 v46, s41, v46
    v_add_f32 v47, s41, v47
    v_mul_f32 v16, s40, v48
    v_mul_f32 v17, s40, v49
    v_mul_f32 v18, s40, v50
    v_mul_f32 v19, s40, v51
    v_mul_f32 v20, s40, v52
    v_mul_f32 v21, s40, v53
    v_mul_f32 v22, s40, v54
    v_mul_f32 v23, s40, v55
    v_min_f32 v16, 0, v16
    v_min_f32 v17, 0, v17
    v_min_f32 v18, 0, v18
    v_min_f32 v19, 0, v19
    v_min_f32 v20, 0, v20
    v_min_f32 v21, 0, v21
    v_min_f32 v22, 0, v22
    v_min_f32 v23, 0, v23
    v_exp_f32 v16, v16
    v_exp_f32 v17, v17
    v_exp_f32 v18, v18
    v_exp_f32 v19, v19
    v_exp_f32 v20, v20
    v_exp_f32 v21, v21
    v_exp_f32 v22, v22
    v_exp_f32 v23, v23
    v_max_f32 v48, 0, v48
    v_max_f32 v49, 0, v49
    v_max_f32 v50, 0, v50
    v_max_f32 v51, 0, v51
    v_max_f32 v52, 0, v52
    v_max_f32 v53, 0, v53
    v_max_f32 v54, 0, v54
    v_max_f32 v55, 0, v55
    v_add_f32 v48, v48, v16
    v_add_f32 v49, v49, v17
    v_add_f32 v50, v50, v18
    v_add_f32 v51, v51, v19
    v_add_f32 v52, v52, v20
    v_add_f32 v53, v53, v21
    v_add_f32 v54, v54, v22
    v_add_f32 v55, v55, v23
    v_add_f32 v48, s41, v48
    v_add_f32 v49, s41, v49
    v_add_f32 v50, s41, v50
    v_add_f32 v51, s41, v51
    v_add_f32 v52, s41, v52
    v_add_f32 v53, s41, v53
    v_add_f32 v54, s41, v54
    v_add_f32 v55, s41, v55
    v_mul_f32 v16, s40, v56
    v_mul_f32 v17, s40, v57
    v_mul_f32 v18, s40, v58
    v_mul_f32 v19, s40, v59
    v_mul_f32 v20, s40, v60
    v_mul_f32 v21, s40, v61
    v_mul_f32 v22, s40, v62
    v_mul_f32 v23, s40, v63
    v_min_f32 v16, 0, v16
    v_min_f32 v17, 0, v17
    v_min_f32 v18, 0, v18
    v_min_f32 v19, 0, v19
    v_min_f32 v20, 0, v20
    v_min_f32 v21, 0, v21
    v_min_f32 v22, 0, v22
    v_min_f32 v23, 0, v23
    v_exp_f32 v16, v16
    v_exp_f32 v17, v17
    v_exp_f32 v18, v18
    v_exp_f32 v19, v19
    v_exp_f32 v20, v20
    v_exp_f32 v21, v21
    v_exp_f32 v22, v22
    v_exp_f32 v23, v23
    v_max_f32 v56, 0, v56
    v_max_f32 v57, 0, v57
    v_max_f32 v58, 0, v58
    v_max_f32 v59, 0, v59
    v_max_f32 v60, 0, v60
    v_max_f32 v61, 0, v61
    v_max_f32 v62, 0, v62
    v_max_f32 v63, 0, v63
    v_add_f32 v56, v56, v16
    v_add_f32 v57, v57, v17
    v_add_f32 v58, v58, v18
    v_add_f32 v59, v59, v19
    v_add_f32 v60, v60, v20
    v_add_f32 v61, v61, v21
    v_add_f32 v62, v62, v22
    v_add_f32 v63, v63, v23
    v_add_f32 v56, s41, v56
    v_add_f32 v57, s41, v57
    v_add_f32 v58, s41, v58
    v_add_f32 v59, s41, v59
    v_add_f32 v60, s41, v60
    v_add_f32 v61, s41, v61
    v_add_f32 v62, s41, v62
    v_add_f32 v63, s41, v63
    v_mul_f32 v16, s40, v64
    v_mul_f32 v17, s40, v65
    v_mul_f32 v18, s40, v66
    v_mul_f32 v19, s40, v67
    v_mul_f32 v20, s40, v68
    v_mul_f32 v21, s40, v69
    v_mul_f32 v22, s40, v70
    v_mul_f32 v23, s40, v71
    v_min_f32 v16, 0, v16
    v_min_f32 v17, 0, v17
    v_min_f32 v18, 0, v18
    v_min_f32 v19, 0, v19
    v_min_f32 v20, 0, v20
    v_min_f32 v21, 0, v21
    v_min_f32 v22, 0, v22
    v_min_f32 v23, 0, v23
    v_exp_f32 v16, v16
    v_exp_f32 v17, v17
    v_exp_f32 v18, v18
    v_exp_f32 v19, v19
    v_exp_f32 v20, v20
    v_exp_f32 v21, v21
    v_exp_f32 v22, v22
    v_exp_f32 v23, v23
    v_max_f32 v64, 0, v64
    v_max_f32 v65, 0, v65
    v_max_f32 v66, 0, v66
    v_max_f32 v67, 0, v67
    v_max_f32 v68, 0, v68
    v_max_f32 v69, 0, v69
    v_max_f32 v70, 0, v70
    v_max_f32 v71, 0, v71
    v_add_f32 v64, v64, v16
    v_add_f32 v65, v65, v17
    v_add_f32 v66, v66, v18
    v_add_f32 v67, v67, v19
    v_add_f32 v68, v68, v20
    v_add_f32 v69, v69, v21
    v_add_f32 v70, v70, v22
    v_add_f32 v71, v71, v23
    v_add_f32 v64, s41, v64
    v_add_f32 v65, s41, v65
    v_add_f32 v66, s41, v66
    v_add_f32 v67, s41, v67
    v_add_f32 v68, s41, v68
    v_add_f32 v69, s41, v69
    v_add_f32 v70, s41, v70
    v_add_f32 v71, s41, v71
    v_mul_f32 v16, s40, v72
    v_mul_f32 v17, s40, v73
    v_mul_f32 v18, s40, v74
    v_mul_f32 v19, s40, v75
    v_mul_f32 v20, s40, v76
    v_mul_f32 v21, s40, v77
    v_mul_f32 v22, s40, v78
    v_mul_f32 v23, s40, v79
    v_min_f32 v16, 0, v16
    v_min_f32 v17, 0, v17
    v_min_f32 v18, 0, v18
    v_min_f32 v19, 0, v19
    v_min_f32 v20, 0, v20
    v_min_f32 v21, 0, v21
    v_min_f32 v22, 0, v22
    v_min_f32 v23, 0, v23
    v_exp_f32 v16, v16
    v_exp_f32 v17, v17
    v_exp_f32 v18, v18
    v_exp_f32 v19, v19
    v_exp_f32 v20, v20
    v_exp_f32 v21, v21
    v_exp_f32 v22, v22
    v_exp_f32 v23, v23
    v_max_f32 v72, 0, v72
    v_max_f32 v73, 0, v73
    v_max_f32 v74, 0, v74
    v_max_f32 v75, 0, v75
    v_max_f32 v76, 0, v76
    v_max_f32 v77, 0, v77
    v_max_f32 v78, 0, v78
    v_max_f32 v79, 0, v79
    v_add_f32 v72, v72, v16
    v_add_f32 v73, v73, v17
    v_add_f32 v74, v74, v18
    v_add_f32 v75, v75, v19
    v_add_f32 v76, v76, v20
    v_add_f32 v77, v77, v21
    v_add_f32 v78, v78, v22
    v_add_f32 v79, v79, v23
    v_add_f32 v72, s41, v72
    v_add_f32 v73, s41, v73
    v_add_f32 v74, s41, v74
    v_add_f32 v75, s41, v75
    v_add_f32 v76, s41, v76
    v_add_f32 v77, s41, v77
    v_add_f32 v78, s41, v78
    v_add_f32 v79, s41, v79
    v_mul_f32 v16, s40, v80
    v_mul_f32 v17, s40, v81
    v_mul_f32 v18, s40, v82
    v_mul_f32 v19, s40, v83
    v_mul_f32 v20, s40, v84
    v_mul_f32 v21, s40, v85
    v_mul_f32 v22, s40, v86
    v_mul_f32 v23, s40, v87
    v_min_f32 v16, 0, v16
    v_min_f32 v17, 0, v17
    v_min_f32 v18, 0, v18
    v_min_f32 v19, 0, v19
    v_min_f32 v20, 0, v20
    v_min_f32 v21, 0, v21
    v_min_f32 v22, 0, v22
    v_min_f32 v23, 0, v23
    v_exp_f32 v16, v16
    v_exp_f32 v17, v17
    v_exp_f32 v18, v18
    v_exp_f32 v19, v19
    v_exp_f32 v20, v20
    v_exp_f32 v21, v21
    v_exp_f32 v22, v22
    v_exp_f32 v23, v23
    v_max_f32 v80, 0, v80
    v_max_f32 v81, 0, v81
    v_max_f32 v82, 0, v82
    v_max_f32 v83, 0, v83
    v_max_f32 v84, 0, v84
    v_max_f32 v85, 0, v85
    v_max_f32 v86, 0, v86
    v_max_f32 v87, 0, v87
    v_add_f32 v80, v80, v16
    v_add_f32 v81, v81, v17
    v_add_f32 v82, v82, v18
    v_add_f32 v83, v83, v19
    v_add_f32 v84, v84, v20
    v_add_f32 v85, v85, v21
    v_add_f32 v86, v86, v22
    v_add_f32 v87, v87, v23
    v_add_f32 v80, s41, v80
    v_add_f32 v81, s41, v81
    v_add_f32 v82, s41, v82
    v_add_f32 v83, s41, v83
    v_add_f32 v84, s41, v84
    v_add_f32 v85, s41, v85
    v_add_f32 v86, s41, v86
    v_add_f32 v87, s41, v87
    v_mul_f32 v16, s40, v88
    v_mul_f32 v17, s40, v89
    v_mul_f32 v18, s40, v90
    v_mul_f32 v19, s40, v91
    v_mul_f32 v20, s40, v92
    v_mul_f32 v21, s40, v93
    v_mul_f32 v22, s40, v94
    v_mul_f32 v23, s40, v95
    v_min_f32 v16, 0, v16
    v_min_f32 v17, 0, v17
    v_min_f32 v18, 0, v18
    v_min_f32 v19, 0, v19
    v_min_f32 v20, 0, v20
    v_min_f32 v21, 0, v21
    v_min_f32 v22, 0, v22
    v_min_f32 v23, 0, v23
    v_exp_f32 v16, v16
    v_exp_f32 v17, v17
    v_exp_f32 v18, v18
    v_exp_f32 v19, v19
    v_exp_f32 v20, v20
    v_exp_f32 v21, v21
    v_exp_f32 v22, v22
    v_exp_f32 v23, v23
    v_max_f32 v88, 0, v88
    v_max_f32 v89, 0, v89
    v_max_f32 v90, 0, v90
    v_max_f32 v91, 0, v91
    v_max_f32 v92, 0, v92
    v_max_f32 v93, 0, v93
    v_max_f32 v94, 0, v94
    v_max_f32 v95, 0, v95
    v_add_f32 v88, v88, v16
    v_add_f32 v89, v89, v17
    v_add_f32 v90, v90, v18
    v_add_f32 v91, v91, v19
    v_add_f32 v92, v92, v20
    v_add_f32 v93, v93, v21
    v_add_f32 v94, v94, v22
    v_add_f32 v95, v95, v23
    v_add_f32 v88, s41, v88
    v_add_f32 v89, s41, v89
    v_add_f32 v90, s41, v90
    v_add_f32 v91, s41, v91
    v_add_f32 v92, s41, v92
    v_add_f32 v93, s41, v93
    v_add_f32 v94, s41, v94
    v_add_f32 v95, s41, v95
    v_mul_f32 v16, s40, v96
    v_mul_f32 v17, s40, v97
    v_mul_f32 v18, s40, v98
    v_mul_f32 v19, s40, v99
    v_mul_f32 v20, s40, v100
    v_mul_f32 v21, s40, v101
    v_mul_f32 v22, s40, v102
    v_mul_f32 v23, s40, v103
    v_min_f32 v16, 0, v16
    v_min_f32 v17, 0, v17
    v_min_f32 v18, 0, v18
    v_min_f32 v19, 0, v19
    v_min_f32 v20, 0, v20
    v_min_f32 v21, 0, v21
    v_min_f32 v22, 0, v22
    v_min_f32 v23, 0, v23
    v_exp_f32 v16, v16
    v_exp_f32 v17, v17
    v_exp_f32 v18, v18
    v_exp_f32 v19, v19
    v_exp_f32 v20, v20
    v_exp_f32 v21, v21
    v_exp_f32 v22, v22
    v_exp_f32 v23, v23
    v_max_f32 v96, 0, v96
    v_max_f32 v97, 0, v97
    v_max_f32 v98, 0, v98
    v_max_f32 v99, 0, v99
    v_max_f32 v100, 0, v100
    v_max_f32 v101, 0, v101
    v_max_f32 v102, 0, v102
    v_max_f32 v103, 0, v103
    v_add_f32 v96, v96, v16
    v_add_f32 v97, v97, v17
    v_add_f32 v98, v98, v18
    v_add_f32 v99, v99, v19
    v_add_f32 v100, v100, v20
    v_add_f32 v101, v101, v21
    v_add_f32 v102, v102, v22
    v_add_f32 v103, v103, v23
    v_add_f32 v96, s41, v96
    v_add_f32 v97, s41, v97
    v_add_f32 v98, s41, v98
    v_add_f32 v99, s41, v99
    v_add_f32 v100, s41, v100
    v_add_f32 v101, s41, v101
    v_add_f32 v102, s41, v102
    v_add_f32 v103, s41, v103
    v_mul_f32 v16, s40, v104
    v_mul_f32 v17, s40, v105
    v_mul_f32 v18, s40, v106
    v_mul_f32 v19, s40, v107
    v_mul_f32 v20, s40, v108
    v_mul_f32 v21, s40, v109
    v_mul_f32 v22, s40, v110
    v_mul_f32 v23, s40, v111
    v_min_f32 v16, 0, v16
    v_min_f32 v17, 0, v17
    v_min_f32 v18, 0, v18
    v_min_f32 v19, 0, v19
    v_min_f32 v20, 0, v20
    v_min_f32 v21, 0, v21
    v_min_f32 v22, 0, v22
    v_min_f32 v23, 0, v23
    v_exp_f32 v16, v16
    v_exp_f32 v17, v17
    v_exp_f32 v18, v18
    v_exp_f32 v19, v19
    v_exp_f32 v20, v20
    v_exp_f32 v21, v21
    v_exp_f32 v22, v22
    v_exp_f32 v23, v23
    v_max_f32 v104, 0, v104
    v_max_f32 v105, 0, v105
    v_max_f32 v106, 0, v106
    v_max_f32 v107, 0, v107
    v_max_f32 v108, 0, v108
    v_max_f32 v109, 0, v109
    v_max_f32 v110, 0, v110
    v_max_f32 v111, 0, v111
    v_add_f32 v104, v104, v16
    v_add_f32 v105, v105, v17
    v_add_f32 v106, v106, v18
    v_add_f32 v107, v107, v19
    v_add_f32 v108, v108, v20
    v_add_f32 v109, v109, v21
    v_add_f32 v110, v110, v22
    v_add_f32 v111, v111, v23
    v_add_f32 v104, s41, v104
    v_add_f32 v105, s41, v105
    v_add_f32 v106, s41, v106
    v_add_f32 v107, s41, v107
    v_add_f32 v108, s41, v108
    v_add_f32 v109, s41, v109
    v_add_f32 v110, s41, v110
    v_add_f32 v111, s41, v111
    v_mul_f32 v16, s40, v112
    v_mul_f32 v17, s40, v113
    v_mul_f32 v18, s40, v114
    v_mul_f32 v19, s40, v115
    v_mul_f32 v20, s40, v116
    v_mul_f32 v21, s40, v117
    v_mul_f32 v22, s40, v118
    v_mul_f32 v23, s40, v119
    v_min_f32 v16, 0, v16
    v_min_f32 v17, 0, v17
    v_min_f32 v18, 0, v18
    v_min_f32 v19, 0, v19
    v_min_f32 v20, 0, v20
    v_min_f32 v21, 0, v21
    v_min_f32 v22, 0, v22
    v_min_f32 v23, 0, v23
    v_exp_f32 v16, v16
    v_exp_f32 v17, v17
    v_exp_f32 v18, v18
    v_exp_f32 v19, v19
    v_exp_f32 v20, v20
    v_exp_f32 v21, v21
    v_exp_f32 v22, v22
    v_exp_f32 v23, v23
    v_max_f32 v112, 0, v112
    v_max_f32 v113, 0, v113
    v_max_f32 v114, 0, v114
    v_max_f32 v115, 0, v115
    v_max_f32 v116, 0, v116
    v_max_f32 v117, 0, v117
    v_max_f32 v118, 0, v118
    v_max_f32 v119, 0, v119
    v_add_f32 v112, v112, v16
    v_add_f32 v113, v113, v17
    v_add_f32 v114, v114, v18
    v_add_f32 v115, v115, v19
    v_add_f32 v116, v116, v20
    v_add_f32 v117, v117, v21
    v_add_f32 v118, v118, v22
    v_add_f32 v119, v119, v23
    v_add_f32 v112, s41, v112
    v_add_f32 v113, s41, v113
    v_add_f32 v114, s41, v114
    v_add_f32 v115, s41, v115
    v_add_f32 v116, s41, v116
    v_add_f32 v117, s41, v117
    v_add_f32 v118, s41, v118
    v_add_f32 v119, s41, v119
    v_mul_f32 v16, s40, v120
    v_mul_f32 v17, s40, v121
    v_mul_f32 v18, s40, v122
    v_mul_f32 v19, s40, v123
    v_mul_f32 v20, s40, v124
    v_mul_f32 v21, s40, v125
    v_mul_f32 v22, s40, v126
    v_mul_f32 v23, s40, v127
    v_min_f32 v16, 0, v16
    v_min_f32 v17, 0, v17
    v_min_f32 v18, 0, v18
    v_min_f32 v19, 0, v19
    v_min_f32 v20, 0, v20
    v_min_f32 v21, 0, v21
    v_min_f32 v22, 0, v22
    v_min_f32 v23, 0, v23
    v_exp_f32 v16, v16
    v_exp_f32 v17, v17
    v_exp_f32 v18, v18
    v_exp_f32 v19, v19
    v_exp_f32 v20, v20
    v_exp_f32 v21, v21
    v_exp_f32 v22, v22
    v_exp_f32 v23, v23
    v_max_f32 v120, 0, v120
    v_max_f32 v121, 0, v121
    v_max_f32 v122, 0, v122
    v_max_f32 v123, 0, v123
    v_max_f32 v124, 0, v124
    v_max_f32 v125, 0, v125
    v_max_f32 v126, 0, v126
    v_max_f32 v127, 0, v127
    v_add_f32 v120, v120, v16
    v_add_f32 v121, v121, v17
    v_add_f32 v122, v122, v18
    v_add_f32 v123, v123, v19
    v_add_f32 v124, v124, v20
    v_add_f32 v125, v125, v21
    v_add_f32 v126, v126, v22
    v_add_f32 v127, v127, v23
    v_add_f32 v120, s41, v120
    v_add_f32 v121, s41, v121
    v_add_f32 v122, s41, v122
    v_add_f32 v123, s41, v123
    v_add_f32 v124, s41, v124
    v_add_f32 v125, s41, v125
    v_add_f32 v126, s41, v126
    v_add_f32 v127, s41, v127
    v_mul_f32 v16, s40, v128
    v_mul_f32 v17, s40, v129
    v_mul_f32 v18, s40, v130
    v_mul_f32 v19, s40, v131
    v_mul_f32 v20, s40, v132
    v_mul_f32 v21, s40, v133
    v_mul_f32 v22, s40, v134
    v_mul_f32 v23, s40, v135
    v_min_f32 v16, 0, v16
    v_min_f32 v17, 0, v17
    v_min_f32 v18, 0, v18
    v_min_f32 v19, 0, v19
    v_min_f32 v20, 0, v20
    v_min_f32 v21, 0, v21
    v_min_f32 v22, 0, v22
    v_min_f32 v23, 0, v23
    v_exp_f32 v16, v16
    v_exp_f32 v17, v17
    v_exp_f32 v18, v18
    v_exp_f32 v19, v19
    v_exp_f32 v20, v20
    v_exp_f32 v21, v21
    v_exp_f32 v22, v22
    v_exp_f32 v23, v23
    v_max_f32 v128, 0, v128
    v_max_f32 v129, 0, v129
    v_max_f32 v130, 0, v130
    v_max_f32 v131, 0, v131
    v_max_f32 v132, 0, v132
    v_max_f32 v133, 0, v133
    v_max_f32 v134, 0, v134
    v_max_f32 v135, 0, v135
    v_add_f32 v128, v128, v16
    v_add_f32 v129, v129, v17
    v_add_f32 v130, v130, v18
    v_add_f32 v131, v131, v19
    v_add_f32 v132, v132, v20
    v_add_f32 v133, v133, v21
    v_add_f32 v134, v134, v22
    v_add_f32 v135, v135, v23
    v_add_f32 v128, s41, v128
    v_add_f32 v129, s41, v129
    v_add_f32 v130, s41, v130
    v_add_f32 v131, s41, v131
    v_add_f32 v132, s41, v132
    v_add_f32 v133, s41, v133
    v_add_f32 v134, s41, v134
    v_add_f32 v135, s41, v135
    v_mul_f32 v16, s40, v136
    v_mul_f32 v17, s40, v137
    v_mul_f32 v18, s40, v138
    v_mul_f32 v19, s40, v139
    v_mul_f32 v20, s40, v140
    v_mul_f32 v21, s40, v141
    v_mul_f32 v22, s40, v142
    v_mul_f32 v23, s40, v143
    v_min_f32 v16, 0, v16
    v_min_f32 v17, 0, v17
    v_min_f32 v18, 0, v18
    v_min_f32 v19, 0, v19
    v_min_f32 v20, 0, v20
    v_min_f32 v21, 0, v21
    v_min_f32 v22, 0, v22
    v_min_f32 v23, 0, v23
    v_exp_f32 v16, v16
    v_exp_f32 v17, v17
    v_exp_f32 v18, v18
    v_exp_f32 v19, v19
    v_exp_f32 v20, v20
    v_exp_f32 v21, v21
    v_exp_f32 v22, v22
    v_exp_f32 v23, v23
    v_max_f32 v136, 0, v136
    v_max_f32 v137, 0, v137
    v_max_f32 v138, 0, v138
    v_max_f32 v139, 0, v139
    v_max_f32 v140, 0, v140
    v_max_f32 v141, 0, v141
    v_max_f32 v142, 0, v142
    v_max_f32 v143, 0, v143
    v_add_f32 v136, v136, v16
    v_add_f32 v137, v137, v17
    v_add_f32 v138, v138, v18
    v_add_f32 v139, v139, v19
    v_add_f32 v140, v140, v20
    v_add_f32 v141, v141, v21
    v_add_f32 v142, v142, v22
    v_add_f32 v143, v143, v23
    v_add_f32 v136, s41, v136
    v_add_f32 v137, s41, v137
    v_add_f32 v138, s41, v138
    v_add_f32 v139, s41, v139
    v_add_f32 v140, s41, v140
    v_add_f32 v141, s41, v141
    v_add_f32 v142, s41, v142
    v_add_f32 v143, s41, v143
    v_mul_f32 v16, s40, v144
    v_mul_f32 v17, s40, v145
    v_mul_f32 v18, s40, v146
    v_mul_f32 v19, s40, v147
    v_mul_f32 v20, s40, v148
    v_mul_f32 v21, s40, v149
    v_mul_f32 v22, s40, v150
    v_mul_f32 v23, s40, v151
    v_min_f32 v16, 0, v16
    v_min_f32 v17, 0, v17
    v_min_f32 v18, 0, v18
    v_min_f32 v19, 0, v19
    v_min_f32 v20, 0, v20
    v_min_f32 v21, 0, v21
    v_min_f32 v22, 0, v22
    v_min_f32 v23, 0, v23
    v_exp_f32 v16, v16
    v_exp_f32 v17, v17
    v_exp_f32 v18, v18
    v_exp_f32 v19, v19
    v_exp_f32 v20, v20
    v_exp_f32 v21, v21
    v_exp_f32 v22, v22
    v_exp_f32 v23, v23
    v_max_f32 v144, 0, v144
    v_max_f32 v145, 0, v145
    v_max_f32 v146, 0, v146
    v_max_f32 v147, 0, v147
    v_max_f32 v148, 0, v148
    v_max_f32 v149, 0, v149
    v_max_f32 v150, 0, v150
    v_max_f32 v151, 0, v151
    v_add_f32 v144, v144, v16
    v_add_f32 v145, v145, v17
    v_add_f32 v146, v146, v18
    v_add_f32 v147, v147, v19
    v_add_f32 v148, v148, v20
    v_add_f32 v149, v149, v21
    v_add_f32 v150, v150, v22
    v_add_f32 v151, v151, v23
    v_add_f32 v144, s41, v144
    v_add_f32 v145, s41, v145
    v_add_f32 v146, s41, v146
    v_add_f32 v147, s41, v147
    v_add_f32 v148, s41, v148
    v_add_f32 v149, s41, v149
    v_add_f32 v150, s41, v150
    v_add_f32 v151, s41, v151
    v_mul_f32 v16, s40, v152
    v_mul_f32 v17, s40, v153
    v_mul_f32 v18, s40, v154
    v_mul_f32 v19, s40, v155
    v_mul_f32 v20, s40, v156
    v_mul_f32 v21, s40, v157
    v_mul_f32 v22, s40, v158
    v_mul_f32 v23, s40, v159
    v_min_f32 v16, 0, v16
    v_min_f32 v17, 0, v17
    v_min_f32 v18, 0, v18
    v_min_f32 v19, 0, v19
    v_min_f32 v20, 0, v20
    v_min_f32 v21, 0, v21
    v_min_f32 v22, 0, v22
    v_min_f32 v23, 0, v23
    v_exp_f32 v16, v16
    v_exp_f32 v17, v17
    v_exp_f32 v18, v18
    v_exp_f32 v19, v19
    v_exp_f32 v20, v20
    v_exp_f32 v21, v21
    v_exp_f32 v22, v22
    v_exp_f32 v23, v23
    v_max_f32 v152, 0, v152
    v_max_f32 v153, 0, v153
    v_max_f32 v154, 0, v154
    v_max_f32 v155, 0, v155
    v_max_f32 v156, 0, v156
    v_max_f32 v157, 0, v157
    v_max_f32 v158, 0, v158
    v_max_f32 v159, 0, v159
    v_add_f32 v152, v152, v16
    v_add_f32 v153, v153, v17
    v_add_f32 v154, v154, v18
    v_add_f32 v155, v155, v19
    v_add_f32 v156, v156, v20
    v_add_f32 v157, v157, v21
    v_add_f32 v158, v158, v22
    v_add_f32 v159, v159, v23
    v_add_f32 v152, s41, v152
    v_add_f32 v153, s41, v153
    v_add_f32 v154, s41, v154
    v_add_f32 v155, s41, v155
    v_add_f32 v156, s41, v156
    v_add_f32 v157, s41, v157
    v_add_f32 v158, s41, v158
    v_add_f32 v159, s41, v159
    v_cvt_pk_bf16_f32 v32, v32, v33
    v_cvt_pk_bf16_f32 v33, v34, v35
    v_cvt_pk_bf16_f32 v34, v36, v37
    v_cvt_pk_bf16_f32 v35, v38, v39
    v_cvt_pk_bf16_f32 v36, v40, v41
    v_cvt_pk_bf16_f32 v37, v42, v43
    v_cvt_pk_bf16_f32 v38, v44, v45
    v_cvt_pk_bf16_f32 v39, v46, v47
    v_cvt_pk_bf16_f32 v40, v48, v49
    v_cvt_pk_bf16_f32 v41, v50, v51
    v_cvt_pk_bf16_f32 v42, v52, v53
    v_cvt_pk_bf16_f32 v43, v54, v55
    v_cvt_pk_bf16_f32 v44, v56, v57
    v_cvt_pk_bf16_f32 v45, v58, v59
    v_cvt_pk_bf16_f32 v46, v60, v61
    v_cvt_pk_bf16_f32 v47, v62, v63
    v_cvt_pk_bf16_f32 v48, v64, v65
    v_cvt_pk_bf16_f32 v49, v66, v67
    v_cvt_pk_bf16_f32 v50, v68, v69
    v_cvt_pk_bf16_f32 v51, v70, v71
    v_cvt_pk_bf16_f32 v52, v72, v73
    v_cvt_pk_bf16_f32 v53, v74, v75
    v_cvt_pk_bf16_f32 v54, v76, v77
    v_cvt_pk_bf16_f32 v55, v78, v79
    v_cvt_pk_bf16_f32 v56, v80, v81
    v_cvt_pk_bf16_f32 v57, v82, v83
    v_cvt_pk_bf16_f32 v58, v84, v85
    v_cvt_pk_bf16_f32 v59, v86, v87
    v_cvt_pk_bf16_f32 v60, v88, v89
    v_cvt_pk_bf16_f32 v61, v90, v91
    v_cvt_pk_bf16_f32 v62, v92, v93
    v_cvt_pk_bf16_f32 v63, v94, v95
    v_cvt_pk_bf16_f32 v64, v96, v97
    v_cvt_pk_bf16_f32 v65, v98, v99
    v_cvt_pk_bf16_f32 v66, v100, v101
    v_cvt_pk_bf16_f32 v67, v102, v103
    v_cvt_pk_bf16_f32 v68, v104, v105
    v_cvt_pk_bf16_f32 v69, v106, v107
    v_cvt_pk_bf16_f32 v70, v108, v109
    v_cvt_pk_bf16_f32 v71, v110, v111
    v_cvt_pk_bf16_f32 v72, v112, v113
    v_cvt_pk_bf16_f32 v73, v114, v115
    v_cvt_pk_bf16_f32 v74, v116, v117
    v_cvt_pk_bf16_f32 v75, v118, v119
    v_cvt_pk_bf16_f32 v76, v120, v121
    v_cvt_pk_bf16_f32 v77, v122, v123
    v_cvt_pk_bf16_f32 v78, v124, v125
    v_cvt_pk_bf16_f32 v79, v126, v127
    v_cvt_pk_bf16_f32 v80, v128, v129
    v_cvt_pk_bf16_f32 v81, v130, v131
    v_cvt_pk_bf16_f32 v82, v132, v133
    v_cvt_pk_bf16_f32 v83, v134, v135
    v_cvt_pk_bf16_f32 v84, v136, v137
    v_cvt_pk_bf16_f32 v85, v138, v139
    v_cvt_pk_bf16_f32 v86, v140, v141
    v_cvt_pk_bf16_f32 v87, v142, v143
    v_cvt_pk_bf16_f32 v88, v144, v145
    v_cvt_pk_bf16_f32 v89, v146, v147
    v_cvt_pk_bf16_f32 v90, v148, v149
    v_cvt_pk_bf16_f32 v91, v150, v151
    v_cvt_pk_bf16_f32 v92, v152, v153
    v_cvt_pk_bf16_f32 v93, v154, v155
    v_cvt_pk_bf16_f32 v94, v156, v157
    v_cvt_pk_bf16_f32 v95, v158, v159
    s_cmp_lg_u32 s75, 0
    s_cbranch_scc1 wd_42
    v_mov_b32 v16, 36
wl_40:
    global_load_dword v17, v16, s[26:27] sc1
    s_waitcnt vmcnt(0)
    v_cmp_ne_u32 vcc, 64, v17
    s_cbranch_vccz wo_41
    s_sleep 8
    s_add_u32 s46, s46, 1
    s_cmp_lt_u32 s46, 400000
    s_cbranch_scc1 wl_40
    s_branch w_fail
wo_41:
wd_42:
    s_barrier
    v_lshlrev_b32 v16, 4, v0
    v_add_u32 v17, 196608, v16
    v_add_u32 v18, 393216, v16
    v_add_u32 v19, 589824, v16
    v_add_u32 v20, 786432, v16
    v_add_u32 v21, 983040, v16
    v_add_u32 v22, 1179648, v16
    v_add_u32 v23, 1376256, v16
    s_lshl_b32 s32, s30, 3
    s_add_u32 s32, s32, s75
    s_mul_i32 s32, s32, 6144
    s_add_u32 s32, s32, 130023424
    s_add_u32 s34, s28, s32
    s_addc_u32 s35, s29, 0
    s_mul_i32 s32, s75, 3072
    v_add_u32 v24, s32, v16
    global_load_dwordx4 v[96:99], v16, s[34:35] offset:0 sc1
    global_load_dwordx4 v[100:103], v16, s[34:35] offset:1024 sc1
    global_load_dwordx4 v[104:107], v17, s[34:35] offset:0 sc1
    global_load_dwordx4 v[108:111], v17, s[34:35] offset:1024 sc1
    global_load_dwordx4 v[112:115], v18, s[34:35] offset:0 sc1
    global_load_dwordx4 v[116:119], v18, s[34:35] offset:1024 sc1
    global_load_dwordx4 v[120:123], v19, s[34:35] offset:0 sc1
    global_load_dwordx4 v[124:127], v19, s[34:35] offset:1024 sc1
    global_load_dwordx4 v[128:131], v20, s[34:35] offset:0 sc1
    global_load_dwordx4 v[132:135], v20, s[34:35] offset:1024 sc1
    global_load_dwordx4 v[136:139], v21, s[34:35] offset:0 sc1
    global_load_dwordx4 v[140:143], v21, s[34:35] offset:1024 sc1
    global_load_dwordx4 v[144:147], v22, s[34:35] offset:0 sc1
    global_load_dwordx4 v[148:151], v22, s[34:35] offset:1024 sc1
    global_load_dwordx4 v[152:155], v23, s[34:35] offset:0 sc1
    global_load_dwordx4 v[156:159], v23, s[34:35] offset:1024 sc1
    s_add_u32 s34, s34, 2048
    s_addc_u32 s35, s35, 0
    s_waitcnt vmcnt(0)
    v_pk_add_f32 v[96:97], v[96:97], v[128:129]
    v_pk_add_f32 v[98:99], v[98:99], v[130:131]
    v_pk_add_f32 v[100:101], v[100:101], v[132:133]
    v_pk_add_f32 v[102:103], v[102:103], v[134:135]
    v_pk_add_f32 v[104:105], v[104:105], v[136:137]
    v_pk_add_f32 v[106:107], v[106:107], v[138:139]
    v_pk_add_f32 v[108:109], v[108:109], v[140:141]
    v_pk_add_f32 v[110:111], v[110:111], v[142:143]
    v_pk_add_f32 v[112:113], v[112:113], v[144:145]
    v_pk_add_f32 v[114:115], v[114:115], v[146:147]
    v_pk_add_f32 v[116:117], v[116:117], v[148:149]
    v_pk_add_f32 v[118:119], v[118:119], v[150:151]
    v_pk_add_f32 v[120:121], v[120:121], v[152:153]
    v_pk_add_f32 v[122:123], v[122:123], v[154:155]
    v_pk_add_f32 v[124:125], v[124:125], v[156:157]
    v_pk_add_f32 v[126:127], v[126:127], v[158:159]
    v_pk_add_f32 v[96:97], v[96:97], v[112:113]
    v_pk_add_f32 v[98:99], v[98:99], v[114:115]
    v_pk_add_f32 v[100:101], v[100:101], v[116:117]
    v_pk_add_f32 v[102:103], v[102:103], v[118:119]
    v_pk_add_f32 v[104:105], v[104:105], v[120:121]
    v_pk_add_f32 v[106:107], v[106:107], v[122:123]
    v_pk_add_f32 v[108:109], v[108:109], v[124:125]
    v_pk_add_f32 v[110:111], v[110:111], v[126:127]
    v_pk_add_f32 v[96:97], v[96:97], v[104:105]
    v_pk_add_f32 v[98:99], v[98:99], v[106:107]
    v_pk_add_f32 v[100:101], v[100:101], v[108:109]
    v_pk_add_f32 v[102:103], v[102:103], v[110:111]
    v_cvt_pk_bf16_f32 v28, v96, v97
    v_cvt_pk_bf16_f32 v29, v98, v99
    v_cvt_pk_bf16_f32 v30, v100, v101
    v_cvt_pk_bf16_f32 v31, v102, v103
    ds_write_b128 v24, v[28:31] offset:0
    global_load_dwordx4 v[96:99], v16, s[34:35] offset:0 sc1
    global_load_dwordx4 v[100:103], v16, s[34:35] offset:1024 sc1
    global_load_dwordx4 v[104:107], v17, s[34:35] offset:0 sc1
    global_load_dwordx4 v[108:111], v17, s[34:35] offset:1024 sc1
    global_load_dwordx4 v[112:115], v18, s[34:35] offset:0 sc1
    global_load_dwordx4 v[116:119], v18, s[34:35] offset:1024 sc1
    global_load_dwordx4 v[120:123], v19, s[34:35] offset:0 sc1
    global_load_dwordx4 v[124:127], v19, s[34:35] offset:1024 sc1
    global_load_dwordx4 v[128:131], v20, s[34:35] offset:0 sc1
    global_load_dwordx4 v[132:135], v20, s[34:35] offset:1024 sc1
    global_load_dwordx4 v[136:139], v21, s[34:35] offset:0 sc1
    global_load_dwordx4 v[140:143], v21, s[34:35] offset:1024 sc1
    global_load_dwordx4 v[144:147], v22, s[34:35] offset:0 sc1
    global_load_dwordx4 v[148:151], v22, s[34:35] offset:1024 sc1
    global_load_dwordx4 v[152:155], v23, s[34:35] offset:0 sc1
    global_load_dwordx4 v[156:159], v23, s[34:35] offset:1024 sc1
    s_add_u32 s34, s34, 2048
    s_addc_u32 s35, s35, 0
    s_waitcnt vmcnt(0)
    v_pk_add_f32 v[96:97], v[96:97], v[128:129]
    v_pk_add_f32 v[98:99], v[98:99], v[130:131]
    v_pk_add_f32 v[100:101], v[100:101], v[132:133]
    v_pk_add_f32 v[102:103], v[102:103], v[134:135]
    v_pk_add_f32 v[104:105], v[104:105], v[136:137]
    v_pk_add_f32 v[106:107], v[106:107], v[138:139]
    v_pk_add_f32 v[108:109], v[108:109], v[140:141]
    v_pk_add_f32 v[110:111], v[110:111], v[142:143]
    v_pk_add_f32 v[112:113], v[112:113], v[144:145]
    v_pk_add_f32 v[114:115], v[114:115], v[146:147]
    v_pk_add_f32 v[116:117], v[116:117], v[148:149]
    v_pk_add_f32 v[118:119], v[118:119], v[150:151]
    v_pk_add_f32 v[120:121], v[120:121], v[152:153]
    v_pk_add_f32 v[122:123], v[122:123], v[154:155]
    v_pk_add_f32 v[124:125], v[124:125], v[156:157]
    v_pk_add_f32 v[126:127], v[126:127], v[158:159]
    v_pk_add_f32 v[96:97], v[96:97], v[112:113]
    v_pk_add_f32 v[98:99], v[98:99], v[114:115]
    v_pk_add_f32 v[100:101], v[100:101], v[116:117]
    v_pk_add_f32 v[102:103], v[102:103], v[118:119]
    v_pk_add_f32 v[104:105], v[104:105], v[120:121]
    v_pk_add_f32 v[106:107], v[106:107], v[122:123]
    v_pk_add_f32 v[108:109], v[108:109], v[124:125]
    v_pk_add_f32 v[110:111], v[110:111], v[126:127]
    v_pk_add_f32 v[96:97], v[96:97], v[104:105]
    v_pk_add_f32 v[98:99], v[98:99], v[106:107]
    v_pk_add_f32 v[100:101], v[100:101], v[108:109]
    v_pk_add_f32 v[102:103], v[102:103], v[110:111]
    v_cvt_pk_bf16_f32 v28, v96, v97
    v_cvt_pk_bf16_f32 v29, v98, v99
    v_cvt_pk_bf16_f32 v30, v100, v101
    v_cvt_pk_bf16_f32 v31, v102, v103
    ds_write_b128 v24, v[28:31] offset:1024
    global_load_dwordx4 v[96:99], v16, s[34:35] offset:0 sc1
    global_load_dwordx4 v[100:103], v16, s[34:35] offset:1024 sc1
    global_load_dwordx4 v[104:107], v17, s[34:35] offset:0 sc1
    global_load_dwordx4 v[108:111], v17, s[34:35] offset:1024 sc1
    global_load_dwordx4 v[112:115], v18, s[34:35] offset:0 sc1
    global_load_dwordx4 v[116:119], v18, s[34:35] offset:1024 sc1
    global_load_dwordx4 v[120:123], v19, s[34:35] offset:0 sc1
    global_load_dwordx4 v[124:127], v19, s[34:35] offset:1024 sc1
    global_load_dwordx4 v[128:131], v20, s[34:35] offset:0 sc1
    global_load_dwordx4 v[132:135], v20, s[34:35] offset:1024 sc1
    global_load_dwordx4 v[136:139], v21, s[34:35] offset:0 sc1
    global_load_dwordx4 v[140:143], v21, s[34:35] offset:1024 sc1
    global_load_dwordx4 v[144:147], v22, s[34:35] offset:0 sc1
    global_load_dwordx4 v[148:151], v22, s[34:35] offset:1024 sc1
    global_load_dwordx4 v[152:155], v23, s[34:35] offset:0 sc1
    global_load_dwordx4 v[156:159], v23, s[34:35] offset:1024 sc1
    s_add_u32 s34, s34, 2048
    s_addc_u32 s35, s35, 0
    s_waitcnt vmcnt(0)
    v_pk_add_f32 v[96:97], v[96:97], v[128:129]
    v_pk_add_f32 v[98:99], v[98:99], v[130:131]
    v_pk_add_f32 v[100:101], v[100:101], v[132:133]
    v_pk_add_f32 v[102:103], v[102:103], v[134:135]
    v_pk_add_f32 v[104:105], v[104:105], v[136:137]
    v_pk_add_f32 v[106:107], v[106:107], v[138:139]
    v_pk_add_f32 v[108:109], v[108:109], v[140:141]
    v_pk_add_f32 v[110:111], v[110:111], v[142:143]
    v_pk_add_f32 v[112:113], v[112:113], v[144:145]
    v_pk_add_f32 v[114:115], v[114:115], v[146:147]
    v_pk_add_f32 v[116:117], v[116:117], v[148:149]
    v_pk_add_f32 v[118:119], v[118:119], v[150:151]
    v_pk_add_f32 v[120:121], v[120:121], v[152:153]
    v_pk_add_f32 v[122:123], v[122:123], v[154:155]
    v_pk_add_f32 v[124:125], v[124:125], v[156:157]
    v_pk_add_f32 v[126:127], v[126:127], v[158:159]
    v_pk_add_f32 v[96:97], v[96:97], v[112:113]
    v_pk_add_f32 v[98:99], v[98:99], v[114:115]
    v_pk_add_f32 v[100:101], v[100:101], v[116:117]
    v_pk_add_f32 v[102:103], v[102:103], v[118:119]
    v_pk_add_f32 v[104:105], v[104:105], v[120:121]
    v_pk_add_f32 v[106:107], v[106:107], v[122:123]
    v_pk_add_f32 v[108:109], v[108:109], v[124:125]
    v_pk_add_f32 v[110:111], v[110:111], v[126:127]
    v_pk_add_f32 v[96:97], v[96:97], v[104:105]
    v_pk_add_f32 v[98:99], v[98:99], v[106:107]
    v_pk_add_f32 v[100:101], v[100:101], v[108:109]
    v_pk_add_f32 v[102:103], v[102:103], v[110:111]
    v_cvt_pk_bf16_f32 v28, v96, v97
    v_cvt_pk_bf16_f32 v29, v98, v99
    v_cvt_pk_bf16_f32 v30, v100, v101
    v_cvt_pk_bf16_f32 v31, v102, v103
    ds_write_b128 v24, v[28:31] offset:2048
    s_mul_i32 s32, s73, 12288
    v_add_u32 v24, s32, v16
    s_waitcnt lgkmcnt(0)
    s_barrier
    ds_read_b128 a[0:3], v24 offset:0
    ds_read_b128 a[4:7], v24 offset:1024
    ds_read_b128 a[8:11], v24 offset:2048
    ds_read_b128 a[12:15], v24 offset:3072
    ds_read_b128 a[16:19], v24 offset:4096
    ds_read_b128 a[20:23], v24 offset:5120
    ds_read_b128 a[24:27], v24 offset:6144
    ds_read_b128 a[28:31], v24 offset:7168
    ds_read_b128 a[32:35], v24 offset:8192
    ds_read_b128 a[36:39], v24 offset:9216
    ds_read_b128 a[40:43], v24 offset:10240
    ds_read_b128 a[44:47], v24 offset:11264
    v_bfe_u32 v25, v0, 4, 1
    v_lshlrev_b32 v25, 1, v25
    v_lshrrev_b32 v26, 5, v0
    v_add_u32 v25, v25, v26
    v_and_b32 v26, 15, v0
    v_lshl_add_u32 v25, v25, 4, v26
    v_lshlrev_b32 v25, 4, v25
    s_lshl_b32 s32, s31, 4
    s_lshl_b32 s33, s72, 2
    s_add_u32 s32, s32, s33
    s_mul_i32 s32, s32, 65536
    s_lshl_b32 s33, s30, 14
    s_add_u32 s32, s32, s33
    s_lshl_b32 s33, s73, 12
    s_add_u32 s32, s32, s33
    s_add_u32 s32, s32, 121634816
    s_lshr_b32 s33, s32, 21
    s_xor_b32 s33, s33, s22
    s_xor_b32 s33, s33, 1
    s_and_b32 s33, s33, 1
    s_lshl_b32 s33, s33, 13
    s_add_u32 s32, s32, s33
    v_add_u32 v20, s32, v25
    v_add_u32 v21, 65536, v20
    v_add_u32 v22, 131072, v20
    v_add_u32 v23, 196608, v20
    s_waitcnt lgkmcnt(0)
    v_mfma_f32_16x16x32_bf16 v[104:107], a[8:11], v[32:35], 0
    v_mfma_f32_16x16x32_bf16 v[96:99], a[0:3], v[32:35], 0
    v_mfma_f32_16x16x32_bf16 v[100:103], a[4:7], v[32:35], 0
    v_mfma_f32_16x16x32_bf16 v[116:119], a[8:11], v[48:51], 0
    v_mfma_f32_16x16x32_bf16 v[108:111], a[0:3], v[48:51], 0
    v_mfma_f32_16x16x32_bf16 v[112:115], a[4:7], v[48:51], 0
    v_mfma_f32_16x16x32_bf16 v[128:131], a[8:11], v[64:67], 0
    v_mfma_f32_16x16x32_bf16 v[120:123], a[0:3], v[64:67], 0
    v_mfma_f32_16x16x32_bf16 v[124:127], a[4:7], v[64:67], 0
    v_mfma_f32_16x16x32_bf16 v[140:143], a[8:11], v[80:83], 0
    v_mfma_f32_16x16x32_bf16 v[132:135], a[0:3], v[80:83], 0
    v_mfma_f32_16x16x32_bf16 v[136:139], a[4:7], v[80:83], 0
    s_nop 7
    v_add_f32 v104, s41, v104
    v_add_f32 v116, s41, v116
    v_add_f32 v128, s41, v128
    v_add_f32 v140, s41, v140
    v_rcp_f32 v104, v104
    v_rcp_f32 v116, v116
    v_rcp_f32 v128, v128
    v_rcp_f32 v140, v140
    v_mov_b32 v105, v104
    v_pk_mul_f32 v[96:97], v[96:97], v[104:105]
    v_pk_mul_f32 v[98:99], v[98:99], v[104:105]
    v_pk_mul_f32 v[100:101], v[100:101], v[104:105]
    v_pk_mul_f32 v[102:103], v[102:103], v[104:105]
    v_cvt_pk_bf16_f32 v144, v96, v97
    v_cvt_pk_bf16_f32 v145, v98, v99
    v_cvt_pk_bf16_f32 v146, v100, v101
    v_cvt_pk_bf16_f32 v147, v102, v103
    s_nop 0
    v_permlane16_swap_b32 v144, v146
    v_permlane16_swap_b32 v145, v147
    global_store_dwordx4 v20, v[144:147], s[28:29] offset:0 sc1
    v_mov_b32 v117, v116
    v_pk_mul_f32 v[108:109], v[108:109], v[116:117]
    v_pk_mul_f32 v[110:111], v[110:111], v[116:117]
    v_pk_mul_f32 v[112:113], v[112:113], v[116:117]
    v_pk_mul_f32 v[114:115], v[114:115], v[116:117]
    v_cvt_pk_bf16_f32 v148, v108, v109
    v_cvt_pk_bf16_f32 v149, v110, v111
    v_cvt_pk_bf16_f32 v150, v112, v113
    v_cvt_pk_bf16_f32 v151, v114, v115
    s_nop 0
    v_permlane16_swap_b32 v148, v150
    v_permlane16_swap_b32 v149, v151
    global_store_dwordx4 v21, v[148:151], s[28:29] offset:0 sc1
    v_mov_b32 v129, v128
    v_pk_mul_f32 v[120:121], v[120:121], v[128:129]
    v_pk_mul_f32 v[122:123], v[122:123], v[128:129]
    v_pk_mul_f32 v[124:125], v[124:125], v[128:129]
    v_pk_mul_f32 v[126:127], v[126:127], v[128:129]
    v_cvt_pk_bf16_f32 v152, v120, v121
    v_cvt_pk_bf16_f32 v153, v122, v123
    v_cvt_pk_bf16_f32 v154, v124, v125
    v_cvt_pk_bf16_f32 v155, v126, v127
    s_nop 0
    v_permlane16_swap_b32 v152, v154
    v_permlane16_swap_b32 v153, v155
    global_store_dwordx4 v22, v[152:155], s[28:29] offset:0 sc1
    v_mov_b32 v141, v140
    v_pk_mul_f32 v[132:133], v[132:133], v[140:141]
    v_pk_mul_f32 v[134:135], v[134:135], v[140:141]
    v_pk_mul_f32 v[136:137], v[136:137], v[140:141]
    v_pk_mul_f32 v[138:139], v[138:139], v[140:141]
    v_cvt_pk_bf16_f32 v156, v132, v133
    v_cvt_pk_bf16_f32 v157, v134, v135
    v_cvt_pk_bf16_f32 v158, v136, v137
    v_cvt_pk_bf16_f32 v159, v138, v139
    s_nop 0
    v_permlane16_swap_b32 v156, v158
    v_permlane16_swap_b32 v157, v159
    global_store_dwordx4 v23, v[156:159], s[28:29] offset:0 sc1
    v_mfma_f32_16x16x32_bf16 v[104:107], a[20:23], v[36:39], 0
    v_mfma_f32_16x16x32_bf16 v[96:99], a[12:15], v[36:39], 0
    v_mfma_f32_16x16x32_bf16 v[100:103], a[16:19], v[36:39], 0
    v_mfma_f32_16x16x32_bf16 v[116:119], a[20:23], v[52:55], 0
    v_mfma_f32_16x16x32_bf16 v[108:111], a[12:15], v[52:55], 0
    v_mfma_f32_16x16x32_bf16 v[112:115], a[16:19], v[52:55], 0
    v_mfma_f32_16x16x32_bf16 v[128:131], a[20:23], v[68:71], 0
    v_mfma_f32_16x16x32_bf16 v[120:123], a[12:15], v[68:71], 0
    v_mfma_f32_16x16x32_bf16 v[124:127], a[16:19], v[68:71], 0
    v_mfma_f32_16x16x32_bf16 v[140:143], a[20:23], v[84:87], 0
    v_mfma_f32_16x16x32_bf16 v[132:135], a[12:15], v[84:87], 0
    v_mfma_f32_16x16x32_bf16 v[136:139], a[16:19], v[84:87], 0
    s_nop 7
    v_add_f32 v104, s41, v104
    v_add_f32 v116, s41, v116
    v_add_f32 v128, s41, v128
    v_add_f32 v140, s41, v140
    v_rcp_f32 v104, v104
    v_rcp_f32 v116, v116
    v_rcp_f32 v128, v128
    v_rcp_f32 v140, v140
    v_mov_b32 v105, v104
    v_pk_mul_f32 v[96:97], v[96:97], v[104:105]
    v_pk_mul_f32 v[98:99], v[98:99], v[104:105]
    v_pk_mul_f32 v[100:101], v[100:101], v[104:105]
    v_pk_mul_f32 v[102:103], v[102:103], v[104:105]
    v_cvt_pk_bf16_f32 v144, v96, v97
    v_cvt_pk_bf16_f32 v145, v98, v99
    v_cvt_pk_bf16_f32 v146, v100, v101
    v_cvt_pk_bf16_f32 v147, v102, v103
    s_nop 0
    v_permlane16_swap_b32 v144, v146
    v_permlane16_swap_b32 v145, v147
    global_store_dwordx4 v20, v[144:147], s[28:29] offset:1024 sc1
    v_mov_b32 v117, v116
    v_pk_mul_f32 v[108:109], v[108:109], v[116:117]
    v_pk_mul_f32 v[110:111], v[110:111], v[116:117]
    v_pk_mul_f32 v[112:113], v[112:113], v[116:117]
    v_pk_mul_f32 v[114:115], v[114:115], v[116:117]
    v_cvt_pk_bf16_f32 v148, v108, v109
    v_cvt_pk_bf16_f32 v149, v110, v111
    v_cvt_pk_bf16_f32 v150, v112, v113
    v_cvt_pk_bf16_f32 v151, v114, v115
    s_nop 0
    v_permlane16_swap_b32 v148, v150
    v_permlane16_swap_b32 v149, v151
    global_store_dwordx4 v21, v[148:151], s[28:29] offset:1024 sc1
    v_mov_b32 v129, v128
    v_pk_mul_f32 v[120:121], v[120:121], v[128:129]
    v_pk_mul_f32 v[122:123], v[122:123], v[128:129]
    v_pk_mul_f32 v[124:125], v[124:125], v[128:129]
    v_pk_mul_f32 v[126:127], v[126:127], v[128:129]
    v_cvt_pk_bf16_f32 v152, v120, v121
    v_cvt_pk_bf16_f32 v153, v122, v123
    v_cvt_pk_bf16_f32 v154, v124, v125
    v_cvt_pk_bf16_f32 v155, v126, v127
    s_nop 0
    v_permlane16_swap_b32 v152, v154
    v_permlane16_swap_b32 v153, v155
    global_store_dwordx4 v22, v[152:155], s[28:29] offset:1024 sc1
    v_mov_b32 v141, v140
    v_pk_mul_f32 v[132:133], v[132:133], v[140:141]
    v_pk_mul_f32 v[134:135], v[134:135], v[140:141]
    v_pk_mul_f32 v[136:137], v[136:137], v[140:141]
    v_pk_mul_f32 v[138:139], v[138:139], v[140:141]
    v_cvt_pk_bf16_f32 v156, v132, v133
    v_cvt_pk_bf16_f32 v157, v134, v135
    v_cvt_pk_bf16_f32 v158, v136, v137
    v_cvt_pk_bf16_f32 v159, v138, v139
    s_nop 0
    v_permlane16_swap_b32 v156, v158
    v_permlane16_swap_b32 v157, v159
    global_store_dwordx4 v23, v[156:159], s[28:29] offset:1024 sc1
    v_mfma_f32_16x16x32_bf16 v[104:107], a[32:35], v[40:43], 0
    v_mfma_f32_16x16x32_bf16 v[96:99], a[24:27], v[40:43], 0
    v_mfma_f32_16x16x32_bf16 v[100:103], a[28:31], v[40:43], 0
    v_mfma_f32_16x16x32_bf16 v[116:119], a[32:35], v[56:59], 0
    v_mfma_f32_16x16x32_bf16 v[108:111], a[24:27], v[56:59], 0
    v_mfma_f32_16x16x32_bf16 v[112:115], a[28:31], v[56:59], 0
    v_mfma_f32_16x16x32_bf16 v[128:131], a[32:35], v[72:75], 0
    v_mfma_f32_16x16x32_bf16 v[120:123], a[24:27], v[72:75], 0
    v_mfma_f32_16x16x32_bf16 v[124:127], a[28:31], v[72:75], 0
    v_mfma_f32_16x16x32_bf16 v[140:143], a[32:35], v[88:91], 0
    v_mfma_f32_16x16x32_bf16 v[132:135], a[24:27], v[88:91], 0
    v_mfma_f32_16x16x32_bf16 v[136:139], a[28:31], v[88:91], 0
    s_nop 7
    v_add_f32 v104, s41, v104
    v_add_f32 v116, s41, v116
    v_add_f32 v128, s41, v128
    v_add_f32 v140, s41, v140
    v_rcp_f32 v104, v104
    v_rcp_f32 v116, v116
    v_rcp_f32 v128, v128
    v_rcp_f32 v140, v140
    v_mov_b32 v105, v104
    v_pk_mul_f32 v[96:97], v[96:97], v[104:105]
    v_pk_mul_f32 v[98:99], v[98:99], v[104:105]
    v_pk_mul_f32 v[100:101], v[100:101], v[104:105]
    v_pk_mul_f32 v[102:103], v[102:103], v[104:105]
    v_cvt_pk_bf16_f32 v144, v96, v97
    v_cvt_pk_bf16_f32 v145, v98, v99
    v_cvt_pk_bf16_f32 v146, v100, v101
    v_cvt_pk_bf16_f32 v147, v102, v103
    s_nop 0
    v_permlane16_swap_b32 v144, v146
    v_permlane16_swap_b32 v145, v147
    global_store_dwordx4 v20, v[144:147], s[28:29] offset:2048 sc1
    v_mov_b32 v117, v116
    v_pk_mul_f32 v[108:109], v[108:109], v[116:117]
    v_pk_mul_f32 v[110:111], v[110:111], v[116:117]
    v_pk_mul_f32 v[112:113], v[112:113], v[116:117]
    v_pk_mul_f32 v[114:115], v[114:115], v[116:117]
    v_cvt_pk_bf16_f32 v148, v108, v109
    v_cvt_pk_bf16_f32 v149, v110, v111
    v_cvt_pk_bf16_f32 v150, v112, v113
    v_cvt_pk_bf16_f32 v151, v114, v115
    s_nop 0
    v_permlane16_swap_b32 v148, v150
    v_permlane16_swap_b32 v149, v151
    global_store_dwordx4 v21, v[148:151], s[28:29] offset:2048 sc1
    v_mov_b32 v129, v128
    v_pk_mul_f32 v[120:121], v[120:121], v[128:129]
    v_pk_mul_f32 v[122:123], v[122:123], v[128:129]
    v_pk_mul_f32 v[124:125], v[124:125], v[128:129]
    v_pk_mul_f32 v[126:127], v[126:127], v[128:129]
    v_cvt_pk_bf16_f32 v152, v120, v121
    v_cvt_pk_bf16_f32 v153, v122, v123
    v_cvt_pk_bf16_f32 v154, v124, v125
    v_cvt_pk_bf16_f32 v155, v126, v127
    s_nop 0
    v_permlane16_swap_b32 v152, v154
    v_permlane16_swap_b32 v153, v155
    global_store_dwordx4 v22, v[152:155], s[28:29] offset:2048 sc1
    v_mov_b32 v141, v140
    v_pk_mul_f32 v[132:133], v[132:133], v[140:141]
    v_pk_mul_f32 v[134:135], v[134:135], v[140:141]
    v_pk_mul_f32 v[136:137], v[136:137], v[140:141]
    v_pk_mul_f32 v[138:139], v[138:139], v[140:141]
    v_cvt_pk_bf16_f32 v156, v132, v133
    v_cvt_pk_bf16_f32 v157, v134, v135
    v_cvt_pk_bf16_f32 v158, v136, v137
    v_cvt_pk_bf16_f32 v159, v138, v139
    s_nop 0
    v_permlane16_swap_b32 v156, v158
    v_permlane16_swap_b32 v157, v159
    global_store_dwordx4 v23, v[156:159], s[28:29] offset:2048 sc1
    v_mfma_f32_16x16x32_bf16 v[104:107], a[44:47], v[44:47], 0
    v_mfma_f32_16x16x32_bf16 v[96:99], a[36:39], v[44:47], 0
    v_mfma_f32_16x16x32_bf16 v[100:103], a[40:43], v[44:47], 0
    v_mfma_f32_16x16x32_bf16 v[116:119], a[44:47], v[60:63], 0
    v_mfma_f32_16x16x32_bf16 v[108:111], a[36:39], v[60:63], 0
    v_mfma_f32_16x16x32_bf16 v[112:115], a[40:43], v[60:63], 0
    v_mfma_f32_16x16x32_bf16 v[128:131], a[44:47], v[76:79], 0
    v_mfma_f32_16x16x32_bf16 v[120:123], a[36:39], v[76:79], 0
    v_mfma_f32_16x16x32_bf16 v[124:127], a[40:43], v[76:79], 0
    v_mfma_f32_16x16x32_bf16 v[140:143], a[44:47], v[92:95], 0
    v_mfma_f32_16x16x32_bf16 v[132:135], a[36:39], v[92:95], 0
    v_mfma_f32_16x16x32_bf16 v[136:139], a[40:43], v[92:95], 0
    s_nop 7
    v_add_f32 v104, s41, v104
    v_add_f32 v116, s41, v116
    v_add_f32 v128, s41, v128
    v_add_f32 v140, s41, v140
    v_rcp_f32 v104, v104
    v_rcp_f32 v116, v116
    v_rcp_f32 v128, v128
    v_rcp_f32 v140, v140
    v_mov_b32 v105, v104
    v_pk_mul_f32 v[96:97], v[96:97], v[104:105]
    v_pk_mul_f32 v[98:99], v[98:99], v[104:105]
    v_pk_mul_f32 v[100:101], v[100:101], v[104:105]
    v_pk_mul_f32 v[102:103], v[102:103], v[104:105]
    v_cvt_pk_bf16_f32 v144, v96, v97
    v_cvt_pk_bf16_f32 v145, v98, v99
    v_cvt_pk_bf16_f32 v146, v100, v101
    v_cvt_pk_bf16_f32 v147, v102, v103
    s_nop 0
    v_permlane16_swap_b32 v144, v146
    v_permlane16_swap_b32 v145, v147
    global_store_dwordx4 v20, v[144:147], s[28:29] offset:3072 sc1
    v_mov_b32 v117, v116
    v_pk_mul_f32 v[108:109], v[108:109], v[116:117]
    v_pk_mul_f32 v[110:111], v[110:111], v[116:117]
    v_pk_mul_f32 v[112:113], v[112:113], v[116:117]
    v_pk_mul_f32 v[114:115], v[114:115], v[116:117]
    v_cvt_pk_bf16_f32 v148, v108, v109
    v_cvt_pk_bf16_f32 v149, v110, v111
    v_cvt_pk_bf16_f32 v150, v112, v113
    v_cvt_pk_bf16_f32 v151, v114, v115
    s_nop 0
    v_permlane16_swap_b32 v148, v150
    v_permlane16_swap_b32 v149, v151
    global_store_dwordx4 v21, v[148:151], s[28:29] offset:3072 sc1
    v_mov_b32 v129, v128
    v_pk_mul_f32 v[120:121], v[120:121], v[128:129]
    v_pk_mul_f32 v[122:123], v[122:123], v[128:129]
    v_pk_mul_f32 v[124:125], v[124:125], v[128:129]
    v_pk_mul_f32 v[126:127], v[126:127], v[128:129]
    v_cvt_pk_bf16_f32 v152, v120, v121
    v_cvt_pk_bf16_f32 v153, v122, v123
    v_cvt_pk_bf16_f32 v154, v124, v125
    v_cvt_pk_bf16_f32 v155, v126, v127
    s_nop 0
    v_permlane16_swap_b32 v152, v154
    v_permlane16_swap_b32 v153, v155
    global_store_dwordx4 v22, v[152:155], s[28:29] offset:3072 sc1
    v_mov_b32 v141, v140
    v_pk_mul_f32 v[132:133], v[132:133], v[140:141]
    v_pk_mul_f32 v[134:135], v[134:135], v[140:141]
    v_pk_mul_f32 v[136:137], v[136:137], v[140:141]
    v_pk_mul_f32 v[138:139], v[138:139], v[140:141]
    v_cvt_pk_bf16_f32 v156, v132, v133
    v_cvt_pk_bf16_f32 v157, v134, v135
    v_cvt_pk_bf16_f32 v158, v136, v137
    v_cvt_pk_bf16_f32 v159, v138, v139
    s_nop 0
    v_permlane16_swap_b32 v156, v158
    v_permlane16_swap_b32 v157, v159
    global_store_dwordx4 v23, v[156:159], s[28:29] offset:3072 sc1
    s_lshl_b32 s32, s31, 2
    s_add_u32 s32, s32, 96
    s_waitcnt vmcnt(0)
    s_barrier
    s_cmp_lg_u32 s75, 0
    s_cbranch_scc1 sig_43
    v_mov_b32 v16, s32
    v_mov_b32 v17, 1
    s_mov_b64 exec, 1
    global_atomic_add v16, v17, s[26:27] sc1
    s_mov_b64 exec, -1
sig_43:
    v_lshlrev_b32 v16, 4, v0
    s_mul_i32 s74, s75, 131072
    s_lshl_b32 s76, s75, 12
    v_add_u32 v28, s74, v16
    v_add_u32 v29, 1024, v28
    v_add_u32 v30, 65536, v28
    v_add_u32 v31, 1024, v30
    s_mul_i32 s74, s72, 8192
    v_add_u32 v6, s74, v16
    v_add_u32 v7, 1024, v6
    s_mov_b32 s64, 2048
    s_mov_b32 s86, 0x2000
    v_lshrrev_b32 v16, 5, v0
    s_lshl_b32 s74, s75, 2
    s_add_u32 s74, s74, 0
    v_add_u32 v16, s74, v16
    v_and_b32 v17, 3, v16
    v_bfe_u32 v18, v16, 3, 1
    v_lshl_add_u32 v17, v18, 2, v17
    v_lshlrev_b32 v17, 1, v17
    v_and_b32 v18, 31, v0
    v_xor_b32 v17, v17, v18
    v_lshlrev_b32 v17, 4, v17
    s_mov_b32 s74, 2048
    v_mul_lo_u32 v16, v16, s74
    v_add_u32 v4, v16, v17
    v_lshrrev_b32 v16, 5, v0
    s_lshl_b32 s74, s75, 2
    s_add_u32 s74, s74, 2
    v_add_u32 v16, s74, v16
    v_and_b32 v17, 3, v16
    v_bfe_u32 v18, v16, 3, 1
    v_lshl_add_u32 v17, v18, 2, v17
    v_lshlrev_b32 v17, 1, v17
    v_and_b32 v18, 31, v0
    v_xor_b32 v17, v17, v18
    v_lshlrev_b32 v17, 4, v17
    s_mov_b32 s74, 2048
    v_mul_lo_u32 v16, v16, s74
    v_add_u32 v5, v16, v17
    s_mov_b32 s65, 65536
    s_mov_b32 s87, 0
    s_lshl_b32 s32, s31, 2
    s_add_u32 s32, s32, 96
    s_cmp_lg_u32 s75, 0
    s_cbranch_scc1 wd_46
    v_mov_b32 v16, s32
wl_44:
    global_load_dword v17, v16, s[26:27] sc1
    s_waitcnt vmcnt(0)
    v_cmp_ne_u32 vcc, 4, v17
    s_cbranch_vccz wo_45
    s_sleep 8
    s_add_u32 s46, s46, 1
    s_cmp_lt_u32 s46, 400000
    s_cbranch_scc1 wl_44
    s_branch w_fail
wo_45:
    buffer_inv sc1
    s_waitcnt vmcnt(0)
wd_46:
    s_barrier
    s_mul_i32 s32, s31, 1048576
    s_add_u32 s32, s32, 121634816
    s_lshr_b32 s33, s32, 21
    s_xor_b32 s33, s33, s22
    s_xor_b32 s33, s33, 1
    s_and_b32 s33, s33, 1
    s_lshl_b32 s33, s33, 13
    s_add_u32 s33, s33, s32
    s_add_u32 s80, s28, s33
    s_addc_u32 s81, s29, 0
    s_lshl_b32 s32, s30, 9
    s_add_u32 s82, s8, s32
    s_addc_u32 s83, s9, 0
    s_mov_b32 s66, 7
    s_getpc_b64 s[70:71]
call_47:
    s_add_u32 s70, s70, core_T-call_47
    s_addc_u32 s71, s71, (core_T-call_47)>>32
    s_swappc_b64 s[68:69], s[70:71]
    v_bfe_u32 v25, v0, 4, 1
    v_lshlrev_b32 v25, 1, v25
    v_lshrrev_b32 v26, 5, v0
    v_add_u32 v25, v25, v26
    v_and_b32 v26, 15, v0
    v_lshlrev_b32 v26, 12, v26
    v_lshl_add_u32 v20, v25, 4, v26
    s_mul_i32 s32, s72, 262144
    s_lshl_b32 s33, s73, 8
    s_add_u32 s32, s32, s33
    v_add_u32 v20, s32, v20
    v_add_u32 v21, 65536, v20
    v_add_u32 v22, 131072, v20
    v_add_u32 v23, 196608, v20
    s_lshl_b32 s32, s31, 20
    s_lshl_b32 s33, s30, 9
    s_add_u32 s32, s32, s33
    s_add_u32 s34, s24, s32
    s_addc_u32 s35, s25, 0
    v_cvt_pk_bf16_f32 v24, v32, v33
    v_cvt_pk_bf16_f32 v25, v34, v35
    v_cvt_pk_bf16_f32 v26, v36, v37
    v_cvt_pk_bf16_f32 v27, v38, v39
    s_nop 0
    v_permlane16_swap_b32 v24, v26
    v_permlane16_swap_b32 v25, v27
    global_store_dwordx4 v20, v[24:27], s[34:35] offset:0 sc1
    v_cvt_pk_bf16_f32 v28, v40, v41
    v_cvt_pk_bf16_f32 v29, v42, v43
    v_cvt_pk_bf16_f32 v30, v44, v45
    v_cvt_pk_bf16_f32 v31, v46, v47
    s_nop 0
    v_permlane16_swap_b32 v28, v30
    v_permlane16_swap_b32 v29, v31
    global_store_dwordx4 v20, v[28:31], s[34:35] offset:64 sc1
    v_cvt_pk_bf16_f32 v24, v48, v49
    v_cvt_pk_bf16_f32 v25, v50, v51
    v_cvt_pk_bf16_f32 v26, v52, v53
    v_cvt_pk_bf16_f32 v27, v54, v55
    s_nop 0
    v_permlane16_swap_b32 v24, v26
    v_permlane16_swap_b32 v25, v27
    global_store_dwordx4 v20, v[24:27], s[34:35] offset:128 sc1
    v_cvt_pk_bf16_f32 v28, v56, v57
    v_cvt_pk_bf16_f32 v29, v58, v59
    v_cvt_pk_bf16_f32 v30, v60, v61
    v_cvt_pk_bf16_f32 v31, v62, v63
    s_nop 0
    v_permlane16_swap_b32 v28, v30
    v_permlane16_swap_b32 v29, v31
    global_store_dwordx4 v20, v[28:31], s[34:35] offset:192 sc1
    v_cvt_pk_bf16_f32 v24, v64, v65
    v_cvt_pk_bf16_f32 v25, v66, v67
    v_cvt_pk_bf16_f32 v26, v68, v69
    v_cvt_pk_bf16_f32 v27, v70, v71
    s_nop 0
    v_permlane16_swap_b32 v24, v26
    v_permlane16_swap_b32 v25, v27
    global_store_dwordx4 v21, v[24:27], s[34:35] offset:0 sc1
    v_cvt_pk_bf16_f32 v28, v72, v73
    v_cvt_pk_bf16_f32 v29, v74, v75
    v_cvt_pk_bf16_f32 v30, v76, v77
    v_cvt_pk_bf16_f32 v31, v78, v79
    s_nop 0
    v_permlane16_swap_b32 v28, v30
    v_permlane16_swap_b32 v29, v31
    global_store_dwordx4 v21, v[28:31], s[34:35] offset:64 sc1
    v_cvt_pk_bf16_f32 v24, v80, v81
    v_cvt_pk_bf16_f32 v25, v82, v83
    v_cvt_pk_bf16_f32 v26, v84, v85
    v_cvt_pk_bf16_f32 v27, v86, v87
    s_nop 0
    v_permlane16_swap_b32 v24, v26
    v_permlane16_swap_b32 v25, v27
    global_store_dwordx4 v21, v[24:27], s[34:35] offset:128 sc1
    v_cvt_pk_bf16_f32 v28, v88, v89
    v_cvt_pk_bf16_f32 v29, v90, v91
    v_cvt_pk_bf16_f32 v30, v92, v93
    v_cvt_pk_bf16_f32 v31, v94, v95
    s_nop 0
    v_permlane16_swap_b32 v28, v30
    v_permlane16_swap_b32 v29, v31
    global_store_dwordx4 v21, v[28:31], s[34:35] offset:192 sc1
    v_cvt_pk_bf16_f32 v24, v96, v97
    v_cvt_pk_bf16_f32 v25, v98, v99
    v_cvt_pk_bf16_f32 v26, v100, v101
    v_cvt_pk_bf16_f32 v27, v102, v103
    s_nop 0
    v_permlane16_swap_b32 v24, v26
    v_permlane16_swap_b32 v25, v27
    global_store_dwordx4 v22, v[24:27], s[34:35] offset:0 sc1
    v_cvt_pk_bf16_f32 v28, v104, v105
    v_cvt_pk_bf16_f32 v29, v106, v107
    v_cvt_pk_bf16_f32 v30, v108, v109
    v_cvt_pk_bf16_f32 v31, v110, v111
    s_nop 0
    v_permlane16_swap_b32 v28, v30
    v_permlane16_swap_b32 v29, v31
    global_store_dwordx4 v22, v[28:31], s[34:35] offset:64 sc1
    v_cvt_pk_bf16_f32 v24, v112, v113
    v_cvt_pk_bf16_f32 v25, v114, v115
    v_cvt_pk_bf16_f32 v26, v116, v117
    v_cvt_pk_bf16_f32 v27, v118, v119
    s_nop 0
    v_permlane16_swap_b32 v24, v26
    v_permlane16_swap_b32 v25, v27
    global_store_dwordx4 v22, v[24:27], s[34:35] offset:128 sc1
    v_cvt_pk_bf16_f32 v28, v120, v121
    v_cvt_pk_bf16_f32 v29, v122, v123
    v_cvt_pk_bf16_f32 v30, v124, v125
    v_cvt_pk_bf16_f32 v31, v126, v127
    s_nop 0
    v_permlane16_swap_b32 v28, v30
    v_permlane16_swap_b32 v29, v31
    global_store_dwordx4 v22, v[28:31], s[34:35] offset:192 sc1
    v_cvt_pk_bf16_f32 v24, v128, v129
    v_cvt_pk_bf16_f32 v25, v130, v131
    v_cvt_pk_bf16_f32 v26, v132, v133
    v_cvt_pk_bf16_f32 v27, v134, v135
    s_nop 0
    v_permlane16_swap_b32 v24, v26
    v_permlane16_swap_b32 v25, v27
    global_store_dwordx4 v23, v[24:27], s[34:35] offset:0 sc1
    v_cvt_pk_bf16_f32 v28, v136, v137
    v_cvt_pk_bf16_f32 v29, v138, v139
    v_cvt_pk_bf16_f32 v30, v140, v141
    v_cvt_pk_bf16_f32 v31, v142, v143
    s_nop 0
    v_permlane16_swap_b32 v28, v30
    v_permlane16_swap_b32 v29, v31
    global_store_dwordx4 v23, v[28:31], s[34:35] offset:64 sc1
    v_cvt_pk_bf16_f32 v24, v144, v145
    v_cvt_pk_bf16_f32 v25, v146, v147
    v_cvt_pk_bf16_f32 v26, v148, v149
    v_cvt_pk_bf16_f32 v27, v150, v151
    s_nop 0
    v_permlane16_swap_b32 v24, v26
    v_permlane16_swap_b32 v25, v27
    global_store_dwordx4 v23, v[24:27], s[34:35] offset:128 sc1
    v_cvt_pk_bf16_f32 v28, v152, v153
    v_cvt_pk_bf16_f32 v29, v154, v155
    v_cvt_pk_bf16_f32 v30, v156, v157
    v_cvt_pk_bf16_f32 v31, v158, v159
    s_nop 0
    v_permlane16_swap_b32 v28, v30
    v_permlane16_swap_b32 v29, v31
    global_store_dwordx4 v23, v[28:31], s[34:35] offset:192 sc1
    s_mov_b32 s34, 0x2470
w_stream:
    s_cmp_lg_u32 s75, 0
    s_cbranch_scc1 to_49
    v_lshlrev_b32 v18, 2, v0
    v_add_u32 v18, 1979904, v18
tl_48:
    global_load_dword v19, v18, s[28:29] sc1
    s_waitcnt vmcnt(0)
    v_cmp_ne_u32 vcc, 0, v19
    s_cbranch_vccz to_49
    s_sleep 8
    s_add_u32 s46, s46, 1
    s_cmp_lt_u32 s46, 400000
    s_cbranch_scc1 tl_48
    s_branch w_fail
to_49:
    s_barrier
    s_and_b32 s42, s45, 1
    s_lshl_b32 s43, s42, 3
    s_add_u32 s43, s43, s75
    s_lshr_b32 s32, s45, 1
    s_lshl_b32 s32, s32, 20
    s_lshl_b32 s33, s43, 15
    s_add_u32 s32, s32, s33
    s_add_u32 s32, s32, 132120576
    s_lshr_b32 s33, s32, 21
    s_xor_b32 s33, s33, s22
    s_xor_b32 s33, s33, 1
    s_and_b32 s33, s33, 1
    s_lshl_b32 s33, s33, 13
    s_add_u32 s32, s32, s33
    v_lshlrev_b32 v10, 4, v0
    v_add_u32 v6, s32, v10
    v_add_u32 v2, 0, v6
    global_load_dwordx4 a[0:3], v2, s[28:29] offset:0 sc1
    global_load_dwordx4 a[4:7], v2, s[28:29] offset:1024 sc1
    global_load_dwordx4 a[16:19], v2, s[28:29] offset:2048 sc1
    global_load_dwordx4 a[20:23], v2, s[28:29] offset:3072 sc1
    v_add_u32 v2, 4096, v6
    global_load_dwordx4 a[32:35], v2, s[28:29] offset:0 sc1
    global_load_dwordx4 a[36:39], v2, s[28:29] offset:1024 sc1
    global_load_dwordx4 a[48:51], v2, s[28:29] offset:2048 sc1
    global_load_dwordx4 a[52:55], v2, s[28:29] offset:3072 sc1
    v_add_u32 v2, 16384, v6
    global_load_dwordx4 a[64:67], v2, s[28:29] offset:0 sc1
    global_load_dwordx4 a[68:71], v2, s[28:29] offset:1024 sc1
    global_load_dwordx4 a[80:83], v2, s[28:29] offset:2048 sc1
    global_load_dwordx4 a[84:87], v2, s[28:29] offset:3072 sc1
    v_add_u32 v2, 20480, v6
    global_load_dwordx4 v[128:131], v2, s[28:29] offset:0 sc1
    global_load_dwordx4 v[132:135], v2, s[28:29] offset:1024 sc1
    global_load_dwordx4 v[144:147], v2, s[28:29] offset:2048 sc1
    global_load_dwordx4 v[148:151], v2, s[28:29] offset:3072 sc1
    v_add_u32 v2, 524288, v6
    global_load_dwordx4 a[8:11], v2, s[28:29] offset:0 sc1
    global_load_dwordx4 a[12:15], v2, s[28:29] offset:1024 sc1
    global_load_dwordx4 a[24:27], v2, s[28:29] offset:2048 sc1
    global_load_dwordx4 a[28:31], v2, s[28:29] offset:3072 sc1
    v_add_u32 v2, 528384, v6
    global_load_dwordx4 a[40:43], v2, s[28:29] offset:0 sc1
    global_load_dwordx4 a[44:47], v2, s[28:29] offset:1024 sc1
    global_load_dwordx4 a[56:59], v2, s[28:29] offset:2048 sc1
    global_load_dwordx4 a[60:63], v2, s[28:29] offset:3072 sc1
    v_add_u32 v2, 540672, v6
    global_load_dwordx4 a[72:75], v2, s[28:29] offset:0 sc1
    global_load_dwordx4 a[76:79], v2, s[28:29] offset:1024 sc1
    global_load_dwordx4 a[88:91], v2, s[28:29] offset:2048 sc1
    global_load_dwordx4 a[92:95], v2, s[28:29] offset:3072 sc1
    v_add_u32 v2, 544768, v6
    global_load_dwordx4 v[136:139], v2, s[28:29] offset:0 sc1
    global_load_dwordx4 v[140:143], v2, s[28:29] offset:1024 sc1
    global_load_dwordx4 v[152:155], v2, s[28:29] offset:2048 sc1
    global_load_dwordx4 v[156:159], v2, s[28:29] offset:3072 sc1
    s_lshl_b32 s32, s43, 14
    v_add_u32 v2, s32, v10
    v_add_u32 v3, 0x1000, v2
    v_add_u32 v4, 0x40000, v2
    v_add_u32 v5, 0x41000, v2
    s_lshl_b32 s33, s75, 13
    v_add_u32 v11, s33, v10
    s_lshr_b32 s33, s75, 2
    s_xor_b32 s47, s33, s42
    s_xor_b32 s36, s45, s47
    s_and_b32 s33, s36, 1
    s_lshl_b32 s33, s33, 12
    s_lshr_b32 s36, s36, 1
    s_lshl_b32 s36, s36, 14
    s_add_u32 s36, s36, s33
    s_and_b32 s33, s75, 3
    s_lshl_b32 s33, s33, 10
    s_add_u32 s36, s36, s33
    v_add_u32 v1, s36, v10
    s_bfe_u32 s32, s75, 0x10001
    s_lshl_b32 s36, s32, 12
    s_lshr_b32 s33, s75, 2
    s_lshl_b32 s33, s33, 11
    s_add_u32 s36, s36, s33
    s_and_b32 s33, s75, 1
    s_lshl_b32 s37, s33, 10
    s_add_u32 s36, s36, s37
    v_add_u32 v12, s36, v10
    s_lshl_b32 s32, s32, 16
    s_lshl_b32 s33, s33, 3
    s_add_u32 s32, s32, s33
    s_lshl_b32 s33, s45, 6
    s_add_u32 s32, s32, s33
    s_add_u32 s32, s32, 6293504
    v_and_b32 v13, 15, v0
    v_lshlrev_b32 v13, 12, v13
    v_lshrrev_b32 v14, 4, v0
    v_lshl_add_u32 v13, v14, 4, v13
    v_add_u32 v13, s32, v13
    v_and_b32 v9, 1, v0
    v_lshlrev_b32 v9, 7, v9
    s_lshl_b32 s32, s43, 8
    s_xor_b32 s33, s22, 1
    s_lshl_b32 s33, s33, 13
    s_add_u32 s32, s32, s33
    s_add_u32 s32, s32, 1310720
    v_add_u32 v9, s32, v9
    v_mov_b32 v8, 0
    s_ff1_i32_b32 s31, s34
    s_bitset0_b32 s34, s31
    s_ff1_i32_b32 s36, s34
    s_bitset0_b32 s34, s36
    s_mov_b32 s37, 0
    s_mov_b32 s52, -1
    s_mov_b32 s53, -1
    s_mov_b64 s[50:51], s[28:29]
st_wait:
    s_add_u32 s32, s31, 49
    s_min_u32 s32, s32, 63
    s_cmp_le_u32 s32, s37
    s_cbranch_scc1 st_near
    s_sleep 6
    global_load_dword v7, v8, s[26:27] offset:192 sc1
    s_waitcnt vmcnt(0)
    v_readfirstlane_b32 s37, v7
    s_branch st_more
st_near:
    s_bfe_u32 s32, s31, 0x30001
    s_lshl_b32 s32, s32, 14
    s_and_b32 s33, s31, 1
    s_lshl_b32 s33, s33, 12
    s_add_u32 s32, s32, s33
    v_add_u32 v14, s32, v9
    global_load_dword v15, v14, s[28:29] sc1
    s_waitcnt vmcnt(0)
    v_cmp_ne_u32 vcc, 0, v15
    s_cbranch_vccz st_rdy
    s_sleep 2
st_more:
    s_add_u32 s46, s46, 1
    s_cmp_lt_u32 s46, 400000
    s_cbranch_scc1 st_wait
    s_branch w_fail
st_rdy:
    s_and_b32 s32, s31, 15
    s_lshl_b32 s32, s32, 19
    s_add_u32 s32, s32, 113246208
    s_lshr_b32 s33, s32, 21
    s_xor_b32 s33, s33, s22
    s_xor_b32 s33, s33, 1
    s_and_b32 s33, s33, 1
    s_lshl_b32 s33, s33, 13
    s_add_u32 s33, s33, s32
    s_add_u32 s38, s28, s33
    s_addc_u32 s39, s29, 0
    s_bfe_u32 s32, s36, 0x30001
    s_lshl_b32 s32, s32, 14
    s_and_b32 s33, s36, 1
    s_lshl_b32 s33, s33, 12
    s_add_u32 s32, s32, s33
    v_add_u32 v14, s32, v9
    global_load_dword v15, v14, s[28:29] sc1
    global_load_dwordx4 v[32:35], v2, s[38:39] offset:0 sc1
    global_load_dwordx4 v[36:39], v2, s[38:39] offset:1024 sc1
    global_load_dwordx4 v[40:43], v2, s[38:39] offset:2048 sc1
    global_load_dwordx4 v[44:47], v2, s[38:39] offset:3072 sc1
    global_load_dwordx4 v[48:51], v3, s[38:39] offset:0 sc1
    global_load_dwordx4 v[52:55], v3, s[38:39] offset:1024 sc1
    global_load_dwordx4 v[56:59], v3, s[38:39] offset:2048 sc1
    global_load_dwordx4 v[60:63], v3, s[38:39] offset:3072 sc1
    global_load_dwordx4 v[64:67], v4, s[38:39] offset:0 sc1
    global_load_dwordx4 v[68:71], v4, s[38:39] offset:1024 sc1
    global_load_dwordx4 v[72:75], v4, s[38:39] offset:2048 sc1
    global_load_dwordx4 v[76:79], v4, s[38:39] offset:3072 sc1
    global_load_dwordx4 v[80:83], v5, s[38:39] offset:0 sc1
    global_load_dwordx4 v[84:87], v5, s[38:39] offset:1024 sc1
    global_load_dwordx4 v[88:91], v5, s[38:39] offset:2048 sc1
    global_load_dwordx4 v[92:95], v5, s[38:39] offset:3072 sc1
    s_mov_b32 s35, -1
st_item:
    s_mov_b32 s30, s31
    s_mov_b32 s31, s36
    s_ff1_i32_b32 s36, s34
    s_bitset0_b32 s34, s36
    s_waitcnt vmcnt(16)
    v_cmp_ne_u32 vcc, 0, v15
    s_cmp_lt_i32 s31, 0
    s_cbranch_scc1 st_slow
    s_cbranch_vccnz st_slow
    s_and_b32 s32, s31, 15
    s_lshl_b32 s32, s32, 19
    s_add_u32 s32, s32, 113246208
    s_lshr_b32 s33, s32, 21
    s_xor_b32 s33, s33, s22
    s_xor_b32 s33, s33, 1
    s_and_b32 s33, s33, 1
    s_lshl_b32 s33, s33, 13
    s_add_u32 s33, s33, s32
    s_add_u32 s38, s28, s33
    s_addc_u32 s39, s29, 0
    s_bfe_u32 s32, s36, 0x30001
    s_lshl_b32 s32, s32, 14
    s_and_b32 s33, s36, 1
    s_lshl_b32 s33, s33, 12
    s_add_u32 s32, s32, s33
    v_add_u32 v14, s32, v9
    global_load_dword v15, v14, s[28:29] sc1
    s_waitcnt vmcnt(16)
    v_mfma_f32_16x16x32_bf16 v[16:19], a[0:3], v[32:35], 0
    v_mfma_f32_16x16x32_bf16 v[20:23], a[4:7], v[32:35], 0
    v_mfma_f32_16x16x32_bf16 v[24:27], a[8:11], v[32:35], 0
    v_mfma_f32_16x16x32_bf16 v[28:31], a[12:15], v[32:35], 0
    global_load_dwordx4 v[32:35], v2, s[38:39] offset:0 sc1
    s_waitcnt vmcnt(16)
    v_mfma_f32_16x16x32_bf16 v[16:19], a[16:19], v[36:39], v[16:19]
    v_mfma_f32_16x16x32_bf16 v[20:23], a[20:23], v[36:39], v[20:23]
    v_mfma_f32_16x16x32_bf16 v[24:27], a[24:27], v[36:39], v[24:27]
    v_mfma_f32_16x16x32_bf16 v[28:31], a[28:31], v[36:39], v[28:31]
    global_load_dwordx4 v[36:39], v2, s[38:39] offset:1024 sc1
    s_waitcnt vmcnt(16)
    v_mfma_f32_16x16x32_bf16 v[16:19], a[32:35], v[40:43], v[16:19]
    v_mfma_f32_16x16x32_bf16 v[20:23], a[36:39], v[40:43], v[20:23]
    v_mfma_f32_16x16x32_bf16 v[24:27], a[40:43], v[40:43], v[24:27]
    v_mfma_f32_16x16x32_bf16 v[28:31], a[44:47], v[40:43], v[28:31]
    global_load_dwordx4 v[40:43], v2, s[38:39] offset:2048 sc1
    s_cmp_lt_i32 s35, 0
    s_cbranch_scc1 pd_50
    s_waitcnt lgkmcnt(0)
    s_barrier
    ds_read_b128 v[112:115], v12
    ds_read_b128 v[96:99], v12 offset:8192
    ds_read_b128 v[100:103], v12 offset:16384
    ds_read_b128 v[104:107], v12 offset:24576
    ds_read_b128 v[108:111], v12 offset:32768
    s_waitcnt lgkmcnt(3)
    v_pk_add_f32 v[112:113], v[112:113], v[96:97]
    v_pk_add_f32 v[114:115], v[114:115], v[98:99]
    s_waitcnt lgkmcnt(2)
    v_pk_add_f32 v[112:113], v[112:113], v[100:101]
    v_pk_add_f32 v[114:115], v[114:115], v[102:103]
    s_waitcnt lgkmcnt(1)
    v_pk_add_f32 v[112:113], v[112:113], v[104:105]
    v_pk_add_f32 v[114:115], v[114:115], v[106:107]
    s_waitcnt lgkmcnt(0)
    v_pk_add_f32 v[112:113], v[112:113], v[108:109]
    v_pk_add_f32 v[114:115], v[114:115], v[110:111]
    ds_read_b128 v[96:99], v12 offset:40960
    ds_read_b128 v[100:103], v12 offset:49152
    ds_read_b128 v[104:107], v12 offset:57344
    s_waitcnt lgkmcnt(2)
    v_pk_add_f32 v[112:113], v[112:113], v[96:97]
    v_pk_add_f32 v[114:115], v[114:115], v[98:99]
    s_waitcnt lgkmcnt(1)
    v_pk_add_f32 v[112:113], v[112:113], v[100:101]
    v_pk_add_f32 v[114:115], v[114:115], v[102:103]
    s_waitcnt lgkmcnt(0)
    v_pk_add_f32 v[112:113], v[112:113], v[104:105]
    v_pk_add_f32 v[114:115], v[114:115], v[106:107]
    v_xor_b32 v12, 0x10000, v12
    s_cmp_eq_u32 s47, 0
    s_cbranch_scc1 fn_51
    s_lshl_b32 s32, s35, 18
    s_add_u32 s32, s32, 148897792
    s_lshr_b32 s33, s32, 21
    s_xor_b32 s33, s33, s22
    s_xor_b32 s33, s33, 1
    s_and_b32 s33, s33, 1
    s_lshl_b32 s33, s33, 13
    s_add_u32 s33, s33, s32
    s_add_u32 s50, s28, s33
    s_addc_u32 s51, s29, 0
    v_min_u32 v112, -2, v112
    v_min_u32 v113, -2, v113
    v_min_u32 v114, -2, v114
    v_min_u32 v115, -2, v115
    global_store_dwordx4 v1, v[112:115], s[50:51] sc1
    s_branch fj_52
fn_51:
    s_mov_b32 s52, s35
fj_52:
pd_50:
    s_waitcnt vmcnt(16)
    v_mfma_f32_16x16x32_bf16 v[16:19], a[48:51], v[44:47], v[16:19]
    v_mfma_f32_16x16x32_bf16 v[20:23], a[52:55], v[44:47], v[20:23]
    v_mfma_f32_16x16x32_bf16 v[24:27], a[56:59], v[44:47], v[24:27]
    v_mfma_f32_16x16x32_bf16 v[28:31], a[60:63], v[44:47], v[28:31]
    global_load_dwordx4 v[44:47], v2, s[38:39] offset:3072 sc1
    s_waitcnt vmcnt(16)
    v_mfma_f32_16x16x32_bf16 v[16:19], a[64:67], v[48:51], v[16:19]
    v_mfma_f32_16x16x32_bf16 v[20:23], a[68:71], v[48:51], v[20:23]
    v_mfma_f32_16x16x32_bf16 v[24:27], a[72:75], v[48:51], v[24:27]
    v_mfma_f32_16x16x32_bf16 v[28:31], a[76:79], v[48:51], v[28:31]
    global_load_dwordx4 v[48:51], v3, s[38:39] offset:0 sc1
    s_waitcnt vmcnt(16)
    v_mfma_f32_16x16x32_bf16 v[16:19], a[80:83], v[52:55], v[16:19]
    v_mfma_f32_16x16x32_bf16 v[20:23], a[84:87], v[52:55], v[20:23]
    v_mfma_f32_16x16x32_bf16 v[24:27], a[88:91], v[52:55], v[24:27]
    v_mfma_f32_16x16x32_bf16 v[28:31], a[92:95], v[52:55], v[28:31]
    global_load_dwordx4 v[52:55], v3, s[38:39] offset:1024 sc1
    s_waitcnt vmcnt(16)
    v_mfma_f32_16x16x32_bf16 v[16:19], v[128:131], v[56:59], v[16:19]
    v_mfma_f32_16x16x32_bf16 v[20:23], v[132:135], v[56:59], v[20:23]
    v_mfma_f32_16x16x32_bf16 v[24:27], v[136:139], v[56:59], v[24:27]
    v_mfma_f32_16x16x32_bf16 v[28:31], v[140:143], v[56:59], v[28:31]
    global_load_dwordx4 v[56:59], v3, s[38:39] offset:2048 sc1
    s_waitcnt vmcnt(16)
    v_mfma_f32_16x16x32_bf16 v[16:19], v[144:147], v[60:63], v[16:19]
    v_mfma_f32_16x16x32_bf16 v[20:23], v[148:151], v[60:63], v[20:23]
    v_mfma_f32_16x16x32_bf16 v[24:27], v[152:155], v[60:63], v[24:27]
    v_mfma_f32_16x16x32_bf16 v[28:31], v[156:159], v[60:63], v[28:31]
    global_load_dwordx4 v[60:63], v3, s[38:39] offset:3072 sc1
    s_nop 4
    ds_write_b128 v11, v[16:19] offset:0
    ds_write_b128 v11, v[20:23] offset:1024
    ds_write_b128 v11, v[24:27] offset:2048
    ds_write_b128 v11, v[28:31] offset:3072
    s_waitcnt lgkmcnt(0)
    s_waitcnt vmcnt(16)
    v_mfma_f32_16x16x32_bf16 v[16:19], a[0:3], v[64:67], 0
    v_mfma_f32_16x16x32_bf16 v[20:23], a[4:7], v[64:67], 0
    v_mfma_f32_16x16x32_bf16 v[24:27], a[8:11], v[64:67], 0
    v_mfma_f32_16x16x32_bf16 v[28:31], a[12:15], v[64:67], 0
    global_load_dwordx4 v[64:67], v4, s[38:39] offset:0 sc1
    s_waitcnt vmcnt(16)
    v_mfma_f32_16x16x32_bf16 v[16:19], a[16:19], v[68:71], v[16:19]
    v_mfma_f32_16x16x32_bf16 v[20:23], a[20:23], v[68:71], v[20:23]
    v_mfma_f32_16x16x32_bf16 v[24:27], a[24:27], v[68:71], v[24:27]
    v_mfma_f32_16x16x32_bf16 v[28:31], a[28:31], v[68:71], v[28:31]
    global_load_dwordx4 v[68:71], v4, s[38:39] offset:1024 sc1
    s_waitcnt vmcnt(16)
    v_mfma_f32_16x16x32_bf16 v[16:19], a[32:35], v[72:75], v[16:19]
    v_mfma_f32_16x16x32_bf16 v[20:23], a[36:39], v[72:75], v[20:23]
    v_mfma_f32_16x16x32_bf16 v[24:27], a[40:43], v[72:75], v[24:27]
    v_mfma_f32_16x16x32_bf16 v[28:31], a[44:47], v[72:75], v[28:31]
    global_load_dwordx4 v[72:75], v4, s[38:39] offset:2048 sc1
    s_waitcnt vmcnt(16)
    v_mfma_f32_16x16x32_bf16 v[16:19], a[48:51], v[76:79], v[16:19]
    v_mfma_f32_16x16x32_bf16 v[20:23], a[52:55], v[76:79], v[20:23]
    v_mfma_f32_16x16x32_bf16 v[24:27], a[56:59], v[76:79], v[24:27]
    v_mfma_f32_16x16x32_bf16 v[28:31], a[60:63], v[76:79], v[28:31]
    global_load_dwordx4 v[76:79], v4, s[38:39] offset:3072 sc1
    s_waitcnt vmcnt(16)
    v_mfma_f32_16x16x32_bf16 v[16:19], a[64:67], v[80:83], v[16:19]
    v_mfma_f32_16x16x32_bf16 v[20:23], a[68:71], v[80:83], v[20:23]
    v_mfma_f32_16x16x32_bf16 v[24:27], a[72:75], v[80:83], v[24:27]
    v_mfma_f32_16x16x32_bf16 v[28:31], a[76:79], v[80:83], v[28:31]
    global_load_dwordx4 v[80:83], v5, s[38:39] offset:0 sc1
    s_waitcnt vmcnt(16)
    v_mfma_f32_16x16x32_bf16 v[16:19], a[80:83], v[84:87], v[16:19]
    v_mfma_f32_16x16x32_bf16 v[20:23], a[84:87], v[84:87], v[20:23]
    v_mfma_f32_16x16x32_bf16 v[24:27], a[88:91], v[84:87], v[24:27]
    v_mfma_f32_16x16x32_bf16 v[28:31], a[92:95], v[84:87], v[28:31]
    global_load_dwordx4 v[84:87], v5, s[38:39] offset:1024 sc1
    s_waitcnt vmcnt(16)
    v_mfma_f32_16x16x32_bf16 v[16:19], v[128:131], v[88:91], v[16:19]
    v_mfma_f32_16x16x32_bf16 v[20:23], v[132:135], v[88:91], v[20:23]
    v_mfma_f32_16x16x32_bf16 v[24:27], v[136:139], v[88:91], v[24:27]
    v_mfma_f32_16x16x32_bf16 v[28:31], v[140:143], v[88:91], v[28:31]
    s_cmp_lt_i32 s53, 0
    s_cbranch_scc1 jn_55
    s_lshl_b32 s32, s53, 17
    s_add_u32 s40, s24, s32
    s_addc_u32 s41, s25, 0
jl_53:
    v_max3_u32 v124, v120, v121, v122
    v_max_u32 v124, v124, v123
    v_cmp_eq_u32 vcc, -1, v124
    s_cbranch_vccz jo_54
    global_load_dwordx4 v[120:123], v1, s[50:51] sc1
    s_waitcnt vmcnt(0)
    s_add_u32 s46, s46, 1
    s_cmp_lt_u32 s46, 400000
    s_cbranch_scc1 jl_53
    s_branch w_fail
jo_54:
    v_pk_add_f32 v[116:117], v[116:117], v[120:121]
    v_pk_add_f32 v[118:119], v[118:119], v[122:123]
    v_cvt_pk_bf16_f32 v120, v116, v117
    v_cvt_pk_bf16_f32 v121, v118, v119
    global_store_dwordx2 v13, v[120:121], s[40:41]
    s_mov_b32 s53, -1
jn_55:
    s_cmp_lt_i32 s52, 0
    s_cbranch_scc1 an_56
    s_lshl_b32 s32, s52, 18
    s_add_u32 s32, s32, 148897792
    s_lshr_b32 s33, s32, 21
    s_xor_b32 s33, s33, s22
    s_xor_b32 s33, s33, 1
    s_and_b32 s33, s33, 1
    s_lshl_b32 s33, s33, 13
    s_add_u32 s33, s33, s32
    s_add_u32 s50, s28, s33
    s_addc_u32 s51, s29, 0
    global_load_dwordx4 v[120:123], v1, s[50:51] sc1
    v_mov_b32 v116, v112
    v_mov_b32 v117, v113
    v_mov_b32 v118, v114
    v_mov_b32 v119, v115
    s_mov_b32 s53, s52
    s_mov_b32 s52, -1
an_56:
    global_load_dwordx4 v[88:91], v5, s[38:39] offset:2048 sc1
    s_waitcnt vmcnt(16)
    v_mfma_f32_16x16x32_bf16 v[16:19], v[144:147], v[92:95], v[16:19]
    v_mfma_f32_16x16x32_bf16 v[20:23], v[148:151], v[92:95], v[20:23]
    v_mfma_f32_16x16x32_bf16 v[24:27], v[152:155], v[92:95], v[24:27]
    v_mfma_f32_16x16x32_bf16 v[28:31], v[156:159], v[92:95], v[28:31]
    global_load_dwordx4 v[92:95], v5, s[38:39] offset:3072 sc1
    s_nop 4
    ds_write_b128 v11, v[16:19] offset:4096
    ds_write_b128 v11, v[20:23] offset:5120
    ds_write_b128 v11, v[24:27] offset:6144
    ds_write_b128 v11, v[28:31] offset:7168
    v_xor_b32 v11, 0x10000, v11
    s_waitcnt lgkmcnt(0)
    s_mov_b32 s35, s30
    s_branch st_item
st_slow:
    s_cmp_lt_i32 s35, 0
    s_cbranch_scc1 pd_57
    s_waitcnt lgkmcnt(0)
    s_barrier
    ds_read_b128 v[112:115], v12
    ds_read_b128 v[96:99], v12 offset:8192
    ds_read_b128 v[100:103], v12 offset:16384
    ds_read_b128 v[104:107], v12 offset:24576
    ds_read_b128 v[108:111], v12 offset:32768
    s_waitcnt lgkmcnt(3)
    v_pk_add_f32 v[112:113], v[112:113], v[96:97]
    v_pk_add_f32 v[114:115], v[114:115], v[98:99]
    s_waitcnt lgkmcnt(2)
    v_pk_add_f32 v[112:113], v[112:113], v[100:101]
    v_pk_add_f32 v[114:115], v[114:115], v[102:103]
    s_waitcnt lgkmcnt(1)
    v_pk_add_f32 v[112:113], v[112:113], v[104:105]
    v_pk_add_f32 v[114:115], v[114:115], v[106:107]
    s_waitcnt lgkmcnt(0)
    v_pk_add_f32 v[112:113], v[112:113], v[108:109]
    v_pk_add_f32 v[114:115], v[114:115], v[110:111]
    ds_read_b128 v[96:99], v12 offset:40960
    ds_read_b128 v[100:103], v12 offset:49152
    ds_read_b128 v[104:107], v12 offset:57344
    s_waitcnt lgkmcnt(2)
    v_pk_add_f32 v[112:113], v[112:113], v[96:97]
    v_pk_add_f32 v[114:115], v[114:115], v[98:99]
    s_waitcnt lgkmcnt(1)
    v_pk_add_f32 v[112:113], v[112:113], v[100:101]
    v_pk_add_f32 v[114:115], v[114:115], v[102:103]
    s_waitcnt lgkmcnt(0)
    v_pk_add_f32 v[112:113], v[112:113], v[104:105]
    v_pk_add_f32 v[114:115], v[114:115], v[106:107]
    v_xor_b32 v12, 0x10000, v12
    s_cmp_eq_u32 s47, 0
    s_cbranch_scc1 fn_58
    s_lshl_b32 s32, s35, 18
    s_add_u32 s32, s32, 148897792
    s_lshr_b32 s33, s32, 21
    s_xor_b32 s33, s33, s22
    s_xor_b32 s33, s33, 1
    s_and_b32 s33, s33, 1
    s_lshl_b32 s33, s33, 13
    s_add_u32 s33, s33, s32
    s_add_u32 s50, s28, s33
    s_addc_u32 s51, s29, 0
    v_min_u32 v112, -2, v112
    v_min_u32 v113, -2, v113
    v_min_u32 v114, -2, v114
    v_min_u32 v115, -2, v115
    global_store_dwordx4 v1, v[112:115], s[50:51] sc1
    s_branch fj_59
fn_58:
    s_mov_b32 s52, s35
fj_59:
pd_57:
    s_waitcnt vmcnt(15)
    v_mfma_f32_16x16x32_bf16 v[16:19], a[0:3], v[32:35], 0
    v_mfma_f32_16x16x32_bf16 v[20:23], a[4:7], v[32:35], 0
    v_mfma_f32_16x16x32_bf16 v[24:27], a[8:11], v[32:35], 0
    v_mfma_f32_16x16x32_bf16 v[28:31], a[12:15], v[32:35], 0
    s_waitcnt vmcnt(14)
    v_mfma_f32_16x16x32_bf16 v[16:19], a[16:19], v[36:39], v[16:19]
    v_mfma_f32_16x16x32_bf16 v[20:23], a[20:23], v[36:39], v[20:23]
    v_mfma_f32_16x16x32_bf16 v[24:27], a[24:27], v[36:39], v[24:27]
    v_mfma_f32_16x16x32_bf16 v[28:31], a[28:31], v[36:39], v[28:31]
    s_waitcnt vmcnt(13)
    v_mfma_f32_16x16x32_bf16 v[16:19], a[32:35], v[40:43], v[16:19]
    v_mfma_f32_16x16x32_bf16 v[20:23], a[36:39], v[40:43], v[20:23]
    v_mfma_f32_16x16x32_bf16 v[24:27], a[40:43], v[40:43], v[24:27]
    v_mfma_f32_16x16x32_bf16 v[28:31], a[44:47], v[40:43], v[28:31]
    s_waitcnt vmcnt(12)
    v_mfma_f32_16x16x32_bf16 v[16:19], a[48:51], v[44:47], v[16:19]
    v_mfma_f32_16x16x32_bf16 v[20:23], a[52:55], v[44:47], v[20:23]
    v_mfma_f32_16x16x32_bf16 v[24:27], a[56:59], v[44:47], v[24:27]
    v_mfma_f32_16x16x32_bf16 v[28:31], a[60:63], v[44:47], v[28:31]
    s_waitcnt vmcnt(11)
    v_mfma_f32_16x16x32_bf16 v[16:19], a[64:67], v[48:51], v[16:19]
    v_mfma_f32_16x16x32_bf16 v[20:23], a[68:71], v[48:51], v[20:23]
    v_mfma_f32_16x16x32_bf16 v[24:27], a[72:75], v[48:51], v[24:27]
    v_mfma_f32_16x16x32_bf16 v[28:31], a[76:79], v[48:51], v[28:31]
    s_waitcnt vmcnt(10)
    v_mfma_f32_16x16x32_bf16 v[16:19], a[80:83], v[52:55], v[16:19]
    v_mfma_f32_16x16x32_bf16 v[20:23], a[84:87], v[52:55], v[20:23]
    v_mfma_f32_16x16x32_bf16 v[24:27], a[88:91], v[52:55], v[24:27]
    v_mfma_f32_16x16x32_bf16 v[28:31], a[92:95], v[52:55], v[28:31]
    s_waitcnt vmcnt(9)
    v_mfma_f32_16x16x32_bf16 v[16:19], v[128:131], v[56:59], v[16:19]
    v_mfma_f32_16x16x32_bf16 v[20:23], v[132:135], v[56:59], v[20:23]
    v_mfma_f32_16x16x32_bf16 v[24:27], v[136:139], v[56:59], v[24:27]
    v_mfma_f32_16x16x32_bf16 v[28:31], v[140:143], v[56:59], v[28:31]
    s_waitcnt vmcnt(8)
    v_mfma_f32_16x16x32_bf16 v[16:19], v[144:147], v[60:63], v[16:19]
    v_mfma_f32_16x16x32_bf16 v[20:23], v[148:151], v[60:63], v[20:23]
    v_mfma_f32_16x16x32_bf16 v[24:27], v[152:155], v[60:63], v[24:27]
    v_mfma_f32_16x16x32_bf16 v[28:31], v[156:159], v[60:63], v[28:31]
    s_nop 4
    ds_write_b128 v11, v[16:19] offset:0
    ds_write_b128 v11, v[20:23] offset:1024
    ds_write_b128 v11, v[24:27] offset:2048
    ds_write_b128 v11, v[28:31] offset:3072
    s_waitcnt lgkmcnt(0)
    s_waitcnt vmcnt(7)
    v_mfma_f32_16x16x32_bf16 v[16:19], a[0:3], v[64:67], 0
    v_mfma_f32_16x16x32_bf16 v[20:23], a[4:7], v[64:67], 0
    v_mfma_f32_16x16x32_bf16 v[24:27], a[8:11], v[64:67], 0
    v_mfma_f32_16x16x32_bf16 v[28:31], a[12:15], v[64:67], 0
    s_waitcnt vmcnt(6)
    v_mfma_f32_16x16x32_bf16 v[16:19], a[16:19], v[68:71], v[16:19]
    v_mfma_f32_16x16x32_bf16 v[20:23], a[20:23], v[68:71], v[20:23]
    v_mfma_f32_16x16x32_bf16 v[24:27], a[24:27], v[68:71], v[24:27]
    v_mfma_f32_16x16x32_bf16 v[28:31], a[28:31], v[68:71], v[28:31]
    s_waitcnt vmcnt(5)
    v_mfma_f32_16x16x32_bf16 v[16:19], a[32:35], v[72:75], v[16:19]
    v_mfma_f32_16x16x32_bf16 v[20:23], a[36:39], v[72:75], v[20:23]
    v_mfma_f32_16x16x32_bf16 v[24:27], a[40:43], v[72:75], v[24:27]
    v_mfma_f32_16x16x32_bf16 v[28:31], a[44:47], v[72:75], v[28:31]
    s_waitcnt vmcnt(4)
    v_mfma_f32_16x16x32_bf16 v[16:19], a[48:51], v[76:79], v[16:19]
    v_mfma_f32_16x16x32_bf16 v[20:23], a[52:55], v[76:79], v[20:23]
    v_mfma_f32_16x16x32_bf16 v[24:27], a[56:59], v[76:79], v[24:27]
    v_mfma_f32_16x16x32_bf16 v[28:31], a[60:63], v[76:79], v[28:31]
    s_waitcnt vmcnt(3)
    v_mfma_f32_16x16x32_bf16 v[16:19], a[64:67], v[80:83], v[16:19]
    v_mfma_f32_16x16x32_bf16 v[20:23], a[68:71], v[80:83], v[20:23]
    v_mfma_f32_16x16x32_bf16 v[24:27], a[72:75], v[80:83], v[24:27]
    v_mfma_f32_16x16x32_bf16 v[28:31], a[76:79], v[80:83], v[28:31]
    s_waitcnt vmcnt(2)
    v_mfma_f32_16x16x32_bf16 v[16:19], a[80:83], v[84:87], v[16:19]
    v_mfma_f32_16x16x32_bf16 v[20:23], a[84:87], v[84:87], v[20:23]
    v_mfma_f32_16x16x32_bf16 v[24:27], a[88:91], v[84:87], v[24:27]
    v_mfma_f32_16x16x32_bf16 v[28:31], a[92:95], v[84:87], v[28:31]
    s_waitcnt vmcnt(1)
    v_mfma_f32_16x16x32_bf16 v[16:19], v[128:131], v[88:91], v[16:19]
    v_mfma_f32_16x16x32_bf16 v[20:23], v[132:135], v[88:91], v[20:23]
    v_mfma_f32_16x16x32_bf16 v[24:27], v[136:139], v[88:91], v[24:27]
    v_mfma_f32_16x16x32_bf16 v[28:31], v[140:143], v[88:91], v[28:31]
    s_waitcnt vmcnt(0)
    v_mfma_f32_16x16x32_bf16 v[16:19], v[144:147], v[92:95], v[16:19]
    v_mfma_f32_16x16x32_bf16 v[20:23], v[148:151], v[92:95], v[20:23]
    v_mfma_f32_16x16x32_bf16 v[24:27], v[152:155], v[92:95], v[24:27]
    v_mfma_f32_16x16x32_bf16 v[28:31], v[156:159], v[92:95], v[28:31]
    s_nop 4
    ds_write_b128 v11, v[16:19] offset:4096
    ds_write_b128 v11, v[20:23] offset:5120
    ds_write_b128 v11, v[24:27] offset:6144
    ds_write_b128 v11, v[28:31] offset:7168
    v_xor_b32 v11, 0x10000, v11
    s_waitcnt lgkmcnt(0)
    s_cmp_lt_i32 s53, 0
    s_cbranch_scc1 jn_62
    s_lshl_b32 s32, s53, 17
    s_add_u32 s40, s24, s32
    s_addc_u32 s41, s25, 0
jl_60:
    v_max3_u32 v124, v120, v121, v122
    v_max_u32 v124, v124, v123
    v_cmp_eq_u32 vcc, -1, v124
    s_cbranch_vccz jo_61
    global_load_dwordx4 v[120:123], v1, s[50:51] sc1
    s_waitcnt vmcnt(0)
    s_add_u32 s46, s46, 1
    s_cmp_lt_u32 s46, 400000
    s_cbranch_scc1 jl_60
    s_branch w_fail
jo_61:
    v_pk_add_f32 v[116:117], v[116:117], v[120:121]
    v_pk_add_f32 v[118:119], v[118:119], v[122:123]
    v_cvt_pk_bf16_f32 v120, v116, v117
    v_cvt_pk_bf16_f32 v121, v118, v119
    global_store_dwordx2 v13, v[120:121], s[40:41]
    s_mov_b32 s53, -1
jn_62:
    s_cmp_lt_i32 s52, 0
    s_cbranch_scc1 an_63
    s_lshl_b32 s32, s52, 18
    s_add_u32 s32, s32, 148897792
    s_lshr_b32 s33, s32, 21
    s_xor_b32 s33, s33, s22
    s_xor_b32 s33, s33, 1
    s_and_b32 s33, s33, 1
    s_lshl_b32 s33, s33, 13
    s_add_u32 s33, s33, s32
    s_add_u32 s50, s28, s33
    s_addc_u32 s51, s29, 0
    global_load_dwordx4 v[120:123], v1, s[50:51] sc1
    v_mov_b32 v116, v112
    v_mov_b32 v117, v113
    v_mov_b32 v118, v114
    v_mov_b32 v119, v115
    s_mov_b32 s53, s52
    s_mov_b32 s52, -1
an_63:
    s_waitcnt lgkmcnt(0)
    s_barrier
    ds_read_b128 v[112:115], v12
    ds_read_b128 v[96:99], v12 offset:8192
    ds_read_b128 v[100:103], v12 offset:16384
    ds_read_b128 v[104:107], v12 offset:24576
    ds_read_b128 v[108:111], v12 offset:32768
    s_waitcnt lgkmcnt(3)
    v_pk_add_f32 v[112:113], v[112:113], v[96:97]
    v_pk_add_f32 v[114:115], v[114:115], v[98:99]
    s_waitcnt lgkmcnt(2)
    v_pk_add_f32 v[112:113], v[112:113], v[100:101]
    v_pk_add_f32 v[114:115], v[114:115], v[102:103]
    s_waitcnt lgkmcnt(1)
    v_pk_add_f32 v[112:113], v[112:113], v[104:105]
    v_pk_add_f32 v[114:115], v[114:115], v[106:107]
    s_waitcnt lgkmcnt(0)
    v_pk_add_f32 v[112:113], v[112:113], v[108:109]
    v_pk_add_f32 v[114:115], v[114:115], v[110:111]
    ds_read_b128 v[96:99], v12 offset:40960
    ds_read_b128 v[100:103], v12 offset:49152
    ds_read_b128 v[104:107], v12 offset:57344
    s_waitcnt lgkmcnt(2)
    v_pk_add_f32 v[112:113], v[112:113], v[96:97]
    v_pk_add_f32 v[114:115], v[114:115], v[98:99]
    s_waitcnt lgkmcnt(1)
    v_pk_add_f32 v[112:113], v[112:113], v[100:101]
    v_pk_add_f32 v[114:115], v[114:115], v[102:103]
    s_waitcnt lgkmcnt(0)
    v_pk_add_f32 v[112:113], v[112:113], v[104:105]
    v_pk_add_f32 v[114:115], v[114:115], v[106:107]
    v_xor_b32 v12, 0x10000, v12
    s_cmp_eq_u32 s47, 0
    s_cbranch_scc1 fn_64
    s_lshl_b32 s32, s30, 18
    s_add_u32 s32, s32, 148897792
    s_lshr_b32 s33, s32, 21
    s_xor_b32 s33, s33, s22
    s_xor_b32 s33, s33, 1
    s_and_b32 s33, s33, 1
    s_lshl_b32 s33, s33, 13
    s_add_u32 s33, s33, s32
    s_add_u32 s50, s28, s33
    s_addc_u32 s51, s29, 0
    v_min_u32 v112, -2, v112
    v_min_u32 v113, -2, v113
    v_min_u32 v114, -2, v114
    v_min_u32 v115, -2, v115
    global_store_dwordx4 v1, v[112:115], s[50:51] sc1
    s_branch fj_65
fn_64:
    s_mov_b32 s52, s30
fj_65:
    s_cmp_lt_i32 s53, 0
    s_cbranch_scc1 jn_68
    s_lshl_b32 s32, s53, 17
    s_add_u32 s40, s24, s32
    s_addc_u32 s41, s25, 0
    s_waitcnt vmcnt(0)
jl_66:
    v_max3_u32 v124, v120, v121, v122
    v_max_u32 v124, v124, v123
    v_cmp_eq_u32 vcc, -1, v124
    s_cbranch_vccz jo_67
    global_load_dwordx4 v[120:123], v1, s[50:51] sc1
    s_waitcnt vmcnt(0)
    s_add_u32 s46, s46, 1
    s_cmp_lt_u32 s46, 400000
    s_cbranch_scc1 jl_66
    s_branch w_fail
jo_67:
    v_pk_add_f32 v[116:117], v[116:117], v[120:121]
    v_pk_add_f32 v[118:119], v[118:119], v[122:123]
    v_cvt_pk_bf16_f32 v120, v116, v117
    v_cvt_pk_bf16_f32 v121, v118, v119
    global_store_dwordx2 v13, v[120:121], s[40:41]
    s_mov_b32 s53, -1
jn_68:
    s_cmp_lt_i32 s52, 0
    s_cbranch_scc1 an_69
    s_lshl_b32 s32, s52, 18
    s_add_u32 s32, s32, 148897792
    s_lshr_b32 s33, s32, 21
    s_xor_b32 s33, s33, s22
    s_xor_b32 s33, s33, 1
    s_and_b32 s33, s33, 1
    s_lshl_b32 s33, s33, 13
    s_add_u32 s33, s33, s32
    s_add_u32 s50, s28, s33
    s_addc_u32 s51, s29, 0
    global_load_dwordx4 v[120:123], v1, s[50:51] sc1
    v_mov_b32 v116, v112
    v_mov_b32 v117, v113
    v_mov_b32 v118, v114
    v_mov_b32 v119, v115
    s_mov_b32 s53, s52
    s_mov_b32 s52, -1
an_69:
    s_cmp_lt_i32 s53, 0
    s_cbranch_scc1 jn_72
    s_lshl_b32 s32, s53, 17
    s_add_u32 s40, s24, s32
    s_addc_u32 s41, s25, 0
    s_waitcnt vmcnt(0)
jl_70:
    v_max3_u32 v124, v120, v121, v122
    v_max_u32 v124, v124, v123
    v_cmp_eq_u32 vcc, -1, v124
    s_cbranch_vccz jo_71
    global_load_dwordx4 v[120:123], v1, s[50:51] sc1
    s_waitcnt vmcnt(0)
    s_add_u32 s46, s46, 1
    s_cmp_lt_u32 s46, 400000
    s_cbranch_scc1 jl_70
    s_branch w_fail
jo_71:
    v_pk_add_f32 v[116:117], v[116:117], v[120:121]
    v_pk_add_f32 v[118:119], v[118:119], v[122:123]
    v_cvt_pk_bf16_f32 v120, v116, v117
    v_cvt_pk_bf16_f32 v121, v118, v119
    global_store_dwordx2 v13, v[120:121], s[40:41]
    s_mov_b32 s53, -1
jn_72:
    s_cmp_lt_i32 s31, 0
    s_cbranch_scc0 st_wait
    s_endpgm
w_fail:
    v_mov_b32 v16, 0
    v_mov_b32 v17, 0xdead
    global_store_dword v16, v17, s[26:27] offset:248
w_exit:
    s_endpgm
core_T:
    s_mov_b32 s84, 0
    s_mov_b32 s85, 0
    s_mov_b64 s[60:61], s[80:81]
    s_mov_b64 s[62:63], s[82:83]
    s_barrier
    s_add_u32 m0, s76, 0
    s_nop 0
    global_load_lds_dwordx4 v28, s[60:61]
    s_add_u32 m0, s76, 1024
    s_nop 0
    global_load_lds_dwordx4 v29, s[60:61]
    s_add_u32 m0, s76, 2048
    s_nop 0
    global_load_lds_dwordx4 v30, s[60:61]
    s_add_u32 m0, s76, 3072
    s_nop 0
    global_load_lds_dwordx4 v31, s[60:61]
    s_or_b32 s84, s84, s86
    s_add_u32 s84, s84, s64
    s_andn2_b32 s84, s84, s86
    s_add_u32 s60, s80, s84
    s_addc_u32 s61, s81, 0
    s_add_u32 m0, s67, 65536
    s_nop 0
    global_load_lds_dwordx4 v4, s[62:63]
    s_add_u32 m0, s67, 66560
    s_nop 0
    global_load_lds_dwordx4 v5, s[62:63]
    s_or_b32 s85, s85, s87
    s_add_u32 s85, s85, s65
    s_andn2_b32 s85, s85, s87
    s_add_u32 s62, s82, s85
    s_addc_u32 s63, s83, 0
    s_add_u32 m0, s67, 81920
    s_nop 0
    global_load_lds_dwordx4 v4, s[62:63]
    s_add_u32 m0, s67, 82944
    s_nop 0
    global_load_lds_dwordx4 v5, s[62:63]
    s_or_b32 s85, s85, s87
    s_add_u32 s85, s85, s65
    s_andn2_b32 s85, s85, s87
    s_add_u32 s62, s82, s85
    s_addc_u32 s63, s83, 0
    s_add_u32 m0, s67, 98304
    s_nop 0
    global_load_lds_dwordx4 v4, s[62:63]
    s_add_u32 m0, s67, 99328
    s_nop 0
    global_load_lds_dwordx4 v5, s[62:63]
    s_or_b32 s85, s85, s87
    s_add_u32 s85, s85, s65
    s_andn2_b32 s85, s85, s87
    s_add_u32 s62, s82, s85
    s_addc_u32 s63, s83, 0
    s_add_u32 m0, s76, 32768
    s_nop 0
    global_load_lds_dwordx4 v28, s[60:61]
    s_add_u32 m0, s76, 33792
    s_nop 0
    global_load_lds_dwordx4 v29, s[60:61]
    s_add_u32 m0, s76, 34816
    s_nop 0
    global_load_lds_dwordx4 v30, s[60:61]
    s_add_u32 m0, s76, 35840
    s_nop 0
    global_load_lds_dwordx4 v31, s[60:61]
    s_or_b32 s84, s84, s86
    s_add_u32 s84, s84, s64
    s_andn2_b32 s84, s84, s86
    s_add_u32 s60, s80, s84
    s_addc_u32 s61, s81, 0
    s_add_u32 m0, s67, 114688
    s_nop 0
    global_load_lds_dwordx4 v4, s[62:63]
    s_add_u32 m0, s67, 115712
    s_nop 0
    global_load_lds_dwordx4 v5, s[62:63]
    s_or_b32 s85, s85, s87
    s_add_u32 s85, s85, s65
    s_andn2_b32 s85, s85, s87
    s_add_u32 s62, s82, s85
    s_addc_u32 s63, s83, 0
    s_cmp_eq_u32 s77, 0
    s_cbranch_scc1 ps_73
    v_cvt_pk_bf16_f32 v24, v32, v33
    v_cvt_pk_bf16_f32 v25, v34, v35
    v_cvt_pk_bf16_f32 v26, v36, v37
    v_cvt_pk_bf16_f32 v27, v38, v39
    global_store_dwordx4 v20, v[24:27], s[28:29] offset:0 sc1
    v_cvt_pk_bf16_f32 v16, v40, v41
    v_cvt_pk_bf16_f32 v17, v42, v43
    v_cvt_pk_bf16_f32 v18, v44, v45
    v_cvt_pk_bf16_f32 v19, v46, v47
    global_store_dwordx4 v20, v[16:19], s[28:29] offset:1024 sc1
    v_cvt_pk_bf16_f32 v24, v48, v49
    v_cvt_pk_bf16_f32 v25, v50, v51
    v_cvt_pk_bf16_f32 v26, v52, v53
    v_cvt_pk_bf16_f32 v27, v54, v55
    global_store_dwordx4 v20, v[24:27], s[28:29] offset:2048 sc1
    v_cvt_pk_bf16_f32 v16, v56, v57
    v_cvt_pk_bf16_f32 v17, v58, v59
    v_cvt_pk_bf16_f32 v18, v60, v61
    v_cvt_pk_bf16_f32 v19, v62, v63
    global_store_dwordx4 v20, v[16:19], s[28:29] offset:3072 sc1
    v_cvt_pk_bf16_f32 v24, v64, v65
    v_cvt_pk_bf16_f32 v25, v66, v67
    v_cvt_pk_bf16_f32 v26, v68, v69
    v_cvt_pk_bf16_f32 v27, v70, v71
    global_store_dwordx4 v21, v[24:27], s[28:29] offset:0 sc1
    v_cvt_pk_bf16_f32 v16, v72, v73
    v_cvt_pk_bf16_f32 v17, v74, v75
    v_cvt_pk_bf16_f32 v18, v76, v77
    v_cvt_pk_bf16_f32 v19, v78, v79
    global_store_dwordx4 v21, v[16:19], s[28:29] offset:1024 sc1
    v_cvt_pk_bf16_f32 v24, v80, v81
    v_cvt_pk_bf16_f32 v25, v82, v83
    v_cvt_pk_bf16_f32 v26, v84, v85
    v_cvt_pk_bf16_f32 v27, v86, v87
    global_store_dwordx4 v21, v[24:27], s[28:29] offset:2048 sc1
    v_cvt_pk_bf16_f32 v16, v88, v89
    v_cvt_pk_bf16_f32 v17, v90, v91
    v_cvt_pk_bf16_f32 v18, v92, v93
    v_cvt_pk_bf16_f32 v19, v94, v95
    global_store_dwordx4 v21, v[16:19], s[28:29] offset:3072 sc1
    v_cvt_pk_bf16_f32 v24, v96, v97
    v_cvt_pk_bf16_f32 v25, v98, v99
    v_cvt_pk_bf16_f32 v26, v100, v101
    v_cvt_pk_bf16_f32 v27, v102, v103
    global_store_dwordx4 v22, v[24:27], s[28:29] offset:0 sc1
    v_cvt_pk_bf16_f32 v16, v104, v105
    v_cvt_pk_bf16_f32 v17, v106, v107
    v_cvt_pk_bf16_f32 v18, v108, v109
    v_cvt_pk_bf16_f32 v19, v110, v111
    global_store_dwordx4 v22, v[16:19], s[28:29] offset:1024 sc1
    v_cvt_pk_bf16_f32 v24, v112, v113
    v_cvt_pk_bf16_f32 v25, v114, v115
    v_cvt_pk_bf16_f32 v26, v116, v117
    v_cvt_pk_bf16_f32 v27, v118, v119
    global_store_dwordx4 v22, v[24:27], s[28:29] offset:2048 sc1
    v_cvt_pk_bf16_f32 v16, v120, v121
    v_cvt_pk_bf16_f32 v17, v122, v123
    v_cvt_pk_bf16_f32 v18, v124, v125
    v_cvt_pk_bf16_f32 v19, v126, v127
    global_store_dwordx4 v22, v[16:19], s[28:29] offset:3072 sc1
ps_73:
core_T_m:
    v_mov_b32 v32, 0
    v_mov_b32 v33, 0
    v_mov_b32 v34, 0
    v_mov_b32 v35, 0
    v_mov_b32 v36, 0
    v_mov_b32 v37, 0
    v_mov_b32 v38, 0
    v_mov_b32 v39, 0
    v_mov_b32 v40, 0
    v_mov_b32 v41, 0
    v_mov_b32 v42, 0
    v_mov_b32 v43, 0
    v_mov_b32 v44, 0
    v_mov_b32 v45, 0
    v_mov_b32 v46, 0
    v_mov_b32 v47, 0
    v_mov_b32 v48, 0
    v_mov_b32 v49, 0
    v_mov_b32 v50, 0
    v_mov_b32 v51, 0
    v_mov_b32 v52, 0
    v_mov_b32 v53, 0
    v_mov_b32 v54, 0
    v_mov_b32 v55, 0
    v_mov_b32 v56, 0
    v_mov_b32 v57, 0
    v_mov_b32 v58, 0
    v_mov_b32 v59, 0
    v_mov_b32 v60, 0
    v_mov_b32 v61, 0
    v_mov_b32 v62, 0
    v_mov_b32 v63, 0
    v_mov_b32 v64, 0
    v_mov_b32 v65, 0
    v_mov_b32 v66, 0
    v_mov_b32 v67, 0
    v_mov_b32 v68, 0
    v_mov_b32 v69, 0
    v_mov_b32 v70, 0
    v_mov_b32 v71, 0
    v_mov_b32 v72, 0
    v_mov_b32 v73, 0
    v_mov_b32 v74, 0
    v_mov_b32 v75, 0
    v_mov_b32 v76, 0
    v_mov_b32 v77, 0
    v_mov_b32 v78, 0
    v_mov_b32 v79, 0
    v_mov_b32 v80, 0
    v_mov_b32 v81, 0
    v_mov_b32 v82, 0
    v_mov_b32 v83, 0
    v_mov_b32 v84, 0
    v_mov_b32 v85, 0
    v_mov_b32 v86, 0
    v_mov_b32 v87, 0
    v_mov_b32 v88, 0
    v_mov_b32 v89, 0
    v_mov_b32 v90, 0
    v_mov_b32 v91, 0
    v_mov_b32 v92, 0
    v_mov_b32 v93, 0
    v_mov_b32 v94, 0
    v_mov_b32 v95, 0
    v_mov_b32 v96, 0
    v_mov_b32 v97, 0
    v_mov_b32 v98, 0
    v_mov_b32 v99, 0
    v_mov_b32 v100, 0
    v_mov_b32 v101, 0
    v_mov_b32 v102, 0
    v_mov_b32 v103, 0
    v_mov_b32 v104, 0
    v_mov_b32 v105, 0
    v_mov_b32 v106, 0
    v_mov_b32 v107, 0
    v_mov_b32 v108, 0
    v_mov_b32 v109, 0
    v_mov_b32 v110, 0
    v_mov_b32 v111, 0
    v_mov_b32 v112, 0
    v_mov_b32 v113, 0
    v_mov_b32 v114, 0
    v_mov_b32 v115, 0
    v_mov_b32 v116, 0
    v_mov_b32 v117, 0
    v_mov_b32 v118, 0
    v_mov_b32 v119, 0
    v_mov_b32 v120, 0
    v_mov_b32 v121, 0
    v_mov_b32 v122, 0
    v_mov_b32 v123, 0
    v_mov_b32 v124, 0
    v_mov_b32 v125, 0
    v_mov_b32 v126, 0
    v_mov_b32 v127, 0
    v_mov_b32 v128, 0
    v_mov_b32 v129, 0
    v_mov_b32 v130, 0
    v_mov_b32 v131, 0
    v_mov_b32 v132, 0
    v_mov_b32 v133, 0
    v_mov_b32 v134, 0
    v_mov_b32 v135, 0
    v_mov_b32 v136, 0
    v_mov_b32 v137, 0
    v_mov_b32 v138, 0
    v_mov_b32 v139, 0
    v_mov_b32 v140, 0
    v_mov_b32 v141, 0
    v_mov_b32 v142, 0
    v_mov_b32 v143, 0
    v_mov_b32 v144, 0
    v_mov_b32 v145, 0
    v_mov_b32 v146, 0
    v_mov_b32 v147, 0
    v_mov_b32 v148, 0
    v_mov_b32 v149, 0
    v_mov_b32 v150, 0
    v_mov_b32 v151, 0
    v_mov_b32 v152, 0
    v_mov_b32 v153, 0
    v_mov_b32 v154, 0
    v_mov_b32 v155, 0
    v_mov_b32 v156, 0
    v_mov_b32 v157, 0
    v_mov_b32 v158, 0
    v_mov_b32 v159, 0
    s_cmp_eq_u32 s77, 0
    s_cbranch_scc1 cw_74
    s_waitcnt vmcnt(22)
    s_branch cw_75
cw_74:
    s_waitcnt vmcnt(10)
cw_75:
    s_barrier
    ds_read_b128 a[0:3], v6 offset:0
    ds_read_b128 a[4:7], v6 offset:2048
    ds_read_b128 a[8:11], v6 offset:4096
    ds_read_b128 a[12:15], v6 offset:6144
    ds_read_b64_tr_b16 a[32:33], v8 offset:0
    ds_read_b64_tr_b16 a[34:35], v8 offset:2048
    ds_read_b64_tr_b16 a[36:37], v9 offset:0
    ds_read_b64_tr_b16 a[38:39], v9 offset:2048
    ds_read_b64_tr_b16 a[40:41], v10 offset:0
    ds_read_b64_tr_b16 a[42:43], v10 offset:2048
    ds_read_b64_tr_b16 a[44:45], v11 offset:0
    ds_read_b64_tr_b16 a[46:47], v11 offset:2048
    s_waitcnt lgkmcnt(4)
    ds_read_b64_tr_b16 a[48:49], v12 offset:0
    ds_read_b64_tr_b16 a[50:51], v12 offset:2048
    ds_read_b64_tr_b16 a[52:53], v13 offset:0
    ds_read_b64_tr_b16 a[54:55], v13 offset:2048
    ds_read_b64_tr_b16 a[56:57], v14 offset:0
    ds_read_b64_tr_b16 a[58:59], v14 offset:2048
    ds_read_b64_tr_b16 a[60:61], v15 offset:0
    ds_read_b64_tr_b16 a[62:63], v15 offset:2048
    s_cmp_eq_u32 s77, 0
    s_cbranch_scc1 cw_76
    s_waitcnt vmcnt(20) lgkmcnt(0)
    s_branch cw_77
cw_76:
    s_waitcnt vmcnt(8) lgkmcnt(0)
cw_77:
    s_barrier
    v_mfma_f32_16x16x32_bf16 v[32:35], a[32:35], a[0:3], v[32:35]
    s_add_u32 m0, s67, 65536
    ds_read_b128 a[16:19], v7 offset:0
    v_mfma_f32_16x16x32_bf16 v[64:67], a[32:35], a[4:7], v[64:67]
    global_load_lds_dwordx4 v4, s[62:63]
    ds_read_b128 a[20:23], v7 offset:2048
    v_mfma_f32_16x16x32_bf16 v[96:99], a[32:35], a[8:11], v[96:99]
    ds_read_b128 a[24:27], v7 offset:4096
    v_mfma_f32_16x16x32_bf16 v[128:131], a[32:35], a[12:15], v[128:131]
    ds_read_b64_tr_b16 a[32:33], v8 offset:16384
    ds_read_b64_tr_b16 a[34:35], v8 offset:18432
    v_mfma_f32_16x16x32_bf16 v[36:39], a[36:39], a[0:3], v[36:39]
    s_add_u32 m0, s67, 66560
    ds_read_b128 a[28:31], v7 offset:6144
    v_mfma_f32_16x16x32_bf16 v[68:71], a[36:39], a[4:7], v[68:71]
    global_load_lds_dwordx4 v5, s[62:63]
    ds_read_b64_tr_b16 a[64:65], v9 offset:16384
    v_mfma_f32_16x16x32_bf16 v[100:103], a[36:39], a[8:11], v[100:103]
    ds_read_b64_tr_b16 a[66:67], v9 offset:18432
    v_mfma_f32_16x16x32_bf16 v[132:135], a[36:39], a[12:15], v[132:135]
    v_mfma_f32_16x16x32_bf16 v[40:43], a[40:43], a[0:3], v[40:43]
    ds_read_b64_tr_b16 a[68:69], v10 offset:16384
    v_mfma_f32_16x16x32_bf16 v[72:75], a[40:43], a[4:7], v[72:75]
    ds_read_b64_tr_b16 a[70:71], v10 offset:18432
    v_mfma_f32_16x16x32_bf16 v[104:107], a[40:43], a[8:11], v[104:107]
    v_mfma_f32_16x16x32_bf16 v[136:139], a[40:43], a[12:15], v[136:139]
    ds_read_b64_tr_b16 a[72:73], v11 offset:16384
    v_mfma_f32_16x16x32_bf16 v[44:47], a[44:47], a[0:3], v[44:47]
    ds_read_b64_tr_b16 a[74:75], v11 offset:18432
    v_mfma_f32_16x16x32_bf16 v[76:79], a[44:47], a[4:7], v[76:79]
    ds_read_b64_tr_b16 a[76:77], v12 offset:16384
    v_mfma_f32_16x16x32_bf16 v[108:111], a[44:47], a[8:11], v[108:111]
    v_mfma_f32_16x16x32_bf16 v[140:143], a[44:47], a[12:15], v[140:143]
    s_waitcnt lgkmcnt(6)
    ds_read_b64_tr_b16 a[78:79], v12 offset:18432
    v_mfma_f32_16x16x32_bf16 v[48:51], a[48:51], a[0:3], v[48:51]
    ds_read_b64_tr_b16 a[80:81], v13 offset:16384
    v_mfma_f32_16x16x32_bf16 v[80:83], a[48:51], a[4:7], v[80:83]
    v_mfma_f32_16x16x32_bf16 v[112:115], a[48:51], a[8:11], v[112:115]
    ds_read_b64_tr_b16 a[82:83], v13 offset:18432
    v_mfma_f32_16x16x32_bf16 v[144:147], a[48:51], a[12:15], v[144:147]
    ds_read_b64_tr_b16 a[84:85], v14 offset:16384
    v_mfma_f32_16x16x32_bf16 v[52:55], a[52:55], a[0:3], v[52:55]
    ds_read_b64_tr_b16 a[86:87], v14 offset:18432
    v_mfma_f32_16x16x32_bf16 v[84:87], a[52:55], a[4:7], v[84:87]
    v_mfma_f32_16x16x32_bf16 v[116:119], a[52:55], a[8:11], v[116:119]
    ds_read_b64_tr_b16 a[88:89], v15 offset:16384
    v_mfma_f32_16x16x32_bf16 v[148:151], a[52:55], a[12:15], v[148:151]
    ds_read_b64_tr_b16 a[90:91], v15 offset:18432
    v_mfma_f32_16x16x32_bf16 v[56:59], a[56:59], a[0:3], v[56:59]
    s_or_b32 s85, s85, s87
    s_add_u32 s85, s85, s65
    s_andn2_b32 s85, s85, s87
    s_add_u32 s62, s82, s85
    s_addc_u32 s63, s83, 0
    v_mfma_f32_16x16x32_bf16 v[88:91], a[56:59], a[4:7], v[88:91]
    v_mfma_f32_16x16x32_bf16 v[120:123], a[56:59], a[8:11], v[120:123]
    v_mfma_f32_16x16x32_bf16 v[152:155], a[56:59], a[12:15], v[152:155]
    v_mfma_f32_16x16x32_bf16 v[60:63], a[60:63], a[0:3], v[60:63]
    v_mfma_f32_16x16x32_bf16 v[92:95], a[60:63], a[4:7], v[92:95]
    v_mfma_f32_16x16x32_bf16 v[124:127], a[60:63], a[8:11], v[124:127]
    v_mfma_f32_16x16x32_bf16 v[156:159], a[60:63], a[12:15], v[156:159]
    s_cmp_eq_u32 s77, 0
    s_cbranch_scc1 cw_78
    s_waitcnt vmcnt(16) lgkmcnt(0)
    s_branch cw_79
cw_78:
    s_waitcnt vmcnt(4) lgkmcnt(0)
cw_79:
    s_barrier
    v_mfma_f32_16x16x32_bf16 v[32:35], a[32:35], a[16:19], v[32:35]
    s_add_u32 m0, s76, 0
    ds_read_b128 a[0:3], v6 offset:32768
    v_mfma_f32_16x16x32_bf16 v[64:67], a[32:35], a[20:23], v[64:67]
    global_load_lds_dwordx4 v28, s[60:61]
    ds_read_b128 a[4:7], v6 offset:34816
    v_mfma_f32_16x16x32_bf16 v[96:99], a[32:35], a[24:27], v[96:99]
    ds_read_b128 a[8:11], v6 offset:36864
    v_mfma_f32_16x16x32_bf16 v[128:131], a[32:35], a[28:31], v[128:131]
    ds_read_b64_tr_b16 a[32:33], v8 offset:32768
    ds_read_b64_tr_b16 a[34:35], v8 offset:34816
    v_mfma_f32_16x16x32_bf16 v[36:39], a[64:67], a[16:19], v[36:39]
    s_add_u32 m0, s76, 1024
    ds_read_b128 a[12:15], v6 offset:38912
    v_mfma_f32_16x16x32_bf16 v[68:71], a[64:67], a[20:23], v[68:71]
    global_load_lds_dwordx4 v29, s[60:61]
    ds_read_b64_tr_b16 a[36:37], v9 offset:32768
    v_mfma_f32_16x16x32_bf16 v[100:103], a[64:67], a[24:27], v[100:103]
    ds_read_b64_tr_b16 a[38:39], v9 offset:34816
    v_mfma_f32_16x16x32_bf16 v[132:135], a[64:67], a[28:31], v[132:135]
    v_mfma_f32_16x16x32_bf16 v[40:43], a[68:71], a[16:19], v[40:43]
    s_add_u32 m0, s76, 2048
    ds_read_b64_tr_b16 a[40:41], v10 offset:32768
    v_mfma_f32_16x16x32_bf16 v[72:75], a[68:71], a[20:23], v[72:75]
    global_load_lds_dwordx4 v30, s[60:61]
    ds_read_b64_tr_b16 a[42:43], v10 offset:34816
    v_mfma_f32_16x16x32_bf16 v[104:107], a[68:71], a[24:27], v[104:107]
    v_mfma_f32_16x16x32_bf16 v[136:139], a[68:71], a[28:31], v[136:139]
    ds_read_b64_tr_b16 a[44:45], v11 offset:32768
    v_mfma_f32_16x16x32_bf16 v[44:47], a[72:75], a[16:19], v[44:47]
    s_add_u32 m0, s76, 3072
    ds_read_b64_tr_b16 a[46:47], v11 offset:34816
    v_mfma_f32_16x16x32_bf16 v[76:79], a[72:75], a[20:23], v[76:79]
    global_load_lds_dwordx4 v31, s[60:61]
    ds_read_b64_tr_b16 a[48:49], v12 offset:32768
    v_mfma_f32_16x16x32_bf16 v[108:111], a[72:75], a[24:27], v[108:111]
    v_mfma_f32_16x16x32_bf16 v[140:143], a[72:75], a[28:31], v[140:143]
    s_waitcnt lgkmcnt(6)
    ds_read_b64_tr_b16 a[50:51], v12 offset:34816
    v_mfma_f32_16x16x32_bf16 v[48:51], a[76:79], a[16:19], v[48:51]
    s_add_u32 m0, s67, 81920
    ds_read_b64_tr_b16 a[52:53], v13 offset:32768
    v_mfma_f32_16x16x32_bf16 v[80:83], a[76:79], a[20:23], v[80:83]
    global_load_lds_dwordx4 v4, s[62:63]
    v_mfma_f32_16x16x32_bf16 v[112:115], a[76:79], a[24:27], v[112:115]
    ds_read_b64_tr_b16 a[54:55], v13 offset:34816
    v_mfma_f32_16x16x32_bf16 v[144:147], a[76:79], a[28:31], v[144:147]
    ds_read_b64_tr_b16 a[56:57], v14 offset:32768
    v_mfma_f32_16x16x32_bf16 v[52:55], a[80:83], a[16:19], v[52:55]
    s_add_u32 m0, s67, 82944
    ds_read_b64_tr_b16 a[58:59], v14 offset:34816
    v_mfma_f32_16x16x32_bf16 v[84:87], a[80:83], a[20:23], v[84:87]
    global_load_lds_dwordx4 v5, s[62:63]
    v_mfma_f32_16x16x32_bf16 v[116:119], a[80:83], a[24:27], v[116:119]
    ds_read_b64_tr_b16 a[60:61], v15 offset:32768
    v_mfma_f32_16x16x32_bf16 v[148:151], a[80:83], a[28:31], v[148:151]
    ds_read_b64_tr_b16 a[62:63], v15 offset:34816
    v_mfma_f32_16x16x32_bf16 v[56:59], a[84:87], a[16:19], v[56:59]
    s_or_b32 s85, s85, s87
    s_add_u32 s85, s85, s65
    s_andn2_b32 s85, s85, s87
    s_add_u32 s62, s82, s85
    s_addc_u32 s63, s83, 0
    v_mfma_f32_16x16x32_bf16 v[88:91], a[84:87], a[20:23], v[88:91]
    v_mfma_f32_16x16x32_bf16 v[120:123], a[84:87], a[24:27], v[120:123]
    v_mfma_f32_16x16x32_bf16 v[152:155], a[84:87], a[28:31], v[152:155]
    v_mfma_f32_16x16x32_bf16 v[60:63], a[88:91], a[16:19], v[60:63]
    s_or_b32 s84, s84, s86
    s_add_u32 s84, s84, s64
    s_andn2_b32 s84, s84, s86
    s_add_u32 s60, s80, s84
    s_addc_u32 s61, s81, 0
    v_mfma_f32_16x16x32_bf16 v[92:95], a[88:91], a[20:23], v[92:95]
    v_mfma_f32_16x16x32_bf16 v[124:127], a[88:91], a[24:27], v[124:127]
    v_mfma_f32_16x16x32_bf16 v[156:159], a[88:91], a[28:31], v[156:159]
    s_cmp_eq_u32 s77, 0
    s_cbranch_scc1 cw_80
    s_waitcnt vmcnt(20) lgkmcnt(0)
    s_branch cw_81
cw_80:
    s_waitcnt vmcnt(8) lgkmcnt(0)
cw_81:
    s_barrier
    v_mfma_f32_16x16x32_bf16 v[32:35], a[32:35], a[0:3], v[32:35]
    s_add_u32 m0, s67, 98304
    ds_read_b128 a[16:19], v7 offset:32768
    v_mfma_f32_16x16x32_bf16 v[64:67], a[32:35], a[4:7], v[64:67]
    global_load_lds_dwordx4 v4, s[62:63]
    ds_read_b128 a[20:23], v7 offset:34816
    v_mfma_f32_16x16x32_bf16 v[96:99], a[32:35], a[8:11], v[96:99]
    ds_read_b128 a[24:27], v7 offset:36864
    v_mfma_f32_16x16x32_bf16 v[128:131], a[32:35], a[12:15], v[128:131]
    ds_read_b64_tr_b16 a[32:33], v8 offset:49152
    ds_read_b64_tr_b16 a[34:35], v8 offset:51200
    v_mfma_f32_16x16x32_bf16 v[36:39], a[36:39], a[0:3], v[36:39]
    s_add_u32 m0, s67, 99328
    ds_read_b128 a[28:31], v7 offset:38912
    v_mfma_f32_16x16x32_bf16 v[68:71], a[36:39], a[4:7], v[68:71]
    global_load_lds_dwordx4 v5, s[62:63]
    ds_read_b64_tr_b16 a[64:65], v9 offset:49152
    v_mfma_f32_16x16x32_bf16 v[100:103], a[36:39], a[8:11], v[100:103]
    ds_read_b64_tr_b16 a[66:67], v9 offset:51200
    v_mfma_f32_16x16x32_bf16 v[132:135], a[36:39], a[12:15], v[132:135]
    v_mfma_f32_16x16x32_bf16 v[40:43], a[40:43], a[0:3], v[40:43]
    ds_read_b64_tr_b16 a[68:69], v10 offset:49152
    v_mfma_f32_16x16x32_bf16 v[72:75], a[40:43], a[4:7], v[72:75]
    ds_read_b64_tr_b16 a[70:71], v10 offset:51200
    v_mfma_f32_16x16x32_bf16 v[104:107], a[40:43], a[8:11], v[104:107]
    v_mfma_f32_16x16x32_bf16 v[136:139], a[40:43], a[12:15], v[136:139]
    ds_read_b64_tr_b16 a[72:73], v11 offset:49152
    v_mfma_f32_16x16x32_bf16 v[44:47], a[44:47], a[0:3], v[44:47]
    ds_read_b64_tr_b16 a[74:75], v11 offset:51200
    v_mfma_f32_16x16x32_bf16 v[76:79], a[44:47], a[4:7], v[76:79]
    ds_read_b64_tr_b16 a[76:77], v12 offset:49152
    v_mfma_f32_16x16x32_bf16 v[108:111], a[44:47], a[8:11], v[108:111]
    v_mfma_f32_16x16x32_bf16 v[140:143], a[44:47], a[12:15], v[140:143]
    s_waitcnt lgkmcnt(6)
    ds_read_b64_tr_b16 a[78:79], v12 offset:51200
    v_mfma_f32_16x16x32_bf16 v[48:51], a[48:51], a[0:3], v[48:51]
    ds_read_b64_tr_b16 a[80:81], v13 offset:49152
    v_mfma_f32_16x16x32_bf16 v[80:83], a[48:51], a[4:7], v[80:83]
    v_mfma_f32_16x16x32_bf16 v[112:115], a[48:51], a[8:11], v[112:115]
    ds_read_b64_tr_b16 a[82:83], v13 offset:51200
    v_mfma_f32_16x16x32_bf16 v[144:147], a[48:51], a[12:15], v[144:147]
    ds_read_b64_tr_b16 a[84:85], v14 offset:49152
    v_mfma_f32_16x16x32_bf16 v[52:55], a[52:55], a[0:3], v[52:55]
    ds_read_b64_tr_b16 a[86:87], v14 offset:51200
    v_mfma_f32_16x16x32_bf16 v[84:87], a[52:55], a[4:7], v[84:87]
    v_mfma_f32_16x16x32_bf16 v[116:119], a[52:55], a[8:11], v[116:119]
    ds_read_b64_tr_b16 a[88:89], v15 offset:49152
    v_mfma_f32_16x16x32_bf16 v[148:151], a[52:55], a[12:15], v[148:151]
    ds_read_b64_tr_b16 a[90:91], v15 offset:51200
    v_mfma_f32_16x16x32_bf16 v[56:59], a[56:59], a[0:3], v[56:59]
    s_or_b32 s85, s85, s87
    s_add_u32 s85, s85, s65
    s_andn2_b32 s85, s85, s87
    s_add_u32 s62, s82, s85
    s_addc_u32 s63, s83, 0
    v_mfma_f32_16x16x32_bf16 v[88:91], a[56:59], a[4:7], v[88:91]
    v_mfma_f32_16x16x32_bf16 v[120:123], a[56:59], a[8:11], v[120:123]
    v_mfma_f32_16x16x32_bf16 v[152:155], a[56:59], a[12:15], v[152:155]
    v_mfma_f32_16x16x32_bf16 v[60:63], a[60:63], a[0:3], v[60:63]
    v_mfma_f32_16x16x32_bf16 v[92:95], a[60:63], a[4:7], v[92:95]
    v_mfma_f32_16x16x32_bf16 v[124:127], a[60:63], a[8:11], v[124:127]
    v_mfma_f32_16x16x32_bf16 v[156:159], a[60:63], a[12:15], v[156:159]
    s_waitcnt vmcnt(4) lgkmcnt(0)
    s_barrier
    s_mov_b32 s77, 0
    s_cmp_eq_u32 s89, 0
    s_cbranch_scc1 core_T_ns
    s_mov_b32 s89, 0
    s_cmp_eq_u32 s75, 0
    s_cbranch_scc0 core_T_ns
    v_mov_b32 v16, s88
    v_mov_b32 v17, 0
    s_mov_b64 exec, 1
    global_store_dword v16, v17, s[28:29] sc1
    s_mov_b64 exec, -1
core_T_ns:
    v_mfma_f32_16x16x32_bf16 v[32:35], a[32:35], a[16:19], v[32:35]
    s_add_u32 m0, s76, 32768
    ds_read_b128 a[0:3], v6 offset:0
    v_mfma_f32_16x16x32_bf16 v[64:67], a[32:35], a[20:23], v[64:67]
    global_load_lds_dwordx4 v28, s[60:61]
    ds_read_b128 a[4:7], v6 offset:2048
    v_mfma_f32_16x16x32_bf16 v[96:99], a[32:35], a[24:27], v[96:99]
    ds_read_b128 a[8:11], v6 offset:4096
    v_mfma_f32_16x16x32_bf16 v[128:131], a[32:35], a[28:31], v[128:131]
    ds_read_b64_tr_b16 a[32:33], v8 offset:0
    ds_read_b64_tr_b16 a[34:35], v8 offset:2048
    v_mfma_f32_16x16x32_bf16 v[36:39], a[64:67], a[16:19], v[36:39]
    s_add_u32 m0, s76, 33792
    ds_read_b128 a[12:15], v6 offset:6144
    v_mfma_f32_16x16x32_bf16 v[68:71], a[64:67], a[20:23], v[68:71]
    global_load_lds_dwordx4 v29, s[60:61]
    ds_read_b64_tr_b16 a[36:37], v9 offset:0
    v_mfma_f32_16x16x32_bf16 v[100:103], a[64:67], a[24:27], v[100:103]
    ds_read_b64_tr_b16 a[38:39], v9 offset:2048
    v_mfma_f32_16x16x32_bf16 v[132:135], a[64:67], a[28:31], v[132:135]
    v_mfma_f32_16x16x32_bf16 v[40:43], a[68:71], a[16:19], v[40:43]
    s_add_u32 m0, s76, 34816
    ds_read_b64_tr_b16 a[40:41], v10 offset:0
    v_mfma_f32_16x16x32_bf16 v[72:75], a[68:71], a[20:23], v[72:75]
    global_load_lds_dwordx4 v30, s[60:61]
    ds_read_b64_tr_b16 a[42:43], v10 offset:2048
    v_mfma_f32_16x16x32_bf16 v[104:107], a[68:71], a[24:27], v[104:107]
    v_mfma_f32_16x16x32_bf16 v[136:139], a[68:71], a[28:31], v[136:139]
    ds_read_b64_tr_b16 a[44:45], v11 offset:0
    v_mfma_f32_16x16x32_bf16 v[44:47], a[72:75], a[16:19], v[44:47]
    s_add_u32 m0, s76, 35840
    ds_read_b64_tr_b16 a[46:47], v11 offset:2048
    v_mfma_f32_16x16x32_bf16 v[76:79], a[72:75], a[20:23], v[76:79]
    global_load_lds_dwordx4 v31, s[60:61]
    ds_read_b64_tr_b16 a[48:49], v12 offset:0
    v_mfma_f32_16x16x32_bf16 v[108:111], a[72:75], a[24:27], v[108:111]
    v_mfma_f32_16x16x32_bf16 v[140:143], a[72:75], a[28:31], v[140:143]
    s_waitcnt lgkmcnt(6)
    ds_read_b64_tr_b16 a[50:51], v12 offset:2048
    v_mfma_f32_16x16x32_bf16 v[48:51], a[76:79], a[16:19], v[48:51]
    s_add_u32 m0, s67, 114688
    ds_read_b64_tr_b16 a[52:53], v13 offset:0
    v_mfma_f32_16x16x32_bf16 v[80:83], a[76:79], a[20:23], v[80:83]
    global_load_lds_dwordx4 v4, s[62:63]
    v_mfma_f32_16x16x32_bf16 v[112:115], a[76:79], a[24:27], v[112:115]
    ds_read_b64_tr_b16 a[54:55], v13 offset:2048
    v_mfma_f32_16x16x32_bf16 v[144:147], a[76:79], a[28:31], v[144:147]
    ds_read_b64_tr_b16 a[56:57], v14 offset:0
    v_mfma_f32_16x16x32_bf16 v[52:55], a[80:83], a[16:19], v[52:55]
    s_add_u32 m0, s67, 115712
    ds_read_b64_tr_b16 a[58:59], v14 offset:2048
    v_mfma_f32_16x16x32_bf16 v[84:87], a[80:83], a[20:23], v[84:87]
    global_load_lds_dwordx4 v5, s[62:63]
    v_mfma_f32_16x16x32_bf16 v[116:119], a[80:83], a[24:27], v[116:119]
    ds_read_b64_tr_b16 a[60:61], v15 offset:0
    v_mfma_f32_16x16x32_bf16 v[148:151], a[80:83], a[28:31], v[148:151]
    ds_read_b64_tr_b16 a[62:63], v15 offset:2048
    v_mfma_f32_16x16x32_bf16 v[56:59], a[84:87], a[16:19], v[56:59]
    s_or_b32 s85, s85, s87
    s_add_u32 s85, s85, s65
    s_andn2_b32 s85, s85, s87
    s_add_u32 s62, s82, s85
    s_addc_u32 s63, s83, 0
    v_mfma_f32_16x16x32_bf16 v[88:91], a[84:87], a[20:23], v[88:91]
    v_mfma_f32_16x16x32_bf16 v[120:123], a[84:87], a[24:27], v[120:123]
    v_mfma_f32_16x16x32_bf16 v[152:155], a[84:87], a[28:31], v[152:155]
    v_mfma_f32_16x16x32_bf16 v[60:63], a[88:91], a[16:19], v[60:63]
    s_or_b32 s84, s84, s86
    s_add_u32 s84, s84, s64
    s_andn2_b32 s84, s84, s86
    s_add_u32 s60, s80, s84
    s_addc_u32 s61, s81, 0
    v_mfma_f32_16x16x32_bf16 v[92:95], a[88:91], a[20:23], v[92:95]
    v_mfma_f32_16x16x32_bf16 v[124:127], a[88:91], a[24:27], v[124:127]
    v_mfma_f32_16x16x32_bf16 v[156:159], a[88:91], a[28:31], v[156:159]
    s_sub_u32 s66, s66, 1
core_T_loop:
    s_waitcnt vmcnt(8) lgkmcnt(0)
    s_barrier
    v_mfma_f32_16x16x32_bf16 v[32:35], a[32:35], a[0:3], v[32:35]
    s_add_u32 m0, s67, 65536
    ds_read_b128 a[16:19], v7 offset:0
    v_mfma_f32_16x16x32_bf16 v[64:67], a[32:35], a[4:7], v[64:67]
    global_load_lds_dwordx4 v4, s[62:63]
    ds_read_b128 a[20:23], v7 offset:2048
    v_mfma_f32_16x16x32_bf16 v[96:99], a[32:35], a[8:11], v[96:99]
    ds_read_b128 a[24:27], v7 offset:4096
    v_mfma_f32_16x16x32_bf16 v[128:131], a[32:35], a[12:15], v[128:131]
    ds_read_b64_tr_b16 a[32:33], v8 offset:16384
    ds_read_b64_tr_b16 a[34:35], v8 offset:18432
    v_mfma_f32_16x16x32_bf16 v[36:39], a[36:39], a[0:3], v[36:39]
    s_add_u32 m0, s67, 66560
    ds_read_b128 a[28:31], v7 offset:6144
    v_mfma_f32_16x16x32_bf16 v[68:71], a[36:39], a[4:7], v[68:71]
    global_load_lds_dwordx4 v5, s[62:63]
    ds_read_b64_tr_b16 a[64:65], v9 offset:16384
    v_mfma_f32_16x16x32_bf16 v[100:103], a[36:39], a[8:11], v[100:103]
    ds_read_b64_tr_b16 a[66:67], v9 offset:18432
    v_mfma_f32_16x16x32_bf16 v[132:135], a[36:39], a[12:15], v[132:135]
    v_mfma_f32_16x16x32_bf16 v[40:43], a[40:43], a[0:3], v[40:43]
    ds_read_b64_tr_b16 a[68:69], v10 offset:16384
    v_mfma_f32_16x16x32_bf16 v[72:75], a[40:43], a[4:7], v[72:75]
    ds_read_b64_tr_b16 a[70:71], v10 offset:18432
    v_mfma_f32_16x16x32_bf16 v[104:107], a[40:43], a[8:11], v[104:107]
    v_mfma_f32_16x16x32_bf16 v[136:139], a[40:43], a[12:15], v[136:139]
    ds_read_b64_tr_b16 a[72:73], v11 offset:16384
    v_mfma_f32_16x16x32_bf16 v[44:47], a[44:47], a[0:3], v[44:47]
    ds_read_b64_tr_b16 a[74:75], v11 offset:18432
    v_mfma_f32_16x16x32_bf16 v[76:79], a[44:47], a[4:7], v[76:79]
    ds_read_b64_tr_b16 a[76:77], v12 offset:16384
    v_mfma_f32_16x16x32_bf16 v[108:111], a[44:47], a[8:11], v[108:111]
    v_mfma_f32_16x16x32_bf16 v[140:143], a[44:47], a[12:15], v[140:143]
    s_waitcnt lgkmcnt(6)
    ds_read_b64_tr_b16 a[78:79], v12 offset:18432
    v_mfma_f32_16x16x32_bf16 v[48:51], a[48:51], a[0:3], v[48:51]
    ds_read_b64_tr_b16 a[80:81], v13 offset:16384
    v_mfma_f32_16x16x32_bf16 v[80:83], a[48:51], a[4:7], v[80:83]
    v_mfma_f32_16x16x32_bf16 v[112:115], a[48:51], a[8:11], v[112:115]
    ds_read_b64_tr_b16 a[82:83], v13 offset:18432
    v_mfma_f32_16x16x32_bf16 v[144:147], a[48:51], a[12:15], v[144:147]
    ds_read_b64_tr_b16 a[84:85], v14 offset:16384
    v_mfma_f32_16x16x32_bf16 v[52:55], a[52:55], a[0:3], v[52:55]
    ds_read_b64_tr_b16 a[86:87], v14 offset:18432
    v_mfma_f32_16x16x32_bf16 v[84:87], a[52:55], a[4:7], v[84:87]
    v_mfma_f32_16x16x32_bf16 v[116:119], a[52:55], a[8:11], v[116:119]
    ds_read_b64_tr_b16 a[88:89], v15 offset:16384
    v_mfma_f32_16x16x32_bf16 v[148:151], a[52:55], a[12:15], v[148:151]
    ds_read_b64_tr_b16 a[90:91], v15 offset:18432
    v_mfma_f32_16x16x32_bf16 v[56:59], a[56:59], a[0:3], v[56:59]
    s_or_b32 s85, s85, s87
    s_add_u32 s85, s85, s65
    s_andn2_b32 s85, s85, s87
    s_add_u32 s62, s82, s85
    s_addc_u32 s63, s83, 0
    v_mfma_f32_16x16x32_bf16 v[88:91], a[56:59], a[4:7], v[88:91]
    v_mfma_f32_16x16x32_bf16 v[120:123], a[56:59], a[8:11], v[120:123]
    v_mfma_f32_16x16x32_bf16 v[152:155], a[56:59], a[12:15], v[152:155]
    v_mfma_f32_16x16x32_bf16 v[60:63], a[60:63], a[0:3], v[60:63]
    v_mfma_f32_16x16x32_bf16 v[92:95], a[60:63], a[4:7], v[92:95]
    v_mfma_f32_16x16x32_bf16 v[124:127], a[60:63], a[8:11], v[124:127]
    v_mfma_f32_16x16x32_bf16 v[156:159], a[60:63], a[12:15], v[156:159]
    s_waitcnt vmcnt(4) lgkmcnt(0)
    s_barrier
    v_mfma_f32_16x16x32_bf16 v[32:35], a[32:35], a[16:19], v[32:35]
    s_add_u32 m0, s76, 0
    ds_read_b128 a[0:3], v6 offset:32768
    v_mfma_f32_16x16x32_bf16 v[64:67], a[32:35], a[20:23], v[64:67]
    global_load_lds_dwordx4 v28, s[60:61]
    ds_read_b128 a[4:7], v6 offset:34816
    v_mfma_f32_16x16x32_bf16 v[96:99], a[32:35], a[24:27], v[96:99]
    ds_read_b128 a[8:11], v6 offset:36864
    v_mfma_f32_16x16x32_bf16 v[128:131], a[32:35], a[28:31], v[128:131]
    ds_read_b64_tr_b16 a[32:33], v8 offset:32768
    ds_read_b64_tr_b16 a[34:35], v8 offset:34816
    v_mfma_f32_16x16x32_bf16 v[36:39], a[64:67], a[16:19], v[36:39]
    s_add_u32 m0, s76, 1024
    ds_read_b128 a[12:15], v6 offset:38912
    v_mfma_f32_16x16x32_bf16 v[68:71], a[64:67], a[20:23], v[68:71]
    global_load_lds_dwordx4 v29, s[60:61]
    ds_read_b64_tr_b16 a[36:37], v9 offset:32768
    v_mfma_f32_16x16x32_bf16 v[100:103], a[64:67], a[24:27], v[100:103]
    ds_read_b64_tr_b16 a[38:39], v9 offset:34816
    v_mfma_f32_16x16x32_bf16 v[132:135], a[64:67], a[28:31], v[132:135]
    v_mfma_f32_16x16x32_bf16 v[40:43], a[68:71], a[16:19], v[40:43]
    s_add_u32 m0, s76, 2048
    ds_read_b64_tr_b16 a[40:41], v10 offset:32768
    v_mfma_f32_16x16x32_bf16 v[72:75], a[68:71], a[20:23], v[72:75]
    global_load_lds_dwordx4 v30, s[60:61]
    ds_read_b64_tr_b16 a[42:43], v10 offset:34816
    v_mfma_f32_16x16x32_bf16 v[104:107], a[68:71], a[24:27], v[104:107]
    v_mfma_f32_16x16x32_bf16 v[136:139], a[68:71], a[28:31], v[136:139]
    ds_read_b64_tr_b16 a[44:45], v11 offset:32768
    v_mfma_f32_16x16x32_bf16 v[44:47], a[72:75], a[16:19], v[44:47]
    s_add_u32 m0, s76, 3072
    ds_read_b64_tr_b16 a[46:47], v11 offset:34816
    v_mfma_f32_16x16x32_bf16 v[76:79], a[72:75], a[20:23], v[76:79]
    global_load_lds_dwordx4 v31, s[60:61]
    ds_read_b64_tr_b16 a[48:49], v12 offset:32768
    v_mfma_f32_16x16x32_bf16 v[108:111], a[72:75], a[24:27], v[108:111]
    v_mfma_f32_16x16x32_bf16 v[140:143], a[72:75], a[28:31], v[140:143]
    s_waitcnt lgkmcnt(6)
    ds_read_b64_tr_b16 a[50:51], v12 offset:34816
    v_mfma_f32_16x16x32_bf16 v[48:51], a[76:79], a[16:19], v[48:51]
    s_add_u32 m0, s67, 81920
    ds_read_b64_tr_b16 a[52:53], v13 offset:32768
    v_mfma_f32_16x16x32_bf16 v[80:83], a[76:79], a[20:23], v[80:83]
    global_load_lds_dwordx4 v4, s[62:63]
    v_mfma_f32_16x16x32_bf16 v[112:115], a[76:79], a[24:27], v[112:115]
    ds_read_b64_tr_b16 a[54:55], v13 offset:34816
    v_mfma_f32_16x16x32_bf16 v[144:147], a[76:79], a[28:31], v[144:147]
    ds_read_b64_tr_b16 a[56:57], v14 offset:32768
    v_mfma_f32_16x16x32_bf16 v[52:55], a[80:83], a[16:19], v[52:55]
    s_add_u32 m0, s67, 82944
    ds_read_b64_tr_b16 a[58:59], v14 offset:34816
    v_mfma_f32_16x16x32_bf16 v[84:87], a[80:83], a[20:23], v[84:87]
    global_load_lds_dwordx4 v5, s[62:63]
    v_mfma_f32_16x16x32_bf16 v[116:119], a[80:83], a[24:27], v[116:119]
    ds_read_b64_tr_b16 a[60:61], v15 offset:32768
    v_mfma_f32_16x16x32_bf16 v[148:151], a[80:83], a[28:31], v[148:151]
    ds_read_b64_tr_b16 a[62:63], v15 offset:34816
    v_mfma_f32_16x16x32_bf16 v[56:59], a[84:87], a[16:19], v[56:59]
    s_or_b32 s85, s85, s87
    s_add_u32 s85, s85, s65
    s_andn2_b32 s85, s85, s87
    s_add_u32 s62, s82, s85
    s_addc_u32 s63, s83, 0
    v_mfma_f32_16x16x32_bf16 v[88:91], a[84:87], a[20:23], v[88:91]
    v_mfma_f32_16x16x32_bf16 v[120:123], a[84:87], a[24:27], v[120:123]
    v_mfma_f32_16x16x32_bf16 v[152:155], a[84:87], a[28:31], v[152:155]
    v_mfma_f32_16x16x32_bf16 v[60:63], a[88:91], a[16:19], v[60:63]
    s_or_b32 s84, s84, s86
    s_add_u32 s84, s84, s64
    s_andn2_b32 s84, s84, s86
    s_add_u32 s60, s80, s84
    s_addc_u32 s61, s81, 0
    v_mfma_f32_16x16x32_bf16 v[92:95], a[88:91], a[20:23], v[92:95]
    v_mfma_f32_16x16x32_bf16 v[124:127], a[88:91], a[24:27], v[124:127]
    v_mfma_f32_16x16x32_bf16 v[156:159], a[88:91], a[28:31], v[156:159]
    s_waitcnt vmcnt(8) lgkmcnt(0)
    s_barrier
    v_mfma_f32_16x16x32_bf16 v[32:35], a[32:35], a[0:3], v[32:35]
    s_add_u32 m0, s67, 98304
    ds_read_b128 a[16:19], v7 offset:32768
    v_mfma_f32_16x16x32_bf16 v[64:67], a[32:35], a[4:7], v[64:67]
    global_load_lds_dwordx4 v4, s[62:63]
    ds_read_b128 a[20:23], v7 offset:34816
    v_mfma_f32_16x16x32_bf16 v[96:99], a[32:35], a[8:11], v[96:99]
    ds_read_b128 a[24:27], v7 offset:36864
    v_mfma_f32_16x16x32_bf16 v[128:131], a[32:35], a[12:15], v[128:131]
    ds_read_b64_tr_b16 a[32:33], v8 offset:49152
    ds_read_b64_tr_b16 a[34:35], v8 offset:51200
    v_mfma_f32_16x16x32_bf16 v[36:39], a[36:39], a[0:3], v[36:39]
    s_add_u32 m0, s67, 99328
    ds_read_b128 a[28:31], v7 offset:38912
    v_mfma_f32_16x16x32_bf16 v[68:71], a[36:39], a[4:7], v[68:71]
    global_load_lds_dwordx4 v5, s[62:63]
    ds_read_b64_tr_b16 a[64:65], v9 offset:49152
    v_mfma_f32_16x16x32_bf16 v[100:103], a[36:39], a[8:11], v[100:103]
    ds_read_b64_tr_b16 a[66:67], v9 offset:51200
    v_mfma_f32_16x16x32_bf16 v[132:135], a[36:39], a[12:15], v[132:135]
    v_mfma_f32_16x16x32_bf16 v[40:43], a[40:43], a[0:3], v[40:43]
    ds_read_b64_tr_b16 a[68:69], v10 offset:49152
    v_mfma_f32_16x16x32_bf16 v[72:75], a[40:43], a[4:7], v[72:75]
    ds_read_b64_tr_b16 a[70:71], v10 offset:51200
    v_mfma_f32_16x16x32_bf16 v[104:107], a[40:43], a[8:11], v[104:107]
    v_mfma_f32_16x16x32_bf16 v[136:139], a[40:43], a[12:15], v[136:139]
    ds_read_b64_tr_b16 a[72:73], v11 offset:49152
    v_mfma_f32_16x16x32_bf16 v[44:47], a[44:47], a[0:3], v[44:47]
    ds_read_b64_tr_b16 a[74:75], v11 offset:51200
    v_mfma_f32_16x16x32_bf16 v[76:79], a[44:47], a[4:7], v[76:79]
    ds_read_b64_tr_b16 a[76:77], v12 offset:49152
    v_mfma_f32_16x16x32_bf16 v[108:111], a[44:47], a[8:11], v[108:111]
    v_mfma_f32_16x16x32_bf16 v[140:143], a[44:47], a[12:15], v[140:143]
    s_waitcnt lgkmcnt(6)
    ds_read_b64_tr_b16 a[78:79], v12 offset:51200
    v_mfma_f32_16x16x32_bf16 v[48:51], a[48:51], a[0:3], v[48:51]
    ds_read_b64_tr_b16 a[80:81], v13 offset:49152
    v_mfma_f32_16x16x32_bf16 v[80:83], a[48:51], a[4:7], v[80:83]
    v_mfma_f32_16x16x32_bf16 v[112:115], a[48:51], a[8:11], v[112:115]
    ds_read_b64_tr_b16 a[82:83], v13 offset:51200
    v_mfma_f32_16x16x32_bf16 v[144:147], a[48:51], a[12:15], v[144:147]
    ds_read_b64_tr_b16 a[84:85], v14 offset:49152
    v_mfma_f32_16x16x32_bf16 v[52:55], a[52:55], a[0:3], v[52:55]
    ds_read_b64_tr_b16 a[86:87], v14 offset:51200
    v_mfma_f32_16x16x32_bf16 v[84:87], a[52:55], a[4:7], v[84:87]
    v_mfma_f32_16x16x32_bf16 v[116:119], a[52:55], a[8:11], v[116:119]
    ds_read_b64_tr_b16 a[88:89], v15 offset:49152
    v_mfma_f32_16x16x32_bf16 v[148:151], a[52:55], a[12:15], v[148:151]
    ds_read_b64_tr_b16 a[90:91], v15 offset:51200
    v_mfma_f32_16x16x32_bf16 v[56:59], a[56:59], a[0:3], v[56:59]
    s_or_b32 s85, s85, s87
    s_add_u32 s85, s85, s65
    s_andn2_b32 s85, s85, s87
    s_add_u32 s62, s82, s85
    s_addc_u32 s63, s83, 0
    v_mfma_f32_16x16x32_bf16 v[88:91], a[56:59], a[4:7], v[88:91]
    v_mfma_f32_16x16x32_bf16 v[120:123], a[56:59], a[8:11], v[120:123]
    v_mfma_f32_16x16x32_bf16 v[152:155], a[56:59], a[12:15], v[152:155]
    v_mfma_f32_16x16x32_bf16 v[60:63], a[60:63], a[0:3], v[60:63]
    v_mfma_f32_16x16x32_bf16 v[92:95], a[60:63], a[4:7], v[92:95]
    v_mfma_f32_16x16x32_bf16 v[124:127], a[60:63], a[8:11], v[124:127]
    v_mfma_f32_16x16x32_bf16 v[156:159], a[60:63], a[12:15], v[156:159]
    s_waitcnt vmcnt(4) lgkmcnt(0)
    s_barrier
    v_mfma_f32_16x16x32_bf16 v[32:35], a[32:35], a[16:19], v[32:35]
    s_add_u32 m0, s76, 32768
    ds_read_b128 a[0:3], v6 offset:0
    v_mfma_f32_16x16x32_bf16 v[64:67], a[32:35], a[20:23], v[64:67]
    global_load_lds_dwordx4 v28, s[60:61]
    ds_read_b128 a[4:7], v6 offset:2048
    v_mfma_f32_16x16x32_bf16 v[96:99], a[32:35], a[24:27], v[96:99]
    ds_read_b128 a[8:11], v6 offset:4096
    v_mfma_f32_16x16x32_bf16 v[128:131], a[32:35], a[28:31], v[128:131]
    ds_read_b64_tr_b16 a[32:33], v8 offset:0
    ds_read_b64_tr_b16 a[34:35], v8 offset:2048
    v_mfma_f32_16x16x32_bf16 v[36:39], a[64:67], a[16:19], v[36:39]
    s_add_u32 m0, s76, 33792
    ds_read_b128 a[12:15], v6 offset:6144
    v_mfma_f32_16x16x32_bf16 v[68:71], a[64:67], a[20:23], v[68:71]
    global_load_lds_dwordx4 v29, s[60:61]
    ds_read_b64_tr_b16 a[36:37], v9 offset:0
    v_mfma_f32_16x16x32_bf16 v[100:103], a[64:67], a[24:27], v[100:103]
    ds_read_b64_tr_b16 a[38:39], v9 offset:2048
    v_mfma_f32_16x16x32_bf16 v[132:135], a[64:67], a[28:31], v[132:135]
    v_mfma_f32_16x16x32_bf16 v[40:43], a[68:71], a[16:19], v[40:43]
    s_add_u32 m0, s76, 34816
    ds_read_b64_tr_b16 a[40:41], v10 offset:0
    v_mfma_f32_16x16x32_bf16 v[72:75], a[68:71], a[20:23], v[72:75]
    global_load_lds_dwordx4 v30, s[60:61]
    ds_read_b64_tr_b16 a[42:43], v10 offset:2048
    v_mfma_f32_16x16x32_bf16 v[104:107], a[68:71], a[24:27], v[104:107]
    v_mfma_f32_16x16x32_bf16 v[136:139], a[68:71], a[28:31], v[136:139]
    ds_read_b64_tr_b16 a[44:45], v11 offset:0
    v_mfma_f32_16x16x32_bf16 v[44:47], a[72:75], a[16:19], v[44:47]
    s_add_u32 m0, s76, 35840
    ds_read_b64_tr_b16 a[46:47], v11 offset:2048
    v_mfma_f32_16x16x32_bf16 v[76:79], a[72:75], a[20:23], v[76:79]
    global_load_lds_dwordx4 v31, s[60:61]
    ds_read_b64_tr_b16 a[48:49], v12 offset:0
    v_mfma_f32_16x16x32_bf16 v[108:111], a[72:75], a[24:27], v[108:111]
    v_mfma_f32_16x16x32_bf16 v[140:143], a[72:75], a[28:31], v[140:143]
    s_waitcnt lgkmcnt(6)
    ds_read_b64_tr_b16 a[50:51], v12 offset:2048
    v_mfma_f32_16x16x32_bf16 v[48:51], a[76:79], a[16:19], v[48:51]
    s_add_u32 m0, s67, 114688
    ds_read_b64_tr_b16 a[52:53], v13 offset:0
    v_mfma_f32_16x16x32_bf16 v[80:83], a[76:79], a[20:23], v[80:83]
    global_load_lds_dwordx4 v4, s[62:63]
    v_mfma_f32_16x16x32_bf16 v[112:115], a[76:79], a[24:27], v[112:115]
    ds_read_b64_tr_b16 a[54:55], v13 offset:2048
    v_mfma_f32_16x16x32_bf16 v[144:147], a[76:79], a[28:31], v[144:147]
    ds_read_b64_tr_b16 a[56:57], v14 offset:0
    v_mfma_f32_16x16x32_bf16 v[52:55], a[80:83], a[16:19], v[52:55]
    s_add_u32 m0, s67, 115712
    ds_read_b64_tr_b16 a[58:59], v14 offset:2048
    v_mfma_f32_16x16x32_bf16 v[84:87], a[80:83], a[20:23], v[84:87]
    global_load_lds_dwordx4 v5, s[62:63]
    v_mfma_f32_16x16x32_bf16 v[116:119], a[80:83], a[24:27], v[116:119]
    ds_read_b64_tr_b16 a[60:61], v15 offset:0
    v_mfma_f32_16x16x32_bf16 v[148:151], a[80:83], a[28:31], v[148:151]
    ds_read_b64_tr_b16 a[62:63], v15 offset:2048
    v_mfma_f32_16x16x32_bf16 v[56:59], a[84:87], a[16:19], v[56:59]
    s_or_b32 s85, s85, s87
    s_add_u32 s85, s85, s65
    s_andn2_b32 s85, s85, s87
    s_add_u32 s62, s82, s85
    s_addc_u32 s63, s83, 0
    v_mfma_f32_16x16x32_bf16 v[88:91], a[84:87], a[20:23], v[88:91]
    v_mfma_f32_16x16x32_bf16 v[120:123], a[84:87], a[24:27], v[120:123]
    v_mfma_f32_16x16x32_bf16 v[152:155], a[84:87], a[28:31], v[152:155]
    v_mfma_f32_16x16x32_bf16 v[60:63], a[88:91], a[16:19], v[60:63]
    s_or_b32 s84, s84, s86
    s_add_u32 s84, s84, s64
    s_andn2_b32 s84, s84, s86
    s_add_u32 s60, s80, s84
    s_addc_u32 s61, s81, 0
    v_mfma_f32_16x16x32_bf16 v[92:95], a[88:91], a[20:23], v[92:95]
    v_mfma_f32_16x16x32_bf16 v[124:127], a[88:91], a[24:27], v[124:127]
    v_mfma_f32_16x16x32_bf16 v[156:159], a[88:91], a[28:31], v[156:159]
    s_sub_u32 s66, s66, 1
    s_cmp_lg_u32 s66, 0
    s_cbranch_scc1 core_T_loop
    s_waitcnt vmcnt(8) lgkmcnt(0)
    s_barrier
    s_cmp_eq_u32 s98, 0
    s_cbranch_scc1 core_T_nt
    v_lshlrev_b32 v20, 6, v0
    v_min_u32 v21, s99, v20
    v_min_u32 v22, s100, v20
    v_min_u32 v23, s101, v20
    global_load_dword a95, v21, s[90:91]
    global_load_dword a95, v22, s[92:93]
    global_load_dword a95, v23, s[94:95]
core_T_nt:
    v_mfma_f32_16x16x32_bf16 v[32:35], a[32:35], a[0:3], v[32:35]
    ds_read_b128 a[16:19], v7 offset:0
    v_mfma_f32_16x16x32_bf16 v[64:67], a[32:35], a[4:7], v[64:67]
    ds_read_b128 a[20:23], v7 offset:2048
    v_mfma_f32_16x16x32_bf16 v[96:99], a[32:35], a[8:11], v[96:99]
    ds_read_b128 a[24:27], v7 offset:4096
    v_mfma_f32_16x16x32_bf16 v[128:131], a[32:35], a[12:15], v[128:131]
    ds_read_b64_tr_b16 a[32:33], v8 offset:16384
    ds_read_b64_tr_b16 a[34:35], v8 offset:18432
    v_mfma_f32_16x16x32_bf16 v[36:39], a[36:39], a[0:3], v[36:39]
    ds_read_b128 a[28:31], v7 offset:6144
    v_mfma_f32_16x16x32_bf16 v[68:71], a[36:39], a[4:7], v[68:71]
    ds_read_b64_tr_b16 a[64:65], v9 offset:16384
    v_mfma_f32_16x16x32_bf16 v[100:103], a[36:39], a[8:11], v[100:103]
    ds_read_b64_tr_b16 a[66:67], v9 offset:18432
    v_mfma_f32_16x16x32_bf16 v[132:135], a[36:39], a[12:15], v[132:135]
    v_mfma_f32_16x16x32_bf16 v[40:43], a[40:43], a[0:3], v[40:43]
    ds_read_b64_tr_b16 a[68:69], v10 offset:16384
    v_mfma_f32_16x16x32_bf16 v[72:75], a[40:43], a[4:7], v[72:75]
    ds_read_b64_tr_b16 a[70:71], v10 offset:18432
    v_mfma_f32_16x16x32_bf16 v[104:107], a[40:43], a[8:11], v[104:107]
    v_mfma_f32_16x16x32_bf16 v[136:139], a[40:43], a[12:15], v[136:139]
    ds_read_b64_tr_b16 a[72:73], v11 offset:16384
    v_mfma_f32_16x16x32_bf16 v[44:47], a[44:47], a[0:3], v[44:47]
    ds_read_b64_tr_b16 a[74:75], v11 offset:18432
    v_mfma_f32_16x16x32_bf16 v[76:79], a[44:47], a[4:7], v[76:79]
    ds_read_b64_tr_b16 a[76:77], v12 offset:16384
    v_mfma_f32_16x16x32_bf16 v[108:111], a[44:47], a[8:11], v[108:111]
    v_mfma_f32_16x16x32_bf16 v[140:143], a[44:47], a[12:15], v[140:143]
    s_waitcnt lgkmcnt(6)
    ds_read_b64_tr_b16 a[78:79], v12 offset:18432
    v_mfma_f32_16x16x32_bf16 v[48:51], a[48:51], a[0:3], v[48:51]
    ds_read_b64_tr_b16 a[80:81], v13 offset:16384
    v_mfma_f32_16x16x32_bf16 v[80:83], a[48:51], a[4:7], v[80:83]
    v_mfma_f32_16x16x32_bf16 v[112:115], a[48:51], a[8:11], v[112:115]
    ds_read_b64_tr_b16 a[82:83], v13 offset:18432
    v_mfma_f32_16x16x32_bf16 v[144:147], a[48:51], a[12:15], v[144:147]
    ds_read_b64_tr_b16 a[84:85], v14 offset:16384
    v_mfma_f32_16x16x32_bf16 v[52:55], a[52:55], a[0:3], v[52:55]
    ds_read_b64_tr_b16 a[86:87], v14 offset:18432
    v_mfma_f32_16x16x32_bf16 v[84:87], a[52:55], a[4:7], v[84:87]
    v_mfma_f32_16x16x32_bf16 v[116:119], a[52:55], a[8:11], v[116:119]
    ds_read_b64_tr_b16 a[88:89], v15 offset:16384
    v_mfma_f32_16x16x32_bf16 v[148:151], a[52:55], a[12:15], v[148:151]
    ds_read_b64_tr_b16 a[90:91], v15 offset:18432
    v_mfma_f32_16x16x32_bf16 v[56:59], a[56:59], a[0:3], v[56:59]
    v_mfma_f32_16x16x32_bf16 v[88:91], a[56:59], a[4:7], v[88:91]
    v_mfma_f32_16x16x32_bf16 v[120:123], a[56:59], a[8:11], v[120:123]
    v_mfma_f32_16x16x32_bf16 v[152:155], a[56:59], a[12:15], v[152:155]
    v_mfma_f32_16x16x32_bf16 v[60:63], a[60:63], a[0:3], v[60:63]
    v_mfma_f32_16x16x32_bf16 v[92:95], a[60:63], a[4:7], v[92:95]
    v_mfma_f32_16x16x32_bf16 v[124:127], a[60:63], a[8:11], v[124:127]
    v_mfma_f32_16x16x32_bf16 v[156:159], a[60:63], a[12:15], v[156:159]
    s_cmp_eq_u32 s98, 0
    s_cbranch_scc1 cw_82
    s_waitcnt vmcnt(5) lgkmcnt(0)
    s_branch cw_83
cw_82:
    s_waitcnt vmcnt(2) lgkmcnt(0)
cw_83:
    s_barrier
    v_mfma_f32_16x16x32_bf16 v[32:35], a[32:35], a[16:19], v[32:35]
    ds_read_b128 a[0:3], v6 offset:32768
    v_mfma_f32_16x16x32_bf16 v[64:67], a[32:35], a[20:23], v[64:67]
    ds_read_b128 a[4:7], v6 offset:34816
    v_mfma_f32_16x16x32_bf16 v[96:99], a[32:35], a[24:27], v[96:99]
    ds_read_b128 a[8:11], v6 offset:36864
    v_mfma_f32_16x16x32_bf16 v[128:131], a[32:35], a[28:31], v[128:131]
    ds_read_b64_tr_b16 a[32:33], v8 offset:32768
    ds_read_b64_tr_b16 a[34:35], v8 offset:34816
    v_mfma_f32_16x16x32_bf16 v[36:39], a[64:67], a[16:19], v[36:39]
    ds_read_b128 a[12:15], v6 offset:38912
    v_mfma_f32_16x16x32_bf16 v[68:71], a[64:67], a[20:23], v[68:71]
    ds_read_b64_tr_b16 a[36:37], v9 offset:32768
    v_mfma_f32_16x16x32_bf16 v[100:103], a[64:67], a[24:27], v[100:103]
    ds_read_b64_tr_b16 a[38:39], v9 offset:34816
    v_mfma_f32_16x16x32_bf16 v[132:135], a[64:67], a[28:31], v[132:135]
    v_mfma_f32_16x16x32_bf16 v[40:43], a[68:71], a[16:19], v[40:43]
    ds_read_b64_tr_b16 a[40:41], v10 offset:32768
    v_mfma_f32_16x16x32_bf16 v[72:75], a[68:71], a[20:23], v[72:75]
    ds_read_b64_tr_b16 a[42:43], v10 offset:34816
    v_mfma_f32_16x16x32_bf16 v[104:107], a[68:71], a[24:27], v[104:107]
    v_mfma_f32_16x16x32_bf16 v[136:139], a[68:71], a[28:31], v[136:139]
    ds_read_b64_tr_b16 a[44:45], v11 offset:32768
    v_mfma_f32_16x16x32_bf16 v[44:47], a[72:75], a[16:19], v[44:47]
    ds_read_b64_tr_b16 a[46:47], v11 offset:34816
    v_mfma_f32_16x16x32_bf16 v[76:79], a[72:75], a[20:23], v[76:79]
    ds_read_b64_tr_b16 a[48:49], v12 offset:32768
    v_mfma_f32_16x16x32_bf16 v[108:111], a[72:75], a[24:27], v[108:111]
    v_mfma_f32_16x16x32_bf16 v[140:143], a[72:75], a[28:31], v[140:143]
    s_waitcnt lgkmcnt(6)
    ds_read_b64_tr_b16 a[50:51], v12 offset:34816
    v_mfma_f32_16x16x32_bf16 v[48:51], a[76:79], a[16:19], v[48:51]
    ds_read_b64_tr_b16 a[52:53], v13 offset:32768
    v_mfma_f32_16x16x32_bf16 v[80:83], a[76:79], a[20:23], v[80:83]
    v_mfma_f32_16x16x32_bf16 v[112:115], a[76:79], a[24:27], v[112:115]
    ds_read_b64_tr_b16 a[54:55], v13 offset:34816
    v_mfma_f32_16x16x32_bf16 v[144:147], a[76:79], a[28:31], v[144:147]
    ds_read_b64_tr_b16 a[56:57], v14 offset:32768
    v_mfma_f32_16x16x32_bf16 v[52:55], a[80:83], a[16:19], v[52:55]
    ds_read_b64_tr_b16 a[58:59], v14 offset:34816
    v_mfma_f32_16x16x32_bf16 v[84:87], a[80:83], a[20:23], v[84:87]
    v_mfma_f32_16x16x32_bf16 v[116:119], a[80:83], a[24:27], v[116:119]
    ds_read_b64_tr_b16 a[60:61], v15 offset:32768
    v_mfma_f32_16x16x32_bf16 v[148:151], a[80:83], a[28:31], v[148:151]
    ds_read_b64_tr_b16 a[62:63], v15 offset:34816
    v_mfma_f32_16x16x32_bf16 v[56:59], a[84:87], a[16:19], v[56:59]
    v_mfma_f32_16x16x32_bf16 v[88:91], a[84:87], a[20:23], v[88:91]
    v_mfma_f32_16x16x32_bf16 v[120:123], a[84:87], a[24:27], v[120:123]
    v_mfma_f32_16x16x32_bf16 v[152:155], a[84:87], a[28:31], v[152:155]
    v_mfma_f32_16x16x32_bf16 v[60:63], a[88:91], a[16:19], v[60:63]
    v_mfma_f32_16x16x32_bf16 v[92:95], a[88:91], a[20:23], v[92:95]
    v_mfma_f32_16x16x32_bf16 v[124:127], a[88:91], a[24:27], v[124:127]
    v_mfma_f32_16x16x32_bf16 v[156:159], a[88:91], a[28:31], v[156:159]
    s_cmp_eq_u32 s98, 0
    s_cbranch_scc1 cw_84
    s_waitcnt vmcnt(3) lgkmcnt(0)
    s_branch cw_85
cw_84:
    s_waitcnt vmcnt(0) lgkmcnt(0)
cw_85:
    s_barrier
    s_mov_b32 s98, 0
    v_mfma_f32_16x16x32_bf16 v[32:35], a[32:35], a[0:3], v[32:35]
    ds_read_b128 a[16:19], v7 offset:32768
    v_mfma_f32_16x16x32_bf16 v[64:67], a[32:35], a[4:7], v[64:67]
    ds_read_b128 a[20:23], v7 offset:34816
    v_mfma_f32_16x16x32_bf16 v[96:99], a[32:35], a[8:11], v[96:99]
    ds_read_b128 a[24:27], v7 offset:36864
    v_mfma_f32_16x16x32_bf16 v[128:131], a[32:35], a[12:15], v[128:131]
    ds_read_b64_tr_b16 a[32:33], v8 offset:49152
    ds_read_b64_tr_b16 a[34:35], v8 offset:51200
    v_mfma_f32_16x16x32_bf16 v[36:39], a[36:39], a[0:3], v[36:39]
    ds_read_b128 a[28:31], v7 offset:38912
    v_mfma_f32_16x16x32_bf16 v[68:71], a[36:39], a[4:7], v[68:71]
    ds_read_b64_tr_b16 a[64:65], v9 offset:49152
    v_mfma_f32_16x16x32_bf16 v[100:103], a[36:39], a[8:11], v[100:103]
    ds_read_b64_tr_b16 a[66:67], v9 offset:51200
    v_mfma_f32_16x16x32_bf16 v[132:135], a[36:39], a[12:15], v[132:135]
    v_mfma_f32_16x16x32_bf16 v[40:43], a[40:43], a[0:3], v[40:43]
    ds_read_b64_tr_b16 a[68:69], v10 offset:49152
    v_mfma_f32_16x16x32_bf16 v[72:75], a[40:43], a[4:7], v[72:75]
    ds_read_b64_tr_b16 a[70:71], v10 offset:51200
    v_mfma_f32_16x16x32_bf16 v[104:107], a[40:43], a[8:11], v[104:107]
    v_mfma_f32_16x16x32_bf16 v[136:139], a[40:43], a[12:15], v[136:139]
    ds_read_b64_tr_b16 a[72:73], v11 offset:49152
    v_mfma_f32_16x16x32_bf16 v[44:47], a[44:47], a[0:3], v[44:47]
    ds_read_b64_tr_b16 a[74:75], v11 offset:51200
    v_mfma_f32_16x16x32_bf16 v[76:79], a[44:47], a[4:7], v[76:79]
    ds_read_b64_tr_b16 a[76:77], v12 offset:49152
    v_mfma_f32_16x16x32_bf16 v[108:111], a[44:47], a[8:11], v[108:111]
    v_mfma_f32_16x16x32_bf16 v[140:143], a[44:47], a[12:15], v[140:143]
    s_waitcnt lgkmcnt(6)
    ds_read_b64_tr_b16 a[78:79], v12 offset:51200
    v_mfma_f32_16x16x32_bf16 v[48:51], a[48:51], a[0:3], v[48:51]
    ds_read_b64_tr_b16 a[80:81], v13 offset:49152
    v_mfma_f32_16x16x32_bf16 v[80:83], a[48:51], a[4:7], v[80:83]
    v_mfma_f32_16x16x32_bf16 v[112:115], a[48:51], a[8:11], v[112:115]
    ds_read_b64_tr_b16 a[82:83], v13 offset:51200
    v_mfma_f32_16x16x32_bf16 v[144:147], a[48:51], a[12:15], v[144:147]
    ds_read_b64_tr_b16 a[84:85], v14 offset:49152
    v_mfma_f32_16x16x32_bf16 v[52:55], a[52:55], a[0:3], v[52:55]
    ds_read_b64_tr_b16 a[86:87], v14 offset:51200
    v_mfma_f32_16x16x32_bf16 v[84:87], a[52:55], a[4:7], v[84:87]
    v_mfma_f32_16x16x32_bf16 v[116:119], a[52:55], a[8:11], v[116:119]
    ds_read_b64_tr_b16 a[88:89], v15 offset:49152
    v_mfma_f32_16x16x32_bf16 v[148:151], a[52:55], a[12:15], v[148:151]
    ds_read_b64_tr_b16 a[90:91], v15 offset:51200
    v_mfma_f32_16x16x32_bf16 v[56:59], a[56:59], a[0:3], v[56:59]
    v_mfma_f32_16x16x32_bf16 v[88:91], a[56:59], a[4:7], v[88:91]
    v_mfma_f32_16x16x32_bf16 v[120:123], a[56:59], a[8:11], v[120:123]
    v_mfma_f32_16x16x32_bf16 v[152:155], a[56:59], a[12:15], v[152:155]
    v_mfma_f32_16x16x32_bf16 v[60:63], a[60:63], a[0:3], v[60:63]
    v_mfma_f32_16x16x32_bf16 v[92:95], a[60:63], a[4:7], v[92:95]
    v_mfma_f32_16x16x32_bf16 v[124:127], a[60:63], a[8:11], v[124:127]
    v_mfma_f32_16x16x32_bf16 v[156:159], a[60:63], a[12:15], v[156:159]
    s_waitcnt lgkmcnt(0)
    v_mfma_f32_16x16x32_bf16 v[32:35], a[32:35], a[16:19], v[32:35]
    v_mfma_f32_16x16x32_bf16 v[64:67], a[32:35], a[20:23], v[64:67]
    v_mfma_f32_16x16x32_bf16 v[96:99], a[32:35], a[24:27], v[96:99]
    v_mfma_f32_16x16x32_bf16 v[128:131], a[32:35], a[28:31], v[128:131]
    v_mfma_f32_16x16x32_bf16 v[36:39], a[64:67], a[16:19], v[36:39]
    v_mfma_f32_16x16x32_bf16 v[68:71], a[64:67], a[20:23], v[68:71]
    v_mfma_f32_16x16x32_bf16 v[100:103], a[64:67], a[24:27], v[100:103]
    v_mfma_f32_16x16x32_bf16 v[132:135], a[64:67], a[28:31], v[132:135]
    v_mfma_f32_16x16x32_bf16 v[40:43], a[68:71], a[16:19], v[40:43]
    v_mfma_f32_16x16x32_bf16 v[72:75], a[68:71], a[20:23], v[72:75]
    v_mfma_f32_16x16x32_bf16 v[104:107], a[68:71], a[24:27], v[104:107]
    v_mfma_f32_16x16x32_bf16 v[136:139], a[68:71], a[28:31], v[136:139]
    v_mfma_f32_16x16x32_bf16 v[44:47], a[72:75], a[16:19], v[44:47]
    v_mfma_f32_16x16x32_bf16 v[76:79], a[72:75], a[20:23], v[76:79]
    v_mfma_f32_16x16x32_bf16 v[108:111], a[72:75], a[24:27], v[108:111]
    v_mfma_f32_16x16x32_bf16 v[140:143], a[72:75], a[28:31], v[140:143]
    v_mfma_f32_16x16x32_bf16 v[48:51], a[76:79], a[16:19], v[48:51]
    v_mfma_f32_16x16x32_bf16 v[80:83], a[76:79], a[20:23], v[80:83]
    v_mfma_f32_16x16x32_bf16 v[112:115], a[76:79], a[24:27], v[112:115]
    v_mfma_f32_16x16x32_bf16 v[144:147], a[76:79], a[28:31], v[144:147]
    v_mfma_f32_16x16x32_bf16 v[52:55], a[80:83], a[16:19], v[52:55]
    v_mfma_f32_16x16x32_bf16 v[84:87], a[80:83], a[20:23], v[84:87]
    v_mfma_f32_16x16x32_bf16 v[116:119], a[80:83], a[24:27], v[116:119]
    v_mfma_f32_16x16x32_bf16 v[148:151], a[80:83], a[28:31], v[148:151]
    v_mfma_f32_16x16x32_bf16 v[56:59], a[84:87], a[16:19], v[56:59]
    v_mfma_f32_16x16x32_bf16 v[88:91], a[84:87], a[20:23], v[88:91]
    v_mfma_f32_16x16x32_bf16 v[120:123], a[84:87], a[24:27], v[120:123]
    v_mfma_f32_16x16x32_bf16 v[152:155], a[84:87], a[28:31], v[152:155]
    v_mfma_f32_16x16x32_bf16 v[60:63], a[88:91], a[16:19], v[60:63]
    v_mfma_f32_16x16x32_bf16 v[92:95], a[88:91], a[20:23], v[92:95]
    v_mfma_f32_16x16x32_bf16 v[124:127], a[88:91], a[24:27], v[124:127]
    v_mfma_f32_16x16x32_bf16 v[156:159], a[88:91], a[28:31], v[156:159]
    s_nop 7
    s_setpc_b64 s[68:69]
core_N:
    s_mov_b32 s84, 0
    s_mov_b32 s85, 0
    s_mov_b64 s[60:61], s[80:81]
    s_mov_b64 s[62:63], s[82:83]
    s_barrier
    s_add_u32 m0, s76, 0
    s_nop 0
    global_load_lds_dwordx4 v28, s[60:61]
    s_add_u32 m0, s76, 1024
    s_nop 0
    global_load_lds_dwordx4 v29, s[60:61]
    s_add_u32 m0, s76, 2048
    s_nop 0
    global_load_lds_dwordx4 v30, s[60:61]
    s_add_u32 m0, s76, 3072
    s_nop 0
    global_load_lds_dwordx4 v31, s[60:61]
    s_or_b32 s84, s84, s86
    s_add_u32 s84, s84, s64
    s_andn2_b32 s84, s84, s86
    s_add_u32 s60, s80, s84
    s_addc_u32 s61, s81, 0
    s_add_u32 m0, s67, 65536
    s_nop 0
    global_load_lds_dwordx4 v4, s[62:63]
    s_add_u32 m0, s67, 66560
    s_nop 0
    global_load_lds_dwordx4 v5, s[62:63]
    s_or_b32 s85, s85, s87
    s_add_u32 s85, s85, s65
    s_andn2_b32 s85, s85, s87
    s_add_u32 s62, s82, s85
    s_addc_u32 s63, s83, 0
    s_add_u32 m0, s67, 81920
    s_nop 0
    global_load_lds_dwordx4 v4, s[62:63]
    s_add_u32 m0, s67, 82944
    s_nop 0
    global_load_lds_dwordx4 v5, s[62:63]
    s_or_b32 s85, s85, s87
    s_add_u32 s85, s85, s65
    s_andn2_b32 s85, s85, s87
    s_add_u32 s62, s82, s85
    s_addc_u32 s63, s83, 0
    s_add_u32 m0, s67, 98304
    s_nop 0
    global_load_lds_dwordx4 v4, s[62:63]
    s_add_u32 m0, s67, 99328
    s_nop 0
    global_load_lds_dwordx4 v5, s[62:63]
    s_or_b32 s85, s85, s87
    s_add_u32 s85, s85, s65
    s_andn2_b32 s85, s85, s87
    s_add_u32 s62, s82, s85
    s_addc_u32 s63, s83, 0
    s_add_u32 m0, s76, 32768
    s_nop 0
    global_load_lds_dwordx4 v28, s[60:61]
    s_add_u32 m0, s76, 33792
    s_nop 0
    global_load_lds_dwordx4 v29, s[60:61]
    s_add_u32 m0, s76, 34816
    s_nop 0
    global_load_lds_dwordx4 v30, s[60:61]
    s_add_u32 m0, s76, 35840
    s_nop 0
    global_load_lds_dwordx4 v31, s[60:61]
    s_or_b32 s84, s84, s86
    s_add_u32 s84, s84, s64
    s_andn2_b32 s84, s84, s86
    s_add_u32 s60, s80, s84
    s_addc_u32 s61, s81, 0
    s_add_u32 m0, s67, 114688
    s_nop 0
    global_load_lds_dwordx4 v4, s[62:63]
    s_add_u32 m0, s67, 115712
    s_nop 0
    global_load_lds_dwordx4 v5, s[62:63]
    s_or_b32 s85, s85, s87
    s_add_u32 s85, s85, s65
    s_andn2_b32 s85, s85, s87
    s_add_u32 s62, s82, s85
    s_addc_u32 s63, s83, 0
    s_cmp_eq_u32 s77, 0
    s_cbranch_scc1 ps_86
    v_cvt_pk_bf16_f32 v24, v32, v33
    v_cvt_pk_bf16_f32 v25, v34, v35
    v_cvt_pk_bf16_f32 v26, v36, v37
    v_cvt_pk_bf16_f32 v27, v38, v39
    global_store_dwordx4 v20, v[24:27], s[28:29] offset:0 sc1
    v_cvt_pk_bf16_f32 v16, v40, v41
    v_cvt_pk_bf16_f32 v17, v42, v43
    v_cvt_pk_bf16_f32 v18, v44, v45
    v_cvt_pk_bf16_f32 v19, v46, v47
    global_store_dwordx4 v20, v[16:19], s[28:29] offset:1024 sc1
    v_cvt_pk_bf16_f32 v24, v48, v49
    v_cvt_pk_bf16_f32 v25, v50, v51
    v_cvt_pk_bf16_f32 v26, v52, v53
    v_cvt_pk_bf16_f32 v27, v54, v55
    global_store_dwordx4 v20, v[24:27], s[28:29] offset:2048 sc1
    v_cvt_pk_bf16_f32 v16, v56, v57
    v_cvt_pk_bf16_f32 v17, v58, v59
    v_cvt_pk_bf16_f32 v18, v60, v61
    v_cvt_pk_bf16_f32 v19, v62, v63
    global_store_dwordx4 v20, v[16:19], s[28:29] offset:3072 sc1
    v_cvt_pk_bf16_f32 v24, v64, v65
    v_cvt_pk_bf16_f32 v25, v66, v67
    v_cvt_pk_bf16_f32 v26, v68, v69
    v_cvt_pk_bf16_f32 v27, v70, v71
    global_store_dwordx4 v21, v[24:27], s[28:29] offset:0 sc1
    v_cvt_pk_bf16_f32 v16, v72, v73
    v_cvt_pk_bf16_f32 v17, v74, v75
    v_cvt_pk_bf16_f32 v18, v76, v77
    v_cvt_pk_bf16_f32 v19, v78, v79
    global_store_dwordx4 v21, v[16:19], s[28:29] offset:1024 sc1
    v_cvt_pk_bf16_f32 v24, v80, v81
    v_cvt_pk_bf16_f32 v25, v82, v83
    v_cvt_pk_bf16_f32 v26, v84, v85
    v_cvt_pk_bf16_f32 v27, v86, v87
    global_store_dwordx4 v21, v[24:27], s[28:29] offset:2048 sc1
    v_cvt_pk_bf16_f32 v16, v88, v89
    v_cvt_pk_bf16_f32 v17, v90, v91
    v_cvt_pk_bf16_f32 v18, v92, v93
    v_cvt_pk_bf16_f32 v19, v94, v95
    global_store_dwordx4 v21, v[16:19], s[28:29] offset:3072 sc1
    v_cvt_pk_bf16_f32 v24, v96, v97
    v_cvt_pk_bf16_f32 v25, v98, v99
    v_cvt_pk_bf16_f32 v26, v100, v101
    v_cvt_pk_bf16_f32 v27, v102, v103
    global_store_dwordx4 v22, v[24:27], s[28:29] offset:0 sc1
    v_cvt_pk_bf16_f32 v16, v104, v105
    v_cvt_pk_bf16_f32 v17, v106, v107
    v_cvt_pk_bf16_f32 v18, v108, v109
    v_cvt_pk_bf16_f32 v19, v110, v111
    global_store_dwordx4 v22, v[16:19], s[28:29] offset:1024 sc1
    v_cvt_pk_bf16_f32 v24, v112, v113
    v_cvt_pk_bf16_f32 v25, v114, v115
    v_cvt_pk_bf16_f32 v26, v116, v117
    v_cvt_pk_bf16_f32 v27, v118, v119
    global_store_dwordx4 v22, v[24:27], s[28:29] offset:2048 sc1
    v_cvt_pk_bf16_f32 v16, v120, v121
    v_cvt_pk_bf16_f32 v17, v122, v123
    v_cvt_pk_bf16_f32 v18, v124, v125
    v_cvt_pk_bf16_f32 v19, v126, v127
    global_store_dwordx4 v22, v[16:19], s[28:29] offset:3072 sc1
ps_86:
core_N_m:
    v_mov_b32 v32, 0
    v_mov_b32 v33, 0
    v_mov_b32 v34, 0
    v_mov_b32 v35, 0
    v_mov_b32 v36, 0
    v_mov_b32 v37, 0
    v_mov_b32 v38, 0
    v_mov_b32 v39, 0
    v_mov_b32 v40, 0
    v_mov_b32 v41, 0
    v_mov_b32 v42, 0
    v_mov_b32 v43, 0
    v_mov_b32 v44, 0
    v_mov_b32 v45, 0
    v_mov_b32 v46, 0
    v_mov_b32 v47, 0
    v_mov_b32 v48, 0
    v_mov_b32 v49, 0
    v_mov_b32 v50, 0
    v_mov_b32 v51, 0
    v_mov_b32 v52, 0
    v_mov_b32 v53, 0
    v_mov_b32 v54, 0
    v_mov_b32 v55, 0
    v_mov_b32 v56, 0
    v_mov_b32 v57, 0
    v_mov_b32 v58, 0
    v_mov_b32 v59, 0
    v_mov_b32 v60, 0
    v_mov_b32 v61, 0
    v_mov_b32 v62, 0
    v_mov_b32 v63, 0
    v_mov_b32 v64, 0
    v_mov_b32 v65, 0
    v_mov_b32 v66, 0
    v_mov_b32 v67, 0
    v_mov_b32 v68, 0
    v_mov_b32 v69, 0
    v_mov_b32 v70, 0
    v_mov_b32 v71, 0
    v_mov_b32 v72, 0
    v_mov_b32 v73, 0
    v_mov_b32 v74, 0
    v_mov_b32 v75, 0
    v_mov_b32 v76, 0
    v_mov_b32 v77, 0
    v_mov_b32 v78, 0
    v_mov_b32 v79, 0
    v_mov_b32 v80, 0
    v_mov_b32 v81, 0
    v_mov_b32 v82, 0
    v_mov_b32 v83, 0
    v_mov_b32 v84, 0
    v_mov_b32 v85, 0
    v_mov_b32 v86, 0
    v_mov_b32 v87, 0
    v_mov_b32 v88, 0
    v_mov_b32 v89, 0
    v_mov_b32 v90, 0
    v_mov_b32 v91, 0
    v_mov_b32 v92, 0
    v_mov_b32 v93, 0
    v_mov_b32 v94, 0
    v_mov_b32 v95, 0
    v_mov_b32 v96, 0
    v_mov_b32 v97, 0
    v_mov_b32 v98, 0
    v_mov_b32 v99, 0
    v_mov_b32 v100, 0
    v_mov_b32 v101, 0
    v_mov_b32 v102, 0
    v_mov_b32 v103, 0
    v_mov_b32 v104, 0
    v_mov_b32 v105, 0
    v_mov_b32 v106, 0
    v_mov_b32 v107, 0
    v_mov_b32 v108, 0
    v_mov_b32 v109, 0
    v_mov_b32 v110, 0
    v_mov_b32 v111, 0
    v_mov_b32 v112, 0
    v_mov_b32 v113, 0
    v_mov_b32 v114, 0
    v_mov_b32 v115, 0
    v_mov_b32 v116, 0
    v_mov_b32 v117, 0
    v_mov_b32 v118, 0
    v_mov_b32 v119, 0
    v_mov_b32 v120, 0
    v_mov_b32 v121, 0
    v_mov_b32 v122, 0
    v_mov_b32 v123, 0
    v_mov_b32 v124, 0
    v_mov_b32 v125, 0
    v_mov_b32 v126, 0
    v_mov_b32 v127, 0
    v_mov_b32 v128, 0
    v_mov_b32 v129, 0
    v_mov_b32 v130, 0
    v_mov_b32 v131, 0
    v_mov_b32 v132, 0
    v_mov_b32 v133, 0
    v_mov_b32 v134, 0
    v_mov_b32 v135, 0
    v_mov_b32 v136, 0
    v_mov_b32 v137, 0
    v_mov_b32 v138, 0
    v_mov_b32 v139, 0
    v_mov_b32 v140, 0
    v_mov_b32 v141, 0
    v_mov_b32 v142, 0
    v_mov_b32 v143, 0
    v_mov_b32 v144, 0
    v_mov_b32 v145, 0
    v_mov_b32 v146, 0
    v_mov_b32 v147, 0
    v_mov_b32 v148, 0
    v_mov_b32 v149, 0
    v_mov_b32 v150, 0
    v_mov_b32 v151, 0
    v_mov_b32 v152, 0
    v_mov_b32 v153, 0
    v_mov_b32 v154, 0
    v_mov_b32 v155, 0
    v_mov_b32 v156, 0
    v_mov_b32 v157, 0
    v_mov_b32 v158, 0
    v_mov_b32 v159, 0
    s_cmp_eq_u32 s77, 0
    s_cbranch_scc1 cw_87
    s_waitcnt vmcnt(22)
    s_branch cw_88
cw_87:
    s_waitcnt vmcnt(10)
cw_88:
    s_barrier
    ds_read_b128 a[0:3], v6 offset:0
    ds_read_b128 a[4:7], v6 offset:2048
    ds_read_b128 a[8:11], v6 offset:4096
    ds_read_b128 a[12:15], v6 offset:6144
    ds_read_b64_tr_b16 a[32:33], v8 offset:0
    ds_read_b64_tr_b16 a[34:35], v8 offset:2048
    ds_read_b64_tr_b16 a[36:37], v9 offset:0
    ds_read_b64_tr_b16 a[38:39], v9 offset:2048
    ds_read_b64_tr_b16 a[40:41], v10 offset:0
    ds_read_b64_tr_b16 a[42:43], v10 offset:2048
    ds_read_b64_tr_b16 a[44:45], v11 offset:0
    ds_read_b64_tr_b16 a[46:47], v11 offset:2048
    s_waitcnt lgkmcnt(4)
    ds_read_b64_tr_b16 a[48:49], v12 offset:0
    ds_read_b64_tr_b16 a[50:51], v12 offset:2048
    ds_read_b64_tr_b16 a[52:53], v13 offset:0
    ds_read_b64_tr_b16 a[54:55], v13 offset:2048
    ds_read_b64_tr_b16 a[56:57], v14 offset:0
    ds_read_b64_tr_b16 a[58:59], v14 offset:2048
    ds_read_b64_tr_b16 a[60:61], v15 offset:0
    ds_read_b64_tr_b16 a[62:63], v15 offset:2048
    s_cmp_eq_u32 s77, 0
    s_cbranch_scc1 cw_89
    s_waitcnt vmcnt(20) lgkmcnt(0)
    s_branch cw_90
cw_89:
    s_waitcnt vmcnt(8) lgkmcnt(0)
cw_90:
    s_barrier
    v_mfma_f32_16x16x32_bf16 v[32:35], a[0:3], a[32:35], v[32:35]
    s_add_u32 m0, s67, 65536
    ds_read_b128 a[16:19], v7 offset:0
    v_mfma_f32_16x16x32_bf16 v[64:67], a[4:7], a[32:35], v[64:67]
    global_load_lds_dwordx4 v4, s[62:63]
    ds_read_b128 a[20:23], v7 offset:2048
    v_mfma_f32_16x16x32_bf16 v[96:99], a[8:11], a[32:35], v[96:99]
    ds_read_b128 a[24:27], v7 offset:4096
    v_mfma_f32_16x16x32_bf16 v[128:131], a[12:15], a[32:35], v[128:131]
    ds_read_b64_tr_b16 a[32:33], v8 offset:16384
    ds_read_b64_tr_b16 a[34:35], v8 offset:18432
    v_mfma_f32_16x16x32_bf16 v[36:39], a[0:3], a[36:39], v[36:39]
    s_add_u32 m0, s67, 66560
    ds_read_b128 a[28:31], v7 offset:6144
    v_mfma_f32_16x16x32_bf16 v[68:71], a[4:7], a[36:39], v[68:71]
    global_load_lds_dwordx4 v5, s[62:63]
    ds_read_b64_tr_b16 a[64:65], v9 offset:16384
    v_mfma_f32_16x16x32_bf16 v[100:103], a[8:11], a[36:39], v[100:103]
    ds_read_b64_tr_b16 a[66:67], v9 offset:18432
    v_mfma_f32_16x16x32_bf16 v[132:135], a[12:15], a[36:39], v[132:135]
    v_mfma_f32_16x16x32_bf16 v[40:43], a[0:3], a[40:43], v[40:43]
    ds_read_b64_tr_b16 a[68:69], v10 offset:16384
    v_mfma_f32_16x16x32_bf16 v[72:75], a[4:7], a[40:43], v[72:75]
    ds_read_b64_tr_b16 a[70:71], v10 offset:18432
    v_mfma_f32_16x16x32_bf16 v[104:107], a[8:11], a[40:43], v[104:107]
    v_mfma_f32_16x16x32_bf16 v[136:139], a[12:15], a[40:43], v[136:139]
    ds_read_b64_tr_b16 a[72:73], v11 offset:16384
    v_mfma_f32_16x16x32_bf16 v[44:47], a[0:3], a[44:47], v[44:47]
    ds_read_b64_tr_b16 a[74:75], v11 offset:18432
    v_mfma_f32_16x16x32_bf16 v[76:79], a[4:7], a[44:47], v[76:79]
    ds_read_b64_tr_b16 a[76:77], v12 offset:16384
    v_mfma_f32_16x16x32_bf16 v[108:111], a[8:11], a[44:47], v[108:111]
    v_mfma_f32_16x16x32_bf16 v[140:143], a[12:15], a[44:47], v[140:143]
    s_waitcnt lgkmcnt(6)
    ds_read_b64_tr_b16 a[78:79], v12 offset:18432
    v_mfma_f32_16x16x32_bf16 v[48:51], a[0:3], a[48:51], v[48:51]
    ds_read_b64_tr_b16 a[80:81], v13 offset:16384
    v_mfma_f32_16x16x32_bf16 v[80:83], a[4:7], a[48:51], v[80:83]
    v_mfma_f32_16x16x32_bf16 v[112:115], a[8:11], a[48:51], v[112:115]
    ds_read_b64_tr_b16 a[82:83], v13 offset:18432
    v_mfma_f32_16x16x32_bf16 v[144:147], a[12:15], a[48:51], v[144:147]
    ds_read_b64_tr_b16 a[84:85], v14 offset:16384
    v_mfma_f32_16x16x32_bf16 v[52:55], a[0:3], a[52:55], v[52:55]
    ds_read_b64_tr_b16 a[86:87], v14 offset:18432
    v_mfma_f32_16x16x32_bf16 v[84:87], a[4:7], a[52:55], v[84:87]
    v_mfma_f32_16x16x32_bf16 v[116:119], a[8:11], a[52:55], v[116:119]
    ds_read_b64_tr_b16 a[88:89], v15 offset:16384
    v_mfma_f32_16x16x32_bf16 v[148:151], a[12:15], a[52:55], v[148:151]
    ds_read_b64_tr_b16 a[90:91], v15 offset:18432
    v_mfma_f32_16x16x32_bf16 v[56:59], a[0:3], a[56:59], v[56:59]
    s_or_b32 s85, s85, s87
    s_add_u32 s85, s85, s65
    s_andn2_b32 s85, s85, s87
    s_add_u32 s62, s82, s85
    s_addc_u32 s63, s83, 0
    v_mfma_f32_16x16x32_bf16 v[88:91], a[4:7], a[56:59], v[88:91]
    v_mfma_f32_16x16x32_bf16 v[120:123], a[8:11], a[56:59], v[120:123]
    v_mfma_f32_16x16x32_bf16 v[152:155], a[12:15], a[56:59], v[152:155]
    v_mfma_f32_16x16x32_bf16 v[60:63], a[0:3], a[60:63], v[60:63]
    v_mfma_f32_16x16x32_bf16 v[92:95], a[4:7], a[60:63], v[92:95]
    v_mfma_f32_16x16x32_bf16 v[124:127], a[8:11], a[60:63], v[124:127]
    v_mfma_f32_16x16x32_bf16 v[156:159], a[12:15], a[60:63], v[156:159]
    s_cmp_eq_u32 s77, 0
    s_cbranch_scc1 cw_91
    s_waitcnt vmcnt(16) lgkmcnt(0)
    s_branch cw_92
cw_91:
    s_waitcnt vmcnt(4) lgkmcnt(0)
cw_92:
    s_barrier
    v_mfma_f32_16x16x32_bf16 v[32:35], a[16:19], a[32:35], v[32:35]
    s_add_u32 m0, s76, 0
    ds_read_b128 a[0:3], v6 offset:32768
    v_mfma_f32_16x16x32_bf16 v[64:67], a[20:23], a[32:35], v[64:67]
    global_load_lds_dwordx4 v28, s[60:61]
    ds_read_b128 a[4:7], v6 offset:34816
    v_mfma_f32_16x16x32_bf16 v[96:99], a[24:27], a[32:35], v[96:99]
    ds_read_b128 a[8:11], v6 offset:36864
    v_mfma_f32_16x16x32_bf16 v[128:131], a[28:31], a[32:35], v[128:131]
    ds_read_b64_tr_b16 a[32:33], v8 offset:32768
    ds_read_b64_tr_b16 a[34:35], v8 offset:34816
    v_mfma_f32_16x16x32_bf16 v[36:39], a[16:19], a[64:67], v[36:39]
    s_add_u32 m0, s76, 1024
    ds_read_b128 a[12:15], v6 offset:38912
    v_mfma_f32_16x16x32_bf16 v[68:71], a[20:23], a[64:67], v[68:71]
    global_load_lds_dwordx4 v29, s[60:61]
    ds_read_b64_tr_b16 a[36:37], v9 offset:32768
    v_mfma_f32_16x16x32_bf16 v[100:103], a[24:27], a[64:67], v[100:103]
    ds_read_b64_tr_b16 a[38:39], v9 offset:34816
    v_mfma_f32_16x16x32_bf16 v[132:135], a[28:31], a[64:67], v[132:135]
    v_mfma_f32_16x16x32_bf16 v[40:43], a[16:19], a[68:71], v[40:43]
    s_add_u32 m0, s76, 2048
    ds_read_b64_tr_b16 a[40:41], v10 offset:32768
    v_mfma_f32_16x16x32_bf16 v[72:75], a[20:23], a[68:71], v[72:75]
    global_load_lds_dwordx4 v30, s[60:61]
    ds_read_b64_tr_b16 a[42:43], v10 offset:34816
    v_mfma_f32_16x16x32_bf16 v[104:107], a[24:27], a[68:71], v[104:107]
    v_mfma_f32_16x16x32_bf16 v[136:139], a[28:31], a[68:71], v[136:139]
    ds_read_b64_tr_b16 a[44:45], v11 offset:32768
    v_mfma_f32_16x16x32_bf16 v[44:47], a[16:19], a[72:75], v[44:47]
    s_add_u32 m0, s76, 3072
    ds_read_b64_tr_b16 a[46:47], v11 offset:34816
    v_mfma_f32_16x16x32_bf16 v[76:79], a[20:23], a[72:75], v[76:79]
    global_load_lds_dwordx4 v31, s[60:61]
    ds_read_b64_tr_b16 a[48:49], v12 offset:32768
    v_mfma_f32_16x16x32_bf16 v[108:111], a[24:27], a[72:75], v[108:111]
    v_mfma_f32_16x16x32_bf16 v[140:143], a[28:31], a[72:75], v[140:143]
    s_waitcnt lgkmcnt(6)
    ds_read_b64_tr_b16 a[50:51], v12 offset:34816
    v_mfma_f32_16x16x32_bf16 v[48:51], a[16:19], a[76:79], v[48:51]
    s_add_u32 m0, s67, 81920
    ds_read_b64_tr_b16 a[52:53], v13 offset:32768
    v_mfma_f32_16x16x32_bf16 v[80:83], a[20:23], a[76:79], v[80:83]
    global_load_lds_dwordx4 v4, s[62:63]
    v_mfma_f32_16x16x32_bf16 v[112:115], a[24:27], a[76:79], v[112:115]
    ds_read_b64_tr_b16 a[54:55], v13 offset:34816
    v_mfma_f32_16x16x32_bf16 v[144:147], a[28:31], a[76:79], v[144:147]
    ds_read_b64_tr_b16 a[56:57], v14 offset:32768
    v_mfma_f32_16x16x32_bf16 v[52:55], a[16:19], a[80:83], v[52:55]
    s_add_u32 m0, s67, 82944
    ds_read_b64_tr_b16 a[58:59], v14 offset:34816
    v_mfma_f32_16x16x32_bf16 v[84:87], a[20:23], a[80:83], v[84:87]
    global_load_lds_dwordx4 v5, s[62:63]
    v_mfma_f32_16x16x32_bf16 v[116:119], a[24:27], a[80:83], v[116:119]
    ds_read_b64_tr_b16 a[60:61], v15 offset:32768
    v_mfma_f32_16x16x32_bf16 v[148:151], a[28:31], a[80:83], v[148:151]
    ds_read_b64_tr_b16 a[62:63], v15 offset:34816
    v_mfma_f32_16x16x32_bf16 v[56:59], a[16:19], a[84:87], v[56:59]
    s_or_b32 s85, s85, s87
    s_add_u32 s85, s85, s65
    s_andn2_b32 s85, s85, s87
    s_add_u32 s62, s82, s85
    s_addc_u32 s63, s83, 0
    v_mfma_f32_16x16x32_bf16 v[88:91], a[20:23], a[84:87], v[88:91]
    v_mfma_f32_16x16x32_bf16 v[120:123], a[24:27], a[84:87], v[120:123]
    v_mfma_f32_16x16x32_bf16 v[152:155], a[28:31], a[84:87], v[152:155]
    v_mfma_f32_16x16x32_bf16 v[60:63], a[16:19], a[88:91], v[60:63]
    s_or_b32 s84, s84, s86
    s_add_u32 s84, s84, s64
    s_andn2_b32 s84, s84, s86
    s_add_u32 s60, s80, s84
    s_addc_u32 s61, s81, 0
    v_mfma_f32_16x16x32_bf16 v[92:95], a[20:23], a[88:91], v[92:95]
    v_mfma_f32_16x16x32_bf16 v[124:127], a[24:27], a[88:91], v[124:127]
    v_mfma_f32_16x16x32_bf16 v[156:159], a[28:31], a[88:91], v[156:159]
    s_cmp_eq_u32 s77, 0
    s_cbranch_scc1 cw_93
    s_waitcnt vmcnt(20) lgkmcnt(0)
    s_branch cw_94
cw_93:
    s_waitcnt vmcnt(8) lgkmcnt(0)
cw_94:
    s_barrier
    v_mfma_f32_16x16x32_bf16 v[32:35], a[0:3], a[32:35], v[32:35]
    s_add_u32 m0, s67, 98304
    ds_read_b128 a[16:19], v7 offset:32768
    v_mfma_f32_16x16x32_bf16 v[64:67], a[4:7], a[32:35], v[64:67]
    global_load_lds_dwordx4 v4, s[62:63]
    ds_read_b128 a[20:23], v7 offset:34816
    v_mfma_f32_16x16x32_bf16 v[96:99], a[8:11], a[32:35], v[96:99]
    ds_read_b128 a[24:27], v7 offset:36864
    v_mfma_f32_16x16x32_bf16 v[128:131], a[12:15], a[32:35], v[128:131]
    ds_read_b64_tr_b16 a[32:33], v8 offset:49152
    ds_read_b64_tr_b16 a[34:35], v8 offset:51200
    v_mfma_f32_16x16x32_bf16 v[36:39], a[0:3], a[36:39], v[36:39]
    s_add_u32 m0, s67, 99328
    ds_read_b128 a[28:31], v7 offset:38912
    v_mfma_f32_16x16x32_bf16 v[68:71], a[4:7], a[36:39], v[68:71]
    global_load_lds_dwordx4 v5, s[62:63]
    ds_read_b64_tr_b16 a[64:65], v9 offset:49152
    v_mfma_f32_16x16x32_bf16 v[100:103], a[8:11], a[36:39], v[100:103]
    ds_read_b64_tr_b16 a[66:67], v9 offset:51200
    v_mfma_f32_16x16x32_bf16 v[132:135], a[12:15], a[36:39], v[132:135]
    v_mfma_f32_16x16x32_bf16 v[40:43], a[0:3], a[40:43], v[40:43]
    ds_read_b64_tr_b16 a[68:69], v10 offset:49152
    v_mfma_f32_16x16x32_bf16 v[72:75], a[4:7], a[40:43], v[72:75]
    ds_read_b64_tr_b16 a[70:71], v10 offset:51200
    v_mfma_f32_16x16x32_bf16 v[104:107], a[8:11], a[40:43], v[104:107]
    v_mfma_f32_16x16x32_bf16 v[136:139], a[12:15], a[40:43], v[136:139]
    ds_read_b64_tr_b16 a[72:73], v11 offset:49152
    v_mfma_f32_16x16x32_bf16 v[44:47], a[0:3], a[44:47], v[44:47]
    ds_read_b64_tr_b16 a[74:75], v11 offset:51200
    v_mfma_f32_16x16x32_bf16 v[76:79], a[4:7], a[44:47], v[76:79]
    ds_read_b64_tr_b16 a[76:77], v12 offset:49152
    v_mfma_f32_16x16x32_bf16 v[108:111], a[8:11], a[44:47], v[108:111]
    v_mfma_f32_16x16x32_bf16 v[140:143], a[12:15], a[44:47], v[140:143]
    s_waitcnt lgkmcnt(6)
    ds_read_b64_tr_b16 a[78:79], v12 offset:51200
    v_mfma_f32_16x16x32_bf16 v[48:51], a[0:3], a[48:51], v[48:51]
    ds_read_b64_tr_b16 a[80:81], v13 offset:49152
    v_mfma_f32_16x16x32_bf16 v[80:83], a[4:7], a[48:51], v[80:83]
    v_mfma_f32_16x16x32_bf16 v[112:115], a[8:11], a[48:51], v[112:115]
    ds_read_b64_tr_b16 a[82:83], v13 offset:51200
    v_mfma_f32_16x16x32_bf16 v[144:147], a[12:15], a[48:51], v[144:147]
    ds_read_b64_tr_b16 a[84:85], v14 offset:49152
    v_mfma_f32_16x16x32_bf16 v[52:55], a[0:3], a[52:55], v[52:55]
    ds_read_b64_tr_b16 a[86:87], v14 offset:51200
    v_mfma_f32_16x16x32_bf16 v[84:87], a[4:7], a[52:55], v[84:87]
    v_mfma_f32_16x16x32_bf16 v[116:119], a[8:11], a[52:55], v[116:119]
    ds_read_b64_tr_b16 a[88:89], v15 offset:49152
    v_mfma_f32_16x16x32_bf16 v[148:151], a[12:15], a[52:55], v[148:151]
    ds_read_b64_tr_b16 a[90:91], v15 offset:51200
    v_mfma_f32_16x16x32_bf16 v[56:59], a[0:3], a[56:59], v[56:59]
    s_or_b32 s85, s85, s87
    s_add_u32 s85, s85, s65
    s_andn2_b32 s85, s85, s87
    s_add_u32 s62, s82, s85
    s_addc_u32 s63, s83, 0
    v_mfma_f32_16x16x32_bf16 v[88:91], a[4:7], a[56:59], v[88:91]
    v_mfma_f32_16x16x32_bf16 v[120:123], a[8:11], a[56:59], v[120:123]
    v_mfma_f32_16x16x32_bf16 v[152:155], a[12:15], a[56:59], v[152:155]
    v_mfma_f32_16x16x32_bf16 v[60:63], a[0:3], a[60:63], v[60:63]
    v_mfma_f32_16x16x32_bf16 v[92:95], a[4:7], a[60:63], v[92:95]
    v_mfma_f32_16x16x32_bf16 v[124:127], a[8:11], a[60:63], v[124:127]
    v_mfma_f32_16x16x32_bf16 v[156:159], a[12:15], a[60:63], v[156:159]
    s_waitcnt vmcnt(4) lgkmcnt(0)
    s_barrier
    s_mov_b32 s77, 0
    s_cmp_eq_u32 s89, 0
    s_cbranch_scc1 core_N_ns
    s_mov_b32 s89, 0
    s_cmp_eq_u32 s75, 0
    s_cbranch_scc0 core_N_ns
    v_mov_b32 v16, s88
    v_mov_b32 v17, 0
    s_mov_b64 exec, 1
    global_store_dword v16, v17, s[28:29] sc1
    s_mov_b64 exec, -1
core_N_ns:
    v_mfma_f32_16x16x32_bf16 v[32:35], a[16:19], a[32:35], v[32:35]
    s_add_u32 m0, s76, 32768
    ds_read_b128 a[0:3], v6 offset:0
    v_mfma_f32_16x16x32_bf16 v[64:67], a[20:23], a[32:35], v[64:67]
    global_load_lds_dwordx4 v28, s[60:61]
    ds_read_b128 a[4:7], v6 offset:2048
    v_mfma_f32_16x16x32_bf16 v[96:99], a[24:27], a[32:35], v[96:99]
    ds_read_b128 a[8:11], v6 offset:4096
    v_mfma_f32_16x16x32_bf16 v[128:131], a[28:31], a[32:35], v[128:131]
    ds_read_b64_tr_b16 a[32:33], v8 offset:0
    ds_read_b64_tr_b16 a[34:35], v8 offset:2048
    v_mfma_f32_16x16x32_bf16 v[36:39], a[16:19], a[64:67], v[36:39]
    s_add_u32 m0, s76, 33792
    ds_read_b128 a[12:15], v6 offset:6144
    v_mfma_f32_16x16x32_bf16 v[68:71], a[20:23], a[64:67], v[68:71]
    global_load_lds_dwordx4 v29, s[60:61]
    ds_read_b64_tr_b16 a[36:37], v9 offset:0
    v_mfma_f32_16x16x32_bf16 v[100:103], a[24:27], a[64:67], v[100:103]
    ds_read_b64_tr_b16 a[38:39], v9 offset:2048
    v_mfma_f32_16x16x32_bf16 v[132:135], a[28:31], a[64:67], v[132:135]
    v_mfma_f32_16x16x32_bf16 v[40:43], a[16:19], a[68:71], v[40:43]
    s_add_u32 m0, s76, 34816
    ds_read_b64_tr_b16 a[40:41], v10 offset:0
    v_mfma_f32_16x16x32_bf16 v[72:75], a[20:23], a[68:71], v[72:75]
    global_load_lds_dwordx4 v30, s[60:61]
    ds_read_b64_tr_b16 a[42:43], v10 offset:2048
    v_mfma_f32_16x16x32_bf16 v[104:107], a[24:27], a[68:71], v[104:107]
    v_mfma_f32_16x16x32_bf16 v[136:139], a[28:31], a[68:71], v[136:139]
    ds_read_b64_tr_b16 a[44:45], v11 offset:0
    v_mfma_f32_16x16x32_bf16 v[44:47], a[16:19], a[72:75], v[44:47]
    s_add_u32 m0, s76, 35840
    ds_read_b64_tr_b16 a[46:47], v11 offset:2048
    v_mfma_f32_16x16x32_bf16 v[76:79], a[20:23], a[72:75], v[76:79]
    global_load_lds_dwordx4 v31, s[60:61]
    ds_read_b64_tr_b16 a[48:49], v12 offset:0
    v_mfma_f32_16x16x32_bf16 v[108:111], a[24:27], a[72:75], v[108:111]
    v_mfma_f32_16x16x32_bf16 v[140:143], a[28:31], a[72:75], v[140:143]
    s_waitcnt lgkmcnt(6)
    ds_read_b64_tr_b16 a[50:51], v12 offset:2048
    v_mfma_f32_16x16x32_bf16 v[48:51], a[16:19], a[76:79], v[48:51]
    s_add_u32 m0, s67, 114688
    ds_read_b64_tr_b16 a[52:53], v13 offset:0
    v_mfma_f32_16x16x32_bf16 v[80:83], a[20:23], a[76:79], v[80:83]
    global_load_lds_dwordx4 v4, s[62:63]
    v_mfma_f32_16x16x32_bf16 v[112:115], a[24:27], a[76:79], v[112:115]
    ds_read_b64_tr_b16 a[54:55], v13 offset:2048
    v_mfma_f32_16x16x32_bf16 v[144:147], a[28:31], a[76:79], v[144:147]
    ds_read_b64_tr_b16 a[56:57], v14 offset:0
    v_mfma_f32_16x16x32_bf16 v[52:55], a[16:19], a[80:83], v[52:55]
    s_add_u32 m0, s67, 115712
    ds_read_b64_tr_b16 a[58:59], v14 offset:2048
    v_mfma_f32_16x16x32_bf16 v[84:87], a[20:23], a[80:83], v[84:87]
    global_load_lds_dwordx4 v5, s[62:63]
    v_mfma_f32_16x16x32_bf16 v[116:119], a[24:27], a[80:83], v[116:119]
    ds_read_b64_tr_b16 a[60:61], v15 offset:0
    v_mfma_f32_16x16x32_bf16 v[148:151], a[28:31], a[80:83], v[148:151]
    ds_read_b64_tr_b16 a[62:63], v15 offset:2048
    v_mfma_f32_16x16x32_bf16 v[56:59], a[16:19], a[84:87], v[56:59]
    s_or_b32 s85, s85, s87
    s_add_u32 s85, s85, s65
    s_andn2_b32 s85, s85, s87
    s_add_u32 s62, s82, s85
    s_addc_u32 s63, s83, 0
    v_mfma_f32_16x16x32_bf16 v[88:91], a[20:23], a[84:87], v[88:91]
    v_mfma_f32_16x16x32_bf16 v[120:123], a[24:27], a[84:87], v[120:123]
    v_mfma_f32_16x16x32_bf16 v[152:155], a[28:31], a[84:87], v[152:155]
    v_mfma_f32_16x16x32_bf16 v[60:63], a[16:19], a[88:91], v[60:63]
    s_or_b32 s84, s84, s86
    s_add_u32 s84, s84, s64
    s_andn2_b32 s84, s84, s86
    s_add_u32 s60, s80, s84
    s_addc_u32 s61, s81, 0
    v_mfma_f32_16x16x32_bf16 v[92:95], a[20:23], a[88:91], v[92:95]
    v_mfma_f32_16x16x32_bf16 v[124:127], a[24:27], a[88:91], v[124:127]
    v_mfma_f32_16x16x32_bf16 v[156:159], a[28:31], a[88:91], v[156:159]
    s_sub_u32 s66, s66, 1
core_N_loop:
    s_waitcnt vmcnt(8) lgkmcnt(0)
    s_barrier
    v_mfma_f32_16x16x32_bf16 v[32:35], a[0:3], a[32:35], v[32:35]
    s_add_u32 m0, s67, 65536
    ds_read_b128 a[16:19], v7 offset:0
    v_mfma_f32_16x16x32_bf16 v[64:67], a[4:7], a[32:35], v[64:67]
    global_load_lds_dwordx4 v4, s[62:63]
    ds_read_b128 a[20:23], v7 offset:2048
    v_mfma_f32_16x16x32_bf16 v[96:99], a[8:11], a[32:35], v[96:99]
    ds_read_b128 a[24:27], v7 offset:4096
    v_mfma_f32_16x16x32_bf16 v[128:131], a[12:15], a[32:35], v[128:131]
    ds_read_b64_tr_b16 a[32:33], v8 offset:16384
    ds_read_b64_tr_b16 a[34:35], v8 offset:18432
    v_mfma_f32_16x16x32_bf16 v[36:39], a[0:3], a[36:39], v[36:39]
    s_add_u32 m0, s67, 66560
    ds_read_b128 a[28:31], v7 offset:6144
    v_mfma_f32_16x16x32_bf16 v[68:71], a[4:7], a[36:39], v[68:71]
    global_load_lds_dwordx4 v5, s[62:63]
    ds_read_b64_tr_b16 a[64:65], v9 offset:16384
    v_mfma_f32_16x16x32_bf16 v[100:103], a[8:11], a[36:39], v[100:103]
    ds_read_b64_tr_b16 a[66:67], v9 offset:18432
    v_mfma_f32_16x16x32_bf16 v[132:135], a[12:15], a[36:39], v[132:135]
    v_mfma_f32_16x16x32_bf16 v[40:43], a[0:3], a[40:43], v[40:43]
    ds_read_b64_tr_b16 a[68:69], v10 offset:16384
    v_mfma_f32_16x16x32_bf16 v[72:75], a[4:7], a[40:43], v[72:75]
    ds_read_b64_tr_b16 a[70:71], v10 offset:18432
    v_mfma_f32_16x16x32_bf16 v[104:107], a[8:11], a[40:43], v[104:107]
    v_mfma_f32_16x16x32_bf16 v[136:139], a[12:15], a[40:43], v[136:139]
    ds_read_b64_tr_b16 a[72:73], v11 offset:16384
    v_mfma_f32_16x16x32_bf16 v[44:47], a[0:3], a[44:47], v[44:47]
    ds_read_b64_tr_b16 a[74:75], v11 offset:18432
    v_mfma_f32_16x16x32_bf16 v[76:79], a[4:7], a[44:47], v[76:79]
    ds_read_b64_tr_b16 a[76:77], v12 offset:16384
    v_mfma_f32_16x16x32_bf16 v[108:111], a[8:11], a[44:47], v[108:111]
    v_mfma_f32_16x16x32_bf16 v[140:143], a[12:15], a[44:47], v[140:143]
    s_waitcnt lgkmcnt(6)
    ds_read_b64_tr_b16 a[78:79], v12 offset:18432
    v_mfma_f32_16x16x32_bf16 v[48:51], a[0:3], a[48:51], v[48:51]
    ds_read_b64_tr_b16 a[80:81], v13 offset:16384
    v_mfma_f32_16x16x32_bf16 v[80:83], a[4:7], a[48:51], v[80:83]
    v_mfma_f32_16x16x32_bf16 v[112:115], a[8:11], a[48:51], v[112:115]
    ds_read_b64_tr_b16 a[82:83], v13 offset:18432
    v_mfma_f32_16x16x32_bf16 v[144:147], a[12:15], a[48:51], v[144:147]
    ds_read_b64_tr_b16 a[84:85], v14 offset:16384
    v_mfma_f32_16x16x32_bf16 v[52:55], a[0:3], a[52:55], v[52:55]
    ds_read_b64_tr_b16 a[86:87], v14 offset:18432
    v_mfma_f32_16x16x32_bf16 v[84:87], a[4:7], a[52:55], v[84:87]
    v_mfma_f32_16x16x32_bf16 v[116:119], a[8:11], a[52:55], v[116:119]
    ds_read_b64_tr_b16 a[88:89], v15 offset:16384
    v_mfma_f32_16x16x32_bf16 v[148:151], a[12:15], a[52:55], v[148:151]
    ds_read_b64_tr_b16 a[90:91], v15 offset:18432
    v_mfma_f32_16x16x32_bf16 v[56:59], a[0:3], a[56:59], v[56:59]
    s_or_b32 s85, s85, s87
    s_add_u32 s85, s85, s65
    s_andn2_b32 s85, s85, s87
    s_add_u32 s62, s82, s85
    s_addc_u32 s63, s83, 0
    v_mfma_f32_16x16x32_bf16 v[88:91], a[4:7], a[56:59], v[88:91]
    v_mfma_f32_16x16x32_bf16 v[120:123], a[8:11], a[56:59], v[120:123]
    v_mfma_f32_16x16x32_bf16 v[152:155], a[12:15], a[56:59], v[152:155]
    v_mfma_f32_16x16x32_bf16 v[60:63], a[0:3], a[60:63], v[60:63]
    v_mfma_f32_16x16x32_bf16 v[92:95], a[4:7], a[60:63], v[92:95]
    v_mfma_f32_16x16x32_bf16 v[124:127], a[8:11], a[60:63], v[124:127]
    v_mfma_f32_16x16x32_bf16 v[156:159], a[12:15], a[60:63], v[156:159]
    s_waitcnt vmcnt(4) lgkmcnt(0)
    s_barrier
    v_mfma_f32_16x16x32_bf16 v[32:35], a[16:19], a[32:35], v[32:35]
    s_add_u32 m0, s76, 0
    ds_read_b128 a[0:3], v6 offset:32768
    v_mfma_f32_16x16x32_bf16 v[64:67], a[20:23], a[32:35], v[64:67]
    global_load_lds_dwordx4 v28, s[60:61]
    ds_read_b128 a[4:7], v6 offset:34816
    v_mfma_f32_16x16x32_bf16 v[96:99], a[24:27], a[32:35], v[96:99]
    ds_read_b128 a[8:11], v6 offset:36864
    v_mfma_f32_16x16x32_bf16 v[128:131], a[28:31], a[32:35], v[128:131]
    ds_read_b64_tr_b16 a[32:33], v8 offset:32768
    ds_read_b64_tr_b16 a[34:35], v8 offset:34816
    v_mfma_f32_16x16x32_bf16 v[36:39], a[16:19], a[64:67], v[36:39]
    s_add_u32 m0, s76, 1024
    ds_read_b128 a[12:15], v6 offset:38912
    v_mfma_f32_16x16x32_bf16 v[68:71], a[20:23], a[64:67], v[68:71]
    global_load_lds_dwordx4 v29, s[60:61]
    ds_read_b64_tr_b16 a[36:37], v9 offset:32768
    v_mfma_f32_16x16x32_bf16 v[100:103], a[24:27], a[64:67], v[100:103]
    ds_read_b64_tr_b16 a[38:39], v9 offset:34816
    v_mfma_f32_16x16x32_bf16 v[132:135], a[28:31], a[64:67], v[132:135]
    v_mfma_f32_16x16x32_bf16 v[40:43], a[16:19], a[68:71], v[40:43]
    s_add_u32 m0, s76, 2048
    ds_read_b64_tr_b16 a[40:41], v10 offset:32768
    v_mfma_f32_16x16x32_bf16 v[72:75], a[20:23], a[68:71], v[72:75]
    global_load_lds_dwordx4 v30, s[60:61]
    ds_read_b64_tr_b16 a[42:43], v10 offset:34816
    v_mfma_f32_16x16x32_bf16 v[104:107], a[24:27], a[68:71], v[104:107]
    v_mfma_f32_16x16x32_bf16 v[136:139], a[28:31], a[68:71], v[136:139]
    ds_read_b64_tr_b16 a[44:45], v11 offset:32768
    v_mfma_f32_16x16x32_bf16 v[44:47], a[16:19], a[72:75], v[44:47]
    s_add_u32 m0, s76, 3072
    ds_read_b64_tr_b16 a[46:47], v11 offset:34816
    v_mfma_f32_16x16x32_bf16 v[76:79], a[20:23], a[72:75], v[76:79]
    global_load_lds_dwordx4 v31, s[60:61]
    ds_read_b64_tr_b16 a[48:49], v12 offset:32768
    v_mfma_f32_16x16x32_bf16 v[108:111], a[24:27], a[72:75], v[108:111]
    v_mfma_f32_16x16x32_bf16 v[140:143], a[28:31], a[72:75], v[140:143]
    s_waitcnt lgkmcnt(6)
    ds_read_b64_tr_b16 a[50:51], v12 offset:34816
    v_mfma_f32_16x16x32_bf16 v[48:51], a[16:19], a[76:79], v[48:51]
    s_add_u32 m0, s67, 81920
    ds_read_b64_tr_b16 a[52:53], v13 offset:32768
    v_mfma_f32_16x16x32_bf16 v[80:83], a[20:23], a[76:79], v[80:83]
    global_load_lds_dwordx4 v4, s[62:63]
    v_mfma_f32_16x16x32_bf16 v[112:115], a[24:27], a[76:79], v[112:115]
    ds_read_b64_tr_b16 a[54:55], v13 offset:34816
    v_mfma_f32_16x16x32_bf16 v[144:147], a[28:31], a[76:79], v[144:147]
    ds_read_b64_tr_b16 a[56:57], v14 offset:32768
    v_mfma_f32_16x16x32_bf16 v[52:55], a[16:19], a[80:83], v[52:55]
    s_add_u32 m0, s67, 82944
    ds_read_b64_tr_b16 a[58:59], v14 offset:34816
    v_mfma_f32_16x16x32_bf16 v[84:87], a[20:23], a[80:83], v[84:87]
    global_load_lds_dwordx4 v5, s[62:63]
    v_mfma_f32_16x16x32_bf16 v[116:119], a[24:27], a[80:83], v[116:119]
    ds_read_b64_tr_b16 a[60:61], v15 offset:32768
    v_mfma_f32_16x16x32_bf16 v[148:151], a[28:31], a[80:83], v[148:151]
    ds_read_b64_tr_b16 a[62:63], v15 offset:34816
    v_mfma_f32_16x16x32_bf16 v[56:59], a[16:19], a[84:87], v[56:59]
    s_or_b32 s85, s85, s87
    s_add_u32 s85, s85, s65
    s_andn2_b32 s85, s85, s87
    s_add_u32 s62, s82, s85
    s_addc_u32 s63, s83, 0
    v_mfma_f32_16x16x32_bf16 v[88:91], a[20:23], a[84:87], v[88:91]
    v_mfma_f32_16x16x32_bf16 v[120:123], a[24:27], a[84:87], v[120:123]
    v_mfma_f32_16x16x32_bf16 v[152:155], a[28:31], a[84:87], v[152:155]
    v_mfma_f32_16x16x32_bf16 v[60:63], a[16:19], a[88:91], v[60:63]
    s_or_b32 s84, s84, s86
    s_add_u32 s84, s84, s64
    s_andn2_b32 s84, s84, s86
    s_add_u32 s60, s80, s84
    s_addc_u32 s61, s81, 0
    v_mfma_f32_16x16x32_bf16 v[92:95], a[20:23], a[88:91], v[92:95]
    v_mfma_f32_16x16x32_bf16 v[124:127], a[24:27], a[88:91], v[124:127]
    v_mfma_f32_16x16x32_bf16 v[156:159], a[28:31], a[88:91], v[156:159]
    s_waitcnt vmcnt(8) lgkmcnt(0)
    s_barrier
    v_mfma_f32_16x16x32_bf16 v[32:35], a[0:3], a[32:35], v[32:35]
    s_add_u32 m0, s67, 98304
    ds_read_b128 a[16:19], v7 offset:32768
    v_mfma_f32_16x16x32_bf16 v[64:67], a[4:7], a[32:35], v[64:67]
    global_load_lds_dwordx4 v4, s[62:63]
    ds_read_b128 a[20:23], v7 offset:34816
    v_mfma_f32_16x16x32_bf16 v[96:99], a[8:11], a[32:35], v[96:99]
    ds_read_b128 a[24:27], v7 offset:36864
    v_mfma_f32_16x16x32_bf16 v[128:131], a[12:15], a[32:35], v[128:131]
    ds_read_b64_tr_b16 a[32:33], v8 offset:49152
    ds_read_b64_tr_b16 a[34:35], v8 offset:51200
    v_mfma_f32_16x16x32_bf16 v[36:39], a[0:3], a[36:39], v[36:39]
    s_add_u32 m0, s67, 99328
    ds_read_b128 a[28:31], v7 offset:38912
    v_mfma_f32_16x16x32_bf16 v[68:71], a[4:7], a[36:39], v[68:71]
    global_load_lds_dwordx4 v5, s[62:63]
    ds_read_b64_tr_b16 a[64:65], v9 offset:49152
    v_mfma_f32_16x16x32_bf16 v[100:103], a[8:11], a[36:39], v[100:103]
    ds_read_b64_tr_b16 a[66:67], v9 offset:51200
    v_mfma_f32_16x16x32_bf16 v[132:135], a[12:15], a[36:39], v[132:135]
    v_mfma_f32_16x16x32_bf16 v[40:43], a[0:3], a[40:43], v[40:43]
    ds_read_b64_tr_b16 a[68:69], v10 offset:49152
    v_mfma_f32_16x16x32_bf16 v[72:75], a[4:7], a[40:43], v[72:75]
    ds_read_b64_tr_b16 a[70:71], v10 offset:51200
    v_mfma_f32_16x16x32_bf16 v[104:107], a[8:11], a[40:43], v[104:107]
    v_mfma_f32_16x16x32_bf16 v[136:139], a[12:15], a[40:43], v[136:139]
    ds_read_b64_tr_b16 a[72:73], v11 offset:49152
    v_mfma_f32_16x16x32_bf16 v[44:47], a[0:3], a[44:47], v[44:47]
    ds_read_b64_tr_b16 a[74:75], v11 offset:51200
    v_mfma_f32_16x16x32_bf16 v[76:79], a[4:7], a[44:47], v[76:79]
    ds_read_b64_tr_b16 a[76:77], v12 offset:49152
    v_mfma_f32_16x16x32_bf16 v[108:111], a[8:11], a[44:47], v[108:111]
    v_mfma_f32_16x16x32_bf16 v[140:143], a[12:15], a[44:47], v[140:143]
    s_waitcnt lgkmcnt(6)
    ds_read_b64_tr_b16 a[78:79], v12 offset:51200
    v_mfma_f32_16x16x32_bf16 v[48:51], a[0:3], a[48:51], v[48:51]
    ds_read_b64_tr_b16 a[80:81], v13 offset:49152
    v_mfma_f32_16x16x32_bf16 v[80:83], a[4:7], a[48:51], v[80:83]
    v_mfma_f32_16x16x32_bf16 v[112:115], a[8:11], a[48:51], v[112:115]
    ds_read_b64_tr_b16 a[82:83], v13 offset:51200
    v_mfma_f32_16x16x32_bf16 v[144:147], a[12:15], a[48:51], v[144:147]
    ds_read_b64_tr_b16 a[84:85], v14 offset:49152
    v_mfma_f32_16x16x32_bf16 v[52:55], a[0:3], a[52:55], v[52:55]
    ds_read_b64_tr_b16 a[86:87], v14 offset:51200
    v_mfma_f32_16x16x32_bf16 v[84:87], a[4:7], a[52:55], v[84:87]
    v_mfma_f32_16x16x32_bf16 v[116:119], a[8:11], a[52:55], v[116:119]
    ds_read_b64_tr_b16 a[88:89], v15 offset:49152
    v_mfma_f32_16x16x32_bf16 v[148:151], a[12:15], a[52:55], v[148:151]
    ds_read_b64_tr_b16 a[90:91], v15 offset:51200
    v_mfma_f32_16x16x32_bf16 v[56:59], a[0:3], a[56:59], v[56:59]
    s_or_b32 s85, s85, s87
    s_add_u32 s85, s85, s65
    s_andn2_b32 s85, s85, s87
    s_add_u32 s62, s82, s85
    s_addc_u32 s63, s83, 0
    v_mfma_f32_16x16x32_bf16 v[88:91], a[4:7], a[56:59], v[88:91]
    v_mfma_f32_16x16x32_bf16 v[120:123], a[8:11], a[56:59], v[120:123]
    v_mfma_f32_16x16x32_bf16 v[152:155], a[12:15], a[56:59], v[152:155]
    v_mfma_f32_16x16x32_bf16 v[60:63], a[0:3], a[60:63], v[60:63]
    v_mfma_f32_16x16x32_bf16 v[92:95], a[4:7], a[60:63], v[92:95]
    v_mfma_f32_16x16x32_bf16 v[124:127], a[8:11], a[60:63], v[124:127]
    v_mfma_f32_16x16x32_bf16 v[156:159], a[12:15], a[60:63], v[156:159]
    s_waitcnt vmcnt(4) lgkmcnt(0)
    s_barrier
    v_mfma_f32_16x16x32_bf16 v[32:35], a[16:19], a[32:35], v[32:35]
    s_add_u32 m0, s76, 32768
    ds_read_b128 a[0:3], v6 offset:0
    v_mfma_f32_16x16x32_bf16 v[64:67], a[20:23], a[32:35], v[64:67]
    global_load_lds_dwordx4 v28, s[60:61]
    ds_read_b128 a[4:7], v6 offset:2048
    v_mfma_f32_16x16x32_bf16 v[96:99], a[24:27], a[32:35], v[96:99]
    ds_read_b128 a[8:11], v6 offset:4096
    v_mfma_f32_16x16x32_bf16 v[128:131], a[28:31], a[32:35], v[128:131]
    ds_read_b64_tr_b16 a[32:33], v8 offset:0
    ds_read_b64_tr_b16 a[34:35], v8 offset:2048
    v_mfma_f32_16x16x32_bf16 v[36:39], a[16:19], a[64:67], v[36:39]
    s_add_u32 m0, s76, 33792
    ds_read_b128 a[12:15], v6 offset:6144
    v_mfma_f32_16x16x32_bf16 v[68:71], a[20:23], a[64:67], v[68:71]
    global_load_lds_dwordx4 v29, s[60:61]
    ds_read_b64_tr_b16 a[36:37], v9 offset:0
    v_mfma_f32_16x16x32_bf16 v[100:103], a[24:27], a[64:67], v[100:103]
    ds_read_b64_tr_b16 a[38:39], v9 offset:2048
    v_mfma_f32_16x16x32_bf16 v[132:135], a[28:31], a[64:67], v[132:135]
    v_mfma_f32_16x16x32_bf16 v[40:43], a[16:19], a[68:71], v[40:43]
    s_add_u32 m0, s76, 34816
    ds_read_b64_tr_b16 a[40:41], v10 offset:0
    v_mfma_f32_16x16x32_bf16 v[72:75], a[20:23], a[68:71], v[72:75]
    global_load_lds_dwordx4 v30, s[60:61]
    ds_read_b64_tr_b16 a[42:43], v10 offset:2048
    v_mfma_f32_16x16x32_bf16 v[104:107], a[24:27], a[68:71], v[104:107]
    v_mfma_f32_16x16x32_bf16 v[136:139], a[28:31], a[68:71], v[136:139]
    ds_read_b64_tr_b16 a[44:45], v11 offset:0
    v_mfma_f32_16x16x32_bf16 v[44:47], a[16:19], a[72:75], v[44:47]
    s_add_u32 m0, s76, 35840
    ds_read_b64_tr_b16 a[46:47], v11 offset:2048
    v_mfma_f32_16x16x32_bf16 v[76:79], a[20:23], a[72:75], v[76:79]
    global_load_lds_dwordx4 v31, s[60:61]
    ds_read_b64_tr_b16 a[48:49], v12 offset:0
    v_mfma_f32_16x16x32_bf16 v[108:111], a[24:27], a[72:75], v[108:111]
    v_mfma_f32_16x16x32_bf16 v[140:143], a[28:31], a[72:75], v[140:143]
    s_waitcnt lgkmcnt(6)
    ds_read_b64_tr_b16 a[50:51], v12 offset:2048
    v_mfma_f32_16x16x32_bf16 v[48:51], a[16:19], a[76:79], v[48:51]
    s_add_u32 m0, s67, 114688
    ds_read_b64_tr_b16 a[52:53], v13 offset:0
    v_mfma_f32_16x16x32_bf16 v[80:83], a[20:23], a[76:79], v[80:83]
    global_load_lds_dwordx4 v4, s[62:63]
    v_mfma_f32_16x16x32_bf16 v[112:115], a[24:27], a[76:79], v[112:115]
    ds_read_b64_tr_b16 a[54:55], v13 offset:2048
    v_mfma_f32_16x16x32_bf16 v[144:147], a[28:31], a[76:79], v[144:147]
    ds_read_b64_tr_b16 a[56:57], v14 offset:0
    v_mfma_f32_16x16x32_bf16 v[52:55], a[16:19], a[80:83], v[52:55]
    s_add_u32 m0, s67, 115712
    ds_read_b64_tr_b16 a[58:59], v14 offset:2048
    v_mfma_f32_16x16x32_bf16 v[84:87], a[20:23], a[80:83], v[84:87]
    global_load_lds_dwordx4 v5, s[62:63]
    v_mfma_f32_16x16x32_bf16 v[116:119], a[24:27], a[80:83], v[116:119]
    ds_read_b64_tr_b16 a[60:61], v15 offset:0
    v_mfma_f32_16x16x32_bf16 v[148:151], a[28:31], a[80:83], v[148:151]
    ds_read_b64_tr_b16 a[62:63], v15 offset:2048
    v_mfma_f32_16x16x32_bf16 v[56:59], a[16:19], a[84:87], v[56:59]
    s_or_b32 s85, s85, s87
    s_add_u32 s85, s85, s65
    s_andn2_b32 s85, s85, s87
    s_add_u32 s62, s82, s85
    s_addc_u32 s63, s83, 0
    v_mfma_f32_16x16x32_bf16 v[88:91], a[20:23], a[84:87], v[88:91]
    v_mfma_f32_16x16x32_bf16 v[120:123], a[24:27], a[84:87], v[120:123]
    v_mfma_f32_16x16x32_bf16 v[152:155], a[28:31], a[84:87], v[152:155]
    v_mfma_f32_16x16x32_bf16 v[60:63], a[16:19], a[88:91], v[60:63]
    s_or_b32 s84, s84, s86
    s_add_u32 s84, s84, s64
    s_andn2_b32 s84, s84, s86
    s_add_u32 s60, s80, s84
    s_addc_u32 s61, s81, 0
    v_mfma_f32_16x16x32_bf16 v[92:95], a[20:23], a[88:91], v[92:95]
    v_mfma_f32_16x16x32_bf16 v[124:127], a[24:27], a[88:91], v[124:127]
    v_mfma_f32_16x16x32_bf16 v[156:159], a[28:31], a[88:91], v[156:159]
    s_sub_u32 s66, s66, 1
    s_cmp_lg_u32 s66, 0
    s_cbranch_scc1 core_N_loop
    s_waitcnt vmcnt(8) lgkmcnt(0)
    s_barrier
    s_cmp_eq_u32 s98, 0
    s_cbranch_scc1 core_N_nt
    v_lshlrev_b32 v20, 6, v0
    v_min_u32 v21, s99, v20
    v_min_u32 v22, s100, v20
    v_min_u32 v23, s101, v20
    global_load_dword a95, v21, s[90:91]
    global_load_dword a95, v22, s[92:93]
    global_load_dword a95, v23, s[94:95]
core_N_nt:
    v_mfma_f32_16x16x32_bf16 v[32:35], a[0:3], a[32:35], v[32:35]
    ds_read_b128 a[16:19], v7 offset:0
    v_mfma_f32_16x16x32_bf16 v[64:67], a[4:7], a[32:35], v[64:67]
    ds_read_b128 a[20:23], v7 offset:2048
    v_mfma_f32_16x16x32_bf16 v[96:99], a[8:11], a[32:35], v[96:99]
    ds_read_b128 a[24:27], v7 offset:4096
    v_mfma_f32_16x16x32_bf16 v[128:131], a[12:15], a[32:35], v[128:131]
    ds_read_b64_tr_b16 a[32:33], v8 offset:16384
    ds_read_b64_tr_b16 a[34:35], v8 offset:18432
    v_mfma_f32_16x16x32_bf16 v[36:39], a[0:3], a[36:39], v[36:39]
    ds_read_b128 a[28:31], v7 offset:6144
    v_mfma_f32_16x16x32_bf16 v[68:71], a[4:7], a[36:39], v[68:71]
    ds_read_b64_tr_b16 a[64:65], v9 offset:16384
    v_mfma_f32_16x16x32_bf16 v[100:103], a[8:11], a[36:39], v[100:103]
    ds_read_b64_tr_b16 a[66:67], v9 offset:18432
    v_mfma_f32_16x16x32_bf16 v[132:135], a[12:15], a[36:39], v[132:135]
    v_mfma_f32_16x16x32_bf16 v[40:43], a[0:3], a[40:43], v[40:43]
    ds_read_b64_tr_b16 a[68:69], v10 offset:16384
    v_mfma_f32_16x16x32_bf16 v[72:75], a[4:7], a[40:43], v[72:75]
    ds_read_b64_tr_b16 a[70:71], v10 offset:18432
    v_mfma_f32_16x16x32_bf16 v[104:107], a[8:11], a[40:43], v[104:107]
    v_mfma_f32_16x16x32_bf16 v[136:139], a[12:15], a[40:43], v[136:139]
    ds_read_b64_tr_b16 a[72:73], v11 offset:16384
    v_mfma_f32_16x16x32_bf16 v[44:47], a[0:3], a[44:47], v[44:47]
    ds_read_b64_tr_b16 a[74:75], v11 offset:18432
    v_mfma_f32_16x16x32_bf16 v[76:79], a[4:7], a[44:47], v[76:79]
    ds_read_b64_tr_b16 a[76:77], v12 offset:16384
    v_mfma_f32_16x16x32_bf16 v[108:111], a[8:11], a[44:47], v[108:111]
    v_mfma_f32_16x16x32_bf16 v[140:143], a[12:15], a[44:47], v[140:143]
    s_waitcnt lgkmcnt(6)
    ds_read_b64_tr_b16 a[78:79], v12 offset:18432
    v_mfma_f32_16x16x32_bf16 v[48:51], a[0:3], a[48:51], v[48:51]
    ds_read_b64_tr_b16 a[80:81], v13 offset:16384
    v_mfma_f32_16x16x32_bf16 v[80:83], a[4:7], a[48:51], v[80:83]
    v_mfma_f32_16x16x32_bf16 v[112:115], a[8:11], a[48:51], v[112:115]
    ds_read_b64_tr_b16 a[82:83], v13 offset:18432
    v_mfma_f32_16x16x32_bf16 v[144:147], a[12:15], a[48:51], v[144:147]
    ds_read_b64_tr_b16 a[84:85], v14 offset:16384
    v_mfma_f32_16x16x32_bf16 v[52:55], a[0:3], a[52:55], v[52:55]
    ds_read_b64_tr_b16 a[86:87], v14 offset:18432
    v_mfma_f32_16x16x32_bf16 v[84:87], a[4:7], a[52:55], v[84:87]
    v_mfma_f32_16x16x32_bf16 v[116:119], a[8:11], a[52:55], v[116:119]
    ds_read_b64_tr_b16 a[88:89], v15 offset:16384
    v_mfma_f32_16x16x32_bf16 v[148:151], a[12:15], a[52:55], v[148:151]
    ds_read_b64_tr_b16 a[90:91], v15 offset:18432
    v_mfma_f32_16x16x32_bf16 v[56:59], a[0:3], a[56:59], v[56:59]
    v_mfma_f32_16x16x32_bf16 v[88:91], a[4:7], a[56:59], v[88:91]
    v_mfma_f32_16x16x32_bf16 v[120:123], a[8:11], a[56:59], v[120:123]
    v_mfma_f32_16x16x32_bf16 v[152:155], a[12:15], a[56:59], v[152:155]
    v_mfma_f32_16x16x32_bf16 v[60:63], a[0:3], a[60:63], v[60:63]
    v_mfma_f32_16x16x32_bf16 v[92:95], a[4:7], a[60:63], v[92:95]
    v_mfma_f32_16x16x32_bf16 v[124:127], a[8:11], a[60:63], v[124:127]
    v_mfma_f32_16x16x32_bf16 v[156:159], a[12:15], a[60:63], v[156:159]
    s_cmp_eq_u32 s98, 0
    s_cbranch_scc1 cw_95
    s_waitcnt vmcnt(5) lgkmcnt(0)
    s_branch cw_96
cw_95:
    s_waitcnt vmcnt(2) lgkmcnt(0)
cw_96:
    s_barrier
    v_mfma_f32_16x16x32_bf16 v[32:35], a[16:19], a[32:35], v[32:35]
    ds_read_b128 a[0:3], v6 offset:32768
    v_mfma_f32_16x16x32_bf16 v[64:67], a[20:23], a[32:35], v[64:67]
    ds_read_b128 a[4:7], v6 offset:34816
    v_mfma_f32_16x16x32_bf16 v[96:99], a[24:27], a[32:35], v[96:99]
    ds_read_b128 a[8:11], v6 offset:36864
    v_mfma_f32_16x16x32_bf16 v[128:131], a[28:31], a[32:35], v[128:131]
    ds_read_b64_tr_b16 a[32:33], v8 offset:32768
    ds_read_b64_tr_b16 a[34:35], v8 offset:34816
    v_mfma_f32_16x16x32_bf16 v[36:39], a[16:19], a[64:67], v[36:39]
    ds_read_b128 a[12:15], v6 offset:38912
    v_mfma_f32_16x16x32_bf16 v[68:71], a[20:23], a[64:67], v[68:71]
    ds_read_b64_tr_b16 a[36:37], v9 offset:32768
    v_mfma_f32_16x16x32_bf16 v[100:103], a[24:27], a[64:67], v[100:103]
    ds_read_b64_tr_b16 a[38:39], v9 offset:34816
    v_mfma_f32_16x16x32_bf16 v[132:135], a[28:31], a[64:67], v[132:135]
    v_mfma_f32_16x16x32_bf16 v[40:43], a[16:19], a[68:71], v[40:43]
    ds_read_b64_tr_b16 a[40:41], v10 offset:32768
    v_mfma_f32_16x16x32_bf16 v[72:75], a[20:23], a[68:71], v[72:75]
    ds_read_b64_tr_b16 a[42:43], v10 offset:34816
    v_mfma_f32_16x16x32_bf16 v[104:107], a[24:27], a[68:71], v[104:107]
    v_mfma_f32_16x16x32_bf16 v[136:139], a[28:31], a[68:71], v[136:139]
    ds_read_b64_tr_b16 a[44:45], v11 offset:32768
    v_mfma_f32_16x16x32_bf16 v[44:47], a[16:19], a[72:75], v[44:47]
    ds_read_b64_tr_b16 a[46:47], v11 offset:34816
    v_mfma_f32_16x16x32_bf16 v[76:79], a[20:23], a[72:75], v[76:79]
    ds_read_b64_tr_b16 a[48:49], v12 offset:32768
    v_mfma_f32_16x16x32_bf16 v[108:111], a[24:27], a[72:75], v[108:111]
    v_mfma_f32_16x16x32_bf16 v[140:143], a[28:31], a[72:75], v[140:143]
    s_waitcnt lgkmcnt(6)
    ds_read_b64_tr_b16 a[50:51], v12 offset:34816
    v_mfma_f32_16x16x32_bf16 v[48:51], a[16:19], a[76:79], v[48:51]
    ds_read_b64_tr_b16 a[52:53], v13 offset:32768
    v_mfma_f32_16x16x32_bf16 v[80:83], a[20:23], a[76:79], v[80:83]
    v_mfma_f32_16x16x32_bf16 v[112:115], a[24:27], a[76:79], v[112:115]
    ds_read_b64_tr_b16 a[54:55], v13 offset:34816
    v_mfma_f32_16x16x32_bf16 v[144:147], a[28:31], a[76:79], v[144:147]
    ds_read_b64_tr_b16 a[56:57], v14 offset:32768
    v_mfma_f32_16x16x32_bf16 v[52:55], a[16:19], a[80:83], v[52:55]
    ds_read_b64_tr_b16 a[58:59], v14 offset:34816
    v_mfma_f32_16x16x32_bf16 v[84:87], a[20:23], a[80:83], v[84:87]
    v_mfma_f32_16x16x32_bf16 v[116:119], a[24:27], a[80:83], v[116:119]
    ds_read_b64_tr_b16 a[60:61], v15 offset:32768
    v_mfma_f32_16x16x32_bf16 v[148:151], a[28:31], a[80:83], v[148:151]
    ds_read_b64_tr_b16 a[62:63], v15 offset:34816
    v_mfma_f32_16x16x32_bf16 v[56:59], a[16:19], a[84:87], v[56:59]
    v_mfma_f32_16x16x32_bf16 v[88:91], a[20:23], a[84:87], v[88:91]
    v_mfma_f32_16x16x32_bf16 v[120:123], a[24:27], a[84:87], v[120:123]
    v_mfma_f32_16x16x32_bf16 v[152:155], a[28:31], a[84:87], v[152:155]
    v_mfma_f32_16x16x32_bf16 v[60:63], a[16:19], a[88:91], v[60:63]
    v_mfma_f32_16x16x32_bf16 v[92:95], a[20:23], a[88:91], v[92:95]
    v_mfma_f32_16x16x32_bf16 v[124:127], a[24:27], a[88:91], v[124:127]
    v_mfma_f32_16x16x32_bf16 v[156:159], a[28:31], a[88:91], v[156:159]
    s_cmp_eq_u32 s98, 0
    s_cbranch_scc1 cw_97
    s_waitcnt vmcnt(3) lgkmcnt(0)
    s_branch cw_98
cw_97:
    s_waitcnt vmcnt(0) lgkmcnt(0)
cw_98:
    s_barrier
    s_mov_b32 s98, 0
    v_mfma_f32_16x16x32_bf16 v[32:35], a[0:3], a[32:35], v[32:35]
    ds_read_b128 a[16:19], v7 offset:32768
    v_mfma_f32_16x16x32_bf16 v[64:67], a[4:7], a[32:35], v[64:67]
    ds_read_b128 a[20:23], v7 offset:34816
    v_mfma_f32_16x16x32_bf16 v[96:99], a[8:11], a[32:35], v[96:99]
    ds_read_b128 a[24:27], v7 offset:36864
    v_mfma_f32_16x16x32_bf16 v[128:131], a[12:15], a[32:35], v[128:131]
    ds_read_b64_tr_b16 a[32:33], v8 offset:49152
    ds_read_b64_tr_b16 a[34:35], v8 offset:51200
    v_mfma_f32_16x16x32_bf16 v[36:39], a[0:3], a[36:39], v[36:39]
    ds_read_b128 a[28:31], v7 offset:38912
    v_mfma_f32_16x16x32_bf16 v[68:71], a[4:7], a[36:39], v[68:71]
    ds_read_b64_tr_b16 a[64:65], v9 offset:49152
    v_mfma_f32_16x16x32_bf16 v[100:103], a[8:11], a[36:39], v[100:103]
    ds_read_b64_tr_b16 a[66:67], v9 offset:51200
    v_mfma_f32_16x16x32_bf16 v[132:135], a[12:15], a[36:39], v[132:135]
    v_mfma_f32_16x16x32_bf16 v[40:43], a[0:3], a[40:43], v[40:43]
    ds_read_b64_tr_b16 a[68:69], v10 offset:49152
    v_mfma_f32_16x16x32_bf16 v[72:75], a[4:7], a[40:43], v[72:75]
    ds_read_b64_tr_b16 a[70:71], v10 offset:51200
    v_mfma_f32_16x16x32_bf16 v[104:107], a[8:11], a[40:43], v[104:107]
    v_mfma_f32_16x16x32_bf16 v[136:139], a[12:15], a[40:43], v[136:139]
    ds_read_b64_tr_b16 a[72:73], v11 offset:49152
    v_mfma_f32_16x16x32_bf16 v[44:47], a[0:3], a[44:47], v[44:47]
    ds_read_b64_tr_b16 a[74:75], v11 offset:51200
    v_mfma_f32_16x16x32_bf16 v[76:79], a[4:7], a[44:47], v[76:79]
    ds_read_b64_tr_b16 a[76:77], v12 offset:49152
    v_mfma_f32_16x16x32_bf16 v[108:111], a[8:11], a[44:47], v[108:111]
    v_mfma_f32_16x16x32_bf16 v[140:143], a[12:15], a[44:47], v[140:143]
    s_waitcnt lgkmcnt(6)
    ds_read_b64_tr_b16 a[78:79], v12 offset:51200
    v_mfma_f32_16x16x32_bf16 v[48:51], a[0:3], a[48:51], v[48:51]
    ds_read_b64_tr_b16 a[80:81], v13 offset:49152
    v_mfma_f32_16x16x32_bf16 v[80:83], a[4:7], a[48:51], v[80:83]
    v_mfma_f32_16x16x32_bf16 v[112:115], a[8:11], a[48:51], v[112:115]
    ds_read_b64_tr_b16 a[82:83], v13 offset:51200
    v_mfma_f32_16x16x32_bf16 v[144:147], a[12:15], a[48:51], v[144:147]
    ds_read_b64_tr_b16 a[84:85], v14 offset:49152
    v_mfma_f32_16x16x32_bf16 v[52:55], a[0:3], a[52:55], v[52:55]
    ds_read_b64_tr_b16 a[86:87], v14 offset:51200
    v_mfma_f32_16x16x32_bf16 v[84:87], a[4:7], a[52:55], v[84:87]
    v_mfma_f32_16x16x32_bf16 v[116:119], a[8:11], a[52:55], v[116:119]
    ds_read_b64_tr_b16 a[88:89], v15 offset:49152
    v_mfma_f32_16x16x32_bf16 v[148:151], a[12:15], a[52:55], v[148:151]
    ds_read_b64_tr_b16 a[90:91], v15 offset:51200
    v_mfma_f32_16x16x32_bf16 v[56:59], a[0:3], a[56:59], v[56:59]
    v_mfma_f32_16x16x32_bf16 v[88:91], a[4:7], a[56:59], v[88:91]
    v_mfma_f32_16x16x32_bf16 v[120:123], a[8:11], a[56:59], v[120:123]
    v_mfma_f32_16x16x32_bf16 v[152:155], a[12:15], a[56:59], v[152:155]
    v_mfma_f32_16x16x32_bf16 v[60:63], a[0:3], a[60:63], v[60:63]
    v_mfma_f32_16x16x32_bf16 v[92:95], a[4:7], a[60:63], v[92:95]
    v_mfma_f32_16x16x32_bf16 v[124:127], a[8:11], a[60:63], v[124:127]
    v_mfma_f32_16x16x32_bf16 v[156:159], a[12:15], a[60:63], v[156:159]
    s_waitcnt lgkmcnt(0)
    v_mfma_f32_16x16x32_bf16 v[32:35], a[16:19], a[32:35], v[32:35]
    v_mfma_f32_16x16x32_bf16 v[64:67], a[20:23], a[32:35], v[64:67]
    v_mfma_f32_16x16x32_bf16 v[96:99], a[24:27], a[32:35], v[96:99]
    v_mfma_f32_16x16x32_bf16 v[128:131], a[28:31], a[32:35], v[128:131]
    v_mfma_f32_16x16x32_bf16 v[36:39], a[16:19], a[64:67], v[36:39]
    v_mfma_f32_16x16x32_bf16 v[68:71], a[20:23], a[64:67], v[68:71]
    v_mfma_f32_16x16x32_bf16 v[100:103], a[24:27], a[64:67], v[100:103]
    v_mfma_f32_16x16x32_bf16 v[132:135], a[28:31], a[64:67], v[132:135]
    v_mfma_f32_16x16x32_bf16 v[40:43], a[16:19], a[68:71], v[40:43]
    v_mfma_f32_16x16x32_bf16 v[72:75], a[20:23], a[68:71], v[72:75]
    v_mfma_f32_16x16x32_bf16 v[104:107], a[24:27], a[68:71], v[104:107]
    v_mfma_f32_16x16x32_bf16 v[136:139], a[28:31], a[68:71], v[136:139]
    v_mfma_f32_16x16x32_bf16 v[44:47], a[16:19], a[72:75], v[44:47]
    v_mfma_f32_16x16x32_bf16 v[76:79], a[20:23], a[72:75], v[76:79]
    v_mfma_f32_16x16x32_bf16 v[108:111], a[24:27], a[72:75], v[108:111]
    v_mfma_f32_16x16x32_bf16 v[140:143], a[28:31], a[72:75], v[140:143]
    v_mfma_f32_16x16x32_bf16 v[48:51], a[16:19], a[76:79], v[48:51]
    v_mfma_f32_16x16x32_bf16 v[80:83], a[20:23], a[76:79], v[80:83]
    v_mfma_f32_16x16x32_bf16 v[112:115], a[24:27], a[76:79], v[112:115]
    v_mfma_f32_16x16x32_bf16 v[144:147], a[28:31], a[76:79], v[144:147]
    v_mfma_f32_16x16x32_bf16 v[52:55], a[16:19], a[80:83], v[52:55]
    v_mfma_f32_16x16x32_bf16 v[84:87], a[20:23], a[80:83], v[84:87]
    v_mfma_f32_16x16x32_bf16 v[116:119], a[24:27], a[80:83], v[116:119]
    v_mfma_f32_16x16x32_bf16 v[148:151], a[28:31], a[80:83], v[148:151]
    v_mfma_f32_16x16x32_bf16 v[56:59], a[16:19], a[84:87], v[56:59]
    v_mfma_f32_16x16x32_bf16 v[88:91], a[20:23], a[84:87], v[88:91]
    v_mfma_f32_16x16x32_bf16 v[120:123], a[24:27], a[84:87], v[120:123]
    v_mfma_f32_16x16x32_bf16 v[152:155], a[28:31], a[84:87], v[152:155]
    v_mfma_f32_16x16x32_bf16 v[60:63], a[16:19], a[88:91], v[60:63]
    v_mfma_f32_16x16x32_bf16 v[92:95], a[20:23], a[88:91], v[92:95]
    v_mfma_f32_16x16x32_bf16 v[124:127], a[24:27], a[88:91], v[124:127]
    v_mfma_f32_16x16x32_bf16 v[156:159], a[28:31], a[88:91], v[156:159]
    s_nop 7
    s_setpc_b64 s[68:69]
core_T3:
    s_mov_b32 s84, 0
    s_mov_b32 s85, 0
    s_mov_b64 s[60:61], s[80:81]
    s_mov_b64 s[62:63], s[82:83]
    s_barrier
    s_add_u32 m0, s76, 0
    s_nop 0
    global_load_lds_dwordx4 v28, s[60:61]
    s_add_u32 m0, s76, 1024
    s_nop 0
    global_load_lds_dwordx4 v29, s[60:61]
    s_add_u32 m0, s76, 2048
    s_nop 0
    global_load_lds_dwordx4 v30, s[60:61]
    s_or_b32 s84, s84, s86
    s_add_u32 s84, s84, s64
    s_andn2_b32 s84, s84, s86
    s_add_u32 s60, s80, s84
    s_addc_u32 s61, s81, 0
    s_add_u32 m0, s67, 65536
    s_nop 0
    global_load_lds_dwordx4 v4, s[62:63]
    s_add_u32 m0, s67, 66560
    s_nop 0
    global_load_lds_dwordx4 v5, s[62:63]
    s_or_b32 s85, s85, s87
    s_add_u32 s85, s85, s65
    s_andn2_b32 s85, s85, s87
    s_add_u32 s62, s82, s85
    s_addc_u32 s63, s83, 0
    s_add_u32 m0, s67, 81920
    s_nop 0
    global_load_lds_dwordx4 v4, s[62:63]
    s_add_u32 m0, s67, 82944
    s_nop 0
    global_load_lds_dwordx4 v5, s[62:63]
    s_or_b32 s85, s85, s87
    s_add_u32 s85, s85, s65
    s_andn2_b32 s85, s85, s87
    s_add_u32 s62, s82, s85
    s_addc_u32 s63, s83, 0
    s_add_u32 m0, s67, 98304
    s_nop 0
    global_load_lds_dwordx4 v4, s[62:63]
    s_add_u32 m0, s67, 99328
    s_nop 0
    global_load_lds_dwordx4 v5, s[62:63]
    s_or_b32 s85, s85, s87
    s_add_u32 s85, s85, s65
    s_andn2_b32 s85, s85, s87
    s_add_u32 s62, s82, s85
    s_addc_u32 s63, s83, 0
    s_add_u32 m0, s76, 32768
    s_nop 0
    global_load_lds_dwordx4 v28, s[60:61]
    s_add_u32 m0, s76, 33792
    s_nop 0
    global_load_lds_dwordx4 v29, s[60:61]
    s_add_u32 m0, s76, 34816
    s_nop 0
    global_load_lds_dwordx4 v30, s[60:61]
    s_or_b32 s84, s84, s86
    s_add_u32 s84, s84, s64
    s_andn2_b32 s84, s84, s86
    s_add_u32 s60, s80, s84
    s_addc_u32 s61, s81, 0
    s_add_u32 m0, s67, 114688
    s_nop 0
    global_load_lds_dwordx4 v4, s[62:63]
    s_add_u32 m0, s67, 115712
    s_nop 0
    global_load_lds_dwordx4 v5, s[62:63]
    s_or_b32 s85, s85, s87
    s_add_u32 s85, s85, s65
    s_andn2_b32 s85, s85, s87
    s_add_u32 s62, s82, s85
    s_addc_u32 s63, s83, 0
    s_cmp_eq_u32 s77, 0
    s_cbranch_scc1 ps_99
    v_cvt_pk_bf16_f32 v24, v32, v33
    v_cvt_pk_bf16_f32 v25, v34, v35
    v_cvt_pk_bf16_f32 v26, v36, v37
    v_cvt_pk_bf16_f32 v27, v38, v39
    global_store_dwordx4 v20, v[24:27], s[28:29] offset:0 sc1
    v_cvt_pk_bf16_f32 v16, v40, v41
    v_cvt_pk_bf16_f32 v17, v42, v43
    v_cvt_pk_bf16_f32 v18, v44, v45
    v_cvt_pk_bf16_f32 v19, v46, v47
    global_store_dwordx4 v20, v[16:19], s[28:29] offset:1024 sc1
    v_cvt_pk_bf16_f32 v24, v48, v49
    v_cvt_pk_bf16_f32 v25, v50, v51
    v_cvt_pk_bf16_f32 v26, v52, v53
    v_cvt_pk_bf16_f32 v27, v54, v55
    global_store_dwordx4 v20, v[24:27], s[28:29] offset:2048 sc1
    v_cvt_pk_bf16_f32 v16, v56, v57
    v_cvt_pk_bf16_f32 v17, v58, v59
    v_cvt_pk_bf16_f32 v18, v60, v61
    v_cvt_pk_bf16_f32 v19, v62, v63
    global_store_dwordx4 v20, v[16:19], s[28:29] offset:3072 sc1
    v_cvt_pk_bf16_f32 v24, v64, v65
    v_cvt_pk_bf16_f32 v25, v66, v67
    v_cvt_pk_bf16_f32 v26, v68, v69
    v_cvt_pk_bf16_f32 v27, v70, v71
    global_store_dwordx4 v21, v[24:27], s[28:29] offset:0 sc1
    v_cvt_pk_bf16_f32 v16, v72, v73
    v_cvt_pk_bf16_f32 v17, v74, v75
    v_cvt_pk_bf16_f32 v18, v76, v77
    v_cvt_pk_bf16_f32 v19, v78, v79
    global_store_dwordx4 v21, v[16:19], s[28:29] offset:1024 sc1
    v_cvt_pk_bf16_f32 v24, v80, v81
    v_cvt_pk_bf16_f32 v25, v82, v83
    v_cvt_pk_bf16_f32 v26, v84, v85
    v_cvt_pk_bf16_f32 v27, v86, v87
    global_store_dwordx4 v21, v[24:27], s[28:29] offset:2048 sc1
    v_cvt_pk_bf16_f32 v16, v88, v89
    v_cvt_pk_bf16_f32 v17, v90, v91
    v_cvt_pk_bf16_f32 v18, v92, v93
    v_cvt_pk_bf16_f32 v19, v94, v95
    global_store_dwordx4 v21, v[16:19], s[28:29] offset:3072 sc1
    v_cvt_pk_bf16_f32 v24, v96, v97
    v_cvt_pk_bf16_f32 v25, v98, v99
    v_cvt_pk_bf16_f32 v26, v100, v101
    v_cvt_pk_bf16_f32 v27, v102, v103
    global_store_dwordx4 v22, v[24:27], s[28:29] offset:0 sc1
    v_cvt_pk_bf16_f32 v16, v104, v105
    v_cvt_pk_bf16_f32 v17, v106, v107
    v_cvt_pk_bf16_f32 v18, v108, v109
    v_cvt_pk_bf16_f32 v19, v110, v111
    global_store_dwordx4 v22, v[16:19], s[28:29] offset:1024 sc1
    v_cvt_pk_bf16_f32 v24, v112, v113
    v_cvt_pk_bf16_f32 v25, v114, v115
    v_cvt_pk_bf16_f32 v26, v116, v117
    v_cvt_pk_bf16_f32 v27, v118, v119
    global_store_dwordx4 v22, v[24:27], s[28:29] offset:2048 sc1
    v_cvt_pk_bf16_f32 v16, v120, v121
    v_cvt_pk_bf16_f32 v17, v122, v123
    v_cvt_pk_bf16_f32 v18, v124, v125
    v_cvt_pk_bf16_f32 v19, v126, v127
    global_store_dwordx4 v22, v[16:19], s[28:29] offset:3072 sc1
ps_99:
core_T3_m:
    v_mov_b32 v32, 0
    v_mov_b32 v33, 0
    v_mov_b32 v34, 0
    v_mov_b32 v35, 0
    v_mov_b32 v36, 0
    v_mov_b32 v37, 0
    v_mov_b32 v38, 0
    v_mov_b32 v39, 0
    v_mov_b32 v40, 0
    v_mov_b32 v41, 0
    v_mov_b32 v42, 0
    v_mov_b32 v43, 0
    v_mov_b32 v44, 0
    v_mov_b32 v45, 0
    v_mov_b32 v46, 0
    v_mov_b32 v47, 0
    v_mov_b32 v48, 0
    v_mov_b32 v49, 0
    v_mov_b32 v50, 0
    v_mov_b32 v51, 0
    v_mov_b32 v52, 0
    v_mov_b32 v53, 0
    v_mov_b32 v54, 0
    v_mov_b32 v55, 0
    v_mov_b32 v56, 0
    v_mov_b32 v57, 0
    v_mov_b32 v58, 0
    v_mov_b32 v59, 0
    v_mov_b32 v60, 0
    v_mov_b32 v61, 0
    v_mov_b32 v62, 0
    v_mov_b32 v63, 0
    v_mov_b32 v64, 0
    v_mov_b32 v65, 0
    v_mov_b32 v66, 0
    v_mov_b32 v67, 0
    v_mov_b32 v68, 0
    v_mov_b32 v69, 0
    v_mov_b32 v70, 0
    v_mov_b32 v71, 0
    v_mov_b32 v72, 0
    v_mov_b32 v73, 0
    v_mov_b32 v74, 0
    v_mov_b32 v75, 0
    v_mov_b32 v76, 0
    v_mov_b32 v77, 0
    v_mov_b32 v78, 0
    v_mov_b32 v79, 0
    v_mov_b32 v80, 0
    v_mov_b32 v81, 0
    v_mov_b32 v82, 0
    v_mov_b32 v83, 0
    v_mov_b32 v84, 0
    v_mov_b32 v85, 0
    v_mov_b32 v86, 0
    v_mov_b32 v87, 0
    v_mov_b32 v88, 0
    v_mov_b32 v89, 0
    v_mov_b32 v90, 0
    v_mov_b32 v91, 0
    v_mov_b32 v92, 0
    v_mov_b32 v93, 0
    v_mov_b32 v94, 0
    v_mov_b32 v95, 0
    v_mov_b32 v96, 0
    v_mov_b32 v97, 0
    v_mov_b32 v98, 0
    v_mov_b32 v99, 0
    v_mov_b32 v100, 0
    v_mov_b32 v101, 0
    v_mov_b32 v102, 0
    v_mov_b32 v103, 0
    v_mov_b32 v104, 0
    v_mov_b32 v105, 0
    v_mov_b32 v106, 0
    v_mov_b32 v107, 0
    v_mov_b32 v108, 0
    v_mov_b32 v109, 0
    v_mov_b32 v110, 0
    v_mov_b32 v111, 0
    v_mov_b32 v112, 0
    v_mov_b32 v113, 0
    v_mov_b32 v114, 0
    v_mov_b32 v115, 0
    v_mov_b32 v116, 0
    v_mov_b32 v117, 0
    v_mov_b32 v118, 0
    v_mov_b32 v119, 0
    v_mov_b32 v120, 0
    v_mov_b32 v121, 0
    v_mov_b32 v122, 0
    v_mov_b32 v123, 0
    v_mov_b32 v124, 0
    v_mov_b32 v125, 0
    v_mov_b32 v126, 0
    v_mov_b32 v127, 0
    s_cmp_eq_u32 s77, 0
    s_cbranch_scc1 cw_100
    s_waitcnt vmcnt(21)
    s_branch cw_101
cw_100:
    s_waitcnt vmcnt(9)
cw_101:
    s_barrier
    ds_read_b128 a[0:3], v6 offset:0
    ds_read_b128 a[4:7], v6 offset:2048
    ds_read_b128 a[8:11], v6 offset:4096
    ds_read_b64_tr_b16 a[32:33], v8 offset:0
    ds_read_b64_tr_b16 a[34:35], v8 offset:2048
    ds_read_b64_tr_b16 a[36:37], v9 offset:0
    ds_read_b64_tr_b16 a[38:39], v9 offset:2048
    ds_read_b64_tr_b16 a[40:41], v10 offset:0
    ds_read_b64_tr_b16 a[42:43], v10 offset:2048
    ds_read_b64_tr_b16 a[44:45], v11 offset:0
    ds_read_b64_tr_b16 a[46:47], v11 offset:2048
    s_waitcnt lgkmcnt(4)
    ds_read_b64_tr_b16 a[48:49], v12 offset:0
    ds_read_b64_tr_b16 a[50:51], v12 offset:2048
    ds_read_b64_tr_b16 a[52:53], v13 offset:0
    ds_read_b64_tr_b16 a[54:55], v13 offset:2048
    ds_read_b64_tr_b16 a[56:57], v14 offset:0
    ds_read_b64_tr_b16 a[58:59], v14 offset:2048
    ds_read_b64_tr_b16 a[60:61], v15 offset:0
    ds_read_b64_tr_b16 a[62:63], v15 offset:2048
    s_cmp_eq_u32 s77, 0
    s_cbranch_scc1 cw_102
    s_waitcnt vmcnt(19) lgkmcnt(0)
    s_branch cw_103
cw_102:
    s_waitcnt vmcnt(7) lgkmcnt(0)
cw_103:
    s_barrier
    v_mfma_f32_16x16x32_bf16 v[32:35], a[32:35], a[0:3], v[32:35]
    s_add_u32 m0, s67, 65536
    ds_read_b128 a[16:19], v7 offset:0
    v_mfma_f32_16x16x32_bf16 v[64:67], a[32:35], a[4:7], v[64:67]
    global_load_lds_dwordx4 v4, s[62:63]
    ds_read_b128 a[20:23], v7 offset:2048
    v_mfma_f32_16x16x32_bf16 v[96:99], a[32:35], a[8:11], v[96:99]
    ds_read_b128 a[24:27], v7 offset:4096
    v_mfma_f32_16x16x32_bf16 v[36:39], a[36:39], a[0:3], v[36:39]
    s_add_u32 m0, s67, 66560
    ds_read_b64_tr_b16 a[64:65], v8 offset:16384
    v_mfma_f32_16x16x32_bf16 v[68:71], a[36:39], a[4:7], v[68:71]
    global_load_lds_dwordx4 v5, s[62:63]
    ds_read_b64_tr_b16 a[66:67], v8 offset:18432
    v_mfma_f32_16x16x32_bf16 v[100:103], a[36:39], a[8:11], v[100:103]
    ds_read_b64_tr_b16 a[68:69], v9 offset:16384
    v_mfma_f32_16x16x32_bf16 v[40:43], a[40:43], a[0:3], v[40:43]
    ds_read_b64_tr_b16 a[70:71], v9 offset:18432
    v_mfma_f32_16x16x32_bf16 v[72:75], a[40:43], a[4:7], v[72:75]
    ds_read_b64_tr_b16 a[72:73], v10 offset:16384
    v_mfma_f32_16x16x32_bf16 v[104:107], a[40:43], a[8:11], v[104:107]
    ds_read_b64_tr_b16 a[74:75], v10 offset:18432
    v_mfma_f32_16x16x32_bf16 v[44:47], a[44:47], a[0:3], v[44:47]
    ds_read_b64_tr_b16 a[76:77], v11 offset:16384
    v_mfma_f32_16x16x32_bf16 v[76:79], a[44:47], a[4:7], v[76:79]
    ds_read_b64_tr_b16 a[78:79], v11 offset:18432
    v_mfma_f32_16x16x32_bf16 v[108:111], a[44:47], a[8:11], v[108:111]
    ds_read_b64_tr_b16 a[80:81], v12 offset:16384
    v_mfma_f32_16x16x32_bf16 v[48:51], a[48:51], a[0:3], v[48:51]
    ds_read_b64_tr_b16 a[82:83], v12 offset:18432
    v_mfma_f32_16x16x32_bf16 v[80:83], a[48:51], a[4:7], v[80:83]
    s_waitcnt lgkmcnt(6)
    ds_read_b64_tr_b16 a[84:85], v13 offset:16384
    v_mfma_f32_16x16x32_bf16 v[112:115], a[48:51], a[8:11], v[112:115]
    ds_read_b64_tr_b16 a[86:87], v13 offset:18432
    v_mfma_f32_16x16x32_bf16 v[52:55], a[52:55], a[0:3], v[52:55]
    ds_read_b64_tr_b16 a[88:89], v14 offset:16384
    v_mfma_f32_16x16x32_bf16 v[84:87], a[52:55], a[4:7], v[84:87]
    ds_read_b64_tr_b16 a[90:91], v14 offset:18432
    v_mfma_f32_16x16x32_bf16 v[116:119], a[52:55], a[8:11], v[116:119]
    ds_read_b64_tr_b16 a[92:93], v15 offset:16384
    v_mfma_f32_16x16x32_bf16 v[56:59], a[56:59], a[0:3], v[56:59]
    s_or_b32 s85, s85, s87
    s_add_u32 s85, s85, s65
    s_andn2_b32 s85, s85, s87
    s_add_u32 s62, s82, s85
    s_addc_u32 s63, s83, 0
    ds_read_b64_tr_b16 a[94:95], v15 offset:18432
    v_mfma_f32_16x16x32_bf16 v[88:91], a[56:59], a[4:7], v[88:91]
    v_mfma_f32_16x16x32_bf16 v[120:123], a[56:59], a[8:11], v[120:123]
    v_mfma_f32_16x16x32_bf16 v[60:63], a[60:63], a[0:3], v[60:63]
    v_mfma_f32_16x16x32_bf16 v[92:95], a[60:63], a[4:7], v[92:95]
    v_mfma_f32_16x16x32_bf16 v[124:127], a[60:63], a[8:11], v[124:127]
    s_cmp_eq_u32 s77, 0
    s_cbranch_scc1 cw_104
    s_waitcnt vmcnt(16) lgkmcnt(0)
    s_branch cw_105
cw_104:
    s_waitcnt vmcnt(4) lgkmcnt(0)
cw_105:
    s_barrier
    v_mfma_f32_16x16x32_bf16 v[32:35], a[64:67], a[16:19], v[32:35]
    s_add_u32 m0, s76, 0
    ds_read_b128 a[0:3], v6 offset:32768
    v_mfma_f32_16x16x32_bf16 v[64:67], a[64:67], a[20:23], v[64:67]
    global_load_lds_dwordx4 v28, s[60:61]
    ds_read_b128 a[4:7], v6 offset:34816
    v_mfma_f32_16x16x32_bf16 v[96:99], a[64:67], a[24:27], v[96:99]
    ds_read_b128 a[8:11], v6 offset:36864
    v_mfma_f32_16x16x32_bf16 v[36:39], a[68:71], a[16:19], v[36:39]
    s_add_u32 m0, s76, 1024
    ds_read_b64_tr_b16 a[32:33], v8 offset:32768
    v_mfma_f32_16x16x32_bf16 v[68:71], a[68:71], a[20:23], v[68:71]
    global_load_lds_dwordx4 v29, s[60:61]
    ds_read_b64_tr_b16 a[34:35], v8 offset:34816
    v_mfma_f32_16x16x32_bf16 v[100:103], a[68:71], a[24:27], v[100:103]
    ds_read_b64_tr_b16 a[36:37], v9 offset:32768
    v_mfma_f32_16x16x32_bf16 v[40:43], a[72:75], a[16:19], v[40:43]
    s_add_u32 m0, s76, 2048
    ds_read_b64_tr_b16 a[38:39], v9 offset:34816
    v_mfma_f32_16x16x32_bf16 v[72:75], a[72:75], a[20:23], v[72:75]
    global_load_lds_dwordx4 v30, s[60:61]
    ds_read_b64_tr_b16 a[40:41], v10 offset:32768
    v_mfma_f32_16x16x32_bf16 v[104:107], a[72:75], a[24:27], v[104:107]
    ds_read_b64_tr_b16 a[42:43], v10 offset:34816
    v_mfma_f32_16x16x32_bf16 v[44:47], a[76:79], a[16:19], v[44:47]
    s_add_u32 m0, s67, 81920
    ds_read_b64_tr_b16 a[44:45], v11 offset:32768
    v_mfma_f32_16x16x32_bf16 v[76:79], a[76:79], a[20:23], v[76:79]
    global_load_lds_dwordx4 v4, s[62:63]
    ds_read_b64_tr_b16 a[46:47], v11 offset:34816
    v_mfma_f32_16x16x32_bf16 v[108:111], a[76:79], a[24:27], v[108:111]
    ds_read_b64_tr_b16 a[48:49], v12 offset:32768
    v_mfma_f32_16x16x32_bf16 v[48:51], a[80:83], a[16:19], v[48:51]
    s_add_u32 m0, s67, 82944
    ds_read_b64_tr_b16 a[50:51], v12 offset:34816
    v_mfma_f32_16x16x32_bf16 v[80:83], a[80:83], a[20:23], v[80:83]
    global_load_lds_dwordx4 v5, s[62:63]
    s_waitcnt lgkmcnt(6)
    ds_read_b64_tr_b16 a[52:53], v13 offset:32768
    v_mfma_f32_16x16x32_bf16 v[112:115], a[80:83], a[24:27], v[112:115]
    ds_read_b64_tr_b16 a[54:55], v13 offset:34816
    v_mfma_f32_16x16x32_bf16 v[52:55], a[84:87], a[16:19], v[52:55]
    ds_read_b64_tr_b16 a[56:57], v14 offset:32768
    v_mfma_f32_16x16x32_bf16 v[84:87], a[84:87], a[20:23], v[84:87]
    ds_read_b64_tr_b16 a[58:59], v14 offset:34816
    v_mfma_f32_16x16x32_bf16 v[116:119], a[84:87], a[24:27], v[116:119]
    ds_read_b64_tr_b16 a[60:61], v15 offset:32768
    v_mfma_f32_16x16x32_bf16 v[56:59], a[88:91], a[16:19], v[56:59]
    s_or_b32 s85, s85, s87
    s_add_u32 s85, s85, s65
    s_andn2_b32 s85, s85, s87
    s_add_u32 s62, s82, s85
    s_addc_u32 s63, s83, 0
    ds_read_b64_tr_b16 a[62:63], v15 offset:34816
    v_mfma_f32_16x16x32_bf16 v[88:91], a[88:91], a[20:23], v[88:91]
    v_mfma_f32_16x16x32_bf16 v[120:123], a[88:91], a[24:27], v[120:123]
    v_mfma_f32_16x16x32_bf16 v[60:63], a[92:95], a[16:19], v[60:63]
    s_or_b32 s84, s84, s86
    s_add_u32 s84, s84, s64
    s_andn2_b32 s84, s84, s86
    s_add_u32 s60, s80, s84
    s_addc_u32 s61, s81, 0
    v_mfma_f32_16x16x32_bf16 v[92:95], a[92:95], a[20:23], v[92:95]
    v_mfma_f32_16x16x32_bf16 v[124:127], a[92:95], a[24:27], v[124:127]
    s_cmp_eq_u32 s77, 0
    s_cbranch_scc1 cw_106
    s_waitcnt vmcnt(19) lgkmcnt(0)
    s_branch cw_107
cw_106:
    s_waitcnt vmcnt(7) lgkmcnt(0)
cw_107:
    s_barrier
    v_mfma_f32_16x16x32_bf16 v[32:35], a[32:35], a[0:3], v[32:35]
    s_add_u32 m0, s67, 98304
    ds_read_b128 a[16:19], v7 offset:32768
    v_mfma_f32_16x16x32_bf16 v[64:67], a[32:35], a[4:7], v[64:67]
    global_load_lds_dwordx4 v4, s[62:63]
    ds_read_b128 a[20:23], v7 offset:34816
    v_mfma_f32_16x16x32_bf16 v[96:99], a[32:35], a[8:11], v[96:99]
    ds_read_b128 a[24:27], v7 offset:36864
    v_mfma_f32_16x16x32_bf16 v[36:39], a[36:39], a[0:3], v[36:39]
    s_add_u32 m0, s67, 99328
    ds_read_b64_tr_b16 a[64:65], v8 offset:49152
    v_mfma_f32_16x16x32_bf16 v[68:71], a[36:39], a[4:7], v[68:71]
    global_load_lds_dwordx4 v5, s[62:63]
    ds_read_b64_tr_b16 a[66:67], v8 offset:51200
    v_mfma_f32_16x16x32_bf16 v[100:103], a[36:39], a[8:11], v[100:103]
    ds_read_b64_tr_b16 a[68:69], v9 offset:49152
    v_mfma_f32_16x16x32_bf16 v[40:43], a[40:43], a[0:3], v[40:43]
    ds_read_b64_tr_b16 a[70:71], v9 offset:51200
    v_mfma_f32_16x16x32_bf16 v[72:75], a[40:43], a[4:7], v[72:75]
    ds_read_b64_tr_b16 a[72:73], v10 offset:49152
    v_mfma_f32_16x16x32_bf16 v[104:107], a[40:43], a[8:11], v[104:107]
    ds_read_b64_tr_b16 a[74:75], v10 offset:51200
    v_mfma_f32_16x16x32_bf16 v[44:47], a[44:47], a[0:3], v[44:47]
    ds_read_b64_tr_b16 a[76:77], v11 offset:49152
    v_mfma_f32_16x16x32_bf16 v[76:79], a[44:47], a[4:7], v[76:79]
    ds_read_b64_tr_b16 a[78:79], v11 offset:51200
    v_mfma_f32_16x16x32_bf16 v[108:111], a[44:47], a[8:11], v[108:111]
    ds_read_b64_tr_b16 a[80:81], v12 offset:49152
    v_mfma_f32_16x16x32_bf16 v[48:51], a[48:51], a[0:3], v[48:51]
    ds_read_b64_tr_b16 a[82:83], v12 offset:51200
    v_mfma_f32_16x16x32_bf16 v[80:83], a[48:51], a[4:7], v[80:83]
    s_waitcnt lgkmcnt(6)
    ds_read_b64_tr_b16 a[84:85], v13 offset:49152
    v_mfma_f32_16x16x32_bf16 v[112:115], a[48:51], a[8:11], v[112:115]
    ds_read_b64_tr_b16 a[86:87], v13 offset:51200
    v_mfma_f32_16x16x32_bf16 v[52:55], a[52:55], a[0:3], v[52:55]
    ds_read_b64_tr_b16 a[88:89], v14 offset:49152
    v_mfma_f32_16x16x32_bf16 v[84:87], a[52:55], a[4:7], v[84:87]
    ds_read_b64_tr_b16 a[90:91], v14 offset:51200
    v_mfma_f32_16x16x32_bf16 v[116:119], a[52:55], a[8:11], v[116:119]
    ds_read_b64_tr_b16 a[92:93], v15 offset:49152
    v_mfma_f32_16x16x32_bf16 v[56:59], a[56:59], a[0:3], v[56:59]
    s_or_b32 s85, s85, s87
    s_add_u32 s85, s85, s65
    s_andn2_b32 s85, s85, s87
    s_add_u32 s62, s82, s85
    s_addc_u32 s63, s83, 0
    ds_read_b64_tr_b16 a[94:95], v15 offset:51200
    v_mfma_f32_16x16x32_bf16 v[88:91], a[56:59], a[4:7], v[88:91]
    v_mfma_f32_16x16x32_bf16 v[120:123], a[56:59], a[8:11], v[120:123]
    v_mfma_f32_16x16x32_bf16 v[60:63], a[60:63], a[0:3], v[60:63]
    v_mfma_f32_16x16x32_bf16 v[92:95], a[60:63], a[4:7], v[92:95]
    v_mfma_f32_16x16x32_bf16 v[124:127], a[60:63], a[8:11], v[124:127]
    s_waitcnt vmcnt(4) lgkmcnt(0)
    s_barrier
    s_mov_b32 s77, 0
    s_cmp_eq_u32 s89, 0
    s_cbranch_scc1 core_T3_ns
    s_mov_b32 s89, 0
    s_cmp_eq_u32 s75, 0
    s_cbranch_scc0 core_T3_ns
    v_mov_b32 v16, s88
    v_mov_b32 v17, 0
    s_mov_b64 exec, 1
    global_store_dword v16, v17, s[28:29] sc1
    s_mov_b64 exec, -1
core_T3_ns:
    v_mfma_f32_16x16x32_bf16 v[32:35], a[64:67], a[16:19], v[32:35]
    s_add_u32 m0, s76, 32768
    ds_read_b128 a[0:3], v6 offset:0
    v_mfma_f32_16x16x32_bf16 v[64:67], a[64:67], a[20:23], v[64:67]
    global_load_lds_dwordx4 v28, s[60:61]
    ds_read_b128 a[4:7], v6 offset:2048
    v_mfma_f32_16x16x32_bf16 v[96:99], a[64:67], a[24:27], v[96:99]
    ds_read_b128 a[8:11], v6 offset:4096
    v_mfma_f32_16x16x32_bf16 v[36:39], a[68:71], a[16:19], v[36:39]
    s_add_u32 m0, s76, 33792
    ds_read_b64_tr_b16 a[32:33], v8 offset:0
    v_mfma_f32_16x16x32_bf16 v[68:71], a[68:71], a[20:23], v[68:71]
    global_load_lds_dwordx4 v29, s[60:61]
    ds_read_b64_tr_b16 a[34:35], v8 offset:2048
    v_mfma_f32_16x16x32_bf16 v[100:103], a[68:71], a[24:27], v[100:103]
    ds_read_b64_tr_b16 a[36:37], v9 offset:0
    v_mfma_f32_16x16x32_bf16 v[40:43], a[72:75], a[16:19], v[40:43]
    s_add_u32 m0, s76, 34816
    ds_read_b64_tr_b16 a[38:39], v9 offset:2048
    v_mfma_f32_16x16x32_bf16 v[72:75], a[72:75], a[20:23], v[72:75]
    global_load_lds_dwordx4 v30, s[60:61]
    ds_read_b64_tr_b16 a[40:41], v10 offset:0
    v_mfma_f32_16x16x32_bf16 v[104:107], a[72:75], a[24:27], v[104:107]
    ds_read_b64_tr_b16 a[42:43], v10 offset:2048
    v_mfma_f32_16x16x32_bf16 v[44:47], a[76:79], a[16:19], v[44:47]
    s_add_u32 m0, s67, 114688
    ds_read_b64_tr_b16 a[44:45], v11 offset:0
    v_mfma_f32_16x16x32_bf16 v[76:79], a[76:79], a[20:23], v[76:79]
    global_load_lds_dwordx4 v4, s[62:63]
    ds_read_b64_tr_b16 a[46:47], v11 offset:2048
    v_mfma_f32_16x16x32_bf16 v[108:111], a[76:79], a[24:27], v[108:111]
    ds_read_b64_tr_b16 a[48:49], v12 offset:0
    v_mfma_f32_16x16x32_bf16 v[48:51], a[80:83], a[16:19], v[48:51]
    s_add_u32 m0, s67, 115712
    ds_read_b64_tr_b16 a[50:51], v12 offset:2048
    v_mfma_f32_16x16x32_bf16 v[80:83], a[80:83], a[20:23], v[80:83]
    global_load_lds_dwordx4 v5, s[62:63]
    s_waitcnt lgkmcnt(6)
    ds_read_b64_tr_b16 a[52:53], v13 offset:0
    v_mfma_f32_16x16x32_bf16 v[112:115], a[80:83], a[24:27], v[112:115]
    ds_read_b64_tr_b16 a[54:55], v13 offset:2048
    v_mfma_f32_16x16x32_bf16 v[52:55], a[84:87], a[16:19], v[52:55]
    ds_read_b64_tr_b16 a[56:57], v14 offset:0
    v_mfma_f32_16x16x32_bf16 v[84:87], a[84:87], a[20:23], v[84:87]
    ds_read_b64_tr_b16 a[58:59], v14 offset:2048
    v_mfma_f32_16x16x32_bf16 v[116:119], a[84:87], a[24:27], v[116:119]
    ds_read_b64_tr_b16 a[60:61], v15 offset:0
    v_mfma_f32_16x16x32_bf16 v[56:59], a[88:91], a[16:19], v[56:59]
    s_or_b32 s85, s85, s87
    s_add_u32 s85, s85, s65
    s_andn2_b32 s85, s85, s87
    s_add_u32 s62, s82, s85
    s_addc_u32 s63, s83, 0
    ds_read_b64_tr_b16 a[62:63], v15 offset:2048
    v_mfma_f32_16x16x32_bf16 v[88:91], a[88:91], a[20:23], v[88:91]
    v_mfma_f32_16x16x32_bf16 v[120:123], a[88:91], a[24:27], v[120:123]
    v_mfma_f32_16x16x32_bf16 v[60:63], a[92:95], a[16:19], v[60:63]
    s_or_b32 s84, s84, s86
    s_add_u32 s84, s84, s64
    s_andn2_b32 s84, s84, s86
    s_add_u32 s60, s80, s84
    s_addc_u32 s61, s81, 0
    v_mfma_f32_16x16x32_bf16 v[92:95], a[92:95], a[20:23], v[92:95]
    v_mfma_f32_16x16x32_bf16 v[124:127], a[92:95], a[24:27], v[124:127]
    s_sub_u32 s66, s66, 1
core_T3_loop:
    s_waitcnt vmcnt(7) lgkmcnt(0)
    s_barrier
    v_mfma_f32_16x16x32_bf16 v[32:35], a[32:35], a[0:3], v[32:35]
    s_add_u32 m0, s67, 65536
    ds_read_b128 a[16:19], v7 offset:0
    v_mfma_f32_16x16x32_bf16 v[64:67], a[32:35], a[4:7], v[64:67]
    global_load_lds_dwordx4 v4, s[62:63]
    ds_read_b128 a[20:23], v7 offset:2048
    v_mfma_f32_16x16x32_bf16 v[96:99], a[32:35], a[8:11], v[96:99]
    ds_read_b128 a[24:27], v7 offset:4096
    v_mfma_f32_16x16x32_bf16 v[36:39], a[36:39], a[0:3], v[36:39]
    s_add_u32 m0, s67, 66560
    ds_read_b64_tr_b16 a[64:65], v8 offset:16384
    v_mfma_f32_16x16x32_bf16 v[68:71], a[36:39], a[4:7], v[68:71]
    global_load_lds_dwordx4 v5, s[62:63]
    ds_read_b64_tr_b16 a[66:67], v8 offset:18432
    v_mfma_f32_16x16x32_bf16 v[100:103], a[36:39], a[8:11], v[100:103]
    ds_read_b64_tr_b16 a[68:69], v9 offset:16384
    v_mfma_f32_16x16x32_bf16 v[40:43], a[40:43], a[0:3], v[40:43]
    ds_read_b64_tr_b16 a[70:71], v9 offset:18432
    v_mfma_f32_16x16x32_bf16 v[72:75], a[40:43], a[4:7], v[72:75]
    ds_read_b64_tr_b16 a[72:73], v10 offset:16384
    v_mfma_f32_16x16x32_bf16 v[104:107], a[40:43], a[8:11], v[104:107]
    ds_read_b64_tr_b16 a[74:75], v10 offset:18432
    v_mfma_f32_16x16x32_bf16 v[44:47], a[44:47], a[0:3], v[44:47]
    ds_read_b64_tr_b16 a[76:77], v11 offset:16384
    v_mfma_f32_16x16x32_bf16 v[76:79], a[44:47], a[4:7], v[76:79]
    ds_read_b64_tr_b16 a[78:79], v11 offset:18432
    v_mfma_f32_16x16x32_bf16 v[108:111], a[44:47], a[8:11], v[108:111]
    ds_read_b64_tr_b16 a[80:81], v12 offset:16384
    v_mfma_f32_16x16x32_bf16 v[48:51], a[48:51], a[0:3], v[48:51]
    ds_read_b64_tr_b16 a[82:83], v12 offset:18432
    v_mfma_f32_16x16x32_bf16 v[80:83], a[48:51], a[4:7], v[80:83]
    s_waitcnt lgkmcnt(6)
    ds_read_b64_tr_b16 a[84:85], v13 offset:16384
    v_mfma_f32_16x16x32_bf16 v[112:115], a[48:51], a[8:11], v[112:115]
    ds_read_b64_tr_b16 a[86:87], v13 offset:18432
    v_mfma_f32_16x16x32_bf16 v[52:55], a[52:55], a[0:3], v[52:55]
    ds_read_b64_tr_b16 a[88:89], v14 offset:16384
    v_mfma_f32_16x16x32_bf16 v[84:87], a[52:55], a[4:7], v[84:87]
    ds_read_b64_tr_b16 a[90:91], v14 offset:18432
    v_mfma_f32_16x16x32_bf16 v[116:119], a[52:55], a[8:11], v[116:119]
    ds_read_b64_tr_b16 a[92:93], v15 offset:16384
    v_mfma_f32_16x16x32_bf16 v[56:59], a[56:59], a[0:3], v[56:59]
    s_or_b32 s85, s85, s87
    s_add_u32 s85, s85, s65
    s_andn2_b32 s85, s85, s87
    s_add_u32 s62, s82, s85
    s_addc_u32 s63, s83, 0
    ds_read_b64_tr_b16 a[94:95], v15 offset:18432
    v_mfma_f32_16x16x32_bf16 v[88:91], a[56:59], a[4:7], v[88:91]
    v_mfma_f32_16x16x32_bf16 v[120:123], a[56:59], a[8:11], v[120:123]
    v_mfma_f32_16x16x32_bf16 v[60:63], a[60:63], a[0:3], v[60:63]
    v_mfma_f32_16x16x32_bf16 v[92:95], a[60:63], a[4:7], v[92:95]
    v_mfma_f32_16x16x32_bf16 v[124:127], a[60:63], a[8:11], v[124:127]
    s_waitcnt vmcnt(4) lgkmcnt(0)
    s_barrier
    v_mfma_f32_16x16x32_bf16 v[32:35], a[64:67], a[16:19], v[32:35]
    s_add_u32 m0, s76, 0
    ds_read_b128 a[0:3], v6 offset:32768
    v_mfma_f32_16x16x32_bf16 v[64:67], a[64:67], a[20:23], v[64:67]
    global_load_lds_dwordx4 v28, s[60:61]
    ds_read_b128 a[4:7], v6 offset:34816
    v_mfma_f32_16x16x32_bf16 v[96:99], a[64:67], a[24:27], v[96:99]
    ds_read_b128 a[8:11], v6 offset:36864
    v_mfma_f32_16x16x32_bf16 v[36:39], a[68:71], a[16:19], v[36:39]
    s_add_u32 m0, s76, 1024
    ds_read_b64_tr_b16 a[32:33], v8 offset:32768
    v_mfma_f32_16x16x32_bf16 v[68:71], a[68:71], a[20:23], v[68:71]
    global_load_lds_dwordx4 v29, s[60:61]
    ds_read_b64_tr_b16 a[34:35], v8 offset:34816
    v_mfma_f32_16x16x32_bf16 v[100:103], a[68:71], a[24:27], v[100:103]
    ds_read_b64_tr_b16 a[36:37], v9 offset:32768
    v_mfma_f32_16x16x32_bf16 v[40:43], a[72:75], a[16:19], v[40:43]
    s_add_u32 m0, s76, 2048
    ds_read_b64_tr_b16 a[38:39], v9 offset:34816
    v_mfma_f32_16x16x32_bf16 v[72:75], a[72:75], a[20:23], v[72:75]
    global_load_lds_dwordx4 v30, s[60:61]
    ds_read_b64_tr_b16 a[40:41], v10 offset:32768
    v_mfma_f32_16x16x32_bf16 v[104:107], a[72:75], a[24:27], v[104:107]
    ds_read_b64_tr_b16 a[42:43], v10 offset:34816
    v_mfma_f32_16x16x32_bf16 v[44:47], a[76:79], a[16:19], v[44:47]
    s_add_u32 m0, s67, 81920
    ds_read_b64_tr_b16 a[44:45], v11 offset:32768
    v_mfma_f32_16x16x32_bf16 v[76:79], a[76:79], a[20:23], v[76:79]
    global_load_lds_dwordx4 v4, s[62:63]
    ds_read_b64_tr_b16 a[46:47], v11 offset:34816
    v_mfma_f32_16x16x32_bf16 v[108:111], a[76:79], a[24:27], v[108:111]
    ds_read_b64_tr_b16 a[48:49], v12 offset:32768
    v_mfma_f32_16x16x32_bf16 v[48:51], a[80:83], a[16:19], v[48:51]
    s_add_u32 m0, s67, 82944
    ds_read_b64_tr_b16 a[50:51], v12 offset:34816
    v_mfma_f32_16x16x32_bf16 v[80:83], a[80:83], a[20:23], v[80:83]
    global_load_lds_dwordx4 v5, s[62:63]
    s_waitcnt lgkmcnt(6)
    ds_read_b64_tr_b16 a[52:53], v13 offset:32768
    v_mfma_f32_16x16x32_bf16 v[112:115], a[80:83], a[24:27], v[112:115]
    ds_read_b64_tr_b16 a[54:55], v13 offset:34816
    v_mfma_f32_16x16x32_bf16 v[52:55], a[84:87], a[16:19], v[52:55]
    ds_read_b64_tr_b16 a[56:57], v14 offset:32768
    v_mfma_f32_16x16x32_bf16 v[84:87], a[84:87], a[20:23], v[84:87]
    ds_read_b64_tr_b16 a[58:59], v14 offset:34816
    v_mfma_f32_16x16x32_bf16 v[116:119], a[84:87], a[24:27], v[116:119]
    ds_read_b64_tr_b16 a[60:61], v15 offset:32768
    v_mfma_f32_16x16x32_bf16 v[56:59], a[88:91], a[16:19], v[56:59]
    s_or_b32 s85, s85, s87
    s_add_u32 s85, s85, s65
    s_andn2_b32 s85, s85, s87
    s_add_u32 s62, s82, s85
    s_addc_u32 s63, s83, 0
    ds_read_b64_tr_b16 a[62:63], v15 offset:34816
    v_mfma_f32_16x16x32_bf16 v[88:91], a[88:91], a[20:23], v[88:91]
    v_mfma_f32_16x16x32_bf16 v[120:123], a[88:91], a[24:27], v[120:123]
    v_mfma_f32_16x16x32_bf16 v[60:63], a[92:95], a[16:19], v[60:63]
    s_or_b32 s84, s84, s86
    s_add_u32 s84, s84, s64
    s_andn2_b32 s84, s84, s86
    s_add_u32 s60, s80, s84
    s_addc_u32 s61, s81, 0
    v_mfma_f32_16x16x32_bf16 v[92:95], a[92:95], a[20:23], v[92:95]
    v_mfma_f32_16x16x32_bf16 v[124:127], a[92:95], a[24:27], v[124:127]
    s_waitcnt vmcnt(7) lgkmcnt(0)
    s_barrier
    v_mfma_f32_16x16x32_bf16 v[32:35], a[32:35], a[0:3], v[32:35]
    s_add_u32 m0, s67, 98304
    ds_read_b128 a[16:19], v7 offset:32768
    v_mfma_f32_16x16x32_bf16 v[64:67], a[32:35], a[4:7], v[64:67]
    global_load_lds_dwordx4 v4, s[62:63]
    ds_read_b128 a[20:23], v7 offset:34816
    v_mfma_f32_16x16x32_bf16 v[96:99], a[32:35], a[8:11], v[96:99]
    ds_read_b128 a[24:27], v7 offset:36864
    v_mfma_f32_16x16x32_bf16 v[36:39], a[36:39], a[0:3], v[36:39]
    s_add_u32 m0, s67, 99328
    ds_read_b64_tr_b16 a[64:65], v8 offset:49152
    v_mfma_f32_16x16x32_bf16 v[68:71], a[36:39], a[4:7], v[68:71]
    global_load_lds_dwordx4 v5, s[62:63]
    ds_read_b64_tr_b16 a[66:67], v8 offset:51200
    v_mfma_f32_16x16x32_bf16 v[100:103], a[36:39], a[8:11], v[100:103]
    ds_read_b64_tr_b16 a[68:69], v9 offset:49152
    v_mfma_f32_16x16x32_bf16 v[40:43], a[40:43], a[0:3], v[40:43]
    ds_read_b64_tr_b16 a[70:71], v9 offset:51200
    v_mfma_f32_16x16x32_bf16 v[72:75], a[40:43], a[4:7], v[72:75]
    ds_read_b64_tr_b16 a[72:73], v10 offset:49152
    v_mfma_f32_16x16x32_bf16 v[104:107], a[40:43], a[8:11], v[104:107]
    ds_read_b64_tr_b16 a[74:75], v10 offset:51200
    v_mfma_f32_16x16x32_bf16 v[44:47], a[44:47], a[0:3], v[44:47]
    ds_read_b64_tr_b16 a[76:77], v11 offset:49152
    v_mfma_f32_16x16x32_bf16 v[76:79], a[44:47], a[4:7], v[76:79]
    ds_read_b64_tr_b16 a[78:79], v11 offset:51200
    v_mfma_f32_16x16x32_bf16 v[108:111], a[44:47], a[8:11], v[108:111]
    ds_read_b64_tr_b16 a[80:81], v12 offset:49152
    v_mfma_f32_16x16x32_bf16 v[48:51], a[48:51], a[0:3], v[48:51]
    ds_read_b64_tr_b16 a[82:83], v12 offset:51200
    v_mfma_f32_16x16x32_bf16 v[80:83], a[48:51], a[4:7], v[80:83]
    s_waitcnt lgkmcnt(6)
    ds_read_b64_tr_b16 a[84:85], v13 offset:49152
    v_mfma_f32_16x16x32_bf16 v[112:115], a[48:51], a[8:11], v[112:115]
    ds_read_b64_tr_b16 a[86:87], v13 offset:51200
    v_mfma_f32_16x16x32_bf16 v[52:55], a[52:55], a[0:3], v[52:55]
    ds_read_b64_tr_b16 a[88:89], v14 offset:49152
    v_mfma_f32_16x16x32_bf16 v[84:87], a[52:55], a[4:7], v[84:87]
    ds_read_b64_tr_b16 a[90:91], v14 offset:51200
    v_mfma_f32_16x16x32_bf16 v[116:119], a[52:55], a[8:11], v[116:119]
    ds_read_b64_tr_b16 a[92:93], v15 offset:49152
    v_mfma_f32_16x16x32_bf16 v[56:59], a[56:59], a[0:3], v[56:59]
    s_or_b32 s85, s85, s87
    s_add_u32 s85, s85, s65
    s_andn2_b32 s85, s85, s87
    s_add_u32 s62, s82, s85
    s_addc_u32 s63, s83, 0
    ds_read_b64_tr_b16 a[94:95], v15 offset:51200
    v_mfma_f32_16x16x32_bf16 v[88:91], a[56:59], a[4:7], v[88:91]
    v_mfma_f32_16x16x32_bf16 v[120:123], a[56:59], a[8:11], v[120:123]
    v_mfma_f32_16x16x32_bf16 v[60:63], a[60:63], a[0:3], v[60:63]
    v_mfma_f32_16x16x32_bf16 v[92:95], a[60:63], a[4:7], v[92:95]
    v_mfma_f32_16x16x32_bf16 v[124:127], a[60:63], a[8:11], v[124:127]
    s_waitcnt vmcnt(4) lgkmcnt(0)
    s_barrier
    v_mfma_f32_16x16x32_bf16 v[32:35], a[64:67], a[16:19], v[32:35]
    s_add_u32 m0, s76, 32768
    ds_read_b128 a[0:3], v6 offset:0
    v_mfma_f32_16x16x32_bf16 v[64:67], a[64:67], a[20:23], v[64:67]
    global_load_lds_dwordx4 v28, s[60:61]
    ds_read_b128 a[4:7], v6 offset:2048
    v_mfma_f32_16x16x32_bf16 v[96:99], a[64:67], a[24:27], v[96:99]
    ds_read_b128 a[8:11], v6 offset:4096
    v_mfma_f32_16x16x32_bf16 v[36:39], a[68:71], a[16:19], v[36:39]
    s_add_u32 m0, s76, 33792
    ds_read_b64_tr_b16 a[32:33], v8 offset:0
    v_mfma_f32_16x16x32_bf16 v[68:71], a[68:71], a[20:23], v[68:71]
    global_load_lds_dwordx4 v29, s[60:61]
    ds_read_b64_tr_b16 a[34:35], v8 offset:2048
    v_mfma_f32_16x16x32_bf16 v[100:103], a[68:71], a[24:27], v[100:103]
    ds_read_b64_tr_b16 a[36:37], v9 offset:0
    v_mfma_f32_16x16x32_bf16 v[40:43], a[72:75], a[16:19], v[40:43]
    s_add_u32 m0, s76, 34816
    ds_read_b64_tr_b16 a[38:39], v9 offset:2048
    v_mfma_f32_16x16x32_bf16 v[72:75], a[72:75], a[20:23], v[72:75]
    global_load_lds_dwordx4 v30, s[60:61]
    ds_read_b64_tr_b16 a[40:41], v10 offset:0
    v_mfma_f32_16x16x32_bf16 v[104:107], a[72:75], a[24:27], v[104:107]
    ds_read_b64_tr_b16 a[42:43], v10 offset:2048
    v_mfma_f32_16x16x32_bf16 v[44:47], a[76:79], a[16:19], v[44:47]
    s_add_u32 m0, s67, 114688
    ds_read_b64_tr_b16 a[44:45], v11 offset:0
    v_mfma_f32_16x16x32_bf16 v[76:79], a[76:79], a[20:23], v[76:79]
    global_load_lds_dwordx4 v4, s[62:63]
    ds_read_b64_tr_b16 a[46:47], v11 offset:2048
    v_mfma_f32_16x16x32_bf16 v[108:111], a[76:79], a[24:27], v[108:111]
    ds_read_b64_tr_b16 a[48:49], v12 offset:0
    v_mfma_f32_16x16x32_bf16 v[48:51], a[80:83], a[16:19], v[48:51]
    s_add_u32 m0, s67, 115712
    ds_read_b64_tr_b16 a[50:51], v12 offset:2048
    v_mfma_f32_16x16x32_bf16 v[80:83], a[80:83], a[20:23], v[80:83]
    global_load_lds_dwordx4 v5, s[62:63]
    s_waitcnt lgkmcnt(6)
    ds_read_b64_tr_b16 a[52:53], v13 offset:0
    v_mfma_f32_16x16x32_bf16 v[112:115], a[80:83], a[24:27], v[112:115]
    ds_read_b64_tr_b16 a[54:55], v13 offset:2048
    v_mfma_f32_16x16x32_bf16 v[52:55], a[84:87], a[16:19], v[52:55]
    ds_read_b64_tr_b16 a[56:57], v14 offset:0
    v_mfma_f32_16x16x32_bf16 v[84:87], a[84:87], a[20:23], v[84:87]
    ds_read_b64_tr_b16 a[58:59], v14 offset:2048
    v_mfma_f32_16x16x32_bf16 v[116:119], a[84:87], a[24:27], v[116:119]
    ds_read_b64_tr_b16 a[60:61], v15 offset:0
    v_mfma_f32_16x16x32_bf16 v[56:59], a[88:91], a[16:19], v[56:59]
    s_or_b32 s85, s85, s87
    s_add_u32 s85, s85, s65
    s_andn2_b32 s85, s85, s87
    s_add_u32 s62, s82, s85
    s_addc_u32 s63, s83, 0
    ds_read_b64_tr_b16 a[62:63], v15 offset:2048
    v_mfma_f32_16x16x32_bf16 v[88:91], a[88:91], a[20:23], v[88:91]
    v_mfma_f32_16x16x32_bf16 v[120:123], a[88:91], a[24:27], v[120:123]
    v_mfma_f32_16x16x32_bf16 v[60:63], a[92:95], a[16:19], v[60:63]
    s_or_b32 s84, s84, s86
    s_add_u32 s84, s84, s64
    s_andn2_b32 s84, s84, s86
    s_add_u32 s60, s80, s84
    s_addc_u32 s61, s81, 0
    v_mfma_f32_16x16x32_bf16 v[92:95], a[92:95], a[20:23], v[92:95]
    v_mfma_f32_16x16x32_bf16 v[124:127], a[92:95], a[24:27], v[124:127]
    s_sub_u32 s66, s66, 1
    s_cmp_lg_u32 s66, 0
    s_cbranch_scc1 core_T3_loop
    s_waitcnt vmcnt(7) lgkmcnt(0)
    s_barrier
    s_cmp_eq_u32 s98, 0
    s_cbranch_scc1 core_T3_nt
    v_lshlrev_b32 v20, 6, v0
    v_min_u32 v21, s99, v20
    v_min_u32 v22, s100, v20
    v_min_u32 v23, s101, v20
    global_load_dword a31, v21, s[90:91]
    global_load_dword a31, v22, s[92:93]
    global_load_dword a31, v23, s[94:95]
core_T3_nt:
    v_mfma_f32_16x16x32_bf16 v[32:35], a[32:35], a[0:3], v[32:35]
    ds_read_b128 a[16:19], v7 offset:0
    v_mfma_f32_16x16x32_bf16 v[64:67], a[32:35], a[4:7], v[64:67]
    ds_read_b128 a[20:23], v7 offset:2048
    v_mfma_f32_16x16x32_bf16 v[96:99], a[32:35], a[8:11], v[96:99]
    ds_read_b128 a[24:27], v7 offset:4096
    v_mfma_f32_16x16x32_bf16 v[36:39], a[36:39], a[0:3], v[36:39]
    ds_read_b64_tr_b16 a[64:65], v8 offset:16384
    v_mfma_f32_16x16x32_bf16 v[68:71], a[36:39], a[4:7], v[68:71]
    ds_read_b64_tr_b16 a[66:67], v8 offset:18432
    v_mfma_f32_16x16x32_bf16 v[100:103], a[36:39], a[8:11], v[100:103]
    ds_read_b64_tr_b16 a[68:69], v9 offset:16384
    v_mfma_f32_16x16x32_bf16 v[40:43], a[40:43], a[0:3], v[40:43]
    ds_read_b64_tr_b16 a[70:71], v9 offset:18432
    v_mfma_f32_16x16x32_bf16 v[72:75], a[40:43], a[4:7], v[72:75]
    ds_read_b64_tr_b16 a[72:73], v10 offset:16384
    v_mfma_f32_16x16x32_bf16 v[104:107], a[40:43], a[8:11], v[104:107]
    ds_read_b64_tr_b16 a[74:75], v10 offset:18432
    v_mfma_f32_16x16x32_bf16 v[44:47], a[44:47], a[0:3], v[44:47]
    ds_read_b64_tr_b16 a[76:77], v11 offset:16384
    v_mfma_f32_16x16x32_bf16 v[76:79], a[44:47], a[4:7], v[76:79]
    ds_read_b64_tr_b16 a[78:79], v11 offset:18432
    v_mfma_f32_16x16x32_bf16 v[108:111], a[44:47], a[8:11], v[108:111]
    ds_read_b64_tr_b16 a[80:81], v12 offset:16384
    v_mfma_f32_16x16x32_bf16 v[48:51], a[48:51], a[0:3], v[48:51]
    ds_read_b64_tr_b16 a[82:83], v12 offset:18432
    v_mfma_f32_16x16x32_bf16 v[80:83], a[48:51], a[4:7], v[80:83]
    s_waitcnt lgkmcnt(6)
    ds_read_b64_tr_b16 a[84:85], v13 offset:16384
    v_mfma_f32_16x16x32_bf16 v[112:115], a[48:51], a[8:11], v[112:115]
    ds_read_b64_tr_b16 a[86:87], v13 offset:18432
    v_mfma_f32_16x16x32_bf16 v[52:55], a[52:55], a[0:3], v[52:55]
    ds_read_b64_tr_b16 a[88:89], v14 offset:16384
    v_mfma_f32_16x16x32_bf16 v[84:87], a[52:55], a[4:7], v[84:87]
    ds_read_b64_tr_b16 a[90:91], v14 offset:18432
    v_mfma_f32_16x16x32_bf16 v[116:119], a[52:55], a[8:11], v[116:119]
    ds_read_b64_tr_b16 a[92:93], v15 offset:16384
    v_mfma_f32_16x16x32_bf16 v[56:59], a[56:59], a[0:3], v[56:59]
    ds_read_b64_tr_b16 a[94:95], v15 offset:18432
    v_mfma_f32_16x16x32_bf16 v[88:91], a[56:59], a[4:7], v[88:91]
    v_mfma_f32_16x16x32_bf16 v[120:123], a[56:59], a[8:11], v[120:123]
    v_mfma_f32_16x16x32_bf16 v[60:63], a[60:63], a[0:3], v[60:63]
    v_mfma_f32_16x16x32_bf16 v[92:95], a[60:63], a[4:7], v[92:95]
    v_mfma_f32_16x16x32_bf16 v[124:127], a[60:63], a[8:11], v[124:127]
    s_cmp_eq_u32 s98, 0
    s_cbranch_scc1 cw_108
    s_waitcnt vmcnt(5) lgkmcnt(0)
    s_branch cw_109
cw_108:
    s_waitcnt vmcnt(2) lgkmcnt(0)
cw_109:
    s_barrier
    v_mfma_f32_16x16x32_bf16 v[32:35], a[64:67], a[16:19], v[32:35]
    ds_read_b128 a[0:3], v6 offset:32768
    v_mfma_f32_16x16x32_bf16 v[64:67], a[64:67], a[20:23], v[64:67]
    ds_read_b128 a[4:7], v6 offset:34816
    v_mfma_f32_16x16x32_bf16 v[96:99], a[64:67], a[24:27], v[96:99]
    ds_read_b128 a[8:11], v6 offset:36864
    v_mfma_f32_16x16x32_bf16 v[36:39], a[68:71], a[16:19], v[36:39]
    ds_read_b64_tr_b16 a[32:33], v8 offset:32768
    v_mfma_f32_16x16x32_bf16 v[68:71], a[68:71], a[20:23], v[68:71]
    ds_read_b64_tr_b16 a[34:35], v8 offset:34816
    v_mfma_f32_16x16x32_bf16 v[100:103], a[68:71], a[24:27], v[100:103]
    ds_read_b64_tr_b16 a[36:37], v9 offset:32768
    v_mfma_f32_16x16x32_bf16 v[40:43], a[72:75], a[16:19], v[40:43]
    ds_read_b64_tr_b16 a[38:39], v9 offset:34816
    v_mfma_f32_16x16x32_bf16 v[72:75], a[72:75], a[20:23], v[72:75]
    ds_read_b64_tr_b16 a[40:41], v10 offset:32768
    v_mfma_f32_16x16x32_bf16 v[104:107], a[72:75], a[24:27], v[104:107]
    ds_read_b64_tr_b16 a[42:43], v10 offset:34816
    v_mfma_f32_16x16x32_bf16 v[44:47], a[76:79], a[16:19], v[44:47]
    ds_read_b64_tr_b16 a[44:45], v11 offset:32768
    v_mfma_f32_16x16x32_bf16 v[76:79], a[76:79], a[20:23], v[76:79]
    ds_read_b64_tr_b16 a[46:47], v11 offset:34816
    v_mfma_f32_16x16x32_bf16 v[108:111], a[76:79], a[24:27], v[108:111]
    ds_read_b64_tr_b16 a[48:49], v12 offset:32768
    v_mfma_f32_16x16x32_bf16 v[48:51], a[80:83], a[16:19], v[48:51]
    ds_read_b64_tr_b16 a[50:51], v12 offset:34816
    v_mfma_f32_16x16x32_bf16 v[80:83], a[80:83], a[20:23], v[80:83]
    s_waitcnt lgkmcnt(6)
    ds_read_b64_tr_b16 a[52:53], v13 offset:32768
    v_mfma_f32_16x16x32_bf16 v[112:115], a[80:83], a[24:27], v[112:115]
    ds_read_b64_tr_b16 a[54:55], v13 offset:34816
    v_mfma_f32_16x16x32_bf16 v[52:55], a[84:87], a[16:19], v[52:55]
    ds_read_b64_tr_b16 a[56:57], v14 offset:32768
    v_mfma_f32_16x16x32_bf16 v[84:87], a[84:87], a[20:23], v[84:87]
    ds_read_b64_tr_b16 a[58:59], v14 offset:34816
    v_mfma_f32_16x16x32_bf16 v[116:119], a[84:87], a[24:27], v[116:119]
    ds_read_b64_tr_b16 a[60:61], v15 offset:32768
    v_mfma_f32_16x16x32_bf16 v[56:59], a[88:91], a[16:19], v[56:59]
    ds_read_b64_tr_b16 a[62:63], v15 offset:34816
    v_mfma_f32_16x16x32_bf16 v[88:91], a[88:91], a[20:23], v[88:91]
    v_mfma_f32_16x16x32_bf16 v[120:123], a[88:91], a[24:27], v[120:123]
    v_mfma_f32_16x16x32_bf16 v[60:63], a[92:95], a[16:19], v[60:63]
    v_mfma_f32_16x16x32_bf16 v[92:95], a[92:95], a[20:23], v[92:95]
    v_mfma_f32_16x16x32_bf16 v[124:127], a[92:95], a[24:27], v[124:127]
    s_cmp_eq_u32 s98, 0
    s_cbranch_scc1 cw_110
    s_waitcnt vmcnt(3) lgkmcnt(0)
    s_branch cw_111
cw_110:
    s_waitcnt vmcnt(0) lgkmcnt(0)
cw_111:
    s_barrier
    s_mov_b32 s98, 0
    v_mfma_f32_16x16x32_bf16 v[32:35], a[32:35], a[0:3], v[32:35]
    ds_read_b128 a[16:19], v7 offset:32768
    v_mfma_f32_16x16x32_bf16 v[64:67], a[32:35], a[4:7], v[64:67]
    ds_read_b128 a[20:23], v7 offset:34816
    v_mfma_f32_16x16x32_bf16 v[96:99], a[32:35], a[8:11], v[96:99]
    ds_read_b128 a[24:27], v7 offset:36864
    v_mfma_f32_16x16x32_bf16 v[36:39], a[36:39], a[0:3], v[36:39]
    ds_read_b64_tr_b16 a[64:65], v8 offset:49152
    v_mfma_f32_16x16x32_bf16 v[68:71], a[36:39], a[4:7], v[68:71]
    ds_read_b64_tr_b16 a[66:67], v8 offset:51200
    v_mfma_f32_16x16x32_bf16 v[100:103], a[36:39], a[8:11], v[100:103]
    ds_read_b64_tr_b16 a[68:69], v9 offset:49152
    v_mfma_f32_16x16x32_bf16 v[40:43], a[40:43], a[0:3], v[40:43]
    ds_read_b64_tr_b16 a[70:71], v9 offset:51200
    v_mfma_f32_16x16x32_bf16 v[72:75], a[40:43], a[4:7], v[72:75]
    ds_read_b64_tr_b16 a[72:73], v10 offset:49152
    v_mfma_f32_16x16x32_bf16 v[104:107], a[40:43], a[8:11], v[104:107]
    ds_read_b64_tr_b16 a[74:75], v10 offset:51200
    v_mfma_f32_16x16x32_bf16 v[44:47], a[44:47], a[0:3], v[44:47]
    ds_read_b64_tr_b16 a[76:77], v11 offset:49152
    v_mfma_f32_16x16x32_bf16 v[76:79], a[44:47], a[4:7], v[76:79]
    ds_read_b64_tr_b16 a[78:79], v11 offset:51200
    v_mfma_f32_16x16x32_bf16 v[108:111], a[44:47], a[8:11], v[108:111]
    ds_read_b64_tr_b16 a[80:81], v12 offset:49152
    v_mfma_f32_16x16x32_bf16 v[48:51], a[48:51], a[0:3], v[48:51]
    ds_read_b64_tr_b16 a[82:83], v12 offset:51200
    v_mfma_f32_16x16x32_bf16 v[80:83], a[48:51], a[4:7], v[80:83]
    s_waitcnt lgkmcnt(6)
    ds_read_b64_tr_b16 a[84:85], v13 offset:49152
    v_mfma_f32_16x16x32_bf16 v[112:115], a[48:51], a[8:11], v[112:115]
    ds_read_b64_tr_b16 a[86:87], v13 offset:51200
    v_mfma_f32_16x16x32_bf16 v[52:55], a[52:55], a[0:3], v[52:55]
    ds_read_b64_tr_b16 a[88:89], v14 offset:49152
    v_mfma_f32_16x16x32_bf16 v[84:87], a[52:55], a[4:7], v[84:87]
    ds_read_b64_tr_b16 a[90:91], v14 offset:51200
    v_mfma_f32_16x16x32_bf16 v[116:119], a[52:55], a[8:11], v[116:119]
    ds_read_b64_tr_b16 a[92:93], v15 offset:49152
    v_mfma_f32_16x16x32_bf16 v[56:59], a[56:59], a[0:3], v[56:59]
    ds_read_b64_tr_b16 a[94:95], v15 offset:51200
    v_mfma_f32_16x16x32_bf16 v[88:91], a[56:59], a[4:7], v[88:91]
    v_mfma_f32_16x16x32_bf16 v[120:123], a[56:59], a[8:11], v[120:123]
    v_mfma_f32_16x16x32_bf16 v[60:63], a[60:63], a[0:3], v[60:63]
    v_mfma_f32_16x16x32_bf16 v[92:95], a[60:63], a[4:7], v[92:95]
    v_mfma_f32_16x16x32_bf16 v[124:127], a[60:63], a[8:11], v[124:127]
    s_waitcnt lgkmcnt(0)
    v_mfma_f32_16x16x32_bf16 v[32:35], a[64:67], a[16:19], v[32:35]
    v_mfma_f32_16x16x32_bf16 v[64:67], a[64:67], a[20:23], v[64:67]
    v_mfma_f32_16x16x32_bf16 v[96:99], a[64:67], a[24:27], v[96:99]
    v_mfma_f32_16x16x32_bf16 v[36:39], a[68:71], a[16:19], v[36:39]
    v_mfma_f32_16x16x32_bf16 v[68:71], a[68:71], a[20:23], v[68:71]
    v_mfma_f32_16x16x32_bf16 v[100:103], a[68:71], a[24:27], v[100:103]
    v_mfma_f32_16x16x32_bf16 v[40:43], a[72:75], a[16:19], v[40:43]
    v_mfma_f32_16x16x32_bf16 v[72:75], a[72:75], a[20:23], v[72:75]
    v_mfma_f32_16x16x32_bf16 v[104:107], a[72:75], a[24:27], v[104:107]
    v_mfma_f32_16x16x32_bf16 v[44:47], a[76:79], a[16:19], v[44:47]
    v_mfma_f32_16x16x32_bf16 v[76:79], a[76:79], a[20:23], v[76:79]
    v_mfma_f32_16x16x32_bf16 v[108:111], a[76:79], a[24:27], v[108:111]
    v_mfma_f32_16x16x32_bf16 v[48:51], a[80:83], a[16:19], v[48:51]
    v_mfma_f32_16x16x32_bf16 v[80:83], a[80:83], a[20:23], v[80:83]
    v_mfma_f32_16x16x32_bf16 v[112:115], a[80:83], a[24:27], v[112:115]
    v_mfma_f32_16x16x32_bf16 v[52:55], a[84:87], a[16:19], v[52:55]
    v_mfma_f32_16x16x32_bf16 v[84:87], a[84:87], a[20:23], v[84:87]
    v_mfma_f32_16x16x32_bf16 v[116:119], a[84:87], a[24:27], v[116:119]
    v_mfma_f32_16x16x32_bf16 v[56:59], a[88:91], a[16:19], v[56:59]
    v_mfma_f32_16x16x32_bf16 v[88:91], a[88:91], a[20:23], v[88:91]
    v_mfma_f32_16x16x32_bf16 v[120:123], a[88:91], a[24:27], v[120:123]
    v_mfma_f32_16x16x32_bf16 v[60:63], a[92:95], a[16:19], v[60:63]
    v_mfma_f32_16x16x32_bf16 v[92:95], a[92:95], a[20:23], v[92:95]
    v_mfma_f32_16x16x32_bf16 v[124:127], a[92:95], a[24:27], v[124:127]
    s_nop 7
    s_setpc_b64 s[68:69]
core_T2:
    s_mov_b32 s84, 0
    s_mov_b32 s85, 0
    s_add_u32 s60, s80, s78
    s_addc_u32 s61, s81, 0
    s_add_u32 s62, s82, s79
    s_addc_u32 s63, s83, 0
    s_barrier
    s_add_u32 m0, s76, 0
    s_nop 0
    global_load_lds_dwordx4 v28, s[60:61]
    s_add_u32 m0, s76, 1024
    s_nop 0
    global_load_lds_dwordx4 v29, s[60:61]
    s_or_b32 s84, s84, s86
    s_add_u32 s84, s84, s64
    s_andn2_b32 s84, s84, s86
    s_xor_b32 s60, s84, s78
    s_add_u32 s60, s80, s60
    s_addc_u32 s61, s81, 0
    s_add_u32 m0, s67, 65536
    s_nop 0
    global_load_lds_dwordx4 v4, s[62:63]
    s_add_u32 m0, s67, 66560
    s_nop 0
    global_load_lds_dwordx4 v5, s[62:63]
    s_or_b32 s85, s85, s87
    s_add_u32 s85, s85, s65
    s_andn2_b32 s85, s85, s87
    s_xor_b32 s62, s85, s79
    s_add_u32 s62, s82, s62
    s_addc_u32 s63, s83, 0
    s_add_u32 m0, s67, 81920
    s_nop 0
    global_load_lds_dwordx4 v4, s[62:63]
    s_add_u32 m0, s67, 82944
    s_nop 0
    global_load_lds_dwordx4 v5, s[62:63]
    s_or_b32 s85, s85, s87
    s_add_u32 s85, s85, s65
    s_andn2_b32 s85, s85, s87
    s_xor_b32 s62, s85, s79
    s_add_u32 s62, s82, s62
    s_addc_u32 s63, s83, 0
    s_add_u32 m0, s67, 98304
    s_nop 0
    global_load_lds_dwordx4 v4, s[62:63]
    s_add_u32 m0, s67, 99328
    s_nop 0
    global_load_lds_dwordx4 v5, s[62:63]
    s_or_b32 s85, s85, s87
    s_add_u32 s85, s85, s65
    s_andn2_b32 s85, s85, s87
    s_xor_b32 s62, s85, s79
    s_add_u32 s62, s82, s62
    s_addc_u32 s63, s83, 0
    s_add_u32 m0, s76, 32768
    s_nop 0
    global_load_lds_dwordx4 v28, s[60:61]
    s_add_u32 m0, s76, 33792
    s_nop 0
    global_load_lds_dwordx4 v29, s[60:61]
    s_or_b32 s84, s84, s86
    s_add_u32 s84, s84, s64
    s_andn2_b32 s84, s84, s86
    s_xor_b32 s60, s84, s78
    s_add_u32 s60, s80, s60
    s_addc_u32 s61, s81, 0
    s_add_u32 m0, s67, 114688
    s_nop 0
    global_load_lds_dwordx4 v4, s[62:63]
    s_add_u32 m0, s67, 115712
    s_nop 0
    global_load_lds_dwordx4 v5, s[62:63]
    s_or_b32 s85, s85, s87
    s_add_u32 s85, s85, s65
    s_andn2_b32 s85, s85, s87
    s_xor_b32 s62, s85, s79
    s_add_u32 s62, s82, s62
    s_addc_u32 s63, s83, 0
core_T2_m:
    v_mov_b32 v32, 0
    v_mov_b32 v33, 0
    v_mov_b32 v34, 0
    v_mov_b32 v35, 0
    v_mov_b32 v36, 0
    v_mov_b32 v37, 0
    v_mov_b32 v38, 0
    v_mov_b32 v39, 0
    v_mov_b32 v40, 0
    v_mov_b32 v41, 0
    v_mov_b32 v42, 0
    v_mov_b32 v43, 0
    v_mov_b32 v44, 0
    v_mov_b32 v45, 0
    v_mov_b32 v46, 0
    v_mov_b32 v47, 0
    v_mov_b32 v48, 0
    v_mov_b32 v49, 0
    v_mov_b32 v50, 0
    v_mov_b32 v51, 0
    v_mov_b32 v52, 0
    v_mov_b32 v53, 0
    v_mov_b32 v54, 0
    v_mov_b32 v55, 0
    v_mov_b32 v56, 0
    v_mov_b32 v57, 0
    v_mov_b32 v58, 0
    v_mov_b32 v59, 0
    v_mov_b32 v60, 0
    v_mov_b32 v61, 0
    v_mov_b32 v62, 0
    v_mov_b32 v63, 0
    v_mov_b32 v64, 0
    v_mov_b32 v65, 0
    v_mov_b32 v66, 0
    v_mov_b32 v67, 0
    v_mov_b32 v68, 0
    v_mov_b32 v69, 0
    v_mov_b32 v70, 0
    v_mov_b32 v71, 0
    v_mov_b32 v72, 0
    v_mov_b32 v73, 0
    v_mov_b32 v74, 0
    v_mov_b32 v75, 0
    v_mov_b32 v76, 0
    v_mov_b32 v77, 0
    v_mov_b32 v78, 0
    v_mov_b32 v79, 0
    v_mov_b32 v80, 0
    v_mov_b32 v81, 0
    v_mov_b32 v82, 0
    v_mov_b32 v83, 0
    v_mov_b32 v84, 0
    v_mov_b32 v85, 0
    v_mov_b32 v86, 0
    v_mov_b32 v87, 0
    v_mov_b32 v88, 0
    v_mov_b32 v89, 0
    v_mov_b32 v90, 0
    v_mov_b32 v91, 0
    v_mov_b32 v92, 0
    v_mov_b32 v93, 0
    v_mov_b32 v94, 0
    v_mov_b32 v95, 0
    s_cmp_eq_u32 s77, 0
    s_cbranch_scc1 cw_112
    s_waitcnt vmcnt(20)
    s_branch cw_113
cw_112:
    s_waitcnt vmcnt(8)
cw_113:
    s_barrier
    ds_read_b128 a[0:3], v6 offset:0
    ds_read_b128 a[4:7], v6 offset:2048
    ds_read_b64_tr_b16 a[32:33], v8 offset:0
    ds_read_b64_tr_b16 a[34:35], v8 offset:2048
    ds_read_b64_tr_b16 a[36:37], v9 offset:0
    ds_read_b64_tr_b16 a[38:39], v9 offset:2048
    ds_read_b64_tr_b16 a[40:41], v10 offset:0
    ds_read_b64_tr_b16 a[42:43], v10 offset:2048
    ds_read_b64_tr_b16 a[44:45], v11 offset:0
    ds_read_b64_tr_b16 a[46:47], v11 offset:2048
    s_waitcnt lgkmcnt(4)
    ds_read_b64_tr_b16 a[48:49], v12 offset:0
    ds_read_b64_tr_b16 a[50:51], v12 offset:2048
    ds_read_b64_tr_b16 a[52:53], v13 offset:0
    ds_read_b64_tr_b16 a[54:55], v13 offset:2048
    ds_read_b64_tr_b16 a[56:57], v14 offset:0
    ds_read_b64_tr_b16 a[58:59], v14 offset:2048
    ds_read_b64_tr_b16 a[60:61], v15 offset:0
    ds_read_b64_tr_b16 a[62:63], v15 offset:2048
core_T2_loop:
    s_waitcnt vmcnt(6) lgkmcnt(0)
    s_barrier
    v_mfma_f32_16x16x32_bf16 v[32:35], a[32:35], a[0:3], v[32:35]
    s_add_u32 m0, s67, 65536
    ds_read_b128 a[16:19], v7 offset:0
    ds_read_b128 a[20:23], v7 offset:2048
    v_mfma_f32_16x16x32_bf16 v[64:67], a[32:35], a[4:7], v[64:67]
    global_load_lds_dwordx4 v4, s[62:63]
    ds_read_b64_tr_b16 a[64:65], v8 offset:16384
    v_mfma_f32_16x16x32_bf16 v[36:39], a[36:39], a[0:3], v[36:39]
    s_add_u32 m0, s67, 66560
    ds_read_b64_tr_b16 a[66:67], v8 offset:18432
    ds_read_b64_tr_b16 a[68:69], v9 offset:16384
    v_mfma_f32_16x16x32_bf16 v[68:71], a[36:39], a[4:7], v[68:71]
    global_load_lds_dwordx4 v5, s[62:63]
    ds_read_b64_tr_b16 a[70:71], v9 offset:18432
    v_mfma_f32_16x16x32_bf16 v[40:43], a[40:43], a[0:3], v[40:43]
    ds_read_b64_tr_b16 a[72:73], v10 offset:16384
    ds_read_b64_tr_b16 a[74:75], v10 offset:18432
    v_mfma_f32_16x16x32_bf16 v[72:75], a[40:43], a[4:7], v[72:75]
    ds_read_b64_tr_b16 a[76:77], v11 offset:16384
    v_mfma_f32_16x16x32_bf16 v[44:47], a[44:47], a[0:3], v[44:47]
    ds_read_b64_tr_b16 a[78:79], v11 offset:18432
    ds_read_b64_tr_b16 a[80:81], v12 offset:16384
    v_mfma_f32_16x16x32_bf16 v[76:79], a[44:47], a[4:7], v[76:79]
    ds_read_b64_tr_b16 a[82:83], v12 offset:18432
    v_mfma_f32_16x16x32_bf16 v[48:51], a[48:51], a[0:3], v[48:51]
    ds_read_b64_tr_b16 a[84:85], v13 offset:16384
    s_waitcnt lgkmcnt(6)
    ds_read_b64_tr_b16 a[86:87], v13 offset:18432
    v_mfma_f32_16x16x32_bf16 v[80:83], a[48:51], a[4:7], v[80:83]
    ds_read_b64_tr_b16 a[88:89], v14 offset:16384
    v_mfma_f32_16x16x32_bf16 v[52:55], a[52:55], a[0:3], v[52:55]
    ds_read_b64_tr_b16 a[90:91], v14 offset:18432
    ds_read_b64_tr_b16 a[92:93], v15 offset:16384
    v_mfma_f32_16x16x32_bf16 v[84:87], a[52:55], a[4:7], v[84:87]
    ds_read_b64_tr_b16 a[94:95], v15 offset:18432
    v_mfma_f32_16x16x32_bf16 v[56:59], a[56:59], a[0:3], v[56:59]
    s_or_b32 s85, s85, s87
    s_add_u32 s85, s85, s65
    s_andn2_b32 s85, s85, s87
    s_xor_b32 s62, s85, s79
    s_add_u32 s62, s82, s62
    s_addc_u32 s63, s83, 0
    v_mfma_f32_16x16x32_bf16 v[88:91], a[56:59], a[4:7], v[88:91]
    v_mfma_f32_16x16x32_bf16 v[60:63], a[60:63], a[0:3], v[60:63]
    v_mfma_f32_16x16x32_bf16 v[92:95], a[60:63], a[4:7], v[92:95]
    s_waitcnt vmcnt(4) lgkmcnt(0)
    s_barrier
    v_mfma_f32_16x16x32_bf16 v[32:35], a[64:67], a[16:19], v[32:35]
    s_add_u32 m0, s76, 0
    ds_read_b128 a[0:3], v6 offset:32768
    ds_read_b128 a[4:7], v6 offset:34816
    v_mfma_f32_16x16x32_bf16 v[64:67], a[64:67], a[20:23], v[64:67]
    global_load_lds_dwordx4 v28, s[60:61]
    ds_read_b64_tr_b16 a[32:33], v8 offset:32768
    v_mfma_f32_16x16x32_bf16 v[36:39], a[68:71], a[16:19], v[36:39]
    s_add_u32 m0, s76, 1024
    ds_read_b64_tr_b16 a[34:35], v8 offset:34816
    ds_read_b64_tr_b16 a[36:37], v9 offset:32768
    v_mfma_f32_16x16x32_bf16 v[68:71], a[68:71], a[20:23], v[68:71]
    global_load_lds_dwordx4 v29, s[60:61]
    ds_read_b64_tr_b16 a[38:39], v9 offset:34816
    v_mfma_f32_16x16x32_bf16 v[40:43], a[72:75], a[16:19], v[40:43]
    s_add_u32 m0, s67, 81920
    ds_read_b64_tr_b16 a[40:41], v10 offset:32768
    ds_read_b64_tr_b16 a[42:43], v10 offset:34816
    v_mfma_f32_16x16x32_bf16 v[72:75], a[72:75], a[20:23], v[72:75]
    global_load_lds_dwordx4 v4, s[62:63]
    ds_read_b64_tr_b16 a[44:45], v11 offset:32768
    v_mfma_f32_16x16x32_bf16 v[44:47], a[76:79], a[16:19], v[44:47]
    s_add_u32 m0, s67, 82944
    ds_read_b64_tr_b16 a[46:47], v11 offset:34816
    ds_read_b64_tr_b16 a[48:49], v12 offset:32768
    v_mfma_f32_16x16x32_bf16 v[76:79], a[76:79], a[20:23], v[76:79]
    global_load_lds_dwordx4 v5, s[62:63]
    ds_read_b64_tr_b16 a[50:51], v12 offset:34816
    v_mfma_f32_16x16x32_bf16 v[48:51], a[80:83], a[16:19], v[48:51]
    ds_read_b64_tr_b16 a[52:53], v13 offset:32768
    s_waitcnt lgkmcnt(6)
    ds_read_b64_tr_b16 a[54:55], v13 offset:34816
    v_mfma_f32_16x16x32_bf16 v[80:83], a[80:83], a[20:23], v[80:83]
    ds_read_b64_tr_b16 a[56:57], v14 offset:32768
    v_mfma_f32_16x16x32_bf16 v[52:55], a[84:87], a[16:19], v[52:55]
    ds_read_b64_tr_b16 a[58:59], v14 offset:34816
    ds_read_b64_tr_b16 a[60:61], v15 offset:32768
    v_mfma_f32_16x16x32_bf16 v[84:87], a[84:87], a[20:23], v[84:87]
    ds_read_b64_tr_b16 a[62:63], v15 offset:34816
    v_mfma_f32_16x16x32_bf16 v[56:59], a[88:91], a[16:19], v[56:59]
    s_or_b32 s85, s85, s87
    s_add_u32 s85, s85, s65
    s_andn2_b32 s85, s85, s87
    s_xor_b32 s62, s85, s79
    s_add_u32 s62, s82, s62
    s_addc_u32 s63, s83, 0
    v_mfma_f32_16x16x32_bf16 v[88:91], a[88:91], a[20:23], v[88:91]
    v_mfma_f32_16x16x32_bf16 v[60:63], a[92:95], a[16:19], v[60:63]
    s_or_b32 s84, s84, s86
    s_add_u32 s84, s84, s64
    s_andn2_b32 s84, s84, s86
    s_xor_b32 s60, s84, s78
    s_add_u32 s60, s80, s60
    s_addc_u32 s61, s81, 0
    v_mfma_f32_16x16x32_bf16 v[92:95], a[92:95], a[20:23], v[92:95]
    s_waitcnt vmcnt(6) lgkmcnt(0)
    s_barrier
    v_mfma_f32_16x16x32_bf16 v[32:35], a[32:35], a[0:3], v[32:35]
    s_add_u32 m0, s67, 98304
    ds_read_b128 a[16:19], v7 offset:32768
    ds_read_b128 a[20:23], v7 offset:34816
    v_mfma_f32_16x16x32_bf16 v[64:67], a[32:35], a[4:7], v[64:67]
    global_load_lds_dwordx4 v4, s[62:63]
    ds_read_b64_tr_b16 a[64:65], v8 offset:49152
    v_mfma_f32_16x16x32_bf16 v[36:39], a[36:39], a[0:3], v[36:39]
    s_add_u32 m0, s67, 99328
    ds_read_b64_tr_b16 a[66:67], v8 offset:51200
    ds_read_b64_tr_b16 a[68:69], v9 offset:49152
    v_mfma_f32_16x16x32_bf16 v[68:71], a[36:39], a[4:7], v[68:71]
    global_load_lds_dwordx4 v5, s[62:63]
    ds_read_b64_tr_b16 a[70:71], v9 offset:51200
    v_mfma_f32_16x16x32_bf16 v[40:43], a[40:43], a[0:3], v[40:43]
    ds_read_b64_tr_b16 a[72:73], v10 offset:49152
    ds_read_b64_tr_b16 a[74:75], v10 offset:51200
    v_mfma_f32_16x16x32_bf16 v[72:75], a[40:43], a[4:7], v[72:75]
    ds_read_b64_tr_b16 a[76:77], v11 offset:49152
    v_mfma_f32_16x16x32_bf16 v[44:47], a[44:47], a[0:3], v[44:47]
    ds_read_b64_tr_b16 a[78:79], v11 offset:51200
    ds_read_b64_tr_b16 a[80:81], v12 offset:49152
    v_mfma_f32_16x16x32_bf16 v[76:79], a[44:47], a[4:7], v[76:79]
    ds_read_b64_tr_b16 a[82:83], v12 offset:51200
    v_mfma_f32_16x16x32_bf16 v[48:51], a[48:51], a[0:3], v[48:51]
    ds_read_b64_tr_b16 a[84:85], v13 offset:49152
    s_waitcnt lgkmcnt(6)
    ds_read_b64_tr_b16 a[86:87], v13 offset:51200
    v_mfma_f32_16x16x32_bf16 v[80:83], a[48:51], a[4:7], v[80:83]
    ds_read_b64_tr_b16 a[88:89], v14 offset:49152
    v_mfma_f32_16x16x32_bf16 v[52:55], a[52:55], a[0:3], v[52:55]
    ds_read_b64_tr_b16 a[90:91], v14 offset:51200
    ds_read_b64_tr_b16 a[92:93], v15 offset:49152
    v_mfma_f32_16x16x32_bf16 v[84:87], a[52:55], a[4:7], v[84:87]
    ds_read_b64_tr_b16 a[94:95], v15 offset:51200
    v_mfma_f32_16x16x32_bf16 v[56:59], a[56:59], a[0:3], v[56:59]
    s_or_b32 s85, s85, s87
    s_add_u32 s85, s85, s65
    s_andn2_b32 s85, s85, s87
    s_xor_b32 s62, s85, s79
    s_add_u32 s62, s82, s62
    s_addc_u32 s63, s83, 0
    v_mfma_f32_16x16x32_bf16 v[88:91], a[56:59], a[4:7], v[88:91]
    v_mfma_f32_16x16x32_bf16 v[60:63], a[60:63], a[0:3], v[60:63]
    v_mfma_f32_16x16x32_bf16 v[92:95], a[60:63], a[4:7], v[92:95]
    s_waitcnt vmcnt(4) lgkmcnt(0)
    s_barrier
    v_mfma_f32_16x16x32_bf16 v[32:35], a[64:67], a[16:19], v[32:35]
    s_add_u32 m0, s76, 32768
    ds_read_b128 a[0:3], v6 offset:0
    ds_read_b128 a[4:7], v6 offset:2048
    v_mfma_f32_16x16x32_bf16 v[64:67], a[64:67], a[20:23], v[64:67]
    global_load_lds_dwordx4 v28, s[60:61]
    ds_read_b64_tr_b16 a[32:33], v8 offset:0
    v_mfma_f32_16x16x32_bf16 v[36:39], a[68:71], a[16:19], v[36:39]
    s_add_u32 m0, s76, 33792
    ds_read_b64_tr_b16 a[34:35], v8 offset:2048
    ds_read_b64_tr_b16 a[36:37], v9 offset:0
    v_mfma_f32_16x16x32_bf16 v[68:71], a[68:71], a[20:23], v[68:71]
    global_load_lds_dwordx4 v29, s[60:61]
    ds_read_b64_tr_b16 a[38:39], v9 offset:2048
    v_mfma_f32_16x16x32_bf16 v[40:43], a[72:75], a[16:19], v[40:43]
    s_add_u32 m0, s67, 114688
    ds_read_b64_tr_b16 a[40:41], v10 offset:0
    ds_read_b64_tr_b16 a[42:43], v10 offset:2048
    v_mfma_f32_16x16x32_bf16 v[72:75], a[72:75], a[20:23], v[72:75]
    global_load_lds_dwordx4 v4, s[62:63]
    ds_read_b64_tr_b16 a[44:45], v11 offset:0
    v_mfma_f32_16x16x32_bf16 v[44:47], a[76:79], a[16:19], v[44:47]
    s_add_u32 m0, s67, 115712
    ds_read_b64_tr_b16 a[46:47], v11 offset:2048
    ds_read_b64_tr_b16 a[48:49], v12 offset:0
    v_mfma_f32_16x16x32_bf16 v[76:79], a[76:79], a[20:23], v[76:79]
    global_load_lds_dwordx4 v5, s[62:63]
    ds_read_b64_tr_b16 a[50:51], v12 offset:2048
    v_mfma_f32_16x16x32_bf16 v[48:51], a[80:83], a[16:19], v[48:51]
    ds_read_b64_tr_b16 a[52:53], v13 offset:0
    s_waitcnt lgkmcnt(6)
    ds_read_b64_tr_b16 a[54:55], v13 offset:2048
    v_mfma_f32_16x16x32_bf16 v[80:83], a[80:83], a[20:23], v[80:83]
    ds_read_b64_tr_b16 a[56:57], v14 offset:0
    v_mfma_f32_16x16x32_bf16 v[52:55], a[84:87], a[16:19], v[52:55]
    ds_read_b64_tr_b16 a[58:59], v14 offset:2048
    ds_read_b64_tr_b16 a[60:61], v15 offset:0
    v_mfma_f32_16x16x32_bf16 v[84:87], a[84:87], a[20:23], v[84:87]
    ds_read_b64_tr_b16 a[62:63], v15 offset:2048
    v_mfma_f32_16x16x32_bf16 v[56:59], a[88:91], a[16:19], v[56:59]
    s_or_b32 s85, s85, s87
    s_add_u32 s85, s85, s65
    s_andn2_b32 s85, s85, s87
    s_xor_b32 s62, s85, s79
    s_add_u32 s62, s82, s62
    s_addc_u32 s63, s83, 0
    v_mfma_f32_16x16x32_bf16 v[88:91], a[88:91], a[20:23], v[88:91]
    v_mfma_f32_16x16x32_bf16 v[60:63], a[92:95], a[16:19], v[60:63]
    s_or_b32 s84, s84, s86
    s_add_u32 s84, s84, s64
    s_andn2_b32 s84, s84, s86
    s_xor_b32 s60, s84, s78
    s_add_u32 s60, s80, s60
    s_addc_u32 s61, s81, 0
    v_mfma_f32_16x16x32_bf16 v[92:95], a[92:95], a[20:23], v[92:95]
    s_sub_u32 s66, s66, 1
    s_cmp_lg_u32 s66, 0
    s_cbranch_scc1 core_T2_loop
    s_waitcnt vmcnt(6) lgkmcnt(0)
    s_barrier
    s_cmp_eq_u32 s98, 0
    s_cbranch_scc1 core_T2_nt
    v_lshlrev_b32 v20, 6, v0
    v_min_u32 v21, s99, v20
    v_min_u32 v22, s100, v20
    v_min_u32 v23, s101, v20
    global_load_dword a31, v21, s[90:91]
    global_load_dword a31, v22, s[92:93]
    global_load_dword a31, v23, s[94:95]
core_T2_nt:
    v_mfma_f32_16x16x32_bf16 v[32:35], a[32:35], a[0:3], v[32:35]
    ds_read_b128 a[16:19], v7 offset:0
    ds_read_b128 a[20:23], v7 offset:2048
    v_mfma_f32_16x16x32_bf16 v[64:67], a[32:35], a[4:7], v[64:67]
    ds_read_b64_tr_b16 a[64:65], v8 offset:16384
    v_mfma_f32_16x16x32_bf16 v[36:39], a[36:39], a[0:3], v[36:39]
    ds_read_b64_tr_b16 a[66:67], v8 offset:18432
    ds_read_b64_tr_b16 a[68:69], v9 offset:16384
    v_mfma_f32_16x16x32_bf16 v[68:71], a[36:39], a[4:7], v[68:71]
    ds_read_b64_tr_b16 a[70:71], v9 offset:18432
    v_mfma_f32_16x16x32_bf16 v[40:43], a[40:43], a[0:3], v[40:43]
    ds_read_b64_tr_b16 a[72:73], v10 offset:16384
    ds_read_b64_tr_b16 a[74:75], v10 offset:18432
    v_mfma_f32_16x16x32_bf16 v[72:75], a[40:43], a[4:7], v[72:75]
    ds_read_b64_tr_b16 a[76:77], v11 offset:16384
    v_mfma_f32_16x16x32_bf16 v[44:47], a[44:47], a[0:3], v[44:47]
    ds_read_b64_tr_b16 a[78:79], v11 offset:18432
    ds_read_b64_tr_b16 a[80:81], v12 offset:16384
    v_mfma_f32_16x16x32_bf16 v[76:79], a[44:47], a[4:7], v[76:79]
    ds_read_b64_tr_b16 a[82:83], v12 offset:18432
    v_mfma_f32_16x16x32_bf16 v[48:51], a[48:51], a[0:3], v[48:51]
    ds_read_b64_tr_b16 a[84:85], v13 offset:16384
    s_waitcnt lgkmcnt(6)
    ds_read_b64_tr_b16 a[86:87], v13 offset:18432
    v_mfma_f32_16x16x32_bf16 v[80:83], a[48:51], a[4:7], v[80:83]
    ds_read_b64_tr_b16 a[88:89], v14 offset:16384
    v_mfma_f32_16x16x32_bf16 v[52:55], a[52:55], a[0:3], v[52:55]
    ds_read_b64_tr_b16 a[90:91], v14 offset:18432
    ds_read_b64_tr_b16 a[92:93], v15 offset:16384
    v_mfma_f32_16x16x32_bf16 v[84:87], a[52:55], a[4:7], v[84:87]
    ds_read_b64_tr_b16 a[94:95], v15 offset:18432
    v_mfma_f32_16x16x32_bf16 v[56:59], a[56:59], a[0:3], v[56:59]
    v_mfma_f32_16x16x32_bf16 v[88:91], a[56:59], a[4:7], v[88:91]
    v_mfma_f32_16x16x32_bf16 v[60:63], a[60:63], a[0:3], v[60:63]
    v_mfma_f32_16x16x32_bf16 v[92:95], a[60:63], a[4:7], v[92:95]
    s_cmp_eq_u32 s98, 0
    s_cbranch_scc1 cw_114
    s_waitcnt vmcnt(5) lgkmcnt(0)
    s_branch cw_115
cw_114:
    s_waitcnt vmcnt(2) lgkmcnt(0)
cw_115:
    s_barrier
    v_mfma_f32_16x16x32_bf16 v[32:35], a[64:67], a[16:19], v[32:35]
    ds_read_b128 a[0:3], v6 offset:32768
    ds_read_b128 a[4:7], v6 offset:34816
    v_mfma_f32_16x16x32_bf16 v[64:67], a[64:67], a[20:23], v[64:67]
    ds_read_b64_tr_b16 a[32:33], v8 offset:32768
    v_mfma_f32_16x16x32_bf16 v[36:39], a[68:71], a[16:19], v[36:39]
    ds_read_b64_tr_b16 a[34:35], v8 offset:34816
    ds_read_b64_tr_b16 a[36:37], v9 offset:32768
    v_mfma_f32_16x16x32_bf16 v[68:71], a[68:71], a[20:23], v[68:71]
    ds_read_b64_tr_b16 a[38:39], v9 offset:34816
    v_mfma_f32_16x16x32_bf16 v[40:43], a[72:75], a[16:19], v[40:43]
    ds_read_b64_tr_b16 a[40:41], v10 offset:32768
    ds_read_b64_tr_b16 a[42:43], v10 offset:34816
    v_mfma_f32_16x16x32_bf16 v[72:75], a[72:75], a[20:23], v[72:75]
    ds_read_b64_tr_b16 a[44:45], v11 offset:32768
    v_mfma_f32_16x16x32_bf16 v[44:47], a[76:79], a[16:19], v[44:47]
    ds_read_b64_tr_b16 a[46:47], v11 offset:34816
    ds_read_b64_tr_b16 a[48:49], v12 offset:32768
    v_mfma_f32_16x16x32_bf16 v[76:79], a[76:79], a[20:23], v[76:79]
    ds_read_b64_tr_b16 a[50:51], v12 offset:34816
    v_mfma_f32_16x16x32_bf16 v[48:51], a[80:83], a[16:19], v[48:51]
    ds_read_b64_tr_b16 a[52:53], v13 offset:32768
    s_waitcnt lgkmcnt(6)
    ds_read_b64_tr_b16 a[54:55], v13 offset:34816
    v_mfma_f32_16x16x32_bf16 v[80:83], a[80:83], a[20:23], v[80:83]
    ds_read_b64_tr_b16 a[56:57], v14 offset:32768
    v_mfma_f32_16x16x32_bf16 v[52:55], a[84:87], a[16:19], v[52:55]
    ds_read_b64_tr_b16 a[58:59], v14 offset:34816
    ds_read_b64_tr_b16 a[60:61], v15 offset:32768
    v_mfma_f32_16x16x32_bf16 v[84:87], a[84:87], a[20:23], v[84:87]
    ds_read_b64_tr_b16 a[62:63], v15 offset:34816
    v_mfma_f32_16x16x32_bf16 v[56:59], a[88:91], a[16:19], v[56:59]
    v_mfma_f32_16x16x32_bf16 v[88:91], a[88:91], a[20:23], v[88:91]
    v_mfma_f32_16x16x32_bf16 v[60:63], a[92:95], a[16:19], v[60:63]
    v_mfma_f32_16x16x32_bf16 v[92:95], a[92:95], a[20:23], v[92:95]
    s_cmp_eq_u32 s98, 0
    s_cbranch_scc1 cw_116
    s_waitcnt vmcnt(3) lgkmcnt(0)
    s_branch cw_117
cw_116:
    s_waitcnt vmcnt(0) lgkmcnt(0)
cw_117:
    s_barrier
    s_mov_b32 s98, 0
    v_mov_b32 v16, 0
    global_load_dwordx2 v[18:19], v16, s[26:27] offset:40 sc1
    v_mfma_f32_16x16x32_bf16 v[32:35], a[32:35], a[0:3], v[32:35]
    ds_read_b128 a[16:19], v7 offset:32768
    ds_read_b128 a[20:23], v7 offset:34816
    v_mfma_f32_16x16x32_bf16 v[64:67], a[32:35], a[4:7], v[64:67]
    ds_read_b64_tr_b16 a[64:65], v8 offset:49152
    v_mfma_f32_16x16x32_bf16 v[36:39], a[36:39], a[0:3], v[36:39]
    ds_read_b64_tr_b16 a[66:67], v8 offset:51200
    ds_read_b64_tr_b16 a[68:69], v9 offset:49152
    v_mfma_f32_16x16x32_bf16 v[68:71], a[36:39], a[4:7], v[68:71]
    ds_read_b64_tr_b16 a[70:71], v9 offset:51200
    v_mfma_f32_16x16x32_bf16 v[40:43], a[40:43], a[0:3], v[40:43]
    ds_read_b64_tr_b16 a[72:73], v10 offset:49152
    ds_read_b64_tr_b16 a[74:75], v10 offset:51200
    v_mfma_f32_16x16x32_bf16 v[72:75], a[40:43], a[4:7], v[72:75]
    ds_read_b64_tr_b16 a[76:77], v11 offset:49152
    v_mfma_f32_16x16x32_bf16 v[44:47], a[44:47], a[0:3], v[44:47]
    ds_read_b64_tr_b16 a[78:79], v11 offset:51200
    ds_read_b64_tr_b16 a[80:81], v12 offset:49152
    v_mfma_f32_16x16x32_bf16 v[76:79], a[44:47], a[4:7], v[76:79]
    ds_read_b64_tr_b16 a[82:83], v12 offset:51200
    v_mfma_f32_16x16x32_bf16 v[48:51], a[48:51], a[0:3], v[48:51]
    ds_read_b64_tr_b16 a[84:85], v13 offset:49152
    s_waitcnt lgkmcnt(6)
    ds_read_b64_tr_b16 a[86:87], v13 offset:51200
    v_mfma_f32_16x16x32_bf16 v[80:83], a[48:51], a[4:7], v[80:83]
    ds_read_b64_tr_b16 a[88:89], v14 offset:49152
    v_mfma_f32_16x16x32_bf16 v[52:55], a[52:55], a[0:3], v[52:55]
    ds_read_b64_tr_b16 a[90:91], v14 offset:51200
    ds_read_b64_tr_b16 a[92:93], v15 offset:49152
    v_mfma_f32_16x16x32_bf16 v[84:87], a[52:55], a[4:7], v[84:87]
    ds_read_b64_tr_b16 a[94:95], v15 offset:51200
    v_mfma_f32_16x16x32_bf16 v[56:59], a[56:59], a[0:3], v[56:59]
    v_mfma_f32_16x16x32_bf16 v[88:91], a[56:59], a[4:7], v[88:91]
    v_mfma_f32_16x16x32_bf16 v[60:63], a[60:63], a[0:3], v[60:63]
    v_mfma_f32_16x16x32_bf16 v[92:95], a[60:63], a[4:7], v[92:95]
    s_waitcnt lgkmcnt(0)
    v_mfma_f32_16x16x32_bf16 v[32:35], a[64:67], a[16:19], v[32:35]
    v_mfma_f32_16x16x32_bf16 v[64:67], a[64:67], a[20:23], v[64:67]
    v_mfma_f32_16x16x32_bf16 v[36:39], a[68:71], a[16:19], v[36:39]
    v_mfma_f32_16x16x32_bf16 v[68:71], a[68:71], a[20:23], v[68:71]
    v_mfma_f32_16x16x32_bf16 v[40:43], a[72:75], a[16:19], v[40:43]
    v_mfma_f32_16x16x32_bf16 v[72:75], a[72:75], a[20:23], v[72:75]
    v_mfma_f32_16x16x32_bf16 v[44:47], a[76:79], a[16:19], v[44:47]
    v_mfma_f32_16x16x32_bf16 v[76:79], a[76:79], a[20:23], v[76:79]
    v_mfma_f32_16x16x32_bf16 v[48:51], a[80:83], a[16:19], v[48:51]
    v_mfma_f32_16x16x32_bf16 v[80:83], a[80:83], a[20:23], v[80:83]
    v_mfma_f32_16x16x32_bf16 v[52:55], a[84:87], a[16:19], v[52:55]
    v_mfma_f32_16x16x32_bf16 v[84:87], a[84:87], a[20:23], v[84:87]
    v_mfma_f32_16x16x32_bf16 v[56:59], a[88:91], a[16:19], v[56:59]
    v_mfma_f32_16x16x32_bf16 v[88:91], a[88:91], a[20:23], v[88:91]
    v_mfma_f32_16x16x32_bf16 v[60:63], a[92:95], a[16:19], v[60:63]
    v_mfma_f32_16x16x32_bf16 v[92:95], a[92:95], a[20:23], v[92:95]
    s_nop 7
    s_setpc_b64 s[68:69]
core_F1:
    s_mov_b32 s84, 0
    s_mov_b32 s85, 0
    s_add_u32 s60, s80, s78
    s_addc_u32 s61, s81, 0
    s_add_u32 s62, s82, s79
    s_addc_u32 s63, s83, 0
    s_barrier
    s_add_u32 m0, s76, 0
    s_nop 0
    global_load_lds_dwordx4 v28, s[60:61] sc1
    s_or_b32 s84, s84, s86
    s_add_u32 s84, s84, s64
    s_andn2_b32 s84, s84, s86
    s_xor_b32 s60, s84, s78
    s_add_u32 s60, s80, s60
    s_addc_u32 s61, s81, 0
    s_add_u32 m0, s67, 65536
    s_nop 0
    global_load_lds_dwordx4 v4, s[62:63] sc1
    s_add_u32 m0, s67, 66560
    s_nop 0
    global_load_lds_dwordx4 v5, s[62:63] sc1
    s_or_b32 s85, s85, s87
    s_add_u32 s85, s85, s65
    s_andn2_b32 s85, s85, s87
    s_xor_b32 s62, s85, s79
    s_add_u32 s62, s82, s62
    s_addc_u32 s63, s83, 0
    s_add_u32 m0, s67, 81920
    s_nop 0
    global_load_lds_dwordx4 v4, s[62:63] sc1
    s_add_u32 m0, s67, 82944
    s_nop 0
    global_load_lds_dwordx4 v5, s[62:63] sc1
    s_or_b32 s85, s85, s87
    s_add_u32 s85, s85, s65
    s_andn2_b32 s85, s85, s87
    s_xor_b32 s62, s85, s79
    s_add_u32 s62, s82, s62
    s_addc_u32 s63, s83, 0
    s_add_u32 m0, s67, 98304
    s_nop 0
    global_load_lds_dwordx4 v4, s[62:63] sc1
    s_add_u32 m0, s67, 99328
    s_nop 0
    global_load_lds_dwordx4 v5, s[62:63] sc1
    s_or_b32 s85, s85, s87
    s_add_u32 s85, s85, s65
    s_andn2_b32 s85, s85, s87
    s_xor_b32 s62, s85, s79
    s_add_u32 s62, s82, s62
    s_addc_u32 s63, s83, 0
    s_add_u32 m0, s76, 32768
    s_nop 0
    global_load_lds_dwordx4 v28, s[60:61] sc1
    s_or_b32 s84, s84, s86
    s_add_u32 s84, s84, s64
    s_andn2_b32 s84, s84, s86
    s_xor_b32 s60, s84, s78
    s_add_u32 s60, s80, s60
    s_addc_u32 s61, s81, 0
    s_add_u32 m0, s67, 114688
    s_nop 0
    global_load_lds_dwordx4 v4, s[62:63] sc1
    s_add_u32 m0, s67, 115712
    s_nop 0
    global_load_lds_dwordx4 v5, s[62:63] sc1
    s_or_b32 s85, s85, s87
    s_add_u32 s85, s85, s65
    s_andn2_b32 s85, s85, s87
    s_xor_b32 s62, s85, s79
    s_add_u32 s62, s82, s62
    s_addc_u32 s63, s83, 0
core_F1_m:
    v_mov_b32 v32, 0
    v_mov_b32 v33, 0
    v_mov_b32 v34, 0
    v_mov_b32 v35, 0
    v_mov_b32 v36, 0
    v_mov_b32 v37, 0
    v_mov_b32 v38, 0
    v_mov_b32 v39, 0
    v_mov_b32 v40, 0
    v_mov_b32 v41, 0
    v_mov_b32 v42, 0
    v_mov_b32 v43, 0
    v_mov_b32 v44, 0
    v_mov_b32 v45, 0
    v_mov_b32 v46, 0
    v_mov_b32 v47, 0
    v_mov_b32 v48, 0
    v_mov_b32 v49, 0
    v_mov_b32 v50, 0
    v_mov_b32 v51, 0
    v_mov_b32 v52, 0
    v_mov_b32 v53, 0
    v_mov_b32 v54, 0
    v_mov_b32 v55, 0
    v_mov_b32 v56, 0
    v_mov_b32 v57, 0
    v_mov_b32 v58, 0
    v_mov_b32 v59, 0
    v_mov_b32 v60, 0
    v_mov_b32 v61, 0
    v_mov_b32 v62, 0
    v_mov_b32 v63, 0
    s_waitcnt vmcnt(7)
    s_barrier
    ds_read_b128 a[0:3], v6 offset:0
    ds_read_b128 a[32:35], v27 offset:0
    ds_read_b128 a[36:39], v27 offset:1024
    ds_read_b128 a[40:43], v27 offset:2048
    ds_read_b128 a[44:47], v27 offset:3072
    s_waitcnt lgkmcnt(4)
    ds_read_b128 a[48:51], v27 offset:4096
    ds_read_b128 a[52:55], v27 offset:5120
    ds_read_b128 a[56:59], v27 offset:6144
    ds_read_b128 a[60:63], v27 offset:7168
core_F1_loop:
    s_waitcnt vmcnt(5) lgkmcnt(0)
    s_barrier
    s_add_u32 m0, s67, 65536
    v_mfma_f32_16x16x32_bf16 v[32:35], a[32:35], a[0:3], v[32:35]
    global_load_lds_dwordx4 v4, s[62:63] sc1
    ds_read_b128 a[16:19], v7 offset:0
    ds_read_b128 a[64:67], v27 offset:16384
    s_add_u32 m0, s67, 66560
    v_mfma_f32_16x16x32_bf16 v[36:39], a[36:39], a[0:3], v[36:39]
    global_load_lds_dwordx4 v5, s[62:63] sc1
    ds_read_b128 a[68:71], v27 offset:17408
    v_mfma_f32_16x16x32_bf16 v[40:43], a[40:43], a[0:3], v[40:43]
    ds_read_b128 a[72:75], v27 offset:18432
    ds_read_b128 a[76:79], v27 offset:19456
    v_mfma_f32_16x16x32_bf16 v[44:47], a[44:47], a[0:3], v[44:47]
    ds_read_b128 a[80:83], v27 offset:20480
    v_mfma_f32_16x16x32_bf16 v[48:51], a[48:51], a[0:3], v[48:51]
    ds_read_b128 a[84:87], v27 offset:21504
    ds_read_b128 a[88:91], v27 offset:22528
    v_mfma_f32_16x16x32_bf16 v[52:55], a[52:55], a[0:3], v[52:55]
    ds_read_b128 a[92:95], v27 offset:23552
    v_mfma_f32_16x16x32_bf16 v[56:59], a[56:59], a[0:3], v[56:59]
    s_or_b32 s85, s85, s87
    s_add_u32 s85, s85, s65
    s_andn2_b32 s85, s85, s87
    s_xor_b32 s62, s85, s79
    s_add_u32 s62, s82, s62
    s_addc_u32 s63, s83, 0
    v_mfma_f32_16x16x32_bf16 v[60:63], a[60:63], a[0:3], v[60:63]
    s_waitcnt vmcnt(4) lgkmcnt(0)
    s_barrier
    s_add_u32 m0, s76, 0
    v_mfma_f32_16x16x32_bf16 v[32:35], a[64:67], a[16:19], v[32:35]
    global_load_lds_dwordx4 v28, s[60:61] sc1
    ds_read_b128 a[0:3], v6 offset:32768
    ds_read_b128 a[32:35], v27 offset:32768
    s_add_u32 m0, s67, 81920
    v_mfma_f32_16x16x32_bf16 v[36:39], a[68:71], a[16:19], v[36:39]
    global_load_lds_dwordx4 v4, s[62:63] sc1
    ds_read_b128 a[36:39], v27 offset:33792
    s_add_u32 m0, s67, 82944
    v_mfma_f32_16x16x32_bf16 v[40:43], a[72:75], a[16:19], v[40:43]
    global_load_lds_dwordx4 v5, s[62:63] sc1
    ds_read_b128 a[40:43], v27 offset:34816
    ds_read_b128 a[44:47], v27 offset:35840
    v_mfma_f32_16x16x32_bf16 v[44:47], a[76:79], a[16:19], v[44:47]
    ds_read_b128 a[48:51], v27 offset:36864
    v_mfma_f32_16x16x32_bf16 v[48:51], a[80:83], a[16:19], v[48:51]
    ds_read_b128 a[52:55], v27 offset:37888
    ds_read_b128 a[56:59], v27 offset:38912
    v_mfma_f32_16x16x32_bf16 v[52:55], a[84:87], a[16:19], v[52:55]
    ds_read_b128 a[60:63], v27 offset:39936
    v_mfma_f32_16x16x32_bf16 v[56:59], a[88:91], a[16:19], v[56:59]
    s_or_b32 s85, s85, s87
    s_add_u32 s85, s85, s65
    s_andn2_b32 s85, s85, s87
    s_xor_b32 s62, s85, s79
    s_add_u32 s62, s82, s62
    s_addc_u32 s63, s83, 0
    v_mfma_f32_16x16x32_bf16 v[60:63], a[92:95], a[16:19], v[60:63]
    s_or_b32 s84, s84, s86
    s_add_u32 s84, s84, s64
    s_andn2_b32 s84, s84, s86
    s_xor_b32 s60, s84, s78
    s_add_u32 s60, s80, s60
    s_addc_u32 s61, s81, 0
    s_waitcnt vmcnt(5) lgkmcnt(0)
    s_barrier
    s_add_u32 m0, s67, 98304
    v_mfma_f32_16x16x32_bf16 v[32:35], a[32:35], a[0:3], v[32:35]
    global_load_lds_dwordx4 v4, s[62:63] sc1
    ds_read_b128 a[16:19], v7 offset:32768
    ds_read_b128 a[64:67], v27 offset:49152
    s_add_u32 m0, s67, 99328
    v_mfma_f32_16x16x32_bf16 v[36:39], a[36:39], a[0:3], v[36:39]
    global_load_lds_dwordx4 v5, s[62:63] sc1
    ds_read_b128 a[68:71], v27 offset:50176
    v_mfma_f32_16x16x32_bf16 v[40:43], a[40:43], a[0:3], v[40:43]
    ds_read_b128 a[72:75], v27 offset:51200
    ds_read_b128 a[76:79], v27 offset:52224
    v_mfma_f32_16x16x32_bf16 v[44:47], a[44:47], a[0:3], v[44:47]
    ds_read_b128 a[80:83], v27 offset:53248
    v_mfma_f32_16x16x32_bf16 v[48:51], a[48:51], a[0:3], v[48:51]
    ds_read_b128 a[84:87], v27 offset:54272
    ds_read_b128 a[88:91], v27 offset:55296
    v_mfma_f32_16x16x32_bf16 v[52:55], a[52:55], a[0:3], v[52:55]
    ds_read_b128 a[92:95], v27 offset:56320
    v_mfma_f32_16x16x32_bf16 v[56:59], a[56:59], a[0:3], v[56:59]
    s_or_b32 s85, s85, s87
    s_add_u32 s85, s85, s65
    s_andn2_b32 s85, s85, s87
    s_xor_b32 s62, s85, s79
    s_add_u32 s62, s82, s62
    s_addc_u32 s63, s83, 0
    v_mfma_f32_16x16x32_bf16 v[60:63], a[60:63], a[0:3], v[60:63]
    s_waitcnt vmcnt(4) lgkmcnt(0)
    s_barrier
    s_add_u32 m0, s76, 32768
    v_mfma_f32_16x16x32_bf16 v[32:35], a[64:67], a[16:19], v[32:35]
    global_load_lds_dwordx4 v28, s[60:61] sc1
    ds_read_b128 a[0:3], v6 offset:0
    ds_read_b128 a[32:35], v27 offset:0
    s_add_u32 m0, s67, 114688
    v_mfma_f32_16x16x32_bf16 v[36:39], a[68:71], a[16:19], v[36:39]
    global_load_lds_dwordx4 v4, s[62:63] sc1
    ds_read_b128 a[36:39], v27 offset:1024
    s_add_u32 m0, s67, 115712
    v_mfma_f32_16x16x32_bf16 v[40:43], a[72:75], a[16:19], v[40:43]
    global_load_lds_dwordx4 v5, s[62:63] sc1
    ds_read_b128 a[40:43], v27 offset:2048
    ds_read_b128 a[44:47], v27 offset:3072
    v_mfma_f32_16x16x32_bf16 v[44:47], a[76:79], a[16:19], v[44:47]
    ds_read_b128 a[48:51], v27 offset:4096
    v_mfma_f32_16x16x32_bf16 v[48:51], a[80:83], a[16:19], v[48:51]
    ds_read_b128 a[52:55], v27 offset:5120
    ds_read_b128 a[56:59], v27 offset:6144
    v_mfma_f32_16x16x32_bf16 v[52:55], a[84:87], a[16:19], v[52:55]
    ds_read_b128 a[60:63], v27 offset:7168
    v_mfma_f32_16x16x32_bf16 v[56:59], a[88:91], a[16:19], v[56:59]
    s_or_b32 s85, s85, s87
    s_add_u32 s85, s85, s65
    s_andn2_b32 s85, s85, s87
    s_xor_b32 s62, s85, s79
    s_add_u32 s62, s82, s62
    s_addc_u32 s63, s83, 0
    v_mfma_f32_16x16x32_bf16 v[60:63], a[92:95], a[16:19], v[60:63]
    s_or_b32 s84, s84, s86
    s_add_u32 s84, s84, s64
    s_andn2_b32 s84, s84, s86
    s_xor_b32 s60, s84, s78
    s_add_u32 s60, s80, s60
    s_addc_u32 s61, s81, 0
    s_sub_u32 s66, s66, 1
    s_cmp_lg_u32 s66, 0
    s_cbranch_scc1 core_F1_loop
    s_waitcnt vmcnt(5) lgkmcnt(0)
    s_barrier
    v_mfma_f32_16x16x32_bf16 v[32:35], a[32:35], a[0:3], v[32:35]
    ds_read_b128 a[16:19], v7 offset:0
    ds_read_b128 a[64:67], v27 offset:16384
    v_mfma_f32_16x16x32_bf16 v[36:39], a[36:39], a[0:3], v[36:39]
    ds_read_b128 a[68:71], v27 offset:17408
    v_mfma_f32_16x16x32_bf16 v[40:43], a[40:43], a[0:3], v[40:43]
    ds_read_b128 a[72:75], v27 offset:18432
    ds_read_b128 a[76:79], v27 offset:19456
    v_mfma_f32_16x16x32_bf16 v[44:47], a[44:47], a[0:3], v[44:47]
    ds_read_b128 a[80:83], v27 offset:20480
    v_mfma_f32_16x16x32_bf16 v[48:51], a[48:51], a[0:3], v[48:51]
    ds_read_b128 a[84:87], v27 offset:21504
    ds_read_b128 a[88:91], v27 offset:22528
    v_mfma_f32_16x16x32_bf16 v[52:55], a[52:55], a[0:3], v[52:55]
    ds_read_b128 a[92:95], v27 offset:23552
    v_mfma_f32_16x16x32_bf16 v[56:59], a[56:59], a[0:3], v[56:59]
    v_mfma_f32_16x16x32_bf16 v[60:63], a[60:63], a[0:3], v[60:63]
    s_waitcnt vmcnt(2) lgkmcnt(0)
    s_barrier
    v_mfma_f32_16x16x32_bf16 v[32:35], a[64:67], a[16:19], v[32:35]
    ds_read_b128 a[0:3], v6 offset:32768
    ds_read_b128 a[32:35], v27 offset:32768
    v_mfma_f32_16x16x32_bf16 v[36:39], a[68:71], a[16:19], v[36:39]
    ds_read_b128 a[36:39], v27 offset:33792
    v_mfma_f32_16x16x32_bf16 v[40:43], a[72:75], a[16:19], v[40:43]
    ds_read_b128 a[40:43], v27 offset:34816
    ds_read_b128 a[44:47], v27 offset:35840
    v_mfma_f32_16x16x32_bf16 v[44:47], a[76:79], a[16:19], v[44:47]
    ds_read_b128 a[48:51], v27 offset:36864
    v_mfma_f32_16x16x32_bf16 v[48:51], a[80:83], a[16:19], v[48:51]
    ds_read_b128 a[52:55], v27 offset:37888
    ds_read_b128 a[56:59], v27 offset:38912
    v_mfma_f32_16x16x32_bf16 v[52:55], a[84:87], a[16:19], v[52:55]
    ds_read_b128 a[60:63], v27 offset:39936
    v_mfma_f32_16x16x32_bf16 v[56:59], a[88:91], a[16:19], v[56:59]
    v_mfma_f32_16x16x32_bf16 v[60:63], a[92:95], a[16:19], v[60:63]
    s_waitcnt vmcnt(0) lgkmcnt(0)
    s_barrier
    v_mfma_f32_16x16x32_bf16 v[32:35], a[32:35], a[0:3], v[32:35]
    ds_read_b128 a[16:19], v7 offset:32768
    ds_read_b128 a[64:67], v27 offset:49152
    v_mfma_f32_16x16x32_bf16 v[36:39], a[36:39], a[0:3], v[36:39]
    ds_read_b128 a[68:71], v27 offset:50176
    v_mfma_f32_16x16x32_bf16 v[40:43], a[40:43], a[0:3], v[40:43]
    ds_read_b128 a[72:75], v27 offset:51200
    ds_read_b128 a[76:79], v27 offset:52224
    v_mfma_f32_16x16x32_bf16 v[44:47], a[44:47], a[0:3], v[44:47]
    ds_read_b128 a[80:83], v27 offset:53248
    v_mfma_f32_16x16x32_bf16 v[48:51], a[48:51], a[0:3], v[48:51]
    ds_read_b128 a[84:87], v27 offset:54272
    ds_read_b128 a[88:91], v27 offset:55296
    v_mfma_f32_16x16x32_bf16 v[52:55], a[52:55], a[0:3], v[52:55]
    ds_read_b128 a[92:95], v27 offset:56320
    v_mfma_f32_16x16x32_bf16 v[56:59], a[56:59], a[0:3], v[56:59]
    v_mfma_f32_16x16x32_bf16 v[60:63], a[60:63], a[0:3], v[60:63]
    s_waitcnt lgkmcnt(0)
    v_mfma_f32_16x16x32_bf16 v[32:35], a[64:67], a[16:19], v[32:35]
    v_mfma_f32_16x16x32_bf16 v[36:39], a[68:71], a[16:19], v[36:39]
    v_mfma_f32_16x16x32_bf16 v[40:43], a[72:75], a[16:19], v[40:43]
    v_mfma_f32_16x16x32_bf16 v[44:47], a[76:79], a[16:19], v[44:47]
    v_mfma_f32_16x16x32_bf16 v[48:51], a[80:83], a[16:19], v[48:51]
    v_mfma_f32_16x16x32_bf16 v[52:55], a[84:87], a[16:19], v[52:55]
    v_mfma_f32_16x16x32_bf16 v[56:59], a[88:91], a[16:19], v[56:59]
    v_mfma_f32_16x16x32_bf16 v[60:63], a[92:95], a[16:19], v[60:63]
    s_nop 7
    s_setpc_b64 s[68:69]
core_F2:
    s_mov_b32 s84, 0
    s_mov_b32 s85, 0
    s_add_u32 s60, s80, s78
    s_addc_u32 s61, s81, 0
    s_add_u32 s62, s82, s79
    s_addc_u32 s63, s83, 0
    s_barrier
    s_add_u32 m0, s76, 0
    s_nop 0
    global_load_lds_dwordx4 v28, s[60:61] sc1
    s_add_u32 m0, s76, 1024
    s_nop 0
    global_load_lds_dwordx4 v29, s[60:61] sc1
    s_or_b32 s84, s84, s86
    s_add_u32 s84, s84, s64
    s_andn2_b32 s84, s84, s86
    s_xor_b32 s60, s84, s78
    s_add_u32 s60, s80, s60
    s_addc_u32 s61, s81, 0
    s_add_u32 m0, s67, 65536
    s_nop 0
    global_load_lds_dwordx4 v4, s[62:63] sc1
    s_add_u32 m0, s67, 66560
    s_nop 0
    global_load_lds_dwordx4 v5, s[62:63] sc1
    s_or_b32 s85, s85, s87
    s_add_u32 s85, s85, s65
    s_andn2_b32 s85, s85, s87
    s_xor_b32 s62, s85, s79
    s_add_u32 s62, s82, s62
    s_addc_u32 s63, s83, 0
    s_add_u32 m0, s67, 81920
    s_nop 0
    global_load_lds_dwordx4 v4, s[62:63] sc1
    s_add_u32 m0, s67, 82944
    s_nop 0
    global_load_lds_dwordx4 v5, s[62:63] sc1
    s_or_b32 s85, s85, s87
    s_add_u32 s85, s85, s65
    s_andn2_b32 s85, s85, s87
    s_xor_b32 s62, s85, s79
    s_add_u32 s62, s82, s62
    s_addc_u32 s63, s83, 0
    s_add_u32 m0, s67, 98304
    s_nop 0
    global_load_lds_dwordx4 v4, s[62:63] sc1
    s_add_u32 m0, s67, 99328
    s_nop 0
    global_load_lds_dwordx4 v5, s[62:63] sc1
    s_or_b32 s85, s85, s87
    s_add_u32 s85, s85, s65
    s_andn2_b32 s85, s85, s87
    s_xor_b32 s62, s85, s79
    s_add_u32 s62, s82, s62
    s_addc_u32 s63, s83, 0
    s_add_u32 m0, s76, 32768
    s_nop 0
    global_load_lds_dwordx4 v28, s[60:61] sc1
    s_add_u32 m0, s76, 33792
    s_nop 0
    global_load_lds_dwordx4 v29, s[60:61] sc1
    s_or_b32 s84, s84, s86
    s_add_u32 s84, s84, s64
    s_andn2_b32 s84, s84, s86
    s_xor_b32 s60, s84, s78
    s_add_u32 s60, s80, s60
    s_addc_u32 s61, s81, 0
    s_add_u32 m0, s67, 114688
    s_nop 0
    global_load_lds_dwordx4 v4, s[62:63] sc1
    s_add_u32 m0, s67, 115712
    s_nop 0
    global_load_lds_dwordx4 v5, s[62:63] sc1
    s_or_b32 s85, s85, s87
    s_add_u32 s85, s85, s65
    s_andn2_b32 s85, s85, s87
    s_xor_b32 s62, s85, s79
    s_add_u32 s62, s82, s62
    s_addc_u32 s63, s83, 0
core_F2_m:
    v_mov_b32 v32, 0
    v_mov_b32 v33, 0
    v_mov_b32 v34, 0
    v_mov_b32 v35, 0
    v_mov_b32 v36, 0
    v_mov_b32 v37, 0
    v_mov_b32 v38, 0
    v_mov_b32 v39, 0
    v_mov_b32 v40, 0
    v_mov_b32 v41, 0
    v_mov_b32 v42, 0
    v_mov_b32 v43, 0
    v_mov_b32 v44, 0
    v_mov_b32 v45, 0
    v_mov_b32 v46, 0
    v_mov_b32 v47, 0
    v_mov_b32 v48, 0
    v_mov_b32 v49, 0
    v_mov_b32 v50, 0
    v_mov_b32 v51, 0
    v_mov_b32 v52, 0
    v_mov_b32 v53, 0
    v_mov_b32 v54, 0
    v_mov_b32 v55, 0
    v_mov_b32 v56, 0
    v_mov_b32 v57, 0
    v_mov_b32 v58, 0
    v_mov_b32 v59, 0
    v_mov_b32 v60, 0
    v_mov_b32 v61, 0
    v_mov_b32 v62, 0
    v_mov_b32 v63, 0
    v_mov_b32 v64, 0
    v_mov_b32 v65, 0
    v_mov_b32 v66, 0
    v_mov_b32 v67, 0
    v_mov_b32 v68, 0
    v_mov_b32 v69, 0
    v_mov_b32 v70, 0
    v_mov_b32 v71, 0
    v_mov_b32 v72, 0
    v_mov_b32 v73, 0
    v_mov_b32 v74, 0
    v_mov_b32 v75, 0
    v_mov_b32 v76, 0
    v_mov_b32 v77, 0
    v_mov_b32 v78, 0
    v_mov_b32 v79, 0
    v_mov_b32 v80, 0
    v_mov_b32 v81, 0
    v_mov_b32 v82, 0
    v_mov_b32 v83, 0
    v_mov_b32 v84, 0
    v_mov_b32 v85, 0
    v_mov_b32 v86, 0
    v_mov_b32 v87, 0
    v_mov_b32 v88, 0
    v_mov_b32 v89, 0
    v_mov_b32 v90, 0
    v_mov_b32 v91, 0
    v_mov_b32 v92, 0
    v_mov_b32 v93, 0
    v_mov_b32 v94, 0
    v_mov_b32 v95, 0
    s_waitcnt vmcnt(8)
    s_barrier
    ds_read_b128 a[0:3], v6 offset:0
    ds_read_b128 a[4:7], v6 offset:2048
    ds_read_b128 a[32:35], v27 offset:0
    ds_read_b128 a[36:39], v27 offset:1024
    ds_read_b128 a[40:43], v27 offset:2048
    ds_read_b128 a[44:47], v27 offset:3072
    s_waitcnt lgkmcnt(4)
    ds_read_b128 a[48:51], v27 offset:4096
    ds_read_b128 a[52:55], v27 offset:5120
    ds_read_b128 a[56:59], v27 offset:6144
    ds_read_b128 a[60:63], v27 offset:7168
core_F2_loop:
    s_waitcnt vmcnt(6) lgkmcnt(0)
    s_barrier
    v_mfma_f32_16x16x32_bf16 v[32:35], a[32:35], a[0:3], v[32:35]
    s_add_u32 m0, s67, 65536
    ds_read_b128 a[16:19], v7 offset:0
    v_mfma_f32_16x16x32_bf16 v[64:67], a[32:35], a[4:7], v[64:67]
    global_load_lds_dwordx4 v4, s[62:63] sc1
    ds_read_b128 a[20:23], v7 offset:2048
    v_mfma_f32_16x16x32_bf16 v[36:39], a[36:39], a[0:3], v[36:39]
    s_add_u32 m0, s67, 66560
    ds_read_b128 a[64:67], v27 offset:16384
    v_mfma_f32_16x16x32_bf16 v[68:71], a[36:39], a[4:7], v[68:71]
    global_load_lds_dwordx4 v5, s[62:63] sc1
    ds_read_b128 a[68:71], v27 offset:17408
    v_mfma_f32_16x16x32_bf16 v[40:43], a[40:43], a[0:3], v[40:43]
    ds_read_b128 a[72:75], v27 offset:18432
    v_mfma_f32_16x16x32_bf16 v[72:75], a[40:43], a[4:7], v[72:75]
    v_mfma_f32_16x16x32_bf16 v[44:47], a[44:47], a[0:3], v[44:47]
    ds_read_b128 a[76:79], v27 offset:19456
    v_mfma_f32_16x16x32_bf16 v[76:79], a[44:47], a[4:7], v[76:79]
    ds_read_b128 a[80:83], v27 offset:20480
    v_mfma_f32_16x16x32_bf16 v[48:51], a[48:51], a[0:3], v[48:51]
    ds_read_b128 a[84:87], v27 offset:21504
    v_mfma_f32_16x16x32_bf16 v[80:83], a[48:51], a[4:7], v[80:83]
    ds_read_b128 a[88:91], v27 offset:22528
    v_mfma_f32_16x16x32_bf16 v[52:55], a[52:55], a[0:3], v[52:55]
    ds_read_b128 a[92:95], v27 offset:23552
    v_mfma_f32_16x16x32_bf16 v[84:87], a[52:55], a[4:7], v[84:87]
    v_mfma_f32_16x16x32_bf16 v[56:59], a[56:59], a[0:3], v[56:59]
    s_or_b32 s85, s85, s87
    s_add_u32 s85, s85, s65
    s_andn2_b32 s85, s85, s87
    s_xor_b32 s62, s85, s79
    s_add_u32 s62, s82, s62
    s_addc_u32 s63, s83, 0
    v_mfma_f32_16x16x32_bf16 v[88:91], a[56:59], a[4:7], v[88:91]
    v_mfma_f32_16x16x32_bf16 v[60:63], a[60:63], a[0:3], v[60:63]
    v_mfma_f32_16x16x32_bf16 v[92:95], a[60:63], a[4:7], v[92:95]
    s_waitcnt vmcnt(4) lgkmcnt(0)
    s_barrier
    v_mfma_f32_16x16x32_bf16 v[32:35], a[64:67], a[16:19], v[32:35]
    s_add_u32 m0, s76, 0
    ds_read_b128 a[0:3], v6 offset:32768
    v_mfma_f32_16x16x32_bf16 v[64:67], a[64:67], a[20:23], v[64:67]
    global_load_lds_dwordx4 v28, s[60:61] sc1
    ds_read_b128 a[4:7], v6 offset:34816
    v_mfma_f32_16x16x32_bf16 v[36:39], a[68:71], a[16:19], v[36:39]
    s_add_u32 m0, s76, 1024
    ds_read_b128 a[32:35], v27 offset:32768
    v_mfma_f32_16x16x32_bf16 v[68:71], a[68:71], a[20:23], v[68:71]
    global_load_lds_dwordx4 v29, s[60:61] sc1
    ds_read_b128 a[36:39], v27 offset:33792
    v_mfma_f32_16x16x32_bf16 v[40:43], a[72:75], a[16:19], v[40:43]
    s_add_u32 m0, s67, 81920
    ds_read_b128 a[40:43], v27 offset:34816
    v_mfma_f32_16x16x32_bf16 v[72:75], a[72:75], a[20:23], v[72:75]
    global_load_lds_dwordx4 v4, s[62:63] sc1
    v_mfma_f32_16x16x32_bf16 v[44:47], a[76:79], a[16:19], v[44:47]
    s_add_u32 m0, s67, 82944
    ds_read_b128 a[44:47], v27 offset:35840
    v_mfma_f32_16x16x32_bf16 v[76:79], a[76:79], a[20:23], v[76:79]
    global_load_lds_dwordx4 v5, s[62:63] sc1
    ds_read_b128 a[48:51], v27 offset:36864
    v_mfma_f32_16x16x32_bf16 v[48:51], a[80:83], a[16:19], v[48:51]
    ds_read_b128 a[52:55], v27 offset:37888
    v_mfma_f32_16x16x32_bf16 v[80:83], a[80:83], a[20:23], v[80:83]
    ds_read_b128 a[56:59], v27 offset:38912
    v_mfma_f32_16x16x32_bf16 v[52:55], a[84:87], a[16:19], v[52:55]
    ds_read_b128 a[60:63], v27 offset:39936
    v_mfma_f32_16x16x32_bf16 v[84:87], a[84:87], a[20:23], v[84:87]
    v_mfma_f32_16x16x32_bf16 v[56:59], a[88:91], a[16:19], v[56:59]
    s_or_b32 s85, s85, s87
    s_add_u32 s85, s85, s65
    s_andn2_b32 s85, s85, s87
    s_xor_b32 s62, s85, s79
    s_add_u32 s62, s82, s62
    s_addc_u32 s63, s83, 0
    v_mfma_f32_16x16x32_bf16 v[88:91], a[88:91], a[20:23], v[88:91]
    v_mfma_f32_16x16x32_bf16 v[60:63], a[92:95], a[16:19], v[60:63]
    s_or_b32 s84, s84, s86
    s_add_u32 s84, s84, s64
    s_andn2_b32 s84, s84, s86
    s_xor_b32 s60, s84, s78
    s_add_u32 s60, s80, s60
    s_addc_u32 s61, s81, 0
    v_mfma_f32_16x16x32_bf16 v[92:95], a[92:95], a[20:23], v[92:95]
    s_waitcnt vmcnt(6) lgkmcnt(0)
    s_barrier
    v_mfma_f32_16x16x32_bf16 v[32:35], a[32:35], a[0:3], v[32:35]
    s_add_u32 m0, s67, 98304
    ds_read_b128 a[16:19], v7 offset:32768
    v_mfma_f32_16x16x32_bf16 v[64:67], a[32:35], a[4:7], v[64:67]
    global_load_lds_dwordx4 v4, s[62:63] sc1
    ds_read_b128 a[20:23], v7 offset:34816
    v_mfma_f32_16x16x32_bf16 v[36:39], a[36:39], a[0:3], v[36:39]
    s_add_u32 m0, s67, 99328
    ds_read_b128 a[64:67], v27 offset:49152
    v_mfma_f32_16x16x32_bf16 v[68:71], a[36:39], a[4:7], v[68:71]
    global_load_lds_dwordx4 v5, s[62:63] sc1
    ds_read_b128 a[68:71], v27 offset:50176
    v_mfma_f32_16x16x32_bf16 v[40:43], a[40:43], a[0:3], v[40:43]
    ds_read_b128 a[72:75], v27 offset:51200
    v_mfma_f32_16x16x32_bf16 v[72:75], a[40:43], a[4:7], v[72:75]
    v_mfma_f32_16x16x32_bf16 v[44:47], a[44:47], a[0:3], v[44:47]
    ds_read_b128 a[76:79], v27 offset:52224
    v_mfma_f32_16x16x32_bf16 v[76:79], a[44:47], a[4:7], v[76:79]
    ds_read_b128 a[80:83], v27 offset:53248
    v_mfma_f32_16x16x32_bf16 v[48:51], a[48:51], a[0:3], v[48:51]
    ds_read_b128 a[84:87], v27 offset:54272
    v_mfma_f32_16x16x32_bf16 v[80:83], a[48:51], a[4:7], v[80:83]
    ds_read_b128 a[88:91], v27 offset:55296
    v_mfma_f32_16x16x32_bf16 v[52:55], a[52:55], a[0:3], v[52:55]
    ds_read_b128 a[92:95], v27 offset:56320
    v_mfma_f32_16x16x32_bf16 v[84:87], a[52:55], a[4:7], v[84:87]
    v_mfma_f32_16x16x32_bf16 v[56:59], a[56:59], a[0:3], v[56:59]
    s_or_b32 s85, s85, s87
    s_add_u32 s85, s85, s65
    s_andn2_b32 s85, s85, s87
    s_xor_b32 s62, s85, s79
    s_add_u32 s62, s82, s62
    s_addc_u32 s63, s83, 0
    v_mfma_f32_16x16x32_bf16 v[88:91], a[56:59], a[4:7], v[88:91]
    v_mfma_f32_16x16x32_bf16 v[60:63], a[60:63], a[0:3], v[60:63]
    v_mfma_f32_16x16x32_bf16 v[92:95], a[60:63], a[4:7], v[92:95]
    s_waitcnt vmcnt(4) lgkmcnt(0)
    s_barrier
    v_mfma_f32_16x16x32_bf16 v[32:35], a[64:67], a[16:19], v[32:35]
    s_add_u32 m0, s76, 32768
    ds_read_b128 a[0:3], v6 offset:0
    v_mfma_f32_16x16x32_bf16 v[64:67], a[64:67], a[20:23], v[64:67]
    global_load_lds_dwordx4 v28, s[60:61] sc1
    ds_read_b128 a[4:7], v6 offset:2048
    v_mfma_f32_16x16x32_bf16 v[36:39], a[68:71], a[16:19], v[36:39]
    s_add_u32 m0, s76, 33792
    ds_read_b128 a[32:35], v27 offset:0
    v_mfma_f32_16x16x32_bf16 v[68:71], a[68:71], a[20:23], v[68:71]
    global_load_lds_dwordx4 v29, s[60:61] sc1
    ds_read_b128 a[36:39], v27 offset:1024
    v_mfma_f32_16x16x32_bf16 v[40:43], a[72:75], a[16:19], v[40:43]
    s_add_u32 m0, s67, 114688
    ds_read_b128 a[40:43], v27 offset:2048
    v_mfma_f32_16x16x32_bf16 v[72:75], a[72:75], a[20:23], v[72:75]
    global_load_lds_dwordx4 v4, s[62:63] sc1
    v_mfma_f32_16x16x32_bf16 v[44:47], a[76:79], a[16:19], v[44:47]
    s_add_u32 m0, s67, 115712
    ds_read_b128 a[44:47], v27 offset:3072
    v_mfma_f32_16x16x32_bf16 v[76:79], a[76:79], a[20:23], v[76:79]
    global_load_lds_dwordx4 v5, s[62:63] sc1
    ds_read_b128 a[48:51], v27 offset:4096
    v_mfma_f32_16x16x32_bf16 v[48:51], a[80:83], a[16:19], v[48:51]
    ds_read_b128 a[52:55], v27 offset:5120
    v_mfma_f32_16x16x32_bf16 v[80:83], a[80:83], a[20:23], v[80:83]
    ds_read_b128 a[56:59], v27 offset:6144
    v_mfma_f32_16x16x32_bf16 v[52:55], a[84:87], a[16:19], v[52:55]
    ds_read_b128 a[60:63], v27 offset:7168
    v_mfma_f32_16x16x32_bf16 v[84:87], a[84:87], a[20:23], v[84:87]
    v_mfma_f32_16x16x32_bf16 v[56:59], a[88:91], a[16:19], v[56:59]
    s_or_b32 s85, s85, s87
    s_add_u32 s85, s85, s65
    s_andn2_b32 s85, s85, s87
    s_xor_b32 s62, s85, s79
    s_add_u32 s62, s82, s62
    s_addc_u32 s63, s83, 0
    v_mfma_f32_16x16x32_bf16 v[88:91], a[88:91], a[20:23], v[88:91]
    v_mfma_f32_16x16x32_bf16 v[60:63], a[92:95], a[16:19], v[60:63]
    s_or_b32 s84, s84, s86
    s_add_u32 s84, s84, s64
    s_andn2_b32 s84, s84, s86
    s_xor_b32 s60, s84, s78
    s_add_u32 s60, s80, s60
    s_addc_u32 s61, s81, 0
    v_mfma_f32_16x16x32_bf16 v[92:95], a[92:95], a[20:23], v[92:95]
    s_sub_u32 s66, s66, 1
    s_cmp_lg_u32 s66, 0
    s_cbranch_scc1 core_F2_loop
    s_waitcnt vmcnt(6) lgkmcnt(0)
    s_barrier
    v_mfma_f32_16x16x32_bf16 v[32:35], a[32:35], a[0:3], v[32:35]
    ds_read_b128 a[16:19], v7 offset:0
    v_mfma_f32_16x16x32_bf16 v[64:67], a[32:35], a[4:7], v[64:67]
    ds_read_b128 a[20:23], v7 offset:2048
    v_mfma_f32_16x16x32_bf16 v[36:39], a[36:39], a[0:3], v[36:39]
    ds_read_b128 a[64:67], v27 offset:16384
    v_mfma_f32_16x16x32_bf16 v[68:71], a[36:39], a[4:7], v[68:71]
    ds_read_b128 a[68:71], v27 offset:17408
    v_mfma_f32_16x16x32_bf16 v[40:43], a[40:43], a[0:3], v[40:43]
    ds_read_b128 a[72:75], v27 offset:18432
    v_mfma_f32_16x16x32_bf16 v[72:75], a[40:43], a[4:7], v[72:75]
    v_mfma_f32_16x16x32_bf16 v[44:47], a[44:47], a[0:3], v[44:47]
    ds_read_b128 a[76:79], v27 offset:19456
    v_mfma_f32_16x16x32_bf16 v[76:79], a[44:47], a[4:7], v[76:79]
    ds_read_b128 a[80:83], v27 offset:20480
    v_mfma_f32_16x16x32_bf16 v[48:51], a[48:51], a[0:3], v[48:51]
    ds_read_b128 a[84:87], v27 offset:21504
    v_mfma_f32_16x16x32_bf16 v[80:83], a[48:51], a[4:7], v[80:83]
    ds_read_b128 a[88:91], v27 offset:22528
    v_mfma_f32_16x16x32_bf16 v[52:55], a[52:55], a[0:3], v[52:55]
    ds_read_b128 a[92:95], v27 offset:23552
    v_mfma_f32_16x16x32_bf16 v[84:87], a[52:55], a[4:7], v[84:87]
    v_mfma_f32_16x16x32_bf16 v[56:59], a[56:59], a[0:3], v[56:59]
    v_mfma_f32_16x16x32_bf16 v[88:91], a[56:59], a[4:7], v[88:91]
    v_mfma_f32_16x16x32_bf16 v[60:63], a[60:63], a[0:3], v[60:63]
    v_mfma_f32_16x16x32_bf16 v[92:95], a[60:63], a[4:7], v[92:95]
    s_waitcnt vmcnt(2) lgkmcnt(0)
    s_barrier
    v_mfma_f32_16x16x32_bf16 v[32:35], a[64:67], a[16:19], v[32:35]
    ds_read_b128 a[0:3], v6 offset:32768
    v_mfma_f32_16x16x32_bf16 v[64:67], a[64:67], a[20:23], v[64:67]
    ds_read_b128 a[4:7], v6 offset:34816
    v_mfma_f32_16x16x32_bf16 v[36:39], a[68:71], a[16:19], v[36:39]
    ds_read_b128 a[32:35], v27 offset:32768
    v_mfma_f32_16x16x32_bf16 v[68:71], a[68:71], a[20:23], v[68:71]
    ds_read_b128 a[36:39], v27 offset:33792
    v_mfma_f32_16x16x32_bf16 v[40:43], a[72:75], a[16:19], v[40:43]
    ds_read_b128 a[40:43], v27 offset:34816
    v_mfma_f32_16x16x32_bf16 v[72:75], a[72:75], a[20:23], v[72:75]
    v_mfma_f32_16x16x32_bf16 v[44:47], a[76:79], a[16:19], v[44:47]
    ds_read_b128 a[44:47], v27 offset:35840
    v_mfma_f32_16x16x32_bf16 v[76:79], a[76:79], a[20:23], v[76:79]
    ds_read_b128 a[48:51], v27 offset:36864
    v_mfma_f32_16x16x32_bf16 v[48:51], a[80:83], a[16:19], v[48:51]
    ds_read_b128 a[52:55], v27 offset:37888
    v_mfma_f32_16x16x32_bf16 v[80:83], a[80:83], a[20:23], v[80:83]
    ds_read_b128 a[56:59], v27 offset:38912
    v_mfma_f32_16x16x32_bf16 v[52:55], a[84:87], a[16:19], v[52:55]
    ds_read_b128 a[60:63], v27 offset:39936
    v_mfma_f32_16x16x32_bf16 v[84:87], a[84:87], a[20:23], v[84:87]
    v_mfma_f32_16x16x32_bf16 v[56:59], a[88:91], a[16:19], v[56:59]
    v_mfma_f32_16x16x32_bf16 v[88:91], a[88:91], a[20:23], v[88:91]
    v_mfma_f32_16x16x32_bf16 v[60:63], a[92:95], a[16:19], v[60:63]
    v_mfma_f32_16x16x32_bf16 v[92:95], a[92:95], a[20:23], v[92:95]
    s_waitcnt vmcnt(0) lgkmcnt(0)
    s_barrier
    v_mfma_f32_16x16x32_bf16 v[32:35], a[32:35], a[0:3], v[32:35]
    ds_read_b128 a[16:19], v7 offset:32768
    v_mfma_f32_16x16x32_bf16 v[64:67], a[32:35], a[4:7], v[64:67]
    ds_read_b128 a[20:23], v7 offset:34816
    v_mfma_f32_16x16x32_bf16 v[36:39], a[36:39], a[0:3], v[36:39]
    ds_read_b128 a[64:67], v27 offset:49152
    v_mfma_f32_16x16x32_bf16 v[68:71], a[36:39], a[4:7], v[68:71]
    ds_read_b128 a[68:71], v27 offset:50176
    v_mfma_f32_16x16x32_bf16 v[40:43], a[40:43], a[0:3], v[40:43]
    ds_read_b128 a[72:75], v27 offset:51200
    v_mfma_f32_16x16x32_bf16 v[72:75], a[40:43], a[4:7], v[72:75]
    v_mfma_f32_16x16x32_bf16 v[44:47], a[44:47], a[0:3], v[44:47]
    ds_read_b128 a[76:79], v27 offset:52224
    v_mfma_f32_16x16x32_bf16 v[76:79], a[44:47], a[4:7], v[76:79]
    ds_read_b128 a[80:83], v27 offset:53248
    v_mfma_f32_16x16x32_bf16 v[48:51], a[48:51], a[0:3], v[48:51]
    ds_read_b128 a[84:87], v27 offset:54272
    v_mfma_f32_16x16x32_bf16 v[80:83], a[48:51], a[4:7], v[80:83]
    ds_read_b128 a[88:91], v27 offset:55296
    v_mfma_f32_16x16x32_bf16 v[52:55], a[52:55], a[0:3], v[52:55]
    ds_read_b128 a[92:95], v27 offset:56320
    v_mfma_f32_16x16x32_bf16 v[84:87], a[52:55], a[4:7], v[84:87]
    v_mfma_f32_16x16x32_bf16 v[56:59], a[56:59], a[0:3], v[56:59]
    v_mfma_f32_16x16x32_bf16 v[88:91], a[56:59], a[4:7], v[88:91]
    v_mfma_f32_16x16x32_bf16 v[60:63], a[60:63], a[0:3], v[60:63]
    v_mfma_f32_16x16x32_bf16 v[92:95], a[60:63], a[4:7], v[92:95]
    s_waitcnt lgkmcnt(0)
    v_mfma_f32_16x16x32_bf16 v[32:35], a[64:67], a[16:19], v[32:35]
    v_mfma_f32_16x16x32_bf16 v[64:67], a[64:67], a[20:23], v[64:67]
    v_mfma_f32_16x16x32_bf16 v[36:39], a[68:71], a[16:19], v[36:39]
    v_mfma_f32_16x16x32_bf16 v[68:71], a[68:71], a[20:23], v[68:71]
    v_mfma_f32_16x16x32_bf16 v[40:43], a[72:75], a[16:19], v[40:43]
    v_mfma_f32_16x16x32_bf16 v[72:75], a[72:75], a[20:23], v[72:75]
    v_mfma_f32_16x16x32_bf16 v[44:47], a[76:79], a[16:19], v[44:47]
    v_mfma_f32_16x16x32_bf16 v[76:79], a[76:79], a[20:23], v[76:79]
    v_mfma_f32_16x16x32_bf16 v[48:51], a[80:83], a[16:19], v[48:51]
    v_mfma_f32_16x16x32_bf16 v[80:83], a[80:83], a[20:23], v[80:83]
    v_mfma_f32_16x16x32_bf16 v[52:55], a[84:87], a[16:19], v[52:55]
    v_mfma_f32_16x16x32_bf16 v[84:87], a[84:87], a[20:23], v[84:87]
    v_mfma_f32_16x16x32_bf16 v[56:59], a[88:91], a[16:19], v[56:59]
    v_mfma_f32_16x16x32_bf16 v[88:91], a[88:91], a[20:23], v[88:91]
    v_mfma_f32_16x16x32_bf16 v[60:63], a[92:95], a[16:19], v[60:63]
    v_mfma_f32_16x16x32_bf16 v[92:95], a[92:95], a[20:23], v[92:95]
    s_nop 7
    s_setpc_b64 s[68:69]
code_end:
.section .rodata,"a"
.p2align 6
.amdhsa_kernel concat_heads__linear_attn_block__memory_aug_recurrent_mem_tr__prompt_kernel
  .amdhsa_next_free_vgpr 256
  .amdhsa_next_free_sgpr 102
  .amdhsa_accum_offset 160
  .amdhsa_group_segment_fixed_size 0
  .amdhsa_kernarg_size 104
  .amdhsa_user_sgpr_count 2
  .amdhsa_user_sgpr_kernarg_segment_ptr 1
  .amdhsa_system_sgpr_workgroup_id_x 1
.end_amdhsa_kernel
```
